```python
import torch

def _softmax(x, axis=-1):
    return torch.softmax(x, dim=axis)

def _gelu(x):
    return torch.nn.functional.gelu(x, approximate='tanh')

def _silu(x):
    return torch.nn.functional.silu(x)

def _sigmoid(x):
    return torch.sigmoid(x)

def _layernorm(x, axis=-1, eps=1e-05):
    m = x.mean(dim=axis, keepdim=True)
    v = x.var(dim=axis, keepdim=True, unbiased=False)
    return (x - m) / torch.sqrt(v + eps)

def _scatter_add(tgt, idx, src, axis=0):
    return tgt.clone().index_add_(axis, idx, src)

def _segment_sum(src, seg, n):
    out = torch.zeros((n,) + src.shape[1:], dtype=src.dtype)
    return out.index_add_(0, seg, src)

def _pad(x, pw):
    flat = tuple((v for pair in reversed(pw) for v in pair))
    return torch.nn.functional.pad(x, flat)
kernel_name = 'gated_mix__memory_aug_recurrent_mem_tr__mixer_channel_mlp__prompt'

def setup_inputs():

    _w = lambda a: (lambda t: t.to(torch.bfloat16) if t.is_floating_point() else t)(torch.as_tensor(a))

    def _A_setup():
        B, S, Dm = (1, 2048, 448)
        H, Dh = (16, 256)
        M, seg = (8, 32)
        seg = min(seg, S)
        S = S // seg * seg
        return {'x': _w((lambda *s: torch.randn(*s, dtype=torch.bfloat16) * 0.05)(B, S, Dm)), 'mem0': _w((lambda *s: torch.randn(*s, dtype=torch.bfloat16) * 0.8)(B, M, Dm)), 'Wq': _w((lambda *s: torch.randn(*s, dtype=torch.bfloat16) * 1.6)(Dm, H, Dh) * Dm ** (-0.5)), 'Wk': _w((lambda *s: torch.randn(*s, dtype=torch.bfloat16) * 1.6)(Dm, H, Dh) * Dm ** (-0.5)), 'Wv': _w((lambda *s: torch.randn(*s, dtype=torch.bfloat16) * 0.8)(Dm, H, Dh) * Dm ** (-0.5)), 'Wo': _w((lambda *s: torch.randn(*s, dtype=torch.bfloat16) * 0.8)(H, Dh, Dm) * (H * Dh) ** (-0.5)), 'seg_len': seg}
    _A_in = _A_setup()

    def _B_setup():
        B, S, D, F = (1, 2048, 448, 1792)
        return {'x': _w((lambda *s: torch.randn(*s, dtype=torch.bfloat16) * 0.05)(B, S, D)), 'w1': _w((lambda *s: torch.randn(*s, dtype=torch.bfloat16) * 1.6)(D, F) * D ** (-0.5)), 'b1': _w((lambda *s: torch.randn(*s, dtype=torch.bfloat16) * 0.4)(F)), 'w2': _w((lambda *s: torch.randn(*s, dtype=torch.bfloat16) * 0.05)(F, D) * F ** (-0.5)), 'b2': _w((lambda *s: torch.randn(*s, dtype=torch.bfloat16) * 0.05)(D))}
    _B_in = _B_setup()
    return {'A_x': _A_in['x'], 'A_mem0': _A_in['mem0'], 'A_Wq': _A_in['Wq'], 'A_Wk': _A_in['Wk'], 'A_Wv': _A_in['Wv'], 'A_Wo': _A_in['Wo'], 'A_seg_len': _A_in['seg_len'], 'B_x': _B_in['x'], 'B_w1': _B_in['w1'], 'B_b1': _B_in['b1'], 'B_w2': _B_in['w2'], 'B_b2': _B_in['b2'], 'gate_w': _w((lambda *s: torch.randn(*s, dtype=torch.bfloat16) * 0.05)(448) * 16.0)}

def reference(A_x, A_mem0, A_Wq, A_Wk, A_Wv, A_Wo, A_seg_len, B_x, B_w1, B_b1, B_w2, B_b2, gate_w):

    def _A_ref(x, mem0, Wq, Wk, Wv, Wo, seg_len):
        B, S, Dm = x.shape
        H, Dh = (Wq.shape[1], Wq.shape[2])
        M = mem0.shape[1]
        scale = Dh ** (-0.5)
        n_seg = S // seg_len
        L = M + seg_len
        idx = torch.arange(L)
        mask = (idx[:, None] < M) | (idx[:, None] >= idx[None, :])
        mem = mem0
        outs = []
        for s in range(n_seg):
            xs = x[:, s * seg_len:(s + 1) * seg_len, :].clone()
            h = torch.concatenate([mem, xs], axis=1)
            q = torch.einsum('btd,dhe->bhte', h, Wq)
            k = torch.einsum('btd,dhe->bhte', h, Wk)
            v = torch.einsum('btd,dhe->bhte', h, Wv)
            scores = torch.einsum('bhqe,bhke->bhqk', q, k) * scale
            scores = torch.where(mask[None, None], scores, -1000000000.0)
            p = _softmax(scores, axis=-1)
            o = torch.einsum('bhqk,bhke->bhqe', p, v)
            o = torch.einsum('bhte,hed->btd', o, Wo)
            mem = o[:, :M, :].clone()
            outs.append(o[:, M:, :])
        return torch.concatenate(outs, axis=1)

    def _B_ref(x, w1, b1, w2, b2):
        y = _layernorm(x, axis=-1)
        h = _gelu(torch.einsum('bsd,df->bsf', y, w1) + b1)
        return torch.einsum('bsf,fd->bsd', h, w2) + b2
    x = A_x
    g = _sigmoid((x * gate_w).sum(-1, keepdims=True))
    a = _A_ref(x, A_mem0, A_Wq, A_Wk, A_Wv, A_Wo, A_seg_len)
    b = _B_ref(x, B_w1, B_b1, B_w2, B_b2)
    return g * a + (1 - g) * b
```

```asm
; @launch grid=(256,1,1) block=(256,1,1) lds=151552
.amdgcn_target "amdgcn-amd-amdhsa--gfx950"
.text
.globl gated_mix__memory_aug_recurrent_mem_tr__mixer_channel_mlp__prompt_kernel
.p2align 8
.type gated_mix__memory_aug_recurrent_mem_tr__mixer_channel_mlp__prompt_kernel,@function
gated_mix__memory_aug_recurrent_mem_tr__mixer_channel_mlp__prompt_kernel:
	s_cmp_ge_u32 s2, 256
	s_cbranch_scc1 Lexit
	s_getpc_b64 s[92:93]
Lpc0:
	s_lshr_b32 s94, s2, 3
	s_mul_i32 s94, s94, 2560
	v_min_u32 v226, 19, v0
	v_lshl_add_u32 v226, v226, 7, s94
	v_min_u32 v226, Lcode_end-Lpc0-4, v226
	global_load_dword v227, v226, s[92:93]
	s_load_dwordx8 s[60:67], s[0:1], 16
	s_load_dwordx2 s[72:73], s[0:1], 120
	s_load_dwordx2 s[74:75], s[0:1], 112
	v_mov_b32 v222, v0
	v_lshrrev_b32 v1, 6, v0
	v_and_b32 v0, 63, v0
	v_readfirstlane_b32 s33, v1
	s_add_u32 s34, s2, 0
	s_and_b32 s34, s34, 7
	s_lshr_b32 s35, s2, 3
	s_waitcnt lgkmcnt(0)
	s_mov_b32 s4, s72
	s_and_b32 s5, s73, 0xffff
	s_mov_b32 s6, 62431232
	s_mov_b32 s7, 0x00020000
	s_mov_b32 s80, s74
	s_and_b32 s81, s75, 0xffff
	s_mov_b32 s82, 256
	s_mov_b32 s83, 0x00020000
	s_getreg_b32 s84, hwreg(HW_REG_XCC_ID)
	s_and_b32 s84, s84, 7
	s_lshr_b32 s85, s84, 2
	s_mul_i32 s85, s85, 32
	s_add_u32 s85, s85, s84
	s_lshl_b32 s85, s85, 2
	s_add_u32 s84, s84, 1
	v_mov_b32 v221, 0x80000000
	v_cmp_eq_u32 vcc, 0, v222
	s_nop 1
	v_cndmask_b32 v221, v221, v222, vcc
	v_mov_b32 v220, 1
	buffer_atomic_add v220, v221, s[80:83], s85 offen sc0
	s_mov_b32 s88, 1
	s_cmp_eq_u32 s34, 7
	s_cbranch_scc1 Lprep_arm
	s_lshl_b32 s34, s34, 5
	s_add_u32 s35, s35, s34
	s_mul_i32 s36, s35, 293
	s_lshr_b32 s36, s36, 11
	s_mul_i32 s37, s36, 7
	s_sub_u32 s37, s35, s37
	s_lshr_b32 s39, s36, 4
	s_xor_b32 s39, s39, 1
	s_and_b32 s38, s36, 15
	s_lshl_b32 s36, s39, 4
	s_add_u32 s36, s36, s38
	s_cmp_eq_u32 s39, 0
	s_cselect_b32 s8, s60, s64
	s_cselect_b32 s9, s61, s65
	s_cselect_b32 s12, s62, s66
	s_cselect_b32 s13, s63, s67
	s_and_b32 s9, s9, 0xffff
	s_mov_b32 s10, 3670016
	s_mov_b32 s11, 0x00020000
	s_and_b32 s13, s13, 0xffff
	s_mov_b32 s14, 3670016
	s_mov_b32 s15, 0x00020000
	s_lshl_b32 s41, s38, 9
	v_lshrrev_b32 v7, 2, v0
	v_lshlrev_b32 v7, 13, v7
	v_and_b32 v8, 3, v0
	v_lshl_add_u32 v7, v8, 7, v7
	s_lshl_b32 s43, s37, 2
	s_add_u32 s43, s43, s33
	s_lshl_b32 s43, s43, 17
	s_add_u32 s43, s43, s41
	buffer_load_dword v223, v7, s[8:11], s43 offen
	v_and_b32 v1, 15, v0
	v_lshrrev_b32 v2, 4, v0
	v_lshlrev_b32 v6, 4, v0
	v_lshrrev_b32 v7, 3, v0
	s_lshl_b32 s40, s33, 3
	v_add_u32 v7, s40, v7
	v_bfe_u32 v8, v7, 2, 2
	v_lshlrev_b32 v8, 3, v8
	v_lshrrev_b32 v9, 4, v7
	v_lshl_add_u32 v8, v9, 2, v8
	v_and_b32 v9, 3, v7
	v_add_u32 v8, v8, v9
	s_mov_b32 s40, 8192
	v_mul_lo_u32 v8, v8, s40
	v_bfe_u32 v9, v7, 1, 3
	v_and_b32 v10, 7, v0
	v_xor_b32 v9, v9, v10
	v_lshl_add_u32 v3, v9, 4, v8
	v_lshrrev_b32 v9, 1, v1
	v_xor_b32 v9, v9, v2
	v_lshlrev_b32 v9, 4, v9
	v_lshl_add_u32 v4, v1, 7, v9
	v_xor_b32 v5, 64, v4
	s_lshl_b32 s42, s33, 10
	s_cmp_eq_u32 s39, 0
	s_cbranch_scc0 Lprep_rb
	s_mul_i32 s44, s37, 524288
	s_add_u32 s44, s44, s41
	v_bfe_u32 v8, v7, 2, 2
	v_lshlrev_b32 v8, 4, v8
	v_lshrrev_b32 v9, 4, v7
	v_lshl_add_u32 v8, v9, 1, v8
	v_and_b32 v9, 1, v7
	v_add_u32 v8, v8, v9
	v_bfe_u32 v9, v7, 1, 1
	v_lshl_add_u32 v8, v9, 2, v8
	v_lshlrev_b32 v8, 13, v8
	v_and_b32 v9, 0x70, v3
	v_add_u32 v8, v8, v9
	s_add_u32 m0, s42, 114688
	s_add_u32 s43, s44, 0
	buffer_load_dwordx4 v8, s[12:15], s43 offen nt lds
	s_add_u32 m0, s42, 118784
	s_add_u32 s43, s44, 65536
	buffer_load_dwordx4 v8, s[12:15], s43 offen nt lds
	s_add_u32 m0, s42, 122880
	s_add_u32 s43, s44, 128
	buffer_load_dwordx4 v8, s[12:15], s43 offen nt lds
	s_add_u32 m0, s42, 126976
	s_add_u32 s43, s44, 65664
	buffer_load_dwordx4 v8, s[12:15], s43 offen nt lds
	s_add_u32 m0, s42, 131072
	s_add_u32 s43, s44, 256
	buffer_load_dwordx4 v8, s[12:15], s43 offen nt lds
	s_add_u32 m0, s42, 135168
	s_add_u32 s43, s44, 65792
	buffer_load_dwordx4 v8, s[12:15], s43 offen nt lds
	s_add_u32 m0, s42, 139264
	s_add_u32 s43, s44, 384
	buffer_load_dwordx4 v8, s[12:15], s43 offen nt lds
	s_add_u32 m0, s42, 143360
	s_add_u32 s43, s44, 65920
	buffer_load_dwordx4 v8, s[12:15], s43 offen nt lds
	s_branch Lprep_rdone
Lprep_rb:
	v_lshrrev_b32 v7, 3, v0
	v_mul_u32_u24 v7, 896, v7
	v_and_b32 v8, 7, v0
	v_lshl_add_u32 v7, v8, 4, v7
	s_mul_i32 s44, s38, 229376
	s_lshl_b32 s45, s37, 7
	s_add_u32 s44, s44, s45
	s_mul_i32 s45, s33, 7168
	s_add_u32 s44, s44, s45
	s_add_u32 m0, s42, 114688
	s_add_u32 s43, s44, 0
	buffer_load_dwordx4 v7, s[12:15], s43 offen nt lds
	s_add_u32 m0, s42, 118784
	s_add_u32 s43, s44, 28672
	buffer_load_dwordx4 v7, s[12:15], s43 offen nt lds
	s_add_u32 m0, s42, 122880
	s_add_u32 s43, s44, 57344
	buffer_load_dwordx4 v7, s[12:15], s43 offen nt lds
	s_add_u32 m0, s42, 126976
	s_add_u32 s43, s44, 86016
	buffer_load_dwordx4 v7, s[12:15], s43 offen nt lds
	s_add_u32 m0, s42, 131072
	s_add_u32 s43, s44, 114688
	buffer_load_dwordx4 v7, s[12:15], s43 offen nt lds
	s_add_u32 m0, s42, 135168
	s_add_u32 s43, s44, 143360
	buffer_load_dwordx4 v7, s[12:15], s43 offen nt lds
	s_add_u32 m0, s42, 139264
	s_add_u32 s43, s44, 172032
	buffer_load_dwordx4 v7, s[12:15], s43 offen nt lds
	s_add_u32 m0, s42, 143360
	s_add_u32 s43, s44, 200704
	buffer_load_dwordx4 v7, s[12:15], s43 offen nt lds
Lprep_rdone:
	s_add_u32 m0, s42, 0
	s_add_u32 s43, s41, 0
	buffer_load_dwordx4 v3, s[8:11], s43 offen offset:0 lds
	s_add_u32 m0, s42, 3968
	s_nop 0
	buffer_load_dwordx4 v3, s[8:11], s43 offen offset:128 lds
	s_add_u32 m0, s42, 7936
	s_nop 0
	buffer_load_dwordx4 v3, s[8:11], s43 offen offset:256 lds
	s_add_u32 m0, s42, 11904
	s_nop 0
	buffer_load_dwordx4 v3, s[8:11], s43 offen offset:384 lds
	s_add_u32 m0, s42, 16384
	s_add_u32 s43, s41, 1835008
	buffer_load_dwordx4 v3, s[8:11], s43 offen offset:0 lds
	s_add_u32 m0, s42, 20352
	s_nop 0
	buffer_load_dwordx4 v3, s[8:11], s43 offen offset:128 lds
	s_add_u32 m0, s42, 24320
	s_nop 0
	buffer_load_dwordx4 v3, s[8:11], s43 offen offset:256 lds
	s_add_u32 m0, s42, 28288
	s_nop 0
	buffer_load_dwordx4 v3, s[8:11], s43 offen offset:384 lds
	s_add_u32 m0, s42, 32768
	s_add_u32 s43, s41, 262144
	buffer_load_dwordx4 v3, s[8:11], s43 offen offset:0 lds
	s_add_u32 m0, s42, 36736
	s_nop 0
	buffer_load_dwordx4 v3, s[8:11], s43 offen offset:128 lds
	s_add_u32 m0, s42, 40704
	s_nop 0
	buffer_load_dwordx4 v3, s[8:11], s43 offen offset:256 lds
	s_add_u32 m0, s42, 44672
	s_nop 0
	buffer_load_dwordx4 v3, s[8:11], s43 offen offset:384 lds
	s_add_u32 m0, s42, 49152
	s_add_u32 s43, s41, 2097152
	buffer_load_dwordx4 v3, s[8:11], s43 offen offset:0 lds
	s_add_u32 m0, s42, 53120
	s_nop 0
	buffer_load_dwordx4 v3, s[8:11], s43 offen offset:128 lds
	s_add_u32 m0, s42, 57088
	s_nop 0
	buffer_load_dwordx4 v3, s[8:11], s43 offen offset:256 lds
	s_add_u32 m0, s42, 61056
	s_nop 0
	buffer_load_dwordx4 v3, s[8:11], s43 offen offset:384 lds
	s_lshr_b32 s46, s33, 1
	s_and_b32 s47, s33, 1
	s_lshl_b32 s40, s46, 14
	v_add_u32 v10, s40, v4
	v_add_u32 v11, s40, v5
	v_add_u32 v12, 65536, v10
	v_add_u32 v13, 65536, v11
	s_waitcnt vmcnt(16)
	s_barrier
	s_cmp_eq_u32 s39, 0
	s_cbranch_scc0 Lprep_rrb
	s_lshl_b32 s40, s47, 12
	s_add_u32 s40, s40, 114688
	v_add_u32 v14, s40, v4
	v_add_u32 v15, s40, v5
	ds_read_b128 v[16:19], v14 offset:0
	ds_read_b128 v[20:23], v15 offset:0
	ds_read_b128 v[24:27], v14 offset:8192
	ds_read_b128 v[28:31], v15 offset:8192
	ds_read_b128 v[32:35], v14 offset:16384
	ds_read_b128 v[36:39], v15 offset:16384
	ds_read_b128 v[40:43], v14 offset:24576
	ds_read_b128 v[44:47], v15 offset:24576
	ds_read_b128 v[48:51], v14 offset:2048
	ds_read_b128 v[52:55], v15 offset:2048
	ds_read_b128 v[56:59], v14 offset:10240
	ds_read_b128 v[60:63], v15 offset:10240
	ds_read_b128 v[64:67], v14 offset:18432
	ds_read_b128 v[68:71], v15 offset:18432
	ds_read_b128 v[72:75], v14 offset:26624
	ds_read_b128 v[76:79], v15 offset:26624
	s_branch Lprep_rrd
Lprep_rrb:
	v_bfe_u32 v14, v0, 2, 2
	v_lshl_add_u32 v14, v2, 3, v14
	v_lshlrev_b32 v14, 7, v14
	v_and_b32 v15, 3, v0
	v_lshl_add_u32 v14, v15, 3, v14
	s_lshl_b32 s40, s47, 6
	s_add_u32 s40, s40, 114688
	v_add_u32 v14, s40, v14
	ds_read_b64_tr_b16 v[16:17], v14 offset:0
	ds_read_b64_tr_b16 v[18:19], v14 offset:512
	ds_read_b64_tr_b16 v[20:21], v14 offset:4096
	ds_read_b64_tr_b16 v[22:23], v14 offset:4608
	ds_read_b64_tr_b16 v[24:25], v14 offset:8192
	ds_read_b64_tr_b16 v[26:27], v14 offset:8704
	ds_read_b64_tr_b16 v[28:29], v14 offset:12288
	ds_read_b64_tr_b16 v[30:31], v14 offset:12800
	ds_read_b64_tr_b16 v[32:33], v14 offset:16384
	ds_read_b64_tr_b16 v[34:35], v14 offset:16896
	ds_read_b64_tr_b16 v[36:37], v14 offset:20480
	ds_read_b64_tr_b16 v[38:39], v14 offset:20992
	ds_read_b64_tr_b16 v[40:41], v14 offset:24576
	ds_read_b64_tr_b16 v[42:43], v14 offset:25088
	ds_read_b64_tr_b16 v[44:45], v14 offset:28672
	ds_read_b64_tr_b16 v[46:47], v14 offset:29184
	ds_read_b64_tr_b16 v[48:49], v14 offset:32
	ds_read_b64_tr_b16 v[50:51], v14 offset:544
	ds_read_b64_tr_b16 v[52:53], v14 offset:4128
	ds_read_b64_tr_b16 v[54:55], v14 offset:4640
	ds_read_b64_tr_b16 v[56:57], v14 offset:8224
	ds_read_b64_tr_b16 v[58:59], v14 offset:8736
	ds_read_b64_tr_b16 v[60:61], v14 offset:12320
	ds_read_b64_tr_b16 v[62:63], v14 offset:12832
	ds_read_b64_tr_b16 v[64:65], v14 offset:16416
	ds_read_b64_tr_b16 v[66:67], v14 offset:16928
	ds_read_b64_tr_b16 v[68:69], v14 offset:20512
	ds_read_b64_tr_b16 v[70:71], v14 offset:21024
	ds_read_b64_tr_b16 v[72:73], v14 offset:24608
	ds_read_b64_tr_b16 v[74:75], v14 offset:25120
	ds_read_b64_tr_b16 v[76:77], v14 offset:28704
	ds_read_b64_tr_b16 v[78:79], v14 offset:29216
Lprep_rrd:
	s_mov_b32 s48, 1.0
	s_cmp_eq_u32 s39, 0
	s_cselect_b32 s48, 0x3db8aa3b, s48
	s_mul_i32 s40, s38, 7
	s_add_u32 s40, s40, s37
	s_lshl_b32 s40, s40, 2
	s_lshl_b32 s43, s47, 1
	s_add_u32 s40, s40, s43
	s_lshl_b32 s44, s37, 2
	s_add_u32 s44, s44, s43
	s_lshl_b32 s44, s44, 4
	s_add_u32 s44, s44, s38
	s_add_u32 s44, s44, 448
	s_cmp_eq_u32 s39, 0
	s_cselect_b32 s40, s40, s44
	s_cselect_b32 s45, 1, 16
	s_mul_i32 s40, s40, 14336
	s_mul_i32 s45, s45, 14336
	s_mul_i32 s43, s46, 7168
	s_add_u32 s76, s40, s43
	s_add_u32 s78, s76, s45
	s_add_u32 s77, s76, 4096
	s_add_u32 s79, s78, 4096
	v_mov_b32 v8, s48
	s_lshl_b32 s87, s36, 7
	s_add_u32 s87, s87, 60295168
	s_waitcnt vmcnt(8) lgkmcnt(0)
	s_barrier
	ds_read_b128 v[80:83], v10 offset:0
	ds_read_b128 v[84:87], v10 offset:2048
	ds_read_b128 v[88:91], v11 offset:0
	ds_read_b128 v[92:95], v11 offset:2048
	s_waitcnt lgkmcnt(3)
	v_mfma_f32_16x16x32_bf16 v[96:99], v[80:83], v[16:19], 0
	v_mfma_f32_16x16x32_bf16 v[100:103], v[80:83], v[48:51], 0
	s_add_u32 m0, s42, 65536
	s_add_u32 s43, s41, 524288
	buffer_load_dwordx4 v3, s[8:11], s43 offen offset:0 lds
	ds_read_b128 v[80:83], v10 offset:4096
	s_waitcnt lgkmcnt(3)
	v_mfma_f32_16x16x32_bf16 v[104:107], v[84:87], v[16:19], 0
	v_mfma_f32_16x16x32_bf16 v[108:111], v[84:87], v[48:51], 0
	s_add_u32 m0, s42, 69504
	s_nop 0
	buffer_load_dwordx4 v3, s[8:11], s43 offen offset:128 lds
	ds_read_b128 v[84:87], v10 offset:6144
	s_waitcnt lgkmcnt(3)
	v_mfma_f32_16x16x32_bf16 v[96:99], v[88:91], v[20:23], v[96:99]
	v_mfma_f32_16x16x32_bf16 v[100:103], v[88:91], v[52:55], v[100:103]
	s_add_u32 m0, s42, 73472
	s_nop 0
	buffer_load_dwordx4 v3, s[8:11], s43 offen offset:256 lds
	ds_read_b128 v[88:91], v11 offset:4096
	s_waitcnt lgkmcnt(3)
	v_mfma_f32_16x16x32_bf16 v[104:107], v[92:95], v[20:23], v[104:107]
	v_mfma_f32_16x16x32_bf16 v[108:111], v[92:95], v[52:55], v[108:111]
	s_add_u32 m0, s42, 77440
	s_nop 0
	buffer_load_dwordx4 v3, s[8:11], s43 offen offset:384 lds
	ds_read_b128 v[92:95], v11 offset:6144
	s_waitcnt lgkmcnt(3)
	v_mfma_f32_16x16x32_bf16 v[96:99], v[80:83], v[24:27], v[96:99]
	v_mfma_f32_16x16x32_bf16 v[100:103], v[80:83], v[56:59], v[100:103]
	s_add_u32 m0, s42, 81920
	s_add_u32 s43, s41, 2359296
	buffer_load_dwordx4 v3, s[8:11], s43 offen offset:0 lds
	ds_read_b128 v[80:83], v10 offset:8192
	s_waitcnt lgkmcnt(3)
	v_mfma_f32_16x16x32_bf16 v[104:107], v[84:87], v[24:27], v[104:107]
	v_mfma_f32_16x16x32_bf16 v[108:111], v[84:87], v[56:59], v[108:111]
	s_add_u32 m0, s42, 85888
	s_nop 0
	buffer_load_dwordx4 v3, s[8:11], s43 offen offset:128 lds
	ds_read_b128 v[84:87], v10 offset:10240
	s_waitcnt lgkmcnt(3)
	v_mfma_f32_16x16x32_bf16 v[96:99], v[88:91], v[28:31], v[96:99]
	v_mfma_f32_16x16x32_bf16 v[100:103], v[88:91], v[60:63], v[100:103]
	s_add_u32 m0, s42, 89856
	s_nop 0
	buffer_load_dwordx4 v3, s[8:11], s43 offen offset:256 lds
	ds_read_b128 v[88:91], v11 offset:8192
	s_waitcnt lgkmcnt(3)
	v_mfma_f32_16x16x32_bf16 v[104:107], v[92:95], v[28:31], v[104:107]
	v_mfma_f32_16x16x32_bf16 v[108:111], v[92:95], v[60:63], v[108:111]
	s_add_u32 m0, s42, 93824
	s_nop 0
	buffer_load_dwordx4 v3, s[8:11], s43 offen offset:384 lds
	ds_read_b128 v[92:95], v11 offset:10240
	s_waitcnt lgkmcnt(3)
	v_mfma_f32_16x16x32_bf16 v[96:99], v[80:83], v[32:35], v[96:99]
	v_mfma_f32_16x16x32_bf16 v[100:103], v[80:83], v[64:67], v[100:103]
	ds_read_b128 v[80:83], v10 offset:12288
	s_waitcnt lgkmcnt(3)
	v_mfma_f32_16x16x32_bf16 v[104:107], v[84:87], v[32:35], v[104:107]
	v_mfma_f32_16x16x32_bf16 v[108:111], v[84:87], v[64:67], v[108:111]
	ds_read_b128 v[84:87], v10 offset:14336
	s_waitcnt lgkmcnt(3)
	v_mfma_f32_16x16x32_bf16 v[96:99], v[88:91], v[36:39], v[96:99]
	v_mfma_f32_16x16x32_bf16 v[100:103], v[88:91], v[68:71], v[100:103]
	ds_read_b128 v[88:91], v11 offset:12288
	s_waitcnt lgkmcnt(3)
	v_mfma_f32_16x16x32_bf16 v[104:107], v[92:95], v[36:39], v[104:107]
	v_mfma_f32_16x16x32_bf16 v[108:111], v[92:95], v[68:71], v[108:111]
	ds_read_b128 v[92:95], v11 offset:14336
	s_waitcnt lgkmcnt(3)
	v_mfma_f32_16x16x32_bf16 v[96:99], v[80:83], v[40:43], v[96:99]
	v_mfma_f32_16x16x32_bf16 v[100:103], v[80:83], v[72:75], v[100:103]
	s_waitcnt lgkmcnt(2)
	v_mfma_f32_16x16x32_bf16 v[104:107], v[84:87], v[40:43], v[104:107]
	v_mfma_f32_16x16x32_bf16 v[108:111], v[84:87], v[72:75], v[108:111]
	s_waitcnt lgkmcnt(1)
	v_mfma_f32_16x16x32_bf16 v[96:99], v[88:91], v[44:47], v[96:99]
	v_mfma_f32_16x16x32_bf16 v[100:103], v[88:91], v[76:79], v[100:103]
	s_waitcnt lgkmcnt(0)
	v_mfma_f32_16x16x32_bf16 v[104:107], v[92:95], v[44:47], v[104:107]
	v_mfma_f32_16x16x32_bf16 v[108:111], v[92:95], v[76:79], v[108:111]
	s_waitcnt vmcnt(8) lgkmcnt(0)
	s_barrier
	ds_read_b128 v[80:83], v10 offset:32768
	ds_read_b128 v[84:87], v10 offset:34816
	ds_read_b128 v[88:91], v11 offset:32768
	ds_read_b128 v[92:95], v11 offset:34816
	s_waitcnt lgkmcnt(3)
	v_mfma_f32_16x16x32_bf16 v[112:115], v[80:83], v[16:19], 0
	v_mfma_f32_16x16x32_bf16 v[116:119], v[80:83], v[48:51], 0
	s_add_u32 m0, s42, 0
	s_add_u32 s43, s41, 786432
	buffer_load_dwordx4 v3, s[8:11], s43 offen offset:0 lds
	ds_read_b128 v[80:83], v10 offset:36864
	s_waitcnt lgkmcnt(3)
	v_mfma_f32_16x16x32_bf16 v[120:123], v[84:87], v[16:19], 0
	v_mfma_f32_16x16x32_bf16 v[124:127], v[84:87], v[48:51], 0
	s_add_u32 m0, s42, 3968
	s_nop 0
	buffer_load_dwordx4 v3, s[8:11], s43 offen offset:128 lds
	ds_read_b128 v[84:87], v10 offset:38912
	s_waitcnt lgkmcnt(3)
	v_mfma_f32_16x16x32_bf16 v[112:115], v[88:91], v[20:23], v[112:115]
	v_mfma_f32_16x16x32_bf16 v[116:119], v[88:91], v[52:55], v[116:119]
	s_add_u32 m0, s42, 7936
	s_nop 0
	buffer_load_dwordx4 v3, s[8:11], s43 offen offset:256 lds
	ds_read_b128 v[88:91], v11 offset:36864
	s_waitcnt lgkmcnt(3)
	v_mfma_f32_16x16x32_bf16 v[120:123], v[92:95], v[20:23], v[120:123]
	v_mfma_f32_16x16x32_bf16 v[124:127], v[92:95], v[52:55], v[124:127]
	s_add_u32 m0, s42, 11904
	s_nop 0
	buffer_load_dwordx4 v3, s[8:11], s43 offen offset:384 lds
	ds_read_b128 v[92:95], v11 offset:38912
	s_waitcnt lgkmcnt(3)
	v_mfma_f32_16x16x32_bf16 v[112:115], v[80:83], v[24:27], v[112:115]
	v_mfma_f32_16x16x32_bf16 v[116:119], v[80:83], v[56:59], v[116:119]
	s_add_u32 m0, s42, 16384
	s_add_u32 s43, s41, 2621440
	buffer_load_dwordx4 v3, s[8:11], s43 offen offset:0 lds
	ds_read_b128 v[80:83], v10 offset:40960
	s_waitcnt lgkmcnt(3)
	v_mfma_f32_16x16x32_bf16 v[120:123], v[84:87], v[24:27], v[120:123]
	v_mfma_f32_16x16x32_bf16 v[124:127], v[84:87], v[56:59], v[124:127]
	s_add_u32 m0, s42, 20352
	s_nop 0
	buffer_load_dwordx4 v3, s[8:11], s43 offen offset:128 lds
	ds_read_b128 v[84:87], v10 offset:43008
	s_waitcnt lgkmcnt(3)
	v_mfma_f32_16x16x32_bf16 v[112:115], v[88:91], v[28:31], v[112:115]
	v_mfma_f32_16x16x32_bf16 v[116:119], v[88:91], v[60:63], v[116:119]
	s_add_u32 m0, s42, 24320
	s_nop 0
	buffer_load_dwordx4 v3, s[8:11], s43 offen offset:256 lds
	ds_read_b128 v[88:91], v11 offset:40960
	s_waitcnt lgkmcnt(3)
	v_mfma_f32_16x16x32_bf16 v[120:123], v[92:95], v[28:31], v[120:123]
	v_pk_mul_f32 v[96:97], v[96:97], v[8:9] op_sel_hi:[1,0]
	v_mfma_f32_16x16x32_bf16 v[124:127], v[92:95], v[60:63], v[124:127]
	v_pk_mul_f32 v[98:99], v[98:99], v[8:9] op_sel_hi:[1,0]
	s_add_u32 m0, s42, 28288
	s_nop 0
	buffer_load_dwordx4 v3, s[8:11], s43 offen offset:384 lds
	ds_read_b128 v[92:95], v11 offset:43008
	s_waitcnt lgkmcnt(3)
	v_mfma_f32_16x16x32_bf16 v[112:115], v[80:83], v[32:35], v[112:115]
	v_cvt_pk_bf16_f32 v128, v96, v97
	v_mfma_f32_16x16x32_bf16 v[116:119], v[80:83], v[64:67], v[116:119]
	v_cvt_pk_bf16_f32 v129, v98, v99
	ds_read_b128 v[80:83], v10 offset:45056
	s_waitcnt lgkmcnt(3)
	v_mfma_f32_16x16x32_bf16 v[120:123], v[84:87], v[32:35], v[120:123]
	v_pk_mul_f32 v[104:105], v[104:105], v[8:9] op_sel_hi:[1,0]
	v_mfma_f32_16x16x32_bf16 v[124:127], v[84:87], v[64:67], v[124:127]
	v_pk_mul_f32 v[106:107], v[106:107], v[8:9] op_sel_hi:[1,0]
	ds_read_b128 v[84:87], v10 offset:47104
	s_waitcnt lgkmcnt(3)
	v_mfma_f32_16x16x32_bf16 v[112:115], v[88:91], v[36:39], v[112:115]
	v_cvt_pk_bf16_f32 v130, v104, v105
	v_mfma_f32_16x16x32_bf16 v[116:119], v[88:91], v[68:71], v[116:119]
	v_cvt_pk_bf16_f32 v131, v106, v107
	ds_read_b128 v[88:91], v11 offset:45056
	s_waitcnt lgkmcnt(3)
	v_mfma_f32_16x16x32_bf16 v[120:123], v[92:95], v[36:39], v[120:123]
	buffer_store_dwordx4 v[128:131], v6, s[4:7], s76 offen offset:0 sc1
	v_mfma_f32_16x16x32_bf16 v[124:127], v[92:95], v[68:71], v[124:127]
	v_pk_mul_f32 v[100:101], v[100:101], v[8:9] op_sel_hi:[1,0]
	ds_read_b128 v[92:95], v11 offset:47104
	s_waitcnt lgkmcnt(3)
	v_mfma_f32_16x16x32_bf16 v[112:115], v[80:83], v[40:43], v[112:115]
	v_pk_mul_f32 v[102:103], v[102:103], v[8:9] op_sel_hi:[1,0]
	v_mfma_f32_16x16x32_bf16 v[116:119], v[80:83], v[72:75], v[116:119]
	v_cvt_pk_bf16_f32 v132, v100, v101
	s_waitcnt lgkmcnt(2)
	v_mfma_f32_16x16x32_bf16 v[120:123], v[84:87], v[40:43], v[120:123]
	v_cvt_pk_bf16_f32 v133, v102, v103
	v_mfma_f32_16x16x32_bf16 v[124:127], v[84:87], v[72:75], v[124:127]
	v_pk_mul_f32 v[108:109], v[108:109], v[8:9] op_sel_hi:[1,0]
	s_waitcnt lgkmcnt(1)
	v_mfma_f32_16x16x32_bf16 v[112:115], v[88:91], v[44:47], v[112:115]
	v_pk_mul_f32 v[110:111], v[110:111], v[8:9] op_sel_hi:[1,0]
	v_mfma_f32_16x16x32_bf16 v[116:119], v[88:91], v[76:79], v[116:119]
	v_cvt_pk_bf16_f32 v134, v108, v109
	s_waitcnt lgkmcnt(0)
	v_mfma_f32_16x16x32_bf16 v[120:123], v[92:95], v[44:47], v[120:123]
	v_cvt_pk_bf16_f32 v135, v110, v111
	v_mfma_f32_16x16x32_bf16 v[124:127], v[92:95], v[76:79], v[124:127]
	buffer_store_dwordx4 v[132:135], v6, s[4:7], s78 offen offset:0 sc1
	s_waitcnt vmcnt(10) lgkmcnt(0)
	s_barrier
	v_mov_b32 v223, 0
	buffer_load_dword v223, v223, s[80:83], 0 offen offset:72 sc1
	ds_read_b128 v[80:83], v12 offset:0
	ds_read_b128 v[84:87], v12 offset:2048
	ds_read_b128 v[88:91], v13 offset:0
	ds_read_b128 v[92:95], v13 offset:2048
	s_waitcnt lgkmcnt(3)
	v_mfma_f32_16x16x32_bf16 v[96:99], v[80:83], v[16:19], 0
	v_mfma_f32_16x16x32_bf16 v[100:103], v[80:83], v[48:51], 0
	s_add_u32 m0, s42, 32768
	s_add_u32 s43, s41, 1048576
	buffer_load_dwordx4 v3, s[8:11], s43 offen offset:0 lds
	ds_read_b128 v[80:83], v12 offset:4096
	s_waitcnt lgkmcnt(3)
	v_mfma_f32_16x16x32_bf16 v[104:107], v[84:87], v[16:19], 0
	v_mfma_f32_16x16x32_bf16 v[108:111], v[84:87], v[48:51], 0
	s_add_u32 m0, s42, 36736
	s_nop 0
	buffer_load_dwordx4 v3, s[8:11], s43 offen offset:128 lds
	ds_read_b128 v[84:87], v12 offset:6144
	s_waitcnt lgkmcnt(3)
	v_mfma_f32_16x16x32_bf16 v[96:99], v[88:91], v[20:23], v[96:99]
	v_mfma_f32_16x16x32_bf16 v[100:103], v[88:91], v[52:55], v[100:103]
	s_add_u32 m0, s42, 40704
	s_nop 0
	buffer_load_dwordx4 v3, s[8:11], s43 offen offset:256 lds
	ds_read_b128 v[88:91], v13 offset:4096
	s_waitcnt lgkmcnt(3)
	v_mfma_f32_16x16x32_bf16 v[104:107], v[92:95], v[20:23], v[104:107]
	v_mfma_f32_16x16x32_bf16 v[108:111], v[92:95], v[52:55], v[108:111]
	s_add_u32 m0, s42, 44672
	s_nop 0
	buffer_load_dwordx4 v3, s[8:11], s43 offen offset:384 lds
	ds_read_b128 v[92:95], v13 offset:6144
	s_waitcnt lgkmcnt(3)
	v_mfma_f32_16x16x32_bf16 v[96:99], v[80:83], v[24:27], v[96:99]
	v_mfma_f32_16x16x32_bf16 v[100:103], v[80:83], v[56:59], v[100:103]
	s_add_u32 m0, s42, 49152
	s_add_u32 s43, s41, 2883584
	buffer_load_dwordx4 v3, s[8:11], s43 offen offset:0 lds
	ds_read_b128 v[80:83], v12 offset:8192
	s_waitcnt lgkmcnt(3)
	v_mfma_f32_16x16x32_bf16 v[104:107], v[84:87], v[24:27], v[104:107]
	v_mfma_f32_16x16x32_bf16 v[108:111], v[84:87], v[56:59], v[108:111]
	s_add_u32 m0, s42, 53120
	s_nop 0
	buffer_load_dwordx4 v3, s[8:11], s43 offen offset:128 lds
	ds_read_b128 v[84:87], v12 offset:10240
	s_waitcnt lgkmcnt(3)
	v_mfma_f32_16x16x32_bf16 v[96:99], v[88:91], v[28:31], v[96:99]
	v_mfma_f32_16x16x32_bf16 v[100:103], v[88:91], v[60:63], v[100:103]
	s_add_u32 m0, s42, 57088
	s_nop 0
	buffer_load_dwordx4 v3, s[8:11], s43 offen offset:256 lds
	ds_read_b128 v[88:91], v13 offset:8192
	s_waitcnt lgkmcnt(3)
	v_mfma_f32_16x16x32_bf16 v[104:107], v[92:95], v[28:31], v[104:107]
	v_pk_mul_f32 v[112:113], v[112:113], v[8:9] op_sel_hi:[1,0]
	v_mfma_f32_16x16x32_bf16 v[108:111], v[92:95], v[60:63], v[108:111]
	v_pk_mul_f32 v[114:115], v[114:115], v[8:9] op_sel_hi:[1,0]
	s_add_u32 m0, s42, 61056
	s_nop 0
	buffer_load_dwordx4 v3, s[8:11], s43 offen offset:384 lds
	ds_read_b128 v[92:95], v13 offset:10240
	s_waitcnt lgkmcnt(3)
	v_mfma_f32_16x16x32_bf16 v[96:99], v[80:83], v[32:35], v[96:99]
	v_cvt_pk_bf16_f32 v128, v112, v113
	v_mfma_f32_16x16x32_bf16 v[100:103], v[80:83], v[64:67], v[100:103]
	v_cvt_pk_bf16_f32 v129, v114, v115
	ds_read_b128 v[80:83], v12 offset:12288
	s_waitcnt lgkmcnt(3)
	v_mfma_f32_16x16x32_bf16 v[104:107], v[84:87], v[32:35], v[104:107]
	v_pk_mul_f32 v[120:121], v[120:121], v[8:9] op_sel_hi:[1,0]
	v_mfma_f32_16x16x32_bf16 v[108:111], v[84:87], v[64:67], v[108:111]
	v_pk_mul_f32 v[122:123], v[122:123], v[8:9] op_sel_hi:[1,0]
	ds_read_b128 v[84:87], v12 offset:14336
	s_waitcnt lgkmcnt(3)
	v_mfma_f32_16x16x32_bf16 v[96:99], v[88:91], v[36:39], v[96:99]
	v_cvt_pk_bf16_f32 v130, v120, v121
	v_mfma_f32_16x16x32_bf16 v[100:103], v[88:91], v[68:71], v[100:103]
	v_cvt_pk_bf16_f32 v131, v122, v123
	ds_read_b128 v[88:91], v13 offset:12288
	s_waitcnt lgkmcnt(3)
	v_mfma_f32_16x16x32_bf16 v[104:107], v[92:95], v[36:39], v[104:107]
	buffer_store_dwordx4 v[128:131], v6, s[4:7], s76 offen offset:1024 sc1
	v_mfma_f32_16x16x32_bf16 v[108:111], v[92:95], v[68:71], v[108:111]
	v_pk_mul_f32 v[116:117], v[116:117], v[8:9] op_sel_hi:[1,0]
	ds_read_b128 v[92:95], v13 offset:14336
	s_waitcnt lgkmcnt(3)
	v_mfma_f32_16x16x32_bf16 v[96:99], v[80:83], v[40:43], v[96:99]
	v_pk_mul_f32 v[118:119], v[118:119], v[8:9] op_sel_hi:[1,0]
	v_mfma_f32_16x16x32_bf16 v[100:103], v[80:83], v[72:75], v[100:103]
	v_cvt_pk_bf16_f32 v132, v116, v117
	s_waitcnt lgkmcnt(2)
	v_mfma_f32_16x16x32_bf16 v[104:107], v[84:87], v[40:43], v[104:107]
	v_cvt_pk_bf16_f32 v133, v118, v119
	v_mfma_f32_16x16x32_bf16 v[108:111], v[84:87], v[72:75], v[108:111]
	v_pk_mul_f32 v[124:125], v[124:125], v[8:9] op_sel_hi:[1,0]
	s_waitcnt lgkmcnt(1)
	v_mfma_f32_16x16x32_bf16 v[96:99], v[88:91], v[44:47], v[96:99]
	v_pk_mul_f32 v[126:127], v[126:127], v[8:9] op_sel_hi:[1,0]
	v_mfma_f32_16x16x32_bf16 v[100:103], v[88:91], v[76:79], v[100:103]
	v_cvt_pk_bf16_f32 v134, v124, v125
	s_waitcnt lgkmcnt(0)
	v_mfma_f32_16x16x32_bf16 v[104:107], v[92:95], v[44:47], v[104:107]
	v_cvt_pk_bf16_f32 v135, v126, v127
	v_mfma_f32_16x16x32_bf16 v[108:111], v[92:95], v[76:79], v[108:111]
	buffer_store_dwordx4 v[132:135], v6, s[4:7], s78 offen offset:1024 sc1
	s_waitcnt vmcnt(13) lgkmcnt(0)
	s_barrier
	ds_read_b128 v[80:83], v10 offset:0
	ds_read_b128 v[84:87], v10 offset:2048
	ds_read_b128 v[88:91], v11 offset:0
	ds_read_b128 v[92:95], v11 offset:2048
	s_waitcnt lgkmcnt(3)
	v_mfma_f32_16x16x32_bf16 v[112:115], v[80:83], v[16:19], 0
	v_mfma_f32_16x16x32_bf16 v[116:119], v[80:83], v[48:51], 0
	s_add_u32 m0, s42, 65536
	s_add_u32 s43, s41, 1310720
	buffer_load_dwordx4 v3, s[8:11], s43 offen offset:0 lds
	ds_read_b128 v[80:83], v10 offset:4096
	s_waitcnt lgkmcnt(3)
	v_mfma_f32_16x16x32_bf16 v[120:123], v[84:87], v[16:19], 0
	v_mfma_f32_16x16x32_bf16 v[124:127], v[84:87], v[48:51], 0
	s_add_u32 m0, s42, 69504
	s_nop 0
	buffer_load_dwordx4 v3, s[8:11], s43 offen offset:128 lds
	ds_read_b128 v[84:87], v10 offset:6144
	s_waitcnt lgkmcnt(3)
	v_mfma_f32_16x16x32_bf16 v[112:115], v[88:91], v[20:23], v[112:115]
	v_mfma_f32_16x16x32_bf16 v[116:119], v[88:91], v[52:55], v[116:119]
	s_add_u32 m0, s42, 73472
	s_nop 0
	buffer_load_dwordx4 v3, s[8:11], s43 offen offset:256 lds
	ds_read_b128 v[88:91], v11 offset:4096
	s_waitcnt lgkmcnt(3)
	v_mfma_f32_16x16x32_bf16 v[120:123], v[92:95], v[20:23], v[120:123]
	v_mfma_f32_16x16x32_bf16 v[124:127], v[92:95], v[52:55], v[124:127]
	s_add_u32 m0, s42, 77440
	s_nop 0
	buffer_load_dwordx4 v3, s[8:11], s43 offen offset:384 lds
	ds_read_b128 v[92:95], v11 offset:6144
	s_waitcnt lgkmcnt(3)
	v_mfma_f32_16x16x32_bf16 v[112:115], v[80:83], v[24:27], v[112:115]
	v_mfma_f32_16x16x32_bf16 v[116:119], v[80:83], v[56:59], v[116:119]
	s_add_u32 m0, s42, 81920
	s_add_u32 s43, s41, 3145728
	buffer_load_dwordx4 v3, s[8:11], s43 offen offset:0 lds
	ds_read_b128 v[80:83], v10 offset:8192
	s_waitcnt lgkmcnt(3)
	v_mfma_f32_16x16x32_bf16 v[120:123], v[84:87], v[24:27], v[120:123]
	v_mfma_f32_16x16x32_bf16 v[124:127], v[84:87], v[56:59], v[124:127]
	s_add_u32 m0, s42, 85888
	s_nop 0
	buffer_load_dwordx4 v3, s[8:11], s43 offen offset:128 lds
	ds_read_b128 v[84:87], v10 offset:10240
	s_waitcnt lgkmcnt(3)
	v_mfma_f32_16x16x32_bf16 v[112:115], v[88:91], v[28:31], v[112:115]
	v_mfma_f32_16x16x32_bf16 v[116:119], v[88:91], v[60:63], v[116:119]
	s_add_u32 m0, s42, 89856
	s_nop 0
	buffer_load_dwordx4 v3, s[8:11], s43 offen offset:256 lds
	ds_read_b128 v[88:91], v11 offset:8192
	s_waitcnt lgkmcnt(3)
	v_mfma_f32_16x16x32_bf16 v[120:123], v[92:95], v[28:31], v[120:123]
	v_pk_mul_f32 v[96:97], v[96:97], v[8:9] op_sel_hi:[1,0]
	v_mfma_f32_16x16x32_bf16 v[124:127], v[92:95], v[60:63], v[124:127]
	v_pk_mul_f32 v[98:99], v[98:99], v[8:9] op_sel_hi:[1,0]
	s_add_u32 m0, s42, 93824
	s_nop 0
	buffer_load_dwordx4 v3, s[8:11], s43 offen offset:384 lds
	ds_read_b128 v[92:95], v11 offset:10240
	s_waitcnt lgkmcnt(3)
	v_mfma_f32_16x16x32_bf16 v[112:115], v[80:83], v[32:35], v[112:115]
	v_cvt_pk_bf16_f32 v128, v96, v97
	v_mfma_f32_16x16x32_bf16 v[116:119], v[80:83], v[64:67], v[116:119]
	v_cvt_pk_bf16_f32 v129, v98, v99
	ds_read_b128 v[80:83], v10 offset:12288
	s_waitcnt lgkmcnt(3)
	v_mfma_f32_16x16x32_bf16 v[120:123], v[84:87], v[32:35], v[120:123]
	v_pk_mul_f32 v[104:105], v[104:105], v[8:9] op_sel_hi:[1,0]
	v_mfma_f32_16x16x32_bf16 v[124:127], v[84:87], v[64:67], v[124:127]
	v_pk_mul_f32 v[106:107], v[106:107], v[8:9] op_sel_hi:[1,0]
	ds_read_b128 v[84:87], v10 offset:14336
	s_waitcnt lgkmcnt(3)
	v_mfma_f32_16x16x32_bf16 v[112:115], v[88:91], v[36:39], v[112:115]
	v_cvt_pk_bf16_f32 v130, v104, v105
	v_mfma_f32_16x16x32_bf16 v[116:119], v[88:91], v[68:71], v[116:119]
	v_cvt_pk_bf16_f32 v131, v106, v107
	ds_read_b128 v[88:91], v11 offset:12288
	s_waitcnt lgkmcnt(3)
	v_mfma_f32_16x16x32_bf16 v[120:123], v[92:95], v[36:39], v[120:123]
	buffer_store_dwordx4 v[128:131], v6, s[4:7], s76 offen offset:2048 sc1
	v_mfma_f32_16x16x32_bf16 v[124:127], v[92:95], v[68:71], v[124:127]
	v_pk_mul_f32 v[100:101], v[100:101], v[8:9] op_sel_hi:[1,0]
	ds_read_b128 v[92:95], v11 offset:14336
	s_waitcnt lgkmcnt(3)
	v_mfma_f32_16x16x32_bf16 v[112:115], v[80:83], v[40:43], v[112:115]
	v_pk_mul_f32 v[102:103], v[102:103], v[8:9] op_sel_hi:[1,0]
	v_mfma_f32_16x16x32_bf16 v[116:119], v[80:83], v[72:75], v[116:119]
	v_cvt_pk_bf16_f32 v132, v100, v101
	s_waitcnt lgkmcnt(2)
	v_mfma_f32_16x16x32_bf16 v[120:123], v[84:87], v[40:43], v[120:123]
	v_cvt_pk_bf16_f32 v133, v102, v103
	v_mfma_f32_16x16x32_bf16 v[124:127], v[84:87], v[72:75], v[124:127]
	v_pk_mul_f32 v[108:109], v[108:109], v[8:9] op_sel_hi:[1,0]
	s_waitcnt lgkmcnt(1)
	v_mfma_f32_16x16x32_bf16 v[112:115], v[88:91], v[44:47], v[112:115]
	v_pk_mul_f32 v[110:111], v[110:111], v[8:9] op_sel_hi:[1,0]
	v_mfma_f32_16x16x32_bf16 v[116:119], v[88:91], v[76:79], v[116:119]
	v_cvt_pk_bf16_f32 v134, v108, v109
	s_waitcnt lgkmcnt(0)
	v_mfma_f32_16x16x32_bf16 v[120:123], v[92:95], v[44:47], v[120:123]
	v_cvt_pk_bf16_f32 v135, v110, v111
	v_mfma_f32_16x16x32_bf16 v[124:127], v[92:95], v[76:79], v[124:127]
	buffer_store_dwordx4 v[132:135], v6, s[4:7], s78 offen offset:2048 sc1
	s_waitcnt vmcnt(10) lgkmcnt(0)
	s_barrier
	v_readfirstlane_b32 s40, v223
	s_nop 0
	s_cmp_lt_u32 s40, 32
	s_cbranch_scc1 Lprep_noe
	s_mov_b32 s88, 0
	v_mov_b32 v223, 1
	buffer_atomic_add v223, v221, s[4:7], s87 offen offset:4
Lprep_noe:
	ds_read_b128 v[80:83], v10 offset:32768
	ds_read_b128 v[84:87], v10 offset:34816
	ds_read_b128 v[88:91], v11 offset:32768
	ds_read_b128 v[92:95], v11 offset:34816
	s_waitcnt lgkmcnt(3)
	v_mfma_f32_16x16x32_bf16 v[96:99], v[80:83], v[16:19], 0
	v_mfma_f32_16x16x32_bf16 v[100:103], v[80:83], v[48:51], 0
	s_add_u32 m0, s42, 0
	s_add_u32 s43, s41, 1572864
	buffer_load_dwordx4 v3, s[8:11], s43 offen offset:0 lds
	ds_read_b128 v[80:83], v10 offset:36864
	s_waitcnt lgkmcnt(3)
	v_mfma_f32_16x16x32_bf16 v[104:107], v[84:87], v[16:19], 0
	v_mfma_f32_16x16x32_bf16 v[108:111], v[84:87], v[48:51], 0
	s_add_u32 m0, s42, 3968
	s_nop 0
	buffer_load_dwordx4 v3, s[8:11], s43 offen offset:128 lds
	ds_read_b128 v[84:87], v10 offset:38912
	s_waitcnt lgkmcnt(3)
	v_mfma_f32_16x16x32_bf16 v[96:99], v[88:91], v[20:23], v[96:99]
	v_mfma_f32_16x16x32_bf16 v[100:103], v[88:91], v[52:55], v[100:103]
	s_add_u32 m0, s42, 7936
	s_nop 0
	buffer_load_dwordx4 v3, s[8:11], s43 offen offset:256 lds
	ds_read_b128 v[88:91], v11 offset:36864
	s_waitcnt lgkmcnt(3)
	v_mfma_f32_16x16x32_bf16 v[104:107], v[92:95], v[20:23], v[104:107]
	v_mfma_f32_16x16x32_bf16 v[108:111], v[92:95], v[52:55], v[108:111]
	s_add_u32 m0, s42, 11904
	s_nop 0
	buffer_load_dwordx4 v3, s[8:11], s43 offen offset:384 lds
	ds_read_b128 v[92:95], v11 offset:38912
	s_waitcnt lgkmcnt(3)
	v_mfma_f32_16x16x32_bf16 v[96:99], v[80:83], v[24:27], v[96:99]
	v_mfma_f32_16x16x32_bf16 v[100:103], v[80:83], v[56:59], v[100:103]
	s_add_u32 m0, s42, 16384
	s_add_u32 s43, s41, 3407872
	buffer_load_dwordx4 v3, s[8:11], s43 offen offset:0 lds
	ds_read_b128 v[80:83], v10 offset:40960
	s_waitcnt lgkmcnt(3)
	v_mfma_f32_16x16x32_bf16 v[104:107], v[84:87], v[24:27], v[104:107]
	v_mfma_f32_16x16x32_bf16 v[108:111], v[84:87], v[56:59], v[108:111]
	s_add_u32 m0, s42, 20352
	s_nop 0
	buffer_load_dwordx4 v3, s[8:11], s43 offen offset:128 lds
	ds_read_b128 v[84:87], v10 offset:43008
	s_waitcnt lgkmcnt(3)
	v_mfma_f32_16x16x32_bf16 v[96:99], v[88:91], v[28:31], v[96:99]
	v_mfma_f32_16x16x32_bf16 v[100:103], v[88:91], v[60:63], v[100:103]
	s_add_u32 m0, s42, 24320
	s_nop 0
	buffer_load_dwordx4 v3, s[8:11], s43 offen offset:256 lds
	ds_read_b128 v[88:91], v11 offset:40960
	s_waitcnt lgkmcnt(3)
	v_mfma_f32_16x16x32_bf16 v[104:107], v[92:95], v[28:31], v[104:107]
	v_pk_mul_f32 v[112:113], v[112:113], v[8:9] op_sel_hi:[1,0]
	v_mfma_f32_16x16x32_bf16 v[108:111], v[92:95], v[60:63], v[108:111]
	v_pk_mul_f32 v[114:115], v[114:115], v[8:9] op_sel_hi:[1,0]
	s_add_u32 m0, s42, 28288
	s_nop 0
	buffer_load_dwordx4 v3, s[8:11], s43 offen offset:384 lds
	ds_read_b128 v[92:95], v11 offset:43008
	s_waitcnt lgkmcnt(3)
	v_mfma_f32_16x16x32_bf16 v[96:99], v[80:83], v[32:35], v[96:99]
	v_cvt_pk_bf16_f32 v128, v112, v113
	v_mfma_f32_16x16x32_bf16 v[100:103], v[80:83], v[64:67], v[100:103]
	v_cvt_pk_bf16_f32 v129, v114, v115
	ds_read_b128 v[80:83], v10 offset:45056
	s_waitcnt lgkmcnt(3)
	v_mfma_f32_16x16x32_bf16 v[104:107], v[84:87], v[32:35], v[104:107]
	v_pk_mul_f32 v[120:121], v[120:121], v[8:9] op_sel_hi:[1,0]
	v_mfma_f32_16x16x32_bf16 v[108:111], v[84:87], v[64:67], v[108:111]
	v_pk_mul_f32 v[122:123], v[122:123], v[8:9] op_sel_hi:[1,0]
	ds_read_b128 v[84:87], v10 offset:47104
	s_waitcnt lgkmcnt(3)
	v_mfma_f32_16x16x32_bf16 v[96:99], v[88:91], v[36:39], v[96:99]
	v_cvt_pk_bf16_f32 v130, v120, v121
	v_mfma_f32_16x16x32_bf16 v[100:103], v[88:91], v[68:71], v[100:103]
	v_cvt_pk_bf16_f32 v131, v122, v123
	ds_read_b128 v[88:91], v11 offset:45056
	s_waitcnt lgkmcnt(3)
	v_mfma_f32_16x16x32_bf16 v[104:107], v[92:95], v[36:39], v[104:107]
	buffer_store_dwordx4 v[128:131], v6, s[4:7], s76 offen offset:3072 sc1
	v_mfma_f32_16x16x32_bf16 v[108:111], v[92:95], v[68:71], v[108:111]
	v_pk_mul_f32 v[116:117], v[116:117], v[8:9] op_sel_hi:[1,0]
	ds_read_b128 v[92:95], v11 offset:47104
	s_waitcnt lgkmcnt(3)
	v_mfma_f32_16x16x32_bf16 v[96:99], v[80:83], v[40:43], v[96:99]
	v_pk_mul_f32 v[118:119], v[118:119], v[8:9] op_sel_hi:[1,0]
	v_mfma_f32_16x16x32_bf16 v[100:103], v[80:83], v[72:75], v[100:103]
	v_cvt_pk_bf16_f32 v132, v116, v117
	s_waitcnt lgkmcnt(2)
	v_mfma_f32_16x16x32_bf16 v[104:107], v[84:87], v[40:43], v[104:107]
	v_cvt_pk_bf16_f32 v133, v118, v119
	v_mfma_f32_16x16x32_bf16 v[108:111], v[84:87], v[72:75], v[108:111]
	v_pk_mul_f32 v[124:125], v[124:125], v[8:9] op_sel_hi:[1,0]
	s_waitcnt lgkmcnt(1)
	v_mfma_f32_16x16x32_bf16 v[96:99], v[88:91], v[44:47], v[96:99]
	v_pk_mul_f32 v[126:127], v[126:127], v[8:9] op_sel_hi:[1,0]
	v_mfma_f32_16x16x32_bf16 v[100:103], v[88:91], v[76:79], v[100:103]
	v_cvt_pk_bf16_f32 v134, v124, v125
	s_waitcnt lgkmcnt(0)
	v_mfma_f32_16x16x32_bf16 v[104:107], v[92:95], v[44:47], v[104:107]
	v_cvt_pk_bf16_f32 v135, v126, v127
	v_mfma_f32_16x16x32_bf16 v[108:111], v[92:95], v[76:79], v[108:111]
	buffer_store_dwordx4 v[132:135], v6, s[4:7], s78 offen offset:3072 sc1
	s_waitcnt vmcnt(12) lgkmcnt(0)
	s_barrier
	ds_read_b128 v[80:83], v12 offset:0
	ds_read_b128 v[84:87], v12 offset:2048
	ds_read_b128 v[88:91], v13 offset:0
	ds_read_b128 v[92:95], v13 offset:2048
	s_waitcnt lgkmcnt(3)
	v_mfma_f32_16x16x32_bf16 v[112:115], v[80:83], v[16:19], 0
	v_mfma_f32_16x16x32_bf16 v[116:119], v[80:83], v[48:51], 0
	ds_read_b128 v[80:83], v12 offset:4096
	s_waitcnt lgkmcnt(3)
	v_mfma_f32_16x16x32_bf16 v[120:123], v[84:87], v[16:19], 0
	v_mfma_f32_16x16x32_bf16 v[124:127], v[84:87], v[48:51], 0
	ds_read_b128 v[84:87], v12 offset:6144
	s_waitcnt lgkmcnt(3)
	v_mfma_f32_16x16x32_bf16 v[112:115], v[88:91], v[20:23], v[112:115]
	v_mfma_f32_16x16x32_bf16 v[116:119], v[88:91], v[52:55], v[116:119]
	ds_read_b128 v[88:91], v13 offset:4096
	s_waitcnt lgkmcnt(3)
	v_mfma_f32_16x16x32_bf16 v[120:123], v[92:95], v[20:23], v[120:123]
	v_mfma_f32_16x16x32_bf16 v[124:127], v[92:95], v[52:55], v[124:127]
	ds_read_b128 v[92:95], v13 offset:6144
	s_waitcnt lgkmcnt(3)
	v_mfma_f32_16x16x32_bf16 v[112:115], v[80:83], v[24:27], v[112:115]
	v_mfma_f32_16x16x32_bf16 v[116:119], v[80:83], v[56:59], v[116:119]
	ds_read_b128 v[80:83], v12 offset:8192
	s_waitcnt lgkmcnt(3)
	v_mfma_f32_16x16x32_bf16 v[120:123], v[84:87], v[24:27], v[120:123]
	v_mfma_f32_16x16x32_bf16 v[124:127], v[84:87], v[56:59], v[124:127]
	ds_read_b128 v[84:87], v12 offset:10240
	s_waitcnt lgkmcnt(3)
	v_mfma_f32_16x16x32_bf16 v[112:115], v[88:91], v[28:31], v[112:115]
	v_mfma_f32_16x16x32_bf16 v[116:119], v[88:91], v[60:63], v[116:119]
	ds_read_b128 v[88:91], v13 offset:8192
	s_waitcnt lgkmcnt(3)
	v_mfma_f32_16x16x32_bf16 v[120:123], v[92:95], v[28:31], v[120:123]
	v_pk_mul_f32 v[96:97], v[96:97], v[8:9] op_sel_hi:[1,0]
	v_mfma_f32_16x16x32_bf16 v[124:127], v[92:95], v[60:63], v[124:127]
	v_pk_mul_f32 v[98:99], v[98:99], v[8:9] op_sel_hi:[1,0]
	ds_read_b128 v[92:95], v13 offset:10240
	s_waitcnt lgkmcnt(3)
	v_mfma_f32_16x16x32_bf16 v[112:115], v[80:83], v[32:35], v[112:115]
	v_cvt_pk_bf16_f32 v128, v96, v97
	v_mfma_f32_16x16x32_bf16 v[116:119], v[80:83], v[64:67], v[116:119]
	v_cvt_pk_bf16_f32 v129, v98, v99
	ds_read_b128 v[80:83], v12 offset:12288
	s_waitcnt lgkmcnt(3)
	v_mfma_f32_16x16x32_bf16 v[120:123], v[84:87], v[32:35], v[120:123]
	v_pk_mul_f32 v[104:105], v[104:105], v[8:9] op_sel_hi:[1,0]
	v_mfma_f32_16x16x32_bf16 v[124:127], v[84:87], v[64:67], v[124:127]
	v_pk_mul_f32 v[106:107], v[106:107], v[8:9] op_sel_hi:[1,0]
	ds_read_b128 v[84:87], v12 offset:14336
	s_waitcnt lgkmcnt(3)
	v_mfma_f32_16x16x32_bf16 v[112:115], v[88:91], v[36:39], v[112:115]
	v_cvt_pk_bf16_f32 v130, v104, v105
	v_mfma_f32_16x16x32_bf16 v[116:119], v[88:91], v[68:71], v[116:119]
	v_cvt_pk_bf16_f32 v131, v106, v107
	ds_read_b128 v[88:91], v13 offset:12288
	s_waitcnt lgkmcnt(3)
	v_mfma_f32_16x16x32_bf16 v[120:123], v[92:95], v[36:39], v[120:123]
	buffer_store_dwordx4 v[128:131], v6, s[4:7], s77 offen offset:0 sc1
	v_mfma_f32_16x16x32_bf16 v[124:127], v[92:95], v[68:71], v[124:127]
	v_pk_mul_f32 v[100:101], v[100:101], v[8:9] op_sel_hi:[1,0]
	ds_read_b128 v[92:95], v13 offset:14336
	s_waitcnt lgkmcnt(3)
	v_mfma_f32_16x16x32_bf16 v[112:115], v[80:83], v[40:43], v[112:115]
	v_pk_mul_f32 v[102:103], v[102:103], v[8:9] op_sel_hi:[1,0]
	v_mfma_f32_16x16x32_bf16 v[116:119], v[80:83], v[72:75], v[116:119]
	v_cvt_pk_bf16_f32 v132, v100, v101
	s_waitcnt lgkmcnt(2)
	v_mfma_f32_16x16x32_bf16 v[120:123], v[84:87], v[40:43], v[120:123]
	v_cvt_pk_bf16_f32 v133, v102, v103
	v_mfma_f32_16x16x32_bf16 v[124:127], v[84:87], v[72:75], v[124:127]
	v_pk_mul_f32 v[108:109], v[108:109], v[8:9] op_sel_hi:[1,0]
	s_waitcnt lgkmcnt(1)
	v_mfma_f32_16x16x32_bf16 v[112:115], v[88:91], v[44:47], v[112:115]
	v_pk_mul_f32 v[110:111], v[110:111], v[8:9] op_sel_hi:[1,0]
	v_mfma_f32_16x16x32_bf16 v[116:119], v[88:91], v[76:79], v[116:119]
	v_cvt_pk_bf16_f32 v134, v108, v109
	s_waitcnt lgkmcnt(0)
	v_mfma_f32_16x16x32_bf16 v[120:123], v[92:95], v[44:47], v[120:123]
	v_cvt_pk_bf16_f32 v135, v110, v111
	v_mfma_f32_16x16x32_bf16 v[124:127], v[92:95], v[76:79], v[124:127]
	buffer_store_dwordx4 v[132:135], v6, s[4:7], s79 offen offset:0 sc1
	s_waitcnt vmcnt(4) lgkmcnt(0)
	s_barrier
	ds_read_b128 v[80:83], v10 offset:0
	ds_read_b128 v[84:87], v10 offset:2048
	ds_read_b128 v[88:91], v11 offset:0
	ds_read_b128 v[92:95], v11 offset:2048
	s_waitcnt lgkmcnt(3)
	v_mfma_f32_16x16x32_bf16 v[96:99], v[80:83], v[16:19], 0
	v_mfma_f32_16x16x32_bf16 v[100:103], v[80:83], v[48:51], 0
	ds_read_b128 v[80:83], v10 offset:4096
	s_waitcnt lgkmcnt(3)
	v_mfma_f32_16x16x32_bf16 v[104:107], v[84:87], v[16:19], 0
	v_mfma_f32_16x16x32_bf16 v[108:111], v[84:87], v[48:51], 0
	ds_read_b128 v[84:87], v10 offset:6144
	s_waitcnt lgkmcnt(3)
	v_mfma_f32_16x16x32_bf16 v[96:99], v[88:91], v[20:23], v[96:99]
	v_mfma_f32_16x16x32_bf16 v[100:103], v[88:91], v[52:55], v[100:103]
	ds_read_b128 v[88:91], v11 offset:4096
	s_waitcnt lgkmcnt(3)
	v_mfma_f32_16x16x32_bf16 v[104:107], v[92:95], v[20:23], v[104:107]
	v_mfma_f32_16x16x32_bf16 v[108:111], v[92:95], v[52:55], v[108:111]
	ds_read_b128 v[92:95], v11 offset:6144
	s_waitcnt lgkmcnt(3)
	v_mfma_f32_16x16x32_bf16 v[96:99], v[80:83], v[24:27], v[96:99]
	v_mfma_f32_16x16x32_bf16 v[100:103], v[80:83], v[56:59], v[100:103]
	ds_read_b128 v[80:83], v10 offset:8192
	s_waitcnt lgkmcnt(3)
	v_mfma_f32_16x16x32_bf16 v[104:107], v[84:87], v[24:27], v[104:107]
	v_mfma_f32_16x16x32_bf16 v[108:111], v[84:87], v[56:59], v[108:111]
	ds_read_b128 v[84:87], v10 offset:10240
	s_waitcnt lgkmcnt(3)
	v_mfma_f32_16x16x32_bf16 v[96:99], v[88:91], v[28:31], v[96:99]
	v_mfma_f32_16x16x32_bf16 v[100:103], v[88:91], v[60:63], v[100:103]
	ds_read_b128 v[88:91], v11 offset:8192
	s_waitcnt lgkmcnt(3)
	v_mfma_f32_16x16x32_bf16 v[104:107], v[92:95], v[28:31], v[104:107]
	v_pk_mul_f32 v[112:113], v[112:113], v[8:9] op_sel_hi:[1,0]
	v_mfma_f32_16x16x32_bf16 v[108:111], v[92:95], v[60:63], v[108:111]
	v_pk_mul_f32 v[114:115], v[114:115], v[8:9] op_sel_hi:[1,0]
	ds_read_b128 v[92:95], v11 offset:10240
	s_waitcnt lgkmcnt(3)
	v_mfma_f32_16x16x32_bf16 v[96:99], v[80:83], v[32:35], v[96:99]
	v_cvt_pk_bf16_f32 v128, v112, v113
	v_mfma_f32_16x16x32_bf16 v[100:103], v[80:83], v[64:67], v[100:103]
	v_cvt_pk_bf16_f32 v129, v114, v115
	ds_read_b128 v[80:83], v10 offset:12288
	s_waitcnt lgkmcnt(3)
	v_mfma_f32_16x16x32_bf16 v[104:107], v[84:87], v[32:35], v[104:107]
	v_pk_mul_f32 v[120:121], v[120:121], v[8:9] op_sel_hi:[1,0]
	v_mfma_f32_16x16x32_bf16 v[108:111], v[84:87], v[64:67], v[108:111]
	v_pk_mul_f32 v[122:123], v[122:123], v[8:9] op_sel_hi:[1,0]
	ds_read_b128 v[84:87], v10 offset:14336
	s_waitcnt lgkmcnt(3)
	v_mfma_f32_16x16x32_bf16 v[96:99], v[88:91], v[36:39], v[96:99]
	v_cvt_pk_bf16_f32 v130, v120, v121
	v_mfma_f32_16x16x32_bf16 v[100:103], v[88:91], v[68:71], v[100:103]
	v_cvt_pk_bf16_f32 v131, v122, v123
	ds_read_b128 v[88:91], v11 offset:12288
	s_waitcnt lgkmcnt(3)
	v_mfma_f32_16x16x32_bf16 v[104:107], v[92:95], v[36:39], v[104:107]
	buffer_store_dwordx4 v[128:131], v6, s[4:7], s77 offen offset:1024 sc1
	v_mfma_f32_16x16x32_bf16 v[108:111], v[92:95], v[68:71], v[108:111]
	v_pk_mul_f32 v[116:117], v[116:117], v[8:9] op_sel_hi:[1,0]
	ds_read_b128 v[92:95], v11 offset:14336
	s_waitcnt lgkmcnt(3)
	v_mfma_f32_16x16x32_bf16 v[96:99], v[80:83], v[40:43], v[96:99]
	v_pk_mul_f32 v[118:119], v[118:119], v[8:9] op_sel_hi:[1,0]
	v_mfma_f32_16x16x32_bf16 v[100:103], v[80:83], v[72:75], v[100:103]
	v_cvt_pk_bf16_f32 v132, v116, v117
	s_waitcnt lgkmcnt(2)
	v_mfma_f32_16x16x32_bf16 v[104:107], v[84:87], v[40:43], v[104:107]
	v_cvt_pk_bf16_f32 v133, v118, v119
	v_mfma_f32_16x16x32_bf16 v[108:111], v[84:87], v[72:75], v[108:111]
	v_pk_mul_f32 v[124:125], v[124:125], v[8:9] op_sel_hi:[1,0]
	s_waitcnt lgkmcnt(1)
	v_mfma_f32_16x16x32_bf16 v[96:99], v[88:91], v[44:47], v[96:99]
	v_pk_mul_f32 v[126:127], v[126:127], v[8:9] op_sel_hi:[1,0]
	v_mfma_f32_16x16x32_bf16 v[100:103], v[88:91], v[76:79], v[100:103]
	v_cvt_pk_bf16_f32 v134, v124, v125
	s_waitcnt lgkmcnt(0)
	v_mfma_f32_16x16x32_bf16 v[104:107], v[92:95], v[44:47], v[104:107]
	v_cvt_pk_bf16_f32 v135, v126, v127
	v_mfma_f32_16x16x32_bf16 v[108:111], v[92:95], v[76:79], v[108:111]
	buffer_store_dwordx4 v[132:135], v6, s[4:7], s79 offen offset:1024 sc1
	v_pk_mul_f32 v[96:97], v[96:97], v[8:9] op_sel_hi:[1,0]
	v_pk_mul_f32 v[98:99], v[98:99], v[8:9] op_sel_hi:[1,0]
	v_cvt_pk_bf16_f32 v128, v96, v97
	v_cvt_pk_bf16_f32 v129, v98, v99
	v_pk_mul_f32 v[104:105], v[104:105], v[8:9] op_sel_hi:[1,0]
	v_pk_mul_f32 v[106:107], v[106:107], v[8:9] op_sel_hi:[1,0]
	v_cvt_pk_bf16_f32 v130, v104, v105
	v_cvt_pk_bf16_f32 v131, v106, v107
	buffer_store_dwordx4 v[128:131], v6, s[4:7], s77 offen offset:2048 sc1
	v_pk_mul_f32 v[100:101], v[100:101], v[8:9] op_sel_hi:[1,0]
	v_pk_mul_f32 v[102:103], v[102:103], v[8:9] op_sel_hi:[1,0]
	v_cvt_pk_bf16_f32 v132, v100, v101
	v_cvt_pk_bf16_f32 v133, v102, v103
	v_pk_mul_f32 v[108:109], v[108:109], v[8:9] op_sel_hi:[1,0]
	v_pk_mul_f32 v[110:111], v[110:111], v[8:9] op_sel_hi:[1,0]
	v_cvt_pk_bf16_f32 v134, v108, v109
	v_cvt_pk_bf16_f32 v135, v110, v111
	buffer_store_dwordx4 v[132:135], v6, s[4:7], s79 offen offset:2048 sc1
	v_readfirstlane_b32 s86, v220
	s_nop 0
	s_cmp_lg_u32 s86, 31
	s_cbranch_scc1 Lcl_1
	v_mov_b32 v224, s84
	v_mov_b32 v225, 0
	buffer_atomic_cmpswap v[224:225], v221, s[80:83], 0 offen offset:64
Lcl_1:
	s_branch Lprep_end
Lprep_arm:
	v_lshlrev_b32 v6, 4, v0
	v_mov_b32 v8, -1
	v_mov_b32 v12, 0
	v_mov_b32 v9, -1
	v_mov_b32 v13, 0
	v_mov_b32 v10, -1
	v_mov_b32 v14, 0
	v_mov_b32 v11, -1
	v_mov_b32 v15, 0
	s_lshl_b32 s40, s35, 10
	s_add_u32 s40, s40, 60268544
	buffer_store_dwordx4 v[12:15], v6, s[4:7], s40 offen sc1
	s_lshl_b32 s35, s35, 2
	s_add_u32 s35, s35, s33
	s_mul_i32 s40, s35, 7168
	s_add_u32 s40, s40, 49086464
	buffer_store_dwordx4 v[8:11], v6, s[4:7], s40 offen offset:0 sc1
	buffer_store_dwordx4 v[8:11], v6, s[4:7], s40 offen offset:1024 sc1
	buffer_store_dwordx4 v[8:11], v6, s[4:7], s40 offen offset:2048 sc1
	buffer_store_dwordx4 v[8:11], v6, s[4:7], s40 offen offset:3072 sc1
	s_add_u32 s40, s40, 4096
	buffer_store_dwordx4 v[8:11], v6, s[4:7], s40 offen offset:0 sc1
	buffer_store_dwordx4 v[8:11], v6, s[4:7], s40 offen offset:1024 sc1
	buffer_store_dwordx4 v[8:11], v6, s[4:7], s40 offen offset:2048 sc1
	s_min_u32 s40, s35, 79
	s_lshl_b32 s40, s40, 11
	s_add_u32 s40, s40, 56426496
	buffer_store_dwordx4 v[8:11], v6, s[4:7], s40 offen offset:0 sc1
	buffer_store_dwordx4 v[8:11], v6, s[4:7], s40 offen offset:1024 sc1
	s_waitcnt vmcnt(10)
	v_readfirstlane_b32 s86, v220
	s_nop 0
	s_cmp_lg_u32 s86, 31
	s_cbranch_scc1 Lcl_2
	v_mov_b32 v224, s84
	v_mov_b32 v225, 0
	buffer_atomic_cmpswap v[224:225], v221, s[80:83], 0 offen offset:64
Lcl_2:
	s_waitcnt vmcnt(0)
	s_barrier
	v_mov_b32 v9, 1
	buffer_atomic_add v9, v221, s[80:83], 0 offen offset:72
	s_mov_b32 s87, 60299328
Lprep_end:
	s_mov_b32 s92, s88
	s_load_dwordx4 s[60:63], s[0:1], 0
	s_load_dwordx2 s[64:65], s[0:1], 72
	s_load_dwordx4 s[88:91], s[0:1], 88
	s_load_dwordx2 s[70:71], s[0:1], 104
	s_load_dwordx4 s[72:75], s[0:1], 112
	s_waitcnt lgkmcnt(0)
	s_mov_b64 s[66:67], s[88:89]
	s_mov_b64 s[68:69], s[90:91]
	s_mov_b32 s8, s60
	s_and_b32 s9, s61, 0xffff
	s_mov_b32 s10, 1835008
	s_mov_b32 s11, 0x00020000
	s_mov_b32 s48, s62
	s_and_b32 s49, s63, 0xffff
	s_mov_b32 s50, 7168
	s_mov_b32 s51, 0x00020000
	s_mov_b32 s44, s72
	s_and_b32 s45, s73, 0xffff
	s_mov_b32 s46, 256
	s_mov_b32 s47, 0x00020000
	s_mov_b32 s4, s74
	s_and_b32 s5, s75, 0xffff
	s_mov_b32 s6, 62431232
	s_mov_b32 s7, 0x00020000
	s_waitcnt vmcnt(0)
	s_barrier
	s_cmp_lg_u32 s33, 0
	s_cbranch_scc1 Lel_done
	s_mov_b32 s40, s84
	s_mov_b32 s42, s86
	s_mov_b32 s43, 0x400000
	v_mov_b32 v2, 0
Lel_poll:
	buffer_load_dwordx4 v[4:7], v2, s[44:47], 0 offen offset:64 sc1
	s_sub_u32 s43, s43, 1
	s_cbranch_scc1 Lel_out
	s_waitcnt vmcnt(0)
	v_cmp_eq_u32 vcc, 0, v4
	s_cbranch_vccnz Lel_poll
	v_cmp_gt_u32 vcc, 32, v6
	s_cbranch_vccnz Lel_poll
Lel_out:
	s_waitcnt vmcnt(0)
	v_mov_b32 v3, 1
	buffer_atomic_add v3, v221, s[4:7], s87 offen
	v_mov_b32 v8, s92
	buffer_atomic_add v8, v221, s[4:7], s87 offen offset:4
	v_readfirstlane_b32 s41, v4
	s_cmp_ge_u32 s42, 32
	s_cbranch_scc1 Lel_over
	s_mov_b32 s38, s40
Lel_map:
	s_cmp_gt_u32 s38, s41
	s_cselect_b32 s43, 1, 0
	s_sub_u32 s43, s38, s43
	s_cmp_eq_u32 s38, s41
	s_cselect_b32 s43, 0, s43
	s_lshl_b32 s43, s43, 5
	s_add_u32 s42, s42, s43
	v_mov_b32 v3, s42
	v_mov_b32 v2, 149504
	ds_write_b32 v2, v3
	s_waitcnt lgkmcnt(0)
Lel_done:
	s_barrier
	v_mov_b32 v2, 149504
	ds_read_b32 v3, v2
	s_waitcnt lgkmcnt(0)
	v_readfirstlane_b32 s32, v3
	s_barrier
	s_mov_b32 s3, s32
	s_cmp_lt_u32 s32, 16
	s_cbranch_scc1 Lca_j
	s_cmp_lt_u32 s32, 30
	s_cbranch_scc1 Lcb_j
	s_cmp_lt_u32 s32, 32
	s_cbranch_scc1 Lax_j
	s_cmp_lt_u32 s32, 96
	s_cbranch_scc1 Lbw_j
	s_cmp_lt_u32 s32, 160
	s_cbranch_scc1 Lmlp_j
	s_cmp_lt_u32 s32, 224
	s_cbranch_scc1 Law_j
	s_cmp_lt_u32 s32, 252
	s_cbranch_scc1 Lfin_j
Lexit:
	s_endpgm
Lel_over:
	v_mov_b32 v2, 0x80000000
	v_cmp_eq_u32 vcc, 0, v0
	s_nop 1
	v_cndmask_b32 v2, v2, v0, vcc
	v_mov_b32 v3, 1
	buffer_atomic_add v3, v2, s[44:47], 0 offen offset:68 sc0
	s_waitcnt vmcnt(0)
	v_readfirstlane_b32 s39, v3
	v_lshlrev_b32 v2, 2, v0
	s_mov_b32 s43, 0x400000
Lel_ow:
	buffer_load_dword v3, v2, s[44:47], 0 offen sc1
	s_waitcnt vmcnt(0)
	s_mov_b32 s38, 0
	v_readlane_b32 s42, v3, 0
	s_nop 0
	s_add_u32 s38, s38, s42
	v_readlane_b32 s42, v3, 1
	s_nop 0
	s_add_u32 s38, s38, s42
	v_readlane_b32 s42, v3, 2
	s_nop 0
	s_add_u32 s38, s38, s42
	v_readlane_b32 s42, v3, 3
	s_nop 0
	s_add_u32 s38, s38, s42
	v_readlane_b32 s42, v3, 36
	s_nop 0
	s_add_u32 s38, s38, s42
	v_readlane_b32 s42, v3, 37
	s_nop 0
	s_add_u32 s38, s38, s42
	v_readlane_b32 s42, v3, 38
	s_nop 0
	s_add_u32 s38, s38, s42
	v_readlane_b32 s42, v3, 39
	s_nop 0
	s_add_u32 s38, s38, s42
	s_cmp_ge_u32 s38, 256
	s_cbranch_scc1 Lel_oh
	s_sub_u32 s43, s43, 1
	s_cbranch_scc0 Lel_ow
Lel_oh:
	v_readlane_b32 s42, v3, 0
	s_nop 0
	s_min_u32 s42, s42, 32
	s_sub_u32 s43, 32, s42
	s_cmp_lt_u32 s39, s43
	s_cbranch_scc0 Lel_on0
	s_add_u32 s42, s42, s39
	s_mov_b32 s38, 1
	s_branch Lel_map
Lel_on0:
	s_sub_u32 s39, s39, s43
	v_readlane_b32 s42, v3, 1
	s_nop 0
	s_min_u32 s42, s42, 32
	s_sub_u32 s43, 32, s42
	s_cmp_lt_u32 s39, s43
	s_cbranch_scc0 Lel_on1
	s_add_u32 s42, s42, s39
	s_mov_b32 s38, 2
	s_branch Lel_map
Lel_on1:
	s_sub_u32 s39, s39, s43
	v_readlane_b32 s42, v3, 2
	s_nop 0
	s_min_u32 s42, s42, 32
	s_sub_u32 s43, 32, s42
	s_cmp_lt_u32 s39, s43
	s_cbranch_scc0 Lel_on2
	s_add_u32 s42, s42, s39
	s_mov_b32 s38, 3
	s_branch Lel_map
Lel_on2:
	s_sub_u32 s39, s39, s43
	v_readlane_b32 s42, v3, 3
	s_nop 0
	s_min_u32 s42, s42, 32
	s_sub_u32 s43, 32, s42
	s_cmp_lt_u32 s39, s43
	s_cbranch_scc0 Lel_on3
	s_add_u32 s42, s42, s39
	s_mov_b32 s38, 4
	s_branch Lel_map
Lel_on3:
	s_sub_u32 s39, s39, s43
	v_readlane_b32 s42, v3, 36
	s_nop 0
	s_min_u32 s42, s42, 32
	s_sub_u32 s43, 32, s42
	s_cmp_lt_u32 s39, s43
	s_cbranch_scc0 Lel_on4
	s_add_u32 s42, s42, s39
	s_mov_b32 s38, 5
	s_branch Lel_map
Lel_on4:
	s_sub_u32 s39, s39, s43
	v_readlane_b32 s42, v3, 37
	s_nop 0
	s_min_u32 s42, s42, 32
	s_sub_u32 s43, 32, s42
	s_cmp_lt_u32 s39, s43
	s_cbranch_scc0 Lel_on5
	s_add_u32 s42, s42, s39
	s_mov_b32 s38, 6
	s_branch Lel_map
Lel_on5:
	s_sub_u32 s39, s39, s43
	v_readlane_b32 s42, v3, 38
	s_nop 0
	s_min_u32 s42, s42, 32
	s_sub_u32 s43, 32, s42
	s_cmp_lt_u32 s39, s43
	s_cbranch_scc0 Lel_on6
	s_add_u32 s42, s42, s39
	s_mov_b32 s38, 7
	s_branch Lel_map
Lel_on6:
	s_sub_u32 s39, s39, s43
	v_readlane_b32 s42, v3, 39
	s_nop 0
	s_min_u32 s42, s42, 32
	s_sub_u32 s43, 32, s42
	s_cmp_lt_u32 s39, s43
	s_cbranch_scc0 Lel_on7
	s_add_u32 s42, s42, s39
	s_mov_b32 s38, 8
	s_branch Lel_map
Lel_on7:
	s_sub_u32 s39, s39, s43
	s_mov_b32 s42, 300
	s_mov_b32 s38, s41
	s_branch Lel_map
Lax_j:
	s_sub_u32 s32, s32, 30
	s_lshl_b32 s24, s32, 2
	s_add_u32 s24, s24, s33
	v_lshlrev_b32 v4, 4, v0
	v_mov_b32 v5, 0x80000000
	v_mov_b32 v12, -1
	v_mov_b32 v13, -1
	v_mov_b32 v14, -1
	v_mov_b32 v15, -1
	s_lshl_b32 s40, s24, 10
	s_add_u32 s41, s40, 50003968
	buffer_load_dwordx4 v[24:27], v4, s[4:7], s41 offen sc1
	s_add_u32 s41, s40, 50012160
	buffer_load_dwordx4 v[24:27], v4, s[4:7], s41 offen sc1
	s_add_u32 s41, s40, 50020352
	buffer_load_dwordx4 v[24:27], v4, s[4:7], s41 offen sc1
	s_add_u32 s41, s40, 50593792
	buffer_load_dwordx4 v[24:27], v4, s[4:7], s41 offen sc1
	s_add_u32 s41, s40, 50601984
	buffer_load_dwordx4 v[24:27], v4, s[4:7], s41 offen sc1
	s_add_u32 s41, s40, 50610176
	buffer_load_dwordx4 v[24:27], v4, s[4:7], s41 offen sc1
	s_add_u32 s41, s40, 50618368
	buffer_load_dwordx4 v[24:27], v4, s[4:7], s41 offen sc1
	s_add_u32 s41, s40, 50626560
	buffer_load_dwordx4 v[24:27], v4, s[4:7], s41 offen sc1
	s_add_u32 s41, s40, 50634752
	buffer_load_dwordx4 v[24:27], v4, s[4:7], s41 offen sc1
	s_add_u32 s41, s40, 50642944
	buffer_load_dwordx4 v[24:27], v4, s[4:7], s41 offen sc1
	s_add_u32 s41, s40, 50651136
	buffer_load_dwordx4 v[24:27], v4, s[4:7], s41 offen sc1
	s_add_u32 s41, s40, 50659328
	buffer_load_dwordx4 v[24:27], v4, s[4:7], s41 offen sc1
	s_add_u32 s41, s40, 50667520
	buffer_load_dwordx4 v[24:27], v4, s[4:7], s41 offen sc1
	s_add_u32 s41, s40, 50675712
	buffer_load_dwordx4 v[24:27], v4, s[4:7], s41 offen sc1
	s_add_u32 s41, s40, 50683904
	buffer_load_dwordx4 v[24:27], v4, s[4:7], s41 offen sc1
	s_waitcnt vmcnt(0)
	s_add_u32 s41, s40, 50003968
	buffer_store_dwordx4 v[12:15], v4, s[4:7], s41 offen
	s_add_u32 s41, s40, 50012160
	buffer_store_dwordx4 v[12:15], v4, s[4:7], s41 offen
	s_add_u32 s41, s40, 50020352
	buffer_store_dwordx4 v[12:15], v4, s[4:7], s41 offen
	s_add_u32 s41, s40, 50593792
	buffer_store_dwordx4 v[12:15], v4, s[4:7], s41 offen
	s_add_u32 s41, s40, 50601984
	buffer_store_dwordx4 v[12:15], v4, s[4:7], s41 offen
	s_add_u32 s41, s40, 50610176
	buffer_store_dwordx4 v[12:15], v4, s[4:7], s41 offen
	s_add_u32 s41, s40, 50618368
	buffer_store_dwordx4 v[12:15], v4, s[4:7], s41 offen
	s_add_u32 s41, s40, 50626560
	buffer_store_dwordx4 v[12:15], v4, s[4:7], s41 offen
	s_add_u32 s41, s40, 50634752
	buffer_store_dwordx4 v[12:15], v4, s[4:7], s41 offen
	s_add_u32 s41, s40, 50642944
	buffer_store_dwordx4 v[12:15], v4, s[4:7], s41 offen
	s_add_u32 s41, s40, 50651136
	buffer_store_dwordx4 v[12:15], v4, s[4:7], s41 offen
	s_add_u32 s41, s40, 50659328
	buffer_store_dwordx4 v[12:15], v4, s[4:7], s41 offen
	s_add_u32 s41, s40, 50667520
	buffer_store_dwordx4 v[12:15], v4, s[4:7], s41 offen
	s_add_u32 s41, s40, 50675712
	buffer_store_dwordx4 v[12:15], v4, s[4:7], s41 offen
	s_add_u32 s41, s40, 50683904
	buffer_store_dwordx4 v[12:15], v4, s[4:7], s41 offen
	s_waitcnt vmcnt(0)
	v_cmp_eq_u32 vcc, 0, v0
	s_nop 1
	v_cndmask_b32 v6, v5, v0, vcc
	v_mov_b32 v7, 1
	buffer_atomic_add v7, v6, s[44:47], 0 offen offset:128
	s_mov_b32 s25, s40
	v_mov_b32 v24, 0
	s_mov_b32 s40, 0x100000
Lrw_3:
	buffer_load_dword v25, v24, s[44:47], 0 offen offset:128 sc1
	s_sub_u32 s40, s40, 1
	s_cbranch_scc1 Lrx_4
	s_waitcnt vmcnt(0)
	v_cmp_gt_u32 vcc, 8, v25
	s_cbranch_vccnz Lrw_3
Lrx_4:
	s_waitcnt vmcnt(0)
	s_mov_b32 s40, s25
	s_mov_b32 s13, 0x400000
	v_mov_b32 v11, 0
	s_cmp_eq_u32 s24, 7
	s_cbranch_scc0 Lax_exp
	v_mul_u32_u24 v8, 1280, v0
	v_cmp_gt_u32 vcc, 8, v0
	s_nop 1
	v_cndmask_b32 v8, v5, v8, vcc
	s_mov_b32 s23, 60268544
	s_mov_b32 s30, 50676024
	s_mov_b32 s12, -1
	v_lshlrev_b32 v10, 7, v0
Lax_rw:
	buffer_load_dword v9, v10, s[4:7], s23 offen sc1
	s_sub_u32 s13, s13, 1
	s_cbranch_scc1 Lax_end
	s_waitcnt vmcnt(0)
	v_cmp_gt_u32 vcc, 64, v9
	s_nop 0
	s_ff1_i32_b64 s41, vcc
	s_cmp_lt_i32 s41, 0
	s_cselect_b32 s41, 102, s41
	s_sub_u32 s41, s41, 2
	s_cmp_le_i32 s41, s12
	s_cbranch_scc1 Lax_rs
	s_mov_b32 s12, s41
	v_mov_b32 v9, s12
	buffer_store_dword v9, v8, s[4:7], s30 offen
	buffer_store_dword v9, v8, s[4:7], s30 offen offset:256
Lax_rs:
	s_cmp_lt_i32 s12, 0
	s_cbranch_scc1 Lax_rw
	s_sleep 12
	s_cmp_lt_i32 s12, 100
	s_cbranch_scc1 Lax_rw
	s_branch Lax_end
Lax_exp:
	s_add_u32 s20, s40, 49545216
	s_mov_b32 s21, 50003968
	s_add_u32 s22, s40, 50044928
	s_mul_i32 s15, s24, 4736
	s_min_u32 s15, s15, 28032
	s_add_u32 s15, s15, 60366848
	s_mov_b32 s30, 50675712
	s_lshl_b32 s42, s24, 6
	v_add_u32 v22, s42, v0
	v_mul_u32_u24 v23, 293, v22
	v_lshrrev_b32 v23, 14, v23
	v_mul_u32_u24 v24, 56, v23
	v_sub_u32 v22, v22, v24
	v_lshrrev_b32 v24, 1, v22
	v_lshlrev_b32 v24, 8, v24
	v_lshrrev_b32 v25, 1, v23
	v_lshl_add_u32 v24, v25, 6, v24
	v_and_b32 v25, 1, v23
	v_lshl_add_u32 v24, v25, 4, v24
	v_and_b32 v22, 1, v22
	v_lshl_add_u32 v22, v22, 3, v24
	v_lshlrev_b32 v8, 7, v0
	v_cmp_gt_u32 vcc, 37, v0
	s_nop 1
	v_cndmask_b32 v9, v5, v8, vcc
	v_cmp_gt_u32 vcc, 8, v0
	s_nop 1
	v_cndmask_b32 v10, v5, v8, vcc
	v_min_u32 v21, 13, v0
	v_lshlrev_b32 v21, 2, v21
	v_min_u32 v18, 14, v0
	v_lshlrev_b32 v18, 2, v18
	v_cmp_le_u32 vcc, 14, v0
	s_nop 1
	v_cndmask_b32 v20, 0, 1, vcc
	s_lshl_b32 s26, s24, 15
	s_add_u32 s26, s26, 13533184
Lax_warm:
	s_mul_i32 s41, s24, 14080
	s_add_u32 s41, s41, 50593792
	buffer_load_dword v24, v8, s[4:7], s41 offen sc1
	s_add_u32 s41, s41, 7040
	buffer_load_dword v24, v8, s[4:7], s41 offen sc1
	s_mul_i32 s41, s24, 7040
	s_add_u32 s41, s41, 50003968
	buffer_load_dword v24, v8, s[4:7], s41 offen sc1
	buffer_load_dword v16, v21, s[4:7], s30 offen offset:256 sc1
	s_sub_u32 s13, s13, 1
	s_cbranch_scc1 Lax_end
	s_waitcnt vmcnt(0)
	v_cmp_gt_i32 vcc, 0, v16
	s_cbranch_vccz Lax_go
	s_sleep 8
	s_branch Lax_warm
Lax_go:
	s_mov_b32 s12, 0
Lax_loop:
	buffer_load_dword v16, v18, s[4:7], s30 offen offset:512 sc1
	s_sub_u32 s13, s13, 1
	s_cbranch_scc1 Lax_end
	s_waitcnt vmcnt(0)
	v_sub_u32 v16, v16, v20
	v_cmp_gt_i32 vcc, s12, v16
	s_cbranch_vccnz Lax_loop
Lax_data:
	buffer_load_dwordx2 v[24:25], v22, s[4:7], s21 offen offset:0 sc1
	buffer_load_dwordx2 v[26:27], v22, s[4:7], s21 offen offset:32 sc1
	s_sub_u32 s13, s13, 1
	s_cbranch_scc1 Lax_end
	s_waitcnt vmcnt(0)
	v_dot2_f32_bf16 v28, v24, v25, 0
	v_dot2_f32_bf16 v28, v26, v27, v28
	v_swap_b32 v25, v26
	s_nop 1
	v_cmp_u_f32 vcc, v28, v28
	s_cbranch_vccnz Lax_data
	buffer_store_dwordx4 v[24:27], v4, s[4:7], s20 offen sc1
	s_add_u32 s26, s26, 458752
	s_min_u32 s26, s26, 41746432
	buffer_load_dword v17, v9, s[4:7], s15 offen sc1
	s_add_u32 s15, s15, 32768
	buffer_load_dword v19, v10, s[4:7], s22 offen sc1
	s_add_u32 s22, s22, 8192
	s_add_u32 s20, s20, 7168
	s_add_u32 s21, s21, 8192
	s_add_u32 s12, s12, 1
	s_cmp_lt_u32 s12, 64
	s_cbranch_scc1 Lax_loop
Lax_end:
	s_waitcnt vmcnt(0)
	s_endpgm
Lfin_j:
	s_sub_u32 s32, s32, 224
	s_mov_b32 s35, s32
	s_load_dwordx2 s[76:77], s[0:1], 64
	s_load_dwordx2 s[78:79], s[0:1], 80
	v_lshlrev_b32 v6, 4, v0
	s_waitcnt lgkmcnt(0)
	s_mov_b32 s20, s76
	s_and_b32 s21, s77, 0xffff
	s_mov_b32 s22, 1605632
	s_mov_b32 s23, 0x00020000
	s_mov_b32 s12, s78
	s_and_b32 s13, s79, 0xffff
	s_mov_b32 s14, 1605632
	s_mov_b32 s15, 0x00020000
	v_lshrrev_b32 v2, 4, v0
	s_lshl_b32 s42, s33, 10
	v_lshrrev_b32 v7, 3, v0
	v_mul_u32_u24 v7, 3584, v7
	v_and_b32 v8, 7, v0
	v_lshl_add_u32 v7, v8, 4, v7
	s_lshl_b32 s44, s35, 7
	s_mul_i32 s45, s33, 28672
	s_add_u32 s44, s44, s45
	s_add_u32 m0, s42, 0
	s_add_u32 s43, s44, 0
	buffer_load_dwordx4 v7, s[20:23], s43 offen nt lds
	s_add_u32 m0, s42, 4096
	s_add_u32 s43, s44, 114688
	buffer_load_dwordx4 v7, s[20:23], s43 offen nt lds
	s_add_u32 m0, s42, 8192
	s_add_u32 s43, s44, 229376
	buffer_load_dwordx4 v7, s[20:23], s43 offen nt lds
	s_add_u32 m0, s42, 12288
	s_add_u32 s43, s44, 344064
	buffer_load_dwordx4 v7, s[20:23], s43 offen nt lds
	s_add_u32 m0, s42, 16384
	s_add_u32 s43, s44, 458752
	buffer_load_dwordx4 v7, s[20:23], s43 offen nt lds
	s_add_u32 m0, s42, 20480
	s_add_u32 s43, s44, 573440
	buffer_load_dwordx4 v7, s[20:23], s43 offen nt lds
	s_add_u32 m0, s42, 24576
	s_add_u32 s43, s44, 688128
	buffer_load_dwordx4 v7, s[20:23], s43 offen nt lds
	s_add_u32 m0, s42, 28672
	s_add_u32 s43, s44, 802816
	buffer_load_dwordx4 v7, s[20:23], s43 offen nt lds
	s_add_u32 m0, s42, 32768
	s_add_u32 s43, s44, 917504
	buffer_load_dwordx4 v7, s[20:23], s43 offen nt lds
	s_add_u32 m0, s42, 36864
	s_add_u32 s43, s44, 1032192
	buffer_load_dwordx4 v7, s[20:23], s43 offen nt lds
	s_add_u32 m0, s42, 40960
	s_add_u32 s43, s44, 1146880
	buffer_load_dwordx4 v7, s[20:23], s43 offen nt lds
	s_add_u32 m0, s42, 45056
	s_add_u32 s43, s44, 1261568
	buffer_load_dwordx4 v7, s[20:23], s43 offen nt lds
	s_add_u32 m0, s42, 49152
	s_add_u32 s43, s44, 1376256
	buffer_load_dwordx4 v7, s[20:23], s43 offen nt lds
	s_add_u32 m0, s42, 53248
	s_add_u32 s43, s44, 1490944
	buffer_load_dwordx4 v7, s[20:23], s43 offen nt lds
	s_mul_i32 s44, s35, 57344
	s_add_u32 s44, s44, s42
	s_add_u32 m0, s42, 57344
	s_add_u32 s43, s44, 0
	buffer_load_dwordx4 v6, s[12:15], s43 offen nt lds
	s_add_u32 m0, s42, 61440
	s_add_u32 s43, s44, 4096
	buffer_load_dwordx4 v6, s[12:15], s43 offen nt lds
	s_add_u32 m0, s42, 65536
	s_add_u32 s43, s44, 8192
	buffer_load_dwordx4 v6, s[12:15], s43 offen nt lds
	s_add_u32 m0, s42, 69632
	s_add_u32 s43, s44, 12288
	buffer_load_dwordx4 v6, s[12:15], s43 offen nt lds
	s_add_u32 m0, s42, 73728
	s_add_u32 s43, s44, 16384
	buffer_load_dwordx4 v6, s[12:15], s43 offen nt lds
	s_add_u32 m0, s42, 77824
	s_add_u32 s43, s44, 20480
	buffer_load_dwordx4 v6, s[12:15], s43 offen nt lds
	s_add_u32 m0, s42, 81920
	s_add_u32 s43, s44, 24576
	buffer_load_dwordx4 v6, s[12:15], s43 offen nt lds
	s_add_u32 m0, s42, 86016
	s_add_u32 s43, s44, 28672
	buffer_load_dwordx4 v6, s[12:15], s43 offen nt lds
	s_add_u32 m0, s42, 90112
	s_add_u32 s43, s44, 32768
	buffer_load_dwordx4 v6, s[12:15], s43 offen nt lds
	s_add_u32 m0, s42, 94208
	s_add_u32 s43, s44, 36864
	buffer_load_dwordx4 v6, s[12:15], s43 offen nt lds
	s_add_u32 m0, s42, 98304
	s_add_u32 s43, s44, 40960
	buffer_load_dwordx4 v6, s[12:15], s43 offen nt lds
	s_add_u32 m0, s42, 102400
	s_add_u32 s43, s44, 45056
	buffer_load_dwordx4 v6, s[12:15], s43 offen nt lds
	s_add_u32 m0, s42, 106496
	s_add_u32 s43, s44, 49152
	buffer_load_dwordx4 v6, s[12:15], s43 offen nt lds
	s_add_u32 m0, s42, 110592
	s_add_u32 s43, s44, 53248
	buffer_load_dwordx4 v6, s[12:15], s43 offen nt lds
	s_lshr_b32 s46, s33, 1
	s_and_b32 s47, s33, 1
	v_bfe_u32 v14, v0, 2, 2
	v_lshl_add_u32 v14, v2, 3, v14
	v_and_b32 v15, 3, v0
	v_lshlrev_b32 v10, 7, v14
	v_lshl_add_u32 v10, v15, 4, v10
	s_lshl_b32 s40, s46, 6
	s_lshl_b32 s43, s47, 3
	s_add_u32 s40, s40, s43
	v_add_u32 v10, s40, v10
	v_mul_u32_u24 v11, 896, v14
	v_lshl_add_u32 v11, v15, 3, v11
	s_mul_i32 s40, s46, 28672
	s_mul_i32 s43, s47, 448
	s_add_u32 s40, s40, s43
	s_add_u32 s40, s40, 57344
	v_add_u32 v11, s40, v11
	s_lshl_b32 s40, s35, 1
	s_add_u32 s40, s40, s46
	s_mul_i32 s40, s40, 57344
	s_mul_i32 s43, s47, 14336
	s_add_u32 s40, s40, s43
	s_add_u32 s40, s40, 50757632
	s_waitcnt vmcnt(0)
	s_barrier
	ds_read_b64_tr_b16 v[16:17], v10 offset:0
	ds_read_b64_tr_b16 v[18:19], v10 offset:512
	ds_read_b64_tr_b16 v[20:21], v10 offset:4096
	ds_read_b64_tr_b16 v[22:23], v10 offset:4608
	ds_read_b64_tr_b16 v[24:25], v10 offset:8192
	ds_read_b64_tr_b16 v[26:27], v10 offset:8704
	ds_read_b64_tr_b16 v[28:29], v10 offset:12288
	ds_read_b64_tr_b16 v[30:31], v10 offset:12800
	ds_read_b64_tr_b16 v[32:33], v10 offset:16384
	ds_read_b64_tr_b16 v[34:35], v10 offset:16896
	ds_read_b64_tr_b16 v[36:37], v10 offset:20480
	ds_read_b64_tr_b16 v[38:39], v10 offset:20992
	ds_read_b64_tr_b16 v[40:41], v10 offset:24576
	ds_read_b64_tr_b16 v[42:43], v10 offset:25088
	ds_read_b64_tr_b16 v[44:45], v10 offset:28672
	ds_read_b64_tr_b16 v[46:47], v10 offset:29184
	ds_read_b64_tr_b16 v[48:49], v10 offset:32768
	ds_read_b64_tr_b16 v[50:51], v10 offset:33280
	ds_read_b64_tr_b16 v[52:53], v10 offset:36864
	ds_read_b64_tr_b16 v[54:55], v10 offset:37376
	ds_read_b64_tr_b16 v[56:57], v10 offset:40960
	ds_read_b64_tr_b16 v[58:59], v10 offset:41472
	ds_read_b64_tr_b16 v[60:61], v10 offset:45056
	ds_read_b64_tr_b16 v[62:63], v10 offset:45568
	ds_read_b64_tr_b16 v[64:65], v10 offset:49152
	ds_read_b64_tr_b16 v[66:67], v10 offset:49664
	ds_read_b64_tr_b16 v[68:69], v10 offset:53248
	ds_read_b64_tr_b16 v[70:71], v10 offset:53760
	ds_read_b64_tr_b16 v[72:73], v11 offset:0
	ds_read_b64_tr_b16 v[74:75], v11 offset:3584
	ds_read_b64_tr_b16 v[76:77], v11 offset:32
	ds_read_b64_tr_b16 v[78:79], v11 offset:3616
	ds_read_b64_tr_b16 v[80:81], v11 offset:64
	ds_read_b64_tr_b16 v[82:83], v11 offset:3648
	ds_read_b64_tr_b16 v[84:85], v11 offset:96
	ds_read_b64_tr_b16 v[86:87], v11 offset:3680
	ds_read_b64_tr_b16 v[88:89], v11 offset:128
	ds_read_b64_tr_b16 v[90:91], v11 offset:3712
	ds_read_b64_tr_b16 v[92:93], v11 offset:160
	ds_read_b64_tr_b16 v[94:95], v11 offset:3744
	ds_read_b64_tr_b16 v[96:97], v11 offset:192
	ds_read_b64_tr_b16 v[98:99], v11 offset:3776
	ds_read_b64_tr_b16 v[100:101], v11 offset:224
	ds_read_b64_tr_b16 v[102:103], v11 offset:3808
	ds_read_b64_tr_b16 v[104:105], v11 offset:256
	ds_read_b64_tr_b16 v[106:107], v11 offset:3840
	ds_read_b64_tr_b16 v[108:109], v11 offset:288
	ds_read_b64_tr_b16 v[110:111], v11 offset:3872
	ds_read_b64_tr_b16 v[112:113], v11 offset:320
	ds_read_b64_tr_b16 v[114:115], v11 offset:3904
	ds_read_b64_tr_b16 v[116:117], v11 offset:352
	ds_read_b64_tr_b16 v[118:119], v11 offset:3936
	ds_read_b64_tr_b16 v[120:121], v11 offset:384
	ds_read_b64_tr_b16 v[122:123], v11 offset:3968
	ds_read_b64_tr_b16 v[124:125], v11 offset:416
	ds_read_b64_tr_b16 v[126:127], v11 offset:4000
	s_waitcnt lgkmcnt(0)
	s_add_u32 s43, s40, 0
	buffer_store_dwordx4 v[16:19], v6, s[4:7], s43 offen sc1
	s_add_u32 s43, s40, 1024
	buffer_store_dwordx4 v[20:23], v6, s[4:7], s43 offen sc1
	s_add_u32 s43, s40, 2048
	buffer_store_dwordx4 v[24:27], v6, s[4:7], s43 offen sc1
	s_add_u32 s43, s40, 3072
	buffer_store_dwordx4 v[28:31], v6, s[4:7], s43 offen sc1
	s_add_u32 s43, s40, 4096
	buffer_store_dwordx4 v[32:35], v6, s[4:7], s43 offen sc1
	s_add_u32 s43, s40, 5120
	buffer_store_dwordx4 v[36:39], v6, s[4:7], s43 offen sc1
	s_add_u32 s43, s40, 6144
	buffer_store_dwordx4 v[40:43], v6, s[4:7], s43 offen sc1
	s_add_u32 s43, s40, 7168
	buffer_store_dwordx4 v[44:47], v6, s[4:7], s43 offen sc1
	s_add_u32 s43, s40, 8192
	buffer_store_dwordx4 v[48:51], v6, s[4:7], s43 offen sc1
	s_add_u32 s43, s40, 9216
	buffer_store_dwordx4 v[52:55], v6, s[4:7], s43 offen sc1
	s_add_u32 s43, s40, 10240
	buffer_store_dwordx4 v[56:59], v6, s[4:7], s43 offen sc1
	s_add_u32 s43, s40, 11264
	buffer_store_dwordx4 v[60:63], v6, s[4:7], s43 offen sc1
	s_add_u32 s43, s40, 12288
	buffer_store_dwordx4 v[64:67], v6, s[4:7], s43 offen sc1
	s_add_u32 s43, s40, 13312
	buffer_store_dwordx4 v[68:71], v6, s[4:7], s43 offen sc1
	s_add_u32 s43, s40, 28672
	buffer_store_dwordx4 v[72:75], v6, s[4:7], s43 offen sc1
	s_add_u32 s43, s40, 29696
	buffer_store_dwordx4 v[76:79], v6, s[4:7], s43 offen sc1
	s_add_u32 s43, s40, 30720
	buffer_store_dwordx4 v[80:83], v6, s[4:7], s43 offen sc1
	s_add_u32 s43, s40, 31744
	buffer_store_dwordx4 v[84:87], v6, s[4:7], s43 offen sc1
	s_add_u32 s43, s40, 32768
	buffer_store_dwordx4 v[88:91], v6, s[4:7], s43 offen sc1
	s_add_u32 s43, s40, 33792
	buffer_store_dwordx4 v[92:95], v6, s[4:7], s43 offen sc1
	s_add_u32 s43, s40, 34816
	buffer_store_dwordx4 v[96:99], v6, s[4:7], s43 offen sc1
	s_add_u32 s43, s40, 35840
	buffer_store_dwordx4 v[100:103], v6, s[4:7], s43 offen sc1
	s_add_u32 s43, s40, 36864
	buffer_store_dwordx4 v[104:107], v6, s[4:7], s43 offen sc1
	s_add_u32 s43, s40, 37888
	buffer_store_dwordx4 v[108:111], v6, s[4:7], s43 offen sc1
	s_add_u32 s43, s40, 38912
	buffer_store_dwordx4 v[112:115], v6, s[4:7], s43 offen sc1
	s_add_u32 s43, s40, 39936
	buffer_store_dwordx4 v[116:119], v6, s[4:7], s43 offen sc1
	s_add_u32 s43, s40, 40960
	buffer_store_dwordx4 v[120:123], v6, s[4:7], s43 offen sc1
	s_add_u32 s43, s40, 41984
	buffer_store_dwordx4 v[124:127], v6, s[4:7], s43 offen sc1
	v_mov_b32 v9, 0x80000000
	v_cmp_eq_u32 vcc, 0, v0
	s_nop 1
	v_cndmask_b32 v8, v9, v0, vcc
	s_mov_b32 s40, 60299264
	s_waitcnt vmcnt(0)
	v_mov_b32 v9, 1
	buffer_atomic_add v9, v8, s[4:7], s40 offen
	s_barrier
Lfin_k:
	v_and_b32 v1, 15, v0
	v_lshrrev_b32 v2, 4, v0
	v_lshlrev_b32 v6, 4, v0
	v_lshrrev_b32 v7, 3, v0
	s_lshl_b32 s40, s33, 3
	v_add_u32 v7, s40, v7
	v_bfe_u32 v8, v7, 2, 2
	v_lshlrev_b32 v8, 3, v8
	v_lshrrev_b32 v9, 4, v7
	v_lshl_add_u32 v8, v9, 2, v8
	v_and_b32 v9, 3, v7
	v_add_u32 v8, v8, v9
	s_mov_b32 s40, 896
	v_mul_lo_u32 v8, v8, s40
	v_bfe_u32 v9, v7, 1, 3
	v_and_b32 v10, 7, v0
	v_xor_b32 v9, v9, v10
	v_lshl_add_u32 v3, v9, 4, v8
	v_lshrrev_b32 v9, 1, v1
	v_xor_b32 v9, v9, v2
	v_lshlrev_b32 v9, 4, v9
	v_lshl_add_u32 v4, v1, 7, v9
	v_xor_b32 v5, 64, v4
	v_mov_b32 v7, 0
	v_mov_b32 v9, 0x80000000
	v_cmp_eq_u32 vcc, 0, v0
	s_nop 1
	v_cndmask_b32 v8, v9, v0, vcc
	s_mov_b32 s16, 0x200000
	s_mov_b32 s20, s70
	s_and_b32 s21, s71, 0xffff
	s_mov_b32 s22, 1835008
	s_mov_b32 s23, 0x00020000
	s_mul_i32 s24, s32, 37
	s_lshr_b32 s24, s24, 8
	s_mul_i32 s40, s24, 7
	s_sub_u32 s25, s32, s40
	s_lshl_b32 s25, s25, 2
	s_add_u32 s25, s25, s33
	v_lshlrev_b32 v10, 2, v1
	v_lshrrev_b32 v11, 2, v1
	v_lshlrev_b32 v11, 3, v11
	v_and_b32 v12, 3, v1
	v_add_u32 v11, v11, v12
	v_mul_u32_u24 v11, 144, v11
	v_lshl_add_u32 v11, v2, 3, v11
	s_lshl_b32 s40, s33, 5
	s_add_u32 s40, s40, 40960
	v_add_u32 v11, s40, v11
	v_lshrrev_b32 v12, 3, v0
	s_lshl_b32 s40, s33, 3
	v_add_u32 v12, s40, v12
	v_and_b32 v15, 7, v0
	v_lshlrev_b32 v15, 4, v15
	v_mul_u32_u24 v14, 144, v12
	v_add_u32 v14, v14, v15
	v_add_u32 v14, 40960, v14
	v_mul_u32_u24 v12, 896, v12
	v_add_u32 v15, v15, v12
	s_mul_i32 s42, s33, 10240
	v_add_u32 v13, s42, v6
Lf_loop:
	s_lshl_b32 s41, s24, 7
	s_add_u32 s40, s41, 60268544
Lwc_5:
	buffer_load_dword v9, v7, s[4:7], s40 offen sc1
	s_waitcnt vmcnt(0)
	v_cmp_gt_u32 vcc, 64, v9
	s_cbranch_vccz Lwo_6
	s_sleep 8
	s_sub_u32 s16, s16, 1
	s_cbranch_scc0 Lwc_5
	s_mov_b32 s16, 0
Lwo_6:
	s_mul_i32 s40, s24, 458752
	s_lshl_b32 s42, s25, 14
	s_add_u32 s40, s40, s42
	s_add_u32 s40, s40, 12845056
	buffer_load_dwordx4 v[32:35], v6, s[4:7], s40 offen offset:0 sc1
	buffer_load_dwordx4 v[36:39], v6, s[4:7], s40 offen offset:1024 sc1
	buffer_load_dwordx4 v[40:43], v6, s[4:7], s40 offen offset:2048 sc1
	buffer_load_dwordx4 v[44:47], v6, s[4:7], s40 offen offset:3072 sc1
	s_add_u32 s40, s40, 4096
	buffer_load_dwordx4 v[48:51], v6, s[4:7], s40 offen offset:0 sc1
	buffer_load_dwordx4 v[52:55], v6, s[4:7], s40 offen offset:1024 sc1
	buffer_load_dwordx4 v[56:59], v6, s[4:7], s40 offen offset:2048 sc1
	buffer_load_dwordx4 v[60:63], v6, s[4:7], s40 offen offset:3072 sc1
	s_add_u32 s40, s40, 4096
	buffer_load_dwordx4 v[64:67], v6, s[4:7], s40 offen offset:0 sc1
	buffer_load_dwordx4 v[68:71], v6, s[4:7], s40 offen offset:1024 sc1
	buffer_load_dwordx4 v[72:75], v6, s[4:7], s40 offen offset:2048 sc1
	buffer_load_dwordx4 v[76:79], v6, s[4:7], s40 offen offset:3072 sc1
	s_add_u32 s40, s40, 4096
	buffer_load_dwordx4 v[80:83], v6, s[4:7], s40 offen offset:0 sc1
	buffer_load_dwordx4 v[84:87], v6, s[4:7], s40 offen offset:1024 sc1
	buffer_load_dwordx4 v[88:91], v6, s[4:7], s40 offen offset:2048 sc1
	buffer_load_dwordx4 v[92:95], v6, s[4:7], s40 offen offset:3072 sc1
	s_add_u32 s40, s41, 60286976
Lwc_7:
	buffer_load_dword v9, v7, s[4:7], s40 offen sc1
	s_waitcnt vmcnt(0)
	v_cmp_gt_u32 vcc, 4, v9
	s_cbranch_vccz Lwo_8
	s_sleep 8
	s_sub_u32 s16, s16, 1
	s_cbranch_scc0 Lwc_7
	s_mov_b32 s16, 0
Lwo_8:
	s_mul_i32 s40, s24, 57344
	s_lshl_b32 s42, s25, 11
	s_add_u32 s40, s40, s42
	s_add_u32 s40, s40, 56590336
	s_add_u32 s42, s41, 60260352
	buffer_load_dwordx4 v[112:115], v6, s[4:7], s40 offen offset:0 sc1
	buffer_load_dword v120, v10, s[4:7], s42 offen offset:0 sc1
	buffer_load_dwordx4 v[116:119], v6, s[4:7], s40 offen offset:1024 sc1
	buffer_load_dword v121, v10, s[4:7], s42 offen offset:64 sc1
	s_mul_i32 s43, s24, 114688
	s_lshl_b32 s42, s25, 12
	s_add_u32 s43, s43, s42
	s_add_u32 s43, s43, 42205184
	s_cmp_ge_u32 s24, 60
	s_cbranch_scc1 Lf_pl
	s_mov_b32 s43, 0x80000000
	s_add_u32 s40, s41, 60276736
Lwc_9:
	buffer_load_dword v9, v7, s[4:7], s40 offen sc1
	s_waitcnt vmcnt(0)
	v_cmp_gt_u32 vcc, 32, v9
	s_cbranch_vccz Lwo_10
	s_sleep 2
	s_sub_u32 s16, s16, 1
	s_cbranch_scc0 Lwc_9
	s_mov_b32 s16, 0
Lwo_10:
Lf_pl:
	s_mul_i32 s40, s24, 40960
	s_mul_i32 s42, s33, 10240
	s_add_u32 s40, s40, s42
	s_add_u32 s40, s40, 53968896
	buffer_load_dwordx4 v[160:163], v6, s[4:7], s40 offen offset:0 sc1
	buffer_load_dwordx4 v[164:167], v6, s[4:7], s40 offen offset:1024 sc1
	buffer_load_dwordx4 v[168:171], v6, s[4:7], s40 offen offset:2048 sc1
	buffer_load_dwordx4 v[172:175], v6, s[4:7], s40 offen offset:3072 sc1
	s_add_u32 s40, s40, 4096
	buffer_load_dwordx4 v[176:179], v6, s[4:7], s40 offen offset:0 sc1
	buffer_load_dwordx4 v[180:183], v6, s[4:7], s40 offen offset:1024 sc1
	buffer_load_dwordx4 v[184:187], v6, s[4:7], s40 offen offset:2048 sc1
	buffer_load_dwordx4 v[188:191], v6, s[4:7], s40 offen offset:3072 sc1
	s_add_u32 s40, s40, 4096
	buffer_load_dwordx4 v[192:195], v6, s[4:7], s40 offen offset:0 sc1
	buffer_load_dwordx4 v[196:199], v6, s[4:7], s40 offen offset:1024 sc1
	buffer_load_dwordx4 v[96:99], v6, s[4:7], s43 offen offset:0 sc1
	buffer_load_dwordx4 v[100:103], v6, s[4:7], s43 offen offset:1024 sc1
	buffer_load_dwordx4 v[104:107], v6, s[4:7], s43 offen offset:2048 sc1
	buffer_load_dwordx4 v[108:111], v6, s[4:7], s43 offen offset:3072 sc1
	s_waitcnt vmcnt(13)
	ds_write_b128 v13, v[160:163] offset:0
	v_dot2_f32_bf16 v9, v160, v161, 0
	v_dot2_f32_bf16 v9, v162, v163, v9
	s_waitcnt vmcnt(12)
	ds_write_b128 v13, v[164:167] offset:1024
	v_dot2_f32_bf16 v9, v164, v165, v9
	v_dot2_f32_bf16 v9, v166, v167, v9
	s_waitcnt vmcnt(11)
	ds_write_b128 v13, v[168:171] offset:2048
	v_dot2_f32_bf16 v9, v168, v169, v9
	v_dot2_f32_bf16 v9, v170, v171, v9
	s_waitcnt vmcnt(10)
	ds_write_b128 v13, v[172:175] offset:3072
	v_dot2_f32_bf16 v9, v172, v173, v9
	v_dot2_f32_bf16 v9, v174, v175, v9
	s_waitcnt vmcnt(9)
	ds_write_b128 v13, v[176:179] offset:4096
	v_dot2_f32_bf16 v9, v176, v177, v9
	v_dot2_f32_bf16 v9, v178, v179, v9
	s_waitcnt vmcnt(8)
	ds_write_b128 v13, v[180:183] offset:5120
	v_dot2_f32_bf16 v9, v180, v181, v9
	v_dot2_f32_bf16 v9, v182, v183, v9
	s_waitcnt vmcnt(7)
	ds_write_b128 v13, v[184:187] offset:6144
	v_dot2_f32_bf16 v9, v184, v185, v9
	v_dot2_f32_bf16 v9, v186, v187, v9
	s_waitcnt vmcnt(6)
	ds_write_b128 v13, v[188:191] offset:7168
	v_dot2_f32_bf16 v9, v188, v189, v9
	v_dot2_f32_bf16 v9, v190, v191, v9
	s_waitcnt vmcnt(5)
	ds_write_b128 v13, v[192:195] offset:8192
	v_dot2_f32_bf16 v9, v192, v193, v9
	v_dot2_f32_bf16 v9, v194, v195, v9
	s_waitcnt vmcnt(4)
	ds_write_b128 v13, v[196:199] offset:9216
	v_dot2_f32_bf16 v9, v196, v197, v9
	v_dot2_f32_bf16 v9, v198, v199, v9
	s_waitcnt vmcnt(0)
	v_dot2_f32_bf16 v9, v96, v97, v9
	v_dot2_f32_bf16 v9, v98, v99, v9
	v_dot2_f32_bf16 v9, v100, v101, v9
	v_dot2_f32_bf16 v9, v102, v103, v9
	v_dot2_f32_bf16 v9, v104, v105, v9
	v_dot2_f32_bf16 v9, v106, v107, v9
	v_dot2_f32_bf16 v9, v108, v109, v9
	v_dot2_f32_bf16 v9, v110, v111, v9
	s_nop 2
	v_cmp_u_f32 vcc, v9, v9
	s_cbranch_vccz Lf_po
	s_sub_u32 s16, s16, 1
	s_cbranch_scc0 Lf_pl
	s_mov_b32 s16, 0
Lf_po:
	s_waitcnt lgkmcnt(0)
	s_barrier
	ds_read_b128 v[124:127], v6 offset:0
	ds_read_b128 v[128:131], v6 offset:20480
	ds_read_b128 v[132:135], v6 offset:1024
	ds_read_b128 v[136:139], v6 offset:21504
	ds_read_b128 v[140:143], v6 offset:2048
	ds_read_b128 v[144:147], v6 offset:22528
	s_waitcnt lgkmcnt(5)
	v_mfma_f32_16x16x32_bf16 v[148:151], v[32:35], v[124:127], 0
	ds_read_b128 v[124:127], v6 offset:3072
	s_waitcnt lgkmcnt(5)
	v_mfma_f32_16x16x32_bf16 v[152:155], v[32:35], v[128:131], 0
	ds_read_b128 v[128:131], v6 offset:23552
	s_waitcnt lgkmcnt(5)
	v_mfma_f32_16x16x32_bf16 v[148:151], v[36:39], v[132:135], v[148:151]
	ds_read_b128 v[132:135], v6 offset:4096
	s_waitcnt lgkmcnt(5)
	v_mfma_f32_16x16x32_bf16 v[152:155], v[36:39], v[136:139], v[152:155]
	ds_read_b128 v[136:139], v6 offset:24576
	s_waitcnt lgkmcnt(5)
	v_mfma_f32_16x16x32_bf16 v[148:151], v[40:43], v[140:143], v[148:151]
	ds_read_b128 v[140:143], v6 offset:5120
	s_waitcnt lgkmcnt(5)
	v_mfma_f32_16x16x32_bf16 v[152:155], v[40:43], v[144:147], v[152:155]
	ds_read_b128 v[144:147], v6 offset:25600
	s_waitcnt lgkmcnt(5)
	v_mfma_f32_16x16x32_bf16 v[148:151], v[44:47], v[124:127], v[148:151]
	ds_read_b128 v[124:127], v6 offset:6144
	s_waitcnt lgkmcnt(5)
	v_mfma_f32_16x16x32_bf16 v[152:155], v[44:47], v[128:131], v[152:155]
	ds_read_b128 v[128:131], v6 offset:26624
	s_waitcnt lgkmcnt(5)
	v_mfma_f32_16x16x32_bf16 v[148:151], v[48:51], v[132:135], v[148:151]
	ds_read_b128 v[132:135], v6 offset:7168
	s_waitcnt lgkmcnt(5)
	v_mfma_f32_16x16x32_bf16 v[152:155], v[48:51], v[136:139], v[152:155]
	ds_read_b128 v[136:139], v6 offset:27648
	s_waitcnt lgkmcnt(5)
	v_mfma_f32_16x16x32_bf16 v[148:151], v[52:55], v[140:143], v[148:151]
	ds_read_b128 v[140:143], v6 offset:8192
	s_waitcnt lgkmcnt(5)
	v_mfma_f32_16x16x32_bf16 v[152:155], v[52:55], v[144:147], v[152:155]
	ds_read_b128 v[144:147], v6 offset:28672
	s_waitcnt lgkmcnt(5)
	v_mfma_f32_16x16x32_bf16 v[148:151], v[56:59], v[124:127], v[148:151]
	ds_read_b128 v[124:127], v6 offset:9216
	s_waitcnt lgkmcnt(5)
	v_mfma_f32_16x16x32_bf16 v[152:155], v[56:59], v[128:131], v[152:155]
	ds_read_b128 v[128:131], v6 offset:29696
	s_waitcnt lgkmcnt(5)
	v_mfma_f32_16x16x32_bf16 v[148:151], v[60:63], v[132:135], v[148:151]
	ds_read_b128 v[132:135], v6 offset:10240
	s_waitcnt lgkmcnt(5)
	v_mfma_f32_16x16x32_bf16 v[152:155], v[60:63], v[136:139], v[152:155]
	ds_read_b128 v[136:139], v6 offset:30720
	s_waitcnt lgkmcnt(5)
	v_mfma_f32_16x16x32_bf16 v[148:151], v[64:67], v[140:143], v[148:151]
	ds_read_b128 v[140:143], v6 offset:11264
	s_waitcnt lgkmcnt(5)
	v_mfma_f32_16x16x32_bf16 v[152:155], v[64:67], v[144:147], v[152:155]
	ds_read_b128 v[144:147], v6 offset:31744
	s_waitcnt lgkmcnt(5)
	v_mfma_f32_16x16x32_bf16 v[148:151], v[68:71], v[124:127], v[148:151]
	ds_read_b128 v[124:127], v6 offset:12288
	s_waitcnt lgkmcnt(5)
	v_mfma_f32_16x16x32_bf16 v[152:155], v[68:71], v[128:131], v[152:155]
	ds_read_b128 v[128:131], v6 offset:32768
	s_waitcnt lgkmcnt(5)
	v_mfma_f32_16x16x32_bf16 v[148:151], v[72:75], v[132:135], v[148:151]
	ds_read_b128 v[132:135], v6 offset:13312
	s_waitcnt lgkmcnt(5)
	v_mfma_f32_16x16x32_bf16 v[152:155], v[72:75], v[136:139], v[152:155]
	ds_read_b128 v[136:139], v6 offset:33792
	s_waitcnt lgkmcnt(5)
	v_mfma_f32_16x16x32_bf16 v[148:151], v[76:79], v[140:143], v[148:151]
	ds_read_b128 v[140:143], v6 offset:14336
	s_waitcnt lgkmcnt(5)
	v_mfma_f32_16x16x32_bf16 v[152:155], v[76:79], v[144:147], v[152:155]
	ds_read_b128 v[144:147], v6 offset:34816
	s_waitcnt lgkmcnt(5)
	v_mfma_f32_16x16x32_bf16 v[148:151], v[80:83], v[124:127], v[148:151]
	ds_read_b128 v[124:127], v6 offset:15360
	s_waitcnt lgkmcnt(5)
	v_mfma_f32_16x16x32_bf16 v[152:155], v[80:83], v[128:131], v[152:155]
	ds_read_b128 v[128:131], v6 offset:35840
	s_waitcnt lgkmcnt(5)
	v_mfma_f32_16x16x32_bf16 v[148:151], v[84:87], v[132:135], v[148:151]
	ds_read_b128 v[132:135], v6 offset:16384
	s_waitcnt lgkmcnt(5)
	v_mfma_f32_16x16x32_bf16 v[152:155], v[84:87], v[136:139], v[152:155]
	ds_read_b128 v[136:139], v6 offset:36864
	s_waitcnt lgkmcnt(5)
	v_mfma_f32_16x16x32_bf16 v[148:151], v[88:91], v[140:143], v[148:151]
	ds_read_b128 v[140:143], v6 offset:17408
	s_waitcnt lgkmcnt(5)
	v_mfma_f32_16x16x32_bf16 v[152:155], v[88:91], v[144:147], v[152:155]
	ds_read_b128 v[144:147], v6 offset:37888
	s_waitcnt lgkmcnt(5)
	v_mfma_f32_16x16x32_bf16 v[148:151], v[92:95], v[124:127], v[148:151]
	ds_read_b128 v[124:127], v6 offset:18432
	s_waitcnt lgkmcnt(5)
	v_mfma_f32_16x16x32_bf16 v[152:155], v[92:95], v[128:131], v[152:155]
	ds_read_b128 v[128:131], v6 offset:38912
	s_cmp_ge_u32 s24, 60
	s_cbranch_scc1 Lf_vs
	s_lshr_b32 s40, s24, 2
	s_lshl_b32 s40, s40, 7
	s_add_u32 s40, s40, 60284928
Lwc_11:
	buffer_load_dword v9, v7, s[4:7], s40 offen sc1
	s_waitcnt vmcnt(0)
	v_cmp_gt_u32 vcc, 64, v9
	s_cbranch_vccz Lwo_12
	s_sleep 2
	s_sub_u32 s16, s16, 1
	s_cbranch_scc0 Lwc_11
	s_mov_b32 s16, 0
Lwo_12:
Lf_vlb:
	s_mul_i32 s40, s24, 114688
	s_lshl_b32 s42, s25, 12
	s_add_u32 s40, s40, s42
	s_add_u32 s40, s40, 42205184
	buffer_load_dwordx4 v[96:99], v6, s[4:7], s40 offen offset:0 sc1
	buffer_load_dwordx4 v[100:103], v6, s[4:7], s40 offen offset:1024 sc1
	buffer_load_dwordx4 v[104:107], v6, s[4:7], s40 offen offset:2048 sc1
	buffer_load_dwordx4 v[108:111], v6, s[4:7], s40 offen offset:3072 sc1
	s_waitcnt vmcnt(0)
	v_dot2_f32_bf16 v9, v96, v97, 0
	v_dot2_f32_bf16 v9, v98, v99, v9
	v_dot2_f32_bf16 v9, v100, v101, v9
	v_dot2_f32_bf16 v9, v102, v103, v9
	v_dot2_f32_bf16 v9, v104, v105, v9
	v_dot2_f32_bf16 v9, v106, v107, v9
	v_dot2_f32_bf16 v9, v108, v109, v9
	v_dot2_f32_bf16 v9, v110, v111, v9
	s_nop 2
	v_cmp_u_f32 vcc, v9, v9
	s_cbranch_vccz Lf_vob
	s_sub_u32 s16, s16, 1
	s_cbranch_scc0 Lf_vlb
	s_mov_b32 s16, 0
Lf_vob:
Lf_vs:
	s_waitcnt lgkmcnt(5)
	v_mfma_f32_16x16x32_bf16 v[148:151], v[96:99], v[132:135], v[148:151]
	ds_read_b128 v[132:135], v6 offset:19456
	s_waitcnt lgkmcnt(5)
	v_mfma_f32_16x16x32_bf16 v[152:155], v[96:99], v[136:139], v[152:155]
	ds_read_b128 v[136:139], v6 offset:39936
	s_waitcnt lgkmcnt(5)
	v_mfma_f32_16x16x32_bf16 v[148:151], v[100:103], v[140:143], v[148:151]
	s_waitcnt lgkmcnt(4)
	v_mfma_f32_16x16x32_bf16 v[152:155], v[100:103], v[144:147], v[152:155]
	s_waitcnt lgkmcnt(3)
	v_mfma_f32_16x16x32_bf16 v[148:151], v[104:107], v[124:127], v[148:151]
	s_waitcnt lgkmcnt(2)
	v_mfma_f32_16x16x32_bf16 v[152:155], v[104:107], v[128:131], v[152:155]
	s_waitcnt lgkmcnt(1)
	v_mfma_f32_16x16x32_bf16 v[148:151], v[108:111], v[132:135], v[148:151]
	s_waitcnt lgkmcnt(0)
	v_mfma_f32_16x16x32_bf16 v[152:155], v[108:111], v[136:139], v[152:155]
	s_mul_i32 s40, s24, 28672
	s_lshr_b32 s42, s25, 2
	s_lshl_b32 s42, s42, 7
	s_add_u32 s40, s40, s42
	s_nop 0
	v_fma_f32 v148, v148, v120, v112
	v_fma_f32 v149, v149, v120, v113
	v_fma_f32 v150, v150, v120, v114
	v_fma_f32 v151, v151, v120, v115
	v_cvt_pk_bf16_f32 v148, v148, v149
	v_cvt_pk_bf16_f32 v149, v150, v151
	ds_write_b64 v11, v[148:149] offset:0
	v_fma_f32 v152, v152, v121, v116
	v_fma_f32 v153, v153, v121, v117
	v_fma_f32 v154, v154, v121, v118
	v_fma_f32 v155, v155, v121, v119
	v_cvt_pk_bf16_f32 v152, v152, v153
	v_cvt_pk_bf16_f32 v153, v154, v155
	ds_write_b64 v11, v[152:153] offset:576
	s_waitcnt lgkmcnt(0)
	s_barrier
	ds_read_b128 v[148:151], v14
	s_waitcnt lgkmcnt(0)
	buffer_store_dwordx4 v[148:151], v15, s[20:23], s40 offen sc1
	s_add_u32 s24, s24, 8
	s_cmp_lt_u32 s24, 64
	s_cbranch_scc1 Lf_loop
	s_waitcnt vmcnt(0)
	s_endpgm
Lmlp_j:
	s_sub_u32 s32, s32, 96
	v_and_b32 v1, 15, v0
	v_lshrrev_b32 v2, 4, v0
	v_lshlrev_b32 v6, 4, v0
	v_lshrrev_b32 v7, 3, v0
	s_lshl_b32 s40, s33, 3
	v_add_u32 v7, s40, v7
	v_bfe_u32 v8, v7, 2, 2
	v_lshlrev_b32 v8, 3, v8
	v_lshrrev_b32 v9, 4, v7
	v_lshl_add_u32 v8, v9, 2, v8
	v_and_b32 v9, 3, v7
	v_add_u32 v8, v8, v9
	s_mov_b32 s40, 896
	v_mul_lo_u32 v8, v8, s40
	v_bfe_u32 v9, v7, 1, 3
	v_and_b32 v10, 7, v0
	v_xor_b32 v9, v9, v10
	v_lshl_add_u32 v3, v9, 4, v8
	v_lshrrev_b32 v9, 1, v1
	v_xor_b32 v9, v9, v2
	v_lshlrev_b32 v9, 4, v9
	v_lshl_add_u32 v4, v1, 7, v9
	v_xor_b32 v5, 64, v4
	v_mov_b32 v7, 0
	v_mov_b32 v9, 0x80000000
	v_cmp_eq_u32 vcc, 0, v0
	s_nop 1
	v_cndmask_b32 v8, v9, v0, vcc
	s_mov_b32 s16, 0x200000
	s_mov_b32 s40, 60299264
Lwc_13:
	buffer_load_dword v9, v7, s[4:7], s40 offen sc1
	s_waitcnt vmcnt(0)
	v_cmp_gt_u32 vcc, 112, v9
	s_cbranch_vccz Lwo_14
	s_sleep 4
	s_sub_u32 s16, s16, 1
	s_cbranch_scc0 Lwc_13
	s_mov_b32 s16, 0
Lwo_14:
	s_mul_i32 s40, s32, 28672
	buffer_load_dwordx4 v[144:147], v3, s[8:11], s40 offen offset:0
	buffer_load_dwordx4 v[148:151], v3, s[8:11], s40 offen offset:128
	buffer_load_dwordx4 v[152:155], v3, s[8:11], s40 offen offset:256
	buffer_load_dwordx4 v[156:159], v3, s[8:11], s40 offen offset:384
	buffer_load_dwordx4 v[160:163], v3, s[8:11], s40 offen offset:512
	buffer_load_dwordx4 v[164:167], v3, s[8:11], s40 offen offset:640
	buffer_load_dwordx4 v[168:171], v3, s[8:11], s40 offen offset:768
	s_mov_b32 s20, s68
	s_and_b32 s21, s69, 0xffff
	s_mov_b32 s22, 896
	s_mov_b32 s23, 0x00020000
	v_and_b32 v10, 0x70, v3
	buffer_load_dwordx4 v[172:175], v10, s[20:23], 0 offen offset:0
	buffer_load_dwordx4 v[176:179], v10, s[20:23], 0 offen offset:128
	buffer_load_dwordx4 v[180:183], v10, s[20:23], 0 offen offset:256
	buffer_load_dwordx4 v[184:187], v10, s[20:23], 0 offen offset:384
	buffer_load_dwordx4 v[188:191], v10, s[20:23], 0 offen offset:512
	buffer_load_dwordx4 v[192:195], v10, s[20:23], 0 offen offset:640
	buffer_load_dwordx4 v[196:199], v10, s[20:23], 0 offen offset:768
	s_mov_b32 s20, s64
	s_and_b32 s21, s65, 0xffff
	s_mov_b32 s22, 3584
	s_mov_b32 s23, 0x00020000
	s_lshl_b32 s41, s33, 10
	s_add_u32 m0, s41, 114688
	s_nop 0
	buffer_load_dwordx4 v6, s[20:23], s41 offen lds
	s_mul_i32 s24, s33, 802816
	s_add_u32 s24, s24, 50757632
	s_add_u32 s42, s24, 0
	buffer_load_dwordx4 v[64:67], v6, s[4:7], s42 offen offset:0 sc1
	buffer_load_dwordx4 v[68:71], v6, s[4:7], s42 offen offset:1024 sc1
	buffer_load_dwordx4 v[72:75], v6, s[4:7], s42 offen offset:2048 sc1
	buffer_load_dwordx4 v[76:79], v6, s[4:7], s42 offen offset:3072 sc1
	s_add_u32 s42, s24, 4096
	buffer_load_dwordx4 v[80:83], v6, s[4:7], s42 offen offset:0 sc1
	buffer_load_dwordx4 v[84:87], v6, s[4:7], s42 offen offset:1024 sc1
	buffer_load_dwordx4 v[88:91], v6, s[4:7], s42 offen offset:2048 sc1
	buffer_load_dwordx4 v[92:95], v6, s[4:7], s42 offen offset:3072 sc1
	s_add_u32 s42, s24, 8192
	buffer_load_dwordx4 v[96:99], v6, s[4:7], s42 offen offset:0 sc1
	buffer_load_dwordx4 v[100:103], v6, s[4:7], s42 offen offset:1024 sc1
	buffer_load_dwordx4 v[104:107], v6, s[4:7], s42 offen offset:2048 sc1
	buffer_load_dwordx4 v[108:111], v6, s[4:7], s42 offen offset:3072 sc1
	s_add_u32 s42, s24, 12288
	buffer_load_dwordx4 v[112:115], v6, s[4:7], s42 offen offset:0 sc1
	buffer_load_dwordx4 v[116:119], v6, s[4:7], s42 offen offset:1024 sc1
	buffer_load_dwordx4 v[120:123], v6, s[4:7], s42 offen offset:2048 sc1
	buffer_load_dwordx4 v[124:127], v6, s[4:7], s42 offen offset:3072 sc1
	s_add_u32 s42, s24, 16384
	buffer_load_dwordx4 v[128:131], v6, s[4:7], s42 offen offset:0 sc1
	buffer_load_dwordx4 v[132:135], v6, s[4:7], s42 offen offset:1024 sc1
	buffer_load_dwordx4 v[136:139], v6, s[4:7], s42 offen offset:2048 sc1
	buffer_load_dwordx4 v[140:143], v6, s[4:7], s42 offen offset:3072 sc1
	s_add_u32 s42, s24, 20480
	buffer_load_dwordx4 a[224:227], v6, s[4:7], s42 offen offset:0 sc1
	buffer_load_dwordx4 a[228:231], v6, s[4:7], s42 offen offset:1024 sc1
	buffer_load_dwordx4 a[232:235], v6, s[4:7], s42 offen offset:2048 sc1
	buffer_load_dwordx4 a[236:239], v6, s[4:7], s42 offen offset:3072 sc1
	s_add_u32 s42, s24, 24576
	buffer_load_dwordx4 a[240:243], v6, s[4:7], s42 offen offset:0 sc1
	buffer_load_dwordx4 a[244:247], v6, s[4:7], s42 offen offset:1024 sc1
	buffer_load_dwordx4 a[248:251], v6, s[4:7], s42 offen offset:2048 sc1
	buffer_load_dwordx4 a[252:255], v6, s[4:7], s42 offen offset:3072 sc1
	s_waitcnt vmcnt(28)
	v_lshlrev_b32 v200, 16, v144
	v_and_b32 v201, 0xffff0000, v144
	v_lshlrev_b32 v202, 16, v145
	v_and_b32 v203, 0xffff0000, v145
	v_lshlrev_b32 v204, 16, v146
	v_and_b32 v205, 0xffff0000, v146
	v_lshlrev_b32 v206, 16, v147
	v_and_b32 v207, 0xffff0000, v147
	v_lshlrev_b32 v208, 16, v148
	v_and_b32 v209, 0xffff0000, v148
	v_lshlrev_b32 v210, 16, v149
	v_and_b32 v211, 0xffff0000, v149
	v_lshlrev_b32 v212, 16, v150
	v_and_b32 v213, 0xffff0000, v150
	v_lshlrev_b32 v214, 16, v151
	v_and_b32 v215, 0xffff0000, v151
	v_lshlrev_b32 v216, 16, v152
	v_and_b32 v217, 0xffff0000, v152
	v_lshlrev_b32 v218, 16, v153
	v_and_b32 v219, 0xffff0000, v153
	v_lshlrev_b32 v220, 16, v154
	v_and_b32 v221, 0xffff0000, v154
	v_lshlrev_b32 v222, 16, v155
	v_and_b32 v223, 0xffff0000, v155
	v_lshlrev_b32 v224, 16, v156
	v_and_b32 v225, 0xffff0000, v156
	v_lshlrev_b32 v226, 16, v157
	v_and_b32 v227, 0xffff0000, v157
	v_lshlrev_b32 v228, 16, v158
	v_and_b32 v229, 0xffff0000, v158
	v_lshlrev_b32 v230, 16, v159
	v_and_b32 v231, 0xffff0000, v159
	v_lshlrev_b32 v232, 16, v160
	v_and_b32 v233, 0xffff0000, v160
	v_lshlrev_b32 v234, 16, v161
	v_and_b32 v235, 0xffff0000, v161
	v_lshlrev_b32 v236, 16, v162
	v_and_b32 v237, 0xffff0000, v162
	v_lshlrev_b32 v238, 16, v163
	v_and_b32 v239, 0xffff0000, v163
	v_lshlrev_b32 v240, 16, v164
	v_and_b32 v241, 0xffff0000, v164
	v_lshlrev_b32 v242, 16, v165
	v_and_b32 v243, 0xffff0000, v165
	v_lshlrev_b32 v244, 16, v166
	v_and_b32 v245, 0xffff0000, v166
	v_lshlrev_b32 v246, 16, v167
	v_and_b32 v247, 0xffff0000, v167
	v_lshlrev_b32 v248, 16, v168
	v_and_b32 v249, 0xffff0000, v168
	v_lshlrev_b32 v250, 16, v169
	v_and_b32 v251, 0xffff0000, v169
	v_lshlrev_b32 v252, 16, v170
	v_and_b32 v253, 0xffff0000, v170
	v_lshlrev_b32 v254, 16, v171
	v_and_b32 v255, 0xffff0000, v171
	v_dot2_f32_bf16 v12, v144, v172, 0
	v_dot2_f32_bf16 v12, v145, v173, v12
	v_dot2_f32_bf16 v12, v146, v174, v12
	v_dot2_f32_bf16 v12, v147, v175, v12
	v_dot2_f32_bf16 v12, v148, v176, v12
	v_dot2_f32_bf16 v12, v149, v177, v12
	v_dot2_f32_bf16 v12, v150, v178, v12
	v_dot2_f32_bf16 v12, v151, v179, v12
	v_dot2_f32_bf16 v12, v152, v180, v12
	v_dot2_f32_bf16 v12, v153, v181, v12
	v_dot2_f32_bf16 v12, v154, v182, v12
	v_dot2_f32_bf16 v12, v155, v183, v12
	v_dot2_f32_bf16 v12, v156, v184, v12
	v_dot2_f32_bf16 v12, v157, v185, v12
	v_dot2_f32_bf16 v12, v158, v186, v12
	v_dot2_f32_bf16 v12, v159, v187, v12
	v_dot2_f32_bf16 v12, v160, v188, v12
	v_dot2_f32_bf16 v12, v161, v189, v12
	v_dot2_f32_bf16 v12, v162, v190, v12
	v_dot2_f32_bf16 v12, v163, v191, v12
	v_dot2_f32_bf16 v12, v164, v192, v12
	v_dot2_f32_bf16 v12, v165, v193, v12
	v_dot2_f32_bf16 v12, v166, v194, v12
	v_dot2_f32_bf16 v12, v167, v195, v12
	v_dot2_f32_bf16 v12, v168, v196, v12
	v_dot2_f32_bf16 v12, v169, v197, v12
	v_dot2_f32_bf16 v12, v170, v198, v12
	v_dot2_f32_bf16 v12, v171, v199, v12
	v_pk_add_f32 v[14:15], v[200:201], v[202:203]
	v_pk_add_f32 v[14:15], v[14:15], v[204:205]
	v_pk_add_f32 v[14:15], v[14:15], v[206:207]
	v_pk_add_f32 v[14:15], v[14:15], v[208:209]
	v_pk_add_f32 v[14:15], v[14:15], v[210:211]
	v_pk_add_f32 v[14:15], v[14:15], v[212:213]
	v_pk_add_f32 v[14:15], v[14:15], v[214:215]
	v_pk_add_f32 v[14:15], v[14:15], v[216:217]
	v_pk_add_f32 v[14:15], v[14:15], v[218:219]
	v_pk_add_f32 v[14:15], v[14:15], v[220:221]
	v_pk_add_f32 v[14:15], v[14:15], v[222:223]
	v_pk_add_f32 v[14:15], v[14:15], v[224:225]
	v_pk_add_f32 v[14:15], v[14:15], v[226:227]
	v_pk_add_f32 v[14:15], v[14:15], v[228:229]
	v_pk_add_f32 v[14:15], v[14:15], v[230:231]
	v_pk_add_f32 v[14:15], v[14:15], v[232:233]
	v_pk_add_f32 v[14:15], v[14:15], v[234:235]
	v_pk_add_f32 v[14:15], v[14:15], v[236:237]
	v_pk_add_f32 v[14:15], v[14:15], v[238:239]
	v_pk_add_f32 v[14:15], v[14:15], v[240:241]
	v_pk_add_f32 v[14:15], v[14:15], v[242:243]
	v_pk_add_f32 v[14:15], v[14:15], v[244:245]
	v_pk_add_f32 v[14:15], v[14:15], v[246:247]
	v_pk_add_f32 v[14:15], v[14:15], v[248:249]
	v_pk_add_f32 v[14:15], v[14:15], v[250:251]
	v_pk_add_f32 v[14:15], v[14:15], v[252:253]
	v_pk_add_f32 v[14:15], v[14:15], v[254:255]
	v_add_f32 v14, v14, v15
	s_nop 1
	v_add_f32_dpp v14, v14, v14 quad_perm:[1,0,3,2] row_mask:0xf bank_mask:0xf
	s_nop 1
	v_add_f32_dpp v14, v14, v14 quad_perm:[2,3,0,1] row_mask:0xf bank_mask:0xf
	s_nop 1
	v_add_f32_dpp v14, v14, v14 row_half_mirror row_mask:0xf bank_mask:0xf
	v_add_f32_dpp v12, v12, v12 quad_perm:[1,0,3,2] row_mask:0xf bank_mask:0xf
	s_nop 1
	v_add_f32_dpp v12, v12, v12 quad_perm:[2,3,0,1] row_mask:0xf bank_mask:0xf
	s_nop 1
	v_add_f32_dpp v12, v12, v12 row_half_mirror row_mask:0xf bank_mask:0xf
	v_mul_f32 v14, 0xbb124925, v14
	v_pk_add_f32 v[200:201], v[200:201], v[14:15] op_sel_hi:[1,0]
	v_pk_add_f32 v[202:203], v[202:203], v[14:15] op_sel_hi:[1,0]
	v_pk_add_f32 v[204:205], v[204:205], v[14:15] op_sel_hi:[1,0]
	v_pk_add_f32 v[206:207], v[206:207], v[14:15] op_sel_hi:[1,0]
	v_pk_add_f32 v[208:209], v[208:209], v[14:15] op_sel_hi:[1,0]
	v_pk_add_f32 v[210:211], v[210:211], v[14:15] op_sel_hi:[1,0]
	v_pk_add_f32 v[212:213], v[212:213], v[14:15] op_sel_hi:[1,0]
	v_pk_add_f32 v[214:215], v[214:215], v[14:15] op_sel_hi:[1,0]
	v_pk_add_f32 v[216:217], v[216:217], v[14:15] op_sel_hi:[1,0]
	v_pk_add_f32 v[218:219], v[218:219], v[14:15] op_sel_hi:[1,0]
	v_pk_add_f32 v[220:221], v[220:221], v[14:15] op_sel_hi:[1,0]
	v_pk_add_f32 v[222:223], v[222:223], v[14:15] op_sel_hi:[1,0]
	v_pk_add_f32 v[224:225], v[224:225], v[14:15] op_sel_hi:[1,0]
	v_pk_add_f32 v[226:227], v[226:227], v[14:15] op_sel_hi:[1,0]
	v_pk_add_f32 v[228:229], v[228:229], v[14:15] op_sel_hi:[1,0]
	v_pk_add_f32 v[230:231], v[230:231], v[14:15] op_sel_hi:[1,0]
	v_pk_add_f32 v[232:233], v[232:233], v[14:15] op_sel_hi:[1,0]
	v_pk_add_f32 v[234:235], v[234:235], v[14:15] op_sel_hi:[1,0]
	v_pk_add_f32 v[236:237], v[236:237], v[14:15] op_sel_hi:[1,0]
	v_pk_add_f32 v[238:239], v[238:239], v[14:15] op_sel_hi:[1,0]
	v_pk_add_f32 v[240:241], v[240:241], v[14:15] op_sel_hi:[1,0]
	v_pk_add_f32 v[242:243], v[242:243], v[14:15] op_sel_hi:[1,0]
	v_pk_add_f32 v[244:245], v[244:245], v[14:15] op_sel_hi:[1,0]
	v_pk_add_f32 v[246:247], v[246:247], v[14:15] op_sel_hi:[1,0]
	v_pk_add_f32 v[248:249], v[248:249], v[14:15] op_sel_hi:[1,0]
	v_pk_add_f32 v[250:251], v[250:251], v[14:15] op_sel_hi:[1,0]
	v_pk_add_f32 v[252:253], v[252:253], v[14:15] op_sel_hi:[1,0]
	v_pk_add_f32 v[254:255], v[254:255], v[14:15] op_sel_hi:[1,0]
	v_pk_mul_f32 v[16:17], v[200:201], v[200:201]
	v_pk_fma_f32 v[16:17], v[202:203], v[202:203], v[16:17]
	v_pk_fma_f32 v[16:17], v[204:205], v[204:205], v[16:17]
	v_pk_fma_f32 v[16:17], v[206:207], v[206:207], v[16:17]
	v_pk_fma_f32 v[16:17], v[208:209], v[208:209], v[16:17]
	v_pk_fma_f32 v[16:17], v[210:211], v[210:211], v[16:17]
	v_pk_fma_f32 v[16:17], v[212:213], v[212:213], v[16:17]
	v_pk_fma_f32 v[16:17], v[214:215], v[214:215], v[16:17]
	v_pk_fma_f32 v[16:17], v[216:217], v[216:217], v[16:17]
	v_pk_fma_f32 v[16:17], v[218:219], v[218:219], v[16:17]
	v_pk_fma_f32 v[16:17], v[220:221], v[220:221], v[16:17]
	v_pk_fma_f32 v[16:17], v[222:223], v[222:223], v[16:17]
	v_pk_fma_f32 v[16:17], v[224:225], v[224:225], v[16:17]
	v_pk_fma_f32 v[16:17], v[226:227], v[226:227], v[16:17]
	v_pk_fma_f32 v[16:17], v[228:229], v[228:229], v[16:17]
	v_pk_fma_f32 v[16:17], v[230:231], v[230:231], v[16:17]
	v_pk_fma_f32 v[16:17], v[232:233], v[232:233], v[16:17]
	v_pk_fma_f32 v[16:17], v[234:235], v[234:235], v[16:17]
	v_pk_fma_f32 v[16:17], v[236:237], v[236:237], v[16:17]
	v_pk_fma_f32 v[16:17], v[238:239], v[238:239], v[16:17]
	v_pk_fma_f32 v[16:17], v[240:241], v[240:241], v[16:17]
	v_pk_fma_f32 v[16:17], v[242:243], v[242:243], v[16:17]
	v_pk_fma_f32 v[16:17], v[244:245], v[244:245], v[16:17]
	v_pk_fma_f32 v[16:17], v[246:247], v[246:247], v[16:17]
	v_pk_fma_f32 v[16:17], v[248:249], v[248:249], v[16:17]
	v_pk_fma_f32 v[16:17], v[250:251], v[250:251], v[16:17]
	v_pk_fma_f32 v[16:17], v[252:253], v[252:253], v[16:17]
	v_pk_fma_f32 v[16:17], v[254:255], v[254:255], v[16:17]
	v_add_f32 v16, v16, v17
	s_nop 1
	v_add_f32_dpp v16, v16, v16 quad_perm:[1,0,3,2] row_mask:0xf bank_mask:0xf
	s_nop 1
	v_add_f32_dpp v16, v16, v16 quad_perm:[2,3,0,1] row_mask:0xf bank_mask:0xf
	s_nop 1
	v_add_f32_dpp v16, v16, v16 row_half_mirror row_mask:0xf bank_mask:0xf
	v_mov_b32 v17, 0x3727c5ac
	v_fmac_f32 v17, 0x3b124925, v16
	v_rsq_f32 v16, v17
	v_mul_f32 v12, 0xbfb8aa3b, v12
	v_exp_f32 v12, v12
	s_nop 0
	v_add_f32 v12, 1.0, v12
	v_rcp_f32 v12, v12
	v_pk_mul_f32 v[200:201], v[200:201], v[16:17] op_sel_hi:[1,0]
	v_pk_mul_f32 v[202:203], v[202:203], v[16:17] op_sel_hi:[1,0]
	v_pk_mul_f32 v[204:205], v[204:205], v[16:17] op_sel_hi:[1,0]
	v_pk_mul_f32 v[206:207], v[206:207], v[16:17] op_sel_hi:[1,0]
	v_pk_mul_f32 v[208:209], v[208:209], v[16:17] op_sel_hi:[1,0]
	v_pk_mul_f32 v[210:211], v[210:211], v[16:17] op_sel_hi:[1,0]
	v_pk_mul_f32 v[212:213], v[212:213], v[16:17] op_sel_hi:[1,0]
	v_pk_mul_f32 v[214:215], v[214:215], v[16:17] op_sel_hi:[1,0]
	v_pk_mul_f32 v[216:217], v[216:217], v[16:17] op_sel_hi:[1,0]
	v_pk_mul_f32 v[218:219], v[218:219], v[16:17] op_sel_hi:[1,0]
	v_pk_mul_f32 v[220:221], v[220:221], v[16:17] op_sel_hi:[1,0]
	v_pk_mul_f32 v[222:223], v[222:223], v[16:17] op_sel_hi:[1,0]
	v_pk_mul_f32 v[224:225], v[224:225], v[16:17] op_sel_hi:[1,0]
	v_pk_mul_f32 v[226:227], v[226:227], v[16:17] op_sel_hi:[1,0]
	v_pk_mul_f32 v[228:229], v[228:229], v[16:17] op_sel_hi:[1,0]
	v_pk_mul_f32 v[230:231], v[230:231], v[16:17] op_sel_hi:[1,0]
	v_pk_mul_f32 v[232:233], v[232:233], v[16:17] op_sel_hi:[1,0]
	v_pk_mul_f32 v[234:235], v[234:235], v[16:17] op_sel_hi:[1,0]
	v_pk_mul_f32 v[236:237], v[236:237], v[16:17] op_sel_hi:[1,0]
	v_pk_mul_f32 v[238:239], v[238:239], v[16:17] op_sel_hi:[1,0]
	v_pk_mul_f32 v[240:241], v[240:241], v[16:17] op_sel_hi:[1,0]
	v_pk_mul_f32 v[242:243], v[242:243], v[16:17] op_sel_hi:[1,0]
	v_pk_mul_f32 v[244:245], v[244:245], v[16:17] op_sel_hi:[1,0]
	v_pk_mul_f32 v[246:247], v[246:247], v[16:17] op_sel_hi:[1,0]
	v_pk_mul_f32 v[248:249], v[248:249], v[16:17] op_sel_hi:[1,0]
	v_pk_mul_f32 v[250:251], v[250:251], v[16:17] op_sel_hi:[1,0]
	v_pk_mul_f32 v[252:253], v[252:253], v[16:17] op_sel_hi:[1,0]
	v_pk_mul_f32 v[254:255], v[254:255], v[16:17] op_sel_hi:[1,0]
	v_cvt_pk_bf16_f32 v144, v200, v201
	v_cvt_pk_bf16_f32 v145, v202, v203
	v_cvt_pk_bf16_f32 v146, v204, v205
	v_cvt_pk_bf16_f32 v147, v206, v207
	v_cvt_pk_bf16_f32 v148, v208, v209
	v_cvt_pk_bf16_f32 v149, v210, v211
	v_cvt_pk_bf16_f32 v150, v212, v213
	v_cvt_pk_bf16_f32 v151, v214, v215
	v_cvt_pk_bf16_f32 v152, v216, v217
	v_cvt_pk_bf16_f32 v153, v218, v219
	v_cvt_pk_bf16_f32 v154, v220, v221
	v_cvt_pk_bf16_f32 v155, v222, v223
	v_cvt_pk_bf16_f32 v156, v224, v225
	v_cvt_pk_bf16_f32 v157, v226, v227
	v_cvt_pk_bf16_f32 v158, v228, v229
	v_cvt_pk_bf16_f32 v159, v230, v231
	v_cvt_pk_bf16_f32 v160, v232, v233
	v_cvt_pk_bf16_f32 v161, v234, v235
	v_cvt_pk_bf16_f32 v162, v236, v237
	v_cvt_pk_bf16_f32 v163, v238, v239
	v_cvt_pk_bf16_f32 v164, v240, v241
	v_cvt_pk_bf16_f32 v165, v242, v243
	v_cvt_pk_bf16_f32 v166, v244, v245
	v_cvt_pk_bf16_f32 v167, v246, v247
	v_cvt_pk_bf16_f32 v168, v248, v249
	v_cvt_pk_bf16_f32 v169, v250, v251
	v_cvt_pk_bf16_f32 v170, v252, v253
	v_cvt_pk_bf16_f32 v171, v254, v255
	v_add_u32 v10, s41, v6
	ds_write_b128 v10, v[144:147] offset:0
	ds_write_b128 v10, v[148:151] offset:4096
	ds_write_b128 v10, v[152:155] offset:8192
	ds_write_b128 v10, v[156:159] offset:12288
	ds_write_b128 v10, v[160:163] offset:16384
	ds_write_b128 v10, v[164:167] offset:20480
	ds_write_b128 v10, v[168:171] offset:24576
	v_lshrrev_b32 v10, 3, v0
	v_lshlrev_b32 v10, 2, v10
	s_lshl_b32 s40, s33, 5
	v_add_u32 v10, s40, v10
	v_add_u32 v11, 118784, v10
	ds_write_b32 v11, v12
	s_lshl_b32 s40, s32, 7
	s_add_u32 s40, s40, 60260352
	buffer_store_dword v12, v10, s[4:7], s40 offen sc1
	s_waitcnt lgkmcnt(0)
	s_barrier
	ds_read_b128 v[144:147], v4 offset:0
	ds_read_b128 v[148:151], v4 offset:2048
	ds_read_b128 v[152:155], v5 offset:0
	ds_read_b128 v[156:159], v5 offset:2048
	ds_read_b128 v[160:163], v4 offset:4096
	ds_read_b128 v[164:167], v4 offset:6144
	ds_read_b128 v[168:171], v5 offset:4096
	ds_read_b128 v[172:175], v5 offset:6144
	ds_read_b128 v[176:179], v4 offset:8192
	ds_read_b128 v[180:183], v4 offset:10240
	ds_read_b128 v[184:187], v5 offset:8192
	ds_read_b128 v[188:191], v5 offset:10240
	ds_read_b128 v[192:195], v4 offset:12288
	ds_read_b128 v[196:199], v4 offset:14336
	ds_read_b128 v[200:203], v5 offset:12288
	ds_read_b128 v[204:207], v5 offset:14336
	ds_read_b128 v[208:211], v4 offset:16384
	ds_read_b128 v[212:215], v4 offset:18432
	ds_read_b128 v[216:219], v5 offset:16384
	ds_read_b128 v[220:223], v5 offset:18432
	ds_read_b128 v[224:227], v4 offset:20480
	ds_read_b128 v[228:231], v4 offset:22528
	ds_read_b128 v[232:235], v5 offset:20480
	ds_read_b128 v[236:239], v5 offset:22528
	ds_read_b128 v[240:243], v4 offset:24576
	ds_read_b128 v[244:247], v4 offset:26624
	ds_read_b128 v[248:251], v5 offset:24576
	ds_read_b128 v[252:255], v5 offset:26624
	v_accvgpr_write_b32 a0, 0
	v_accvgpr_write_b32 a1, 0
	v_accvgpr_write_b32 a2, 0
	v_accvgpr_write_b32 a3, 0
	v_accvgpr_write_b32 a4, 0
	v_accvgpr_write_b32 a5, 0
	v_accvgpr_write_b32 a6, 0
	v_accvgpr_write_b32 a7, 0
	v_accvgpr_write_b32 a8, 0
	v_accvgpr_write_b32 a9, 0
	v_accvgpr_write_b32 a10, 0
	v_accvgpr_write_b32 a11, 0
	v_accvgpr_write_b32 a12, 0
	v_accvgpr_write_b32 a13, 0
	v_accvgpr_write_b32 a14, 0
	v_accvgpr_write_b32 a15, 0
	v_accvgpr_write_b32 a16, 0
	v_accvgpr_write_b32 a17, 0
	v_accvgpr_write_b32 a18, 0
	v_accvgpr_write_b32 a19, 0
	v_accvgpr_write_b32 a20, 0
	v_accvgpr_write_b32 a21, 0
	v_accvgpr_write_b32 a22, 0
	v_accvgpr_write_b32 a23, 0
	v_accvgpr_write_b32 a24, 0
	v_accvgpr_write_b32 a25, 0
	v_accvgpr_write_b32 a26, 0
	v_accvgpr_write_b32 a27, 0
	v_accvgpr_write_b32 a28, 0
	v_accvgpr_write_b32 a29, 0
	v_accvgpr_write_b32 a30, 0
	v_accvgpr_write_b32 a31, 0
	v_accvgpr_write_b32 a32, 0
	v_accvgpr_write_b32 a33, 0
	v_accvgpr_write_b32 a34, 0
	v_accvgpr_write_b32 a35, 0
	v_accvgpr_write_b32 a36, 0
	v_accvgpr_write_b32 a37, 0
	v_accvgpr_write_b32 a38, 0
	v_accvgpr_write_b32 a39, 0
	v_accvgpr_write_b32 a40, 0
	v_accvgpr_write_b32 a41, 0
	v_accvgpr_write_b32 a42, 0
	v_accvgpr_write_b32 a43, 0
	v_accvgpr_write_b32 a44, 0
	v_accvgpr_write_b32 a45, 0
	v_accvgpr_write_b32 a46, 0
	v_accvgpr_write_b32 a47, 0
	v_accvgpr_write_b32 a48, 0
	v_accvgpr_write_b32 a49, 0
	v_accvgpr_write_b32 a50, 0
	v_accvgpr_write_b32 a51, 0
	v_accvgpr_write_b32 a52, 0
	v_accvgpr_write_b32 a53, 0
	v_accvgpr_write_b32 a54, 0
	v_accvgpr_write_b32 a55, 0
	v_accvgpr_write_b32 a56, 0
	v_accvgpr_write_b32 a57, 0
	v_accvgpr_write_b32 a58, 0
	v_accvgpr_write_b32 a59, 0
	v_accvgpr_write_b32 a60, 0
	v_accvgpr_write_b32 a61, 0
	v_accvgpr_write_b32 a62, 0
	v_accvgpr_write_b32 a63, 0
	v_accvgpr_write_b32 a64, 0
	v_accvgpr_write_b32 a65, 0
	v_accvgpr_write_b32 a66, 0
	v_accvgpr_write_b32 a67, 0
	v_accvgpr_write_b32 a68, 0
	v_accvgpr_write_b32 a69, 0
	v_accvgpr_write_b32 a70, 0
	v_accvgpr_write_b32 a71, 0
	v_accvgpr_write_b32 a72, 0
	v_accvgpr_write_b32 a73, 0
	v_accvgpr_write_b32 a74, 0
	v_accvgpr_write_b32 a75, 0
	v_accvgpr_write_b32 a76, 0
	v_accvgpr_write_b32 a77, 0
	v_accvgpr_write_b32 a78, 0
	v_accvgpr_write_b32 a79, 0
	v_accvgpr_write_b32 a80, 0
	v_accvgpr_write_b32 a81, 0
	v_accvgpr_write_b32 a82, 0
	v_accvgpr_write_b32 a83, 0
	v_accvgpr_write_b32 a84, 0
	v_accvgpr_write_b32 a85, 0
	v_accvgpr_write_b32 a86, 0
	v_accvgpr_write_b32 a87, 0
	v_accvgpr_write_b32 a88, 0
	v_accvgpr_write_b32 a89, 0
	v_accvgpr_write_b32 a90, 0
	v_accvgpr_write_b32 a91, 0
	v_accvgpr_write_b32 a92, 0
	v_accvgpr_write_b32 a93, 0
	v_accvgpr_write_b32 a94, 0
	v_accvgpr_write_b32 a95, 0
	v_accvgpr_write_b32 a96, 0
	v_accvgpr_write_b32 a97, 0
	v_accvgpr_write_b32 a98, 0
	v_accvgpr_write_b32 a99, 0
	v_accvgpr_write_b32 a100, 0
	v_accvgpr_write_b32 a101, 0
	v_accvgpr_write_b32 a102, 0
	v_accvgpr_write_b32 a103, 0
	v_accvgpr_write_b32 a104, 0
	v_accvgpr_write_b32 a105, 0
	v_accvgpr_write_b32 a106, 0
	v_accvgpr_write_b32 a107, 0
	v_accvgpr_write_b32 a108, 0
	v_accvgpr_write_b32 a109, 0
	v_accvgpr_write_b32 a110, 0
	v_accvgpr_write_b32 a111, 0
	v_accvgpr_write_b32 a112, 0
	v_accvgpr_write_b32 a113, 0
	v_accvgpr_write_b32 a114, 0
	v_accvgpr_write_b32 a115, 0
	v_accvgpr_write_b32 a116, 0
	v_accvgpr_write_b32 a117, 0
	v_accvgpr_write_b32 a118, 0
	v_accvgpr_write_b32 a119, 0
	v_accvgpr_write_b32 a120, 0
	v_accvgpr_write_b32 a121, 0
	v_accvgpr_write_b32 a122, 0
	v_accvgpr_write_b32 a123, 0
	v_accvgpr_write_b32 a124, 0
	v_accvgpr_write_b32 a125, 0
	v_accvgpr_write_b32 a126, 0
	v_accvgpr_write_b32 a127, 0
	v_accvgpr_write_b32 a128, 0
	v_accvgpr_write_b32 a129, 0
	v_accvgpr_write_b32 a130, 0
	v_accvgpr_write_b32 a131, 0
	v_accvgpr_write_b32 a132, 0
	v_accvgpr_write_b32 a133, 0
	v_accvgpr_write_b32 a134, 0
	v_accvgpr_write_b32 a135, 0
	v_accvgpr_write_b32 a136, 0
	v_accvgpr_write_b32 a137, 0
	v_accvgpr_write_b32 a138, 0
	v_accvgpr_write_b32 a139, 0
	v_accvgpr_write_b32 a140, 0
	v_accvgpr_write_b32 a141, 0
	v_accvgpr_write_b32 a142, 0
	v_accvgpr_write_b32 a143, 0
	v_accvgpr_write_b32 a144, 0
	v_accvgpr_write_b32 a145, 0
	v_accvgpr_write_b32 a146, 0
	v_accvgpr_write_b32 a147, 0
	v_accvgpr_write_b32 a148, 0
	v_accvgpr_write_b32 a149, 0
	v_accvgpr_write_b32 a150, 0
	v_accvgpr_write_b32 a151, 0
	v_accvgpr_write_b32 a152, 0
	v_accvgpr_write_b32 a153, 0
	v_accvgpr_write_b32 a154, 0
	v_accvgpr_write_b32 a155, 0
	v_accvgpr_write_b32 a156, 0
	v_accvgpr_write_b32 a157, 0
	v_accvgpr_write_b32 a158, 0
	v_accvgpr_write_b32 a159, 0
	v_accvgpr_write_b32 a160, 0
	v_accvgpr_write_b32 a161, 0
	v_accvgpr_write_b32 a162, 0
	v_accvgpr_write_b32 a163, 0
	v_accvgpr_write_b32 a164, 0
	v_accvgpr_write_b32 a165, 0
	v_accvgpr_write_b32 a166, 0
	v_accvgpr_write_b32 a167, 0
	v_accvgpr_write_b32 a168, 0
	v_accvgpr_write_b32 a169, 0
	v_accvgpr_write_b32 a170, 0
	v_accvgpr_write_b32 a171, 0
	v_accvgpr_write_b32 a172, 0
	v_accvgpr_write_b32 a173, 0
	v_accvgpr_write_b32 a174, 0
	v_accvgpr_write_b32 a175, 0
	v_accvgpr_write_b32 a176, 0
	v_accvgpr_write_b32 a177, 0
	v_accvgpr_write_b32 a178, 0
	v_accvgpr_write_b32 a179, 0
	v_accvgpr_write_b32 a180, 0
	v_accvgpr_write_b32 a181, 0
	v_accvgpr_write_b32 a182, 0
	v_accvgpr_write_b32 a183, 0
	v_accvgpr_write_b32 a184, 0
	v_accvgpr_write_b32 a185, 0
	v_accvgpr_write_b32 a186, 0
	v_accvgpr_write_b32 a187, 0
	v_accvgpr_write_b32 a188, 0
	v_accvgpr_write_b32 a189, 0
	v_accvgpr_write_b32 a190, 0
	v_accvgpr_write_b32 a191, 0
	v_accvgpr_write_b32 a192, 0
	v_accvgpr_write_b32 a193, 0
	v_accvgpr_write_b32 a194, 0
	v_accvgpr_write_b32 a195, 0
	v_accvgpr_write_b32 a196, 0
	v_accvgpr_write_b32 a197, 0
	v_accvgpr_write_b32 a198, 0
	v_accvgpr_write_b32 a199, 0
	v_accvgpr_write_b32 a200, 0
	v_accvgpr_write_b32 a201, 0
	v_accvgpr_write_b32 a202, 0
	v_accvgpr_write_b32 a203, 0
	v_accvgpr_write_b32 a204, 0
	v_accvgpr_write_b32 a205, 0
	v_accvgpr_write_b32 a206, 0
	v_accvgpr_write_b32 a207, 0
	v_accvgpr_write_b32 a208, 0
	v_accvgpr_write_b32 a209, 0
	v_accvgpr_write_b32 a210, 0
	v_accvgpr_write_b32 a211, 0
	v_accvgpr_write_b32 a212, 0
	v_accvgpr_write_b32 a213, 0
	v_accvgpr_write_b32 a214, 0
	v_accvgpr_write_b32 a215, 0
	v_accvgpr_write_b32 a216, 0
	v_accvgpr_write_b32 a217, 0
	v_accvgpr_write_b32 a218, 0
	v_accvgpr_write_b32 a219, 0
	v_accvgpr_write_b32 a220, 0
	v_accvgpr_write_b32 a221, 0
	v_accvgpr_write_b32 a222, 0
	v_accvgpr_write_b32 a223, 0
	s_mul_i32 s40, s33, 896
	s_add_u32 s40, s40, 114688
	v_lshl_add_u32 v11, v2, 4, s40
	s_mov_b32 s26, 0xbdd2d3e8
	v_mov_b32 v20, 0xc0135761
	s_mov_b32 s25, 0
	s_waitcnt vmcnt(0) lgkmcnt(0)
Lm_loop:
	ds_read_b128 v[48:51], v11
	v_add_u32 v11, 64, v11
	s_waitcnt lgkmcnt(0)
	v_lshlrev_b32 v40, 16, v48
	v_and_b32 v41, 0xffff0000, v48
	v_lshlrev_b32 v42, 16, v49
	v_and_b32 v43, 0xffff0000, v49
	v_lshlrev_b32 v44, 16, v50
	v_and_b32 v45, 0xffff0000, v50
	v_lshlrev_b32 v46, 16, v51
	v_and_b32 v47, 0xffff0000, v51
	s_waitcnt vmcnt(27)
	v_mfma_f32_16x16x32_bf16 v[24:27], v[64:67], v[144:147], v[40:43]
	v_mfma_f32_16x16x32_bf16 v[32:35], v[64:67], v[148:151], v[40:43]
	s_add_u32 s42, s24, 28672
	buffer_load_dwordx4 v[64:67], v6, s[4:7], s42 offen offset:0 sc1
	s_waitcnt vmcnt(27)
	v_mfma_f32_16x16x32_bf16 v[24:27], v[68:71], v[152:155], v[24:27]
	v_mfma_f32_16x16x32_bf16 v[32:35], v[68:71], v[156:159], v[32:35]
	buffer_load_dwordx4 v[68:71], v6, s[4:7], s42 offen offset:1024 sc1
	s_waitcnt vmcnt(27)
	v_mfma_f32_16x16x32_bf16 v[24:27], v[72:75], v[160:163], v[24:27]
	v_mfma_f32_16x16x32_bf16 v[32:35], v[72:75], v[164:167], v[32:35]
	buffer_load_dwordx4 v[72:75], v6, s[4:7], s42 offen offset:2048 sc1
	s_waitcnt vmcnt(27)
	v_mfma_f32_16x16x32_bf16 v[24:27], v[76:79], v[168:171], v[24:27]
	v_mfma_f32_16x16x32_bf16 v[32:35], v[76:79], v[172:175], v[32:35]
	buffer_load_dwordx4 v[76:79], v6, s[4:7], s42 offen offset:3072 sc1
	s_waitcnt vmcnt(27)
	v_mfma_f32_16x16x32_bf16 v[24:27], v[80:83], v[176:179], v[24:27]
	v_mfma_f32_16x16x32_bf16 v[32:35], v[80:83], v[180:183], v[32:35]
	s_add_u32 s42, s24, 32768
	buffer_load_dwordx4 v[80:83], v6, s[4:7], s42 offen offset:0 sc1
	s_waitcnt vmcnt(27)
	v_mfma_f32_16x16x32_bf16 v[24:27], v[84:87], v[184:187], v[24:27]
	v_mfma_f32_16x16x32_bf16 v[32:35], v[84:87], v[188:191], v[32:35]
	buffer_load_dwordx4 v[84:87], v6, s[4:7], s42 offen offset:1024 sc1
	s_waitcnt vmcnt(27)
	v_mfma_f32_16x16x32_bf16 v[24:27], v[88:91], v[192:195], v[24:27]
	v_mfma_f32_16x16x32_bf16 v[32:35], v[88:91], v[196:199], v[32:35]
	buffer_load_dwordx4 v[88:91], v6, s[4:7], s42 offen offset:2048 sc1
	s_waitcnt vmcnt(27)
	v_mfma_f32_16x16x32_bf16 v[24:27], v[92:95], v[200:203], v[24:27]
	v_mfma_f32_16x16x32_bf16 v[32:35], v[92:95], v[204:207], v[32:35]
	buffer_load_dwordx4 v[92:95], v6, s[4:7], s42 offen offset:3072 sc1
	s_waitcnt vmcnt(27)
	v_mfma_f32_16x16x32_bf16 v[24:27], v[96:99], v[208:211], v[24:27]
	v_mfma_f32_16x16x32_bf16 v[32:35], v[96:99], v[212:215], v[32:35]
	s_add_u32 s42, s24, 36864
	buffer_load_dwordx4 v[96:99], v6, s[4:7], s42 offen offset:0 sc1
	s_waitcnt vmcnt(27)
	v_mfma_f32_16x16x32_bf16 v[24:27], v[100:103], v[216:219], v[24:27]
	v_mfma_f32_16x16x32_bf16 v[32:35], v[100:103], v[220:223], v[32:35]
	buffer_load_dwordx4 v[100:103], v6, s[4:7], s42 offen offset:1024 sc1
	s_waitcnt vmcnt(27)
	v_mfma_f32_16x16x32_bf16 v[24:27], v[104:107], v[224:227], v[24:27]
	v_mfma_f32_16x16x32_bf16 v[32:35], v[104:107], v[228:231], v[32:35]
	buffer_load_dwordx4 v[104:107], v6, s[4:7], s42 offen offset:2048 sc1
	s_waitcnt vmcnt(27)
	v_mfma_f32_16x16x32_bf16 v[24:27], v[108:111], v[232:235], v[24:27]
	v_mfma_f32_16x16x32_bf16 v[32:35], v[108:111], v[236:239], v[32:35]
	buffer_load_dwordx4 v[108:111], v6, s[4:7], s42 offen offset:3072 sc1
	s_waitcnt vmcnt(27)
	v_mfma_f32_16x16x32_bf16 v[24:27], v[112:115], v[240:243], v[24:27]
	v_mfma_f32_16x16x32_bf16 v[32:35], v[112:115], v[244:247], v[32:35]
	s_add_u32 s42, s24, 40960
	buffer_load_dwordx4 v[112:115], v6, s[4:7], s42 offen offset:0 sc1
	s_waitcnt vmcnt(27)
	v_mfma_f32_16x16x32_bf16 v[24:27], v[116:119], v[248:251], v[24:27]
	v_mfma_f32_16x16x32_bf16 v[32:35], v[116:119], v[252:255], v[32:35]
	buffer_load_dwordx4 v[116:119], v6, s[4:7], s42 offen offset:1024 sc1
	s_waitcnt vmcnt(27)
	v_mfma_f32_16x16x32_bf16 v[28:31], v[120:123], v[144:147], v[44:47]
	v_mfma_f32_16x16x32_bf16 v[36:39], v[120:123], v[148:151], v[44:47]
	buffer_load_dwordx4 v[120:123], v6, s[4:7], s42 offen offset:2048 sc1
	s_waitcnt vmcnt(27)
	v_mfma_f32_16x16x32_bf16 v[28:31], v[124:127], v[152:155], v[28:31]
	v_mfma_f32_16x16x32_bf16 v[36:39], v[124:127], v[156:159], v[36:39]
	buffer_load_dwordx4 v[124:127], v6, s[4:7], s42 offen offset:3072 sc1
	s_waitcnt vmcnt(27)
	v_mfma_f32_16x16x32_bf16 v[28:31], v[128:131], v[160:163], v[28:31]
	v_mfma_f32_16x16x32_bf16 v[36:39], v[128:131], v[164:167], v[36:39]
	s_add_u32 s42, s24, 45056
	buffer_load_dwordx4 v[128:131], v6, s[4:7], s42 offen offset:0 sc1
	s_waitcnt vmcnt(27)
	v_mfma_f32_16x16x32_bf16 v[28:31], v[132:135], v[168:171], v[28:31]
	v_mfma_f32_16x16x32_bf16 v[36:39], v[132:135], v[172:175], v[36:39]
	buffer_load_dwordx4 v[132:135], v6, s[4:7], s42 offen offset:1024 sc1
	s_waitcnt vmcnt(27)
	v_mfma_f32_16x16x32_bf16 v[28:31], v[136:139], v[176:179], v[28:31]
	v_mfma_f32_16x16x32_bf16 v[36:39], v[136:139], v[180:183], v[36:39]
	buffer_load_dwordx4 v[136:139], v6, s[4:7], s42 offen offset:2048 sc1
	s_waitcnt vmcnt(27)
	v_mfma_f32_16x16x32_bf16 v[28:31], v[140:143], v[184:187], v[28:31]
	v_mfma_f32_16x16x32_bf16 v[36:39], v[140:143], v[188:191], v[36:39]
	buffer_load_dwordx4 v[140:143], v6, s[4:7], s42 offen offset:3072 sc1
	s_waitcnt vmcnt(27)
	v_mfma_f32_16x16x32_bf16 v[28:31], a[224:227], v[192:195], v[28:31]
	v_mfma_f32_16x16x32_bf16 v[36:39], a[224:227], v[196:199], v[36:39]
	s_add_u32 s42, s24, 49152
	buffer_load_dwordx4 a[224:227], v6, s[4:7], s42 offen offset:0 sc1
	s_waitcnt vmcnt(27)
	v_mfma_f32_16x16x32_bf16 v[28:31], a[228:231], v[200:203], v[28:31]
	v_mfma_f32_16x16x32_bf16 v[36:39], a[228:231], v[204:207], v[36:39]
	buffer_load_dwordx4 a[228:231], v6, s[4:7], s42 offen offset:1024 sc1
	s_waitcnt vmcnt(27)
	v_mfma_f32_16x16x32_bf16 v[28:31], a[232:235], v[208:211], v[28:31]
	v_mfma_f32_16x16x32_bf16 v[36:39], a[232:235], v[212:215], v[36:39]
	buffer_load_dwordx4 a[232:235], v6, s[4:7], s42 offen offset:2048 sc1
	s_waitcnt vmcnt(27)
	v_mfma_f32_16x16x32_bf16 v[28:31], a[236:239], v[216:219], v[28:31]
	v_mfma_f32_16x16x32_bf16 v[36:39], a[236:239], v[220:223], v[36:39]
	buffer_load_dwordx4 a[236:239], v6, s[4:7], s42 offen offset:3072 sc1
	s_waitcnt vmcnt(27)
	v_mfma_f32_16x16x32_bf16 v[28:31], a[240:243], v[224:227], v[28:31]
	v_mfma_f32_16x16x32_bf16 v[36:39], a[240:243], v[228:231], v[36:39]
	s_add_u32 s42, s24, 53248
	buffer_load_dwordx4 a[240:243], v6, s[4:7], s42 offen offset:0 sc1
	s_waitcnt vmcnt(27)
	v_mfma_f32_16x16x32_bf16 v[28:31], a[244:247], v[232:235], v[28:31]
	v_mfma_f32_16x16x32_bf16 v[36:39], a[244:247], v[236:239], v[36:39]
	buffer_load_dwordx4 a[244:247], v6, s[4:7], s42 offen offset:1024 sc1
	s_waitcnt vmcnt(27)
	v_mfma_f32_16x16x32_bf16 v[28:31], a[248:251], v[240:243], v[28:31]
	v_mfma_f32_16x16x32_bf16 v[36:39], a[248:251], v[244:247], v[36:39]
	buffer_load_dwordx4 a[248:251], v6, s[4:7], s42 offen offset:2048 sc1
	s_waitcnt vmcnt(27)
	v_mfma_f32_16x16x32_bf16 v[28:31], a[252:255], v[248:251], v[28:31]
	v_mfma_f32_16x16x32_bf16 v[36:39], a[252:255], v[252:255], v[36:39]
	buffer_load_dwordx4 a[252:255], v6, s[4:7], s42 offen offset:3072 sc1
	v_mul_f32 v48, v24, v24
	v_mul_f32 v49, v25, v25
	v_mul_f32 v50, v26, v26
	v_mul_f32 v51, v27, v27
	v_mul_f32 v52, v28, v28
	v_mul_f32 v53, v29, v29
	v_mul_f32 v54, v30, v30
	v_mul_f32 v55, v31, v31
	v_mul_f32 v56, v32, v32
	v_mul_f32 v57, v33, v33
	v_mul_f32 v58, v34, v34
	v_mul_f32 v59, v35, v35
	v_mul_f32 v60, v36, v36
	v_mul_f32 v61, v37, v37
	v_mul_f32 v62, v38, v38
	v_mul_f32 v63, v39, v39
	v_fma_f32 v48, v48, s26, v20
	v_fma_f32 v49, v49, s26, v20
	v_fma_f32 v50, v50, s26, v20
	v_fma_f32 v51, v51, s26, v20
	v_fma_f32 v52, v52, s26, v20
	v_fma_f32 v53, v53, s26, v20
	v_fma_f32 v54, v54, s26, v20
	v_fma_f32 v55, v55, s26, v20
	v_fma_f32 v56, v56, s26, v20
	v_fma_f32 v57, v57, s26, v20
	v_fma_f32 v58, v58, s26, v20
	v_fma_f32 v59, v59, s26, v20
	v_fma_f32 v60, v60, s26, v20
	v_fma_f32 v61, v61, s26, v20
	v_fma_f32 v62, v62, s26, v20
	v_fma_f32 v63, v63, s26, v20
	v_mul_f32 v48, v48, v24
	v_mul_f32 v49, v49, v25
	v_mul_f32 v50, v50, v26
	v_mul_f32 v51, v51, v27
	v_mul_f32 v52, v52, v28
	v_mul_f32 v53, v53, v29
	v_mul_f32 v54, v54, v30
	v_mul_f32 v55, v55, v31
	v_mul_f32 v56, v56, v32
	v_mul_f32 v57, v57, v33
	v_mul_f32 v58, v58, v34
	v_mul_f32 v59, v59, v35
	v_mul_f32 v60, v60, v36
	v_mul_f32 v61, v61, v37
	v_mul_f32 v62, v62, v38
	v_mul_f32 v63, v63, v39
	v_exp_f32 v48, v48
	v_exp_f32 v49, v49
	v_exp_f32 v50, v50
	v_exp_f32 v51, v51
	v_exp_f32 v52, v52
	v_exp_f32 v53, v53
	v_exp_f32 v54, v54
	v_exp_f32 v55, v55
	v_exp_f32 v56, v56
	v_exp_f32 v57, v57
	v_exp_f32 v58, v58
	v_exp_f32 v59, v59
	v_exp_f32 v60, v60
	v_exp_f32 v61, v61
	v_exp_f32 v62, v62
	v_exp_f32 v63, v63
	v_add_f32 v48, 1.0, v48
	v_add_f32 v49, 1.0, v49
	v_add_f32 v50, 1.0, v50
	v_add_f32 v51, 1.0, v51
	v_add_f32 v52, 1.0, v52
	v_add_f32 v53, 1.0, v53
	v_add_f32 v54, 1.0, v54
	v_add_f32 v55, 1.0, v55
	v_add_f32 v56, 1.0, v56
	v_add_f32 v57, 1.0, v57
	v_add_f32 v58, 1.0, v58
	v_add_f32 v59, 1.0, v59
	v_add_f32 v60, 1.0, v60
	v_add_f32 v61, 1.0, v61
	v_add_f32 v62, 1.0, v62
	v_add_f32 v63, 1.0, v63
	v_rcp_f32 v48, v48
	v_rcp_f32 v49, v49
	v_rcp_f32 v50, v50
	v_rcp_f32 v51, v51
	v_rcp_f32 v52, v52
	v_rcp_f32 v53, v53
	v_rcp_f32 v54, v54
	v_rcp_f32 v55, v55
	v_rcp_f32 v56, v56
	v_rcp_f32 v57, v57
	v_rcp_f32 v58, v58
	v_rcp_f32 v59, v59
	v_rcp_f32 v60, v60
	v_rcp_f32 v61, v61
	v_rcp_f32 v62, v62
	v_rcp_f32 v63, v63
	v_mul_f32 v48, v48, v24
	v_mul_f32 v49, v49, v25
	v_mul_f32 v50, v50, v26
	v_mul_f32 v51, v51, v27
	v_mul_f32 v52, v52, v28
	v_mul_f32 v53, v53, v29
	v_mul_f32 v54, v54, v30
	v_mul_f32 v55, v55, v31
	v_mul_f32 v56, v56, v32
	v_mul_f32 v57, v57, v33
	v_mul_f32 v58, v58, v34
	v_mul_f32 v59, v59, v35
	v_mul_f32 v60, v60, v36
	v_mul_f32 v61, v61, v37
	v_mul_f32 v62, v62, v38
	v_mul_f32 v63, v63, v39
	v_cvt_pk_bf16_f32 v12, v48, v49
	v_cvt_pk_bf16_f32 v13, v50, v51
	v_cvt_pk_bf16_f32 v14, v52, v53
	v_cvt_pk_bf16_f32 v15, v54, v55
	v_cvt_pk_bf16_f32 v16, v56, v57
	v_cvt_pk_bf16_f32 v17, v58, v59
	v_cvt_pk_bf16_f32 v18, v60, v61
	v_cvt_pk_bf16_f32 v19, v62, v63
	s_waitcnt vmcnt(27)
	v_mfma_f32_16x16x32_bf16 a[0:3], v[64:67], v[12:15], a[0:3]
	v_mfma_f32_16x16x32_bf16 a[112:115], v[64:67], v[16:19], a[112:115]
	s_add_u32 s42, s24, 57344
	buffer_load_dwordx4 v[64:67], v6, s[4:7], s42 offen offset:0 sc1
	s_waitcnt vmcnt(27)
	v_mfma_f32_16x16x32_bf16 a[4:7], v[68:71], v[12:15], a[4:7]
	v_mfma_f32_16x16x32_bf16 a[116:119], v[68:71], v[16:19], a[116:119]
	buffer_load_dwordx4 v[68:71], v6, s[4:7], s42 offen offset:1024 sc1
	s_waitcnt vmcnt(27)
	v_mfma_f32_16x16x32_bf16 a[8:11], v[72:75], v[12:15], a[8:11]
	v_mfma_f32_16x16x32_bf16 a[120:123], v[72:75], v[16:19], a[120:123]
	buffer_load_dwordx4 v[72:75], v6, s[4:7], s42 offen offset:2048 sc1
	s_waitcnt vmcnt(27)
	v_mfma_f32_16x16x32_bf16 a[12:15], v[76:79], v[12:15], a[12:15]
	v_mfma_f32_16x16x32_bf16 a[124:127], v[76:79], v[16:19], a[124:127]
	buffer_load_dwordx4 v[76:79], v6, s[4:7], s42 offen offset:3072 sc1
	s_waitcnt vmcnt(27)
	v_mfma_f32_16x16x32_bf16 a[16:19], v[80:83], v[12:15], a[16:19]
	v_mfma_f32_16x16x32_bf16 a[128:131], v[80:83], v[16:19], a[128:131]
	s_add_u32 s42, s24, 61440
	buffer_load_dwordx4 v[80:83], v6, s[4:7], s42 offen offset:0 sc1
	s_waitcnt vmcnt(27)
	v_mfma_f32_16x16x32_bf16 a[20:23], v[84:87], v[12:15], a[20:23]
	v_mfma_f32_16x16x32_bf16 a[132:135], v[84:87], v[16:19], a[132:135]
	buffer_load_dwordx4 v[84:87], v6, s[4:7], s42 offen offset:1024 sc1
	s_waitcnt vmcnt(27)
	v_mfma_f32_16x16x32_bf16 a[24:27], v[88:91], v[12:15], a[24:27]
	v_mfma_f32_16x16x32_bf16 a[136:139], v[88:91], v[16:19], a[136:139]
	buffer_load_dwordx4 v[88:91], v6, s[4:7], s42 offen offset:2048 sc1
	s_waitcnt vmcnt(27)
	v_mfma_f32_16x16x32_bf16 a[28:31], v[92:95], v[12:15], a[28:31]
	v_mfma_f32_16x16x32_bf16 a[140:143], v[92:95], v[16:19], a[140:143]
	buffer_load_dwordx4 v[92:95], v6, s[4:7], s42 offen offset:3072 sc1
	s_waitcnt vmcnt(27)
	v_mfma_f32_16x16x32_bf16 a[32:35], v[96:99], v[12:15], a[32:35]
	v_mfma_f32_16x16x32_bf16 a[144:147], v[96:99], v[16:19], a[144:147]
	s_add_u32 s42, s24, 65536
	buffer_load_dwordx4 v[96:99], v6, s[4:7], s42 offen offset:0 sc1
	s_waitcnt vmcnt(27)
	v_mfma_f32_16x16x32_bf16 a[36:39], v[100:103], v[12:15], a[36:39]
	v_mfma_f32_16x16x32_bf16 a[148:151], v[100:103], v[16:19], a[148:151]
	buffer_load_dwordx4 v[100:103], v6, s[4:7], s42 offen offset:1024 sc1
	s_waitcnt vmcnt(27)
	v_mfma_f32_16x16x32_bf16 a[40:43], v[104:107], v[12:15], a[40:43]
	v_mfma_f32_16x16x32_bf16 a[152:155], v[104:107], v[16:19], a[152:155]
	buffer_load_dwordx4 v[104:107], v6, s[4:7], s42 offen offset:2048 sc1
	s_waitcnt vmcnt(27)
	v_mfma_f32_16x16x32_bf16 a[44:47], v[108:111], v[12:15], a[44:47]
	v_mfma_f32_16x16x32_bf16 a[156:159], v[108:111], v[16:19], a[156:159]
	buffer_load_dwordx4 v[108:111], v6, s[4:7], s42 offen offset:3072 sc1
	s_waitcnt vmcnt(27)
	v_mfma_f32_16x16x32_bf16 a[48:51], v[112:115], v[12:15], a[48:51]
	v_mfma_f32_16x16x32_bf16 a[160:163], v[112:115], v[16:19], a[160:163]
	s_add_u32 s42, s24, 69632
	buffer_load_dwordx4 v[112:115], v6, s[4:7], s42 offen offset:0 sc1
	s_waitcnt vmcnt(27)
	v_mfma_f32_16x16x32_bf16 a[52:55], v[116:119], v[12:15], a[52:55]
	v_mfma_f32_16x16x32_bf16 a[164:167], v[116:119], v[16:19], a[164:167]
	buffer_load_dwordx4 v[116:119], v6, s[4:7], s42 offen offset:1024 sc1
	s_waitcnt vmcnt(27)
	v_mfma_f32_16x16x32_bf16 a[56:59], v[120:123], v[12:15], a[56:59]
	v_mfma_f32_16x16x32_bf16 a[168:171], v[120:123], v[16:19], a[168:171]
	buffer_load_dwordx4 v[120:123], v6, s[4:7], s42 offen offset:2048 sc1
	s_waitcnt vmcnt(27)
	v_mfma_f32_16x16x32_bf16 a[60:63], v[124:127], v[12:15], a[60:63]
	v_mfma_f32_16x16x32_bf16 a[172:175], v[124:127], v[16:19], a[172:175]
	buffer_load_dwordx4 v[124:127], v6, s[4:7], s42 offen offset:3072 sc1
	s_waitcnt vmcnt(27)
	v_mfma_f32_16x16x32_bf16 a[64:67], v[128:131], v[12:15], a[64:67]
	v_mfma_f32_16x16x32_bf16 a[176:179], v[128:131], v[16:19], a[176:179]
	s_add_u32 s42, s24, 73728
	buffer_load_dwordx4 v[128:131], v6, s[4:7], s42 offen offset:0 sc1
	s_waitcnt vmcnt(27)
	v_mfma_f32_16x16x32_bf16 a[68:71], v[132:135], v[12:15], a[68:71]
	v_mfma_f32_16x16x32_bf16 a[180:183], v[132:135], v[16:19], a[180:183]
	buffer_load_dwordx4 v[132:135], v6, s[4:7], s42 offen offset:1024 sc1
	s_waitcnt vmcnt(27)
	v_mfma_f32_16x16x32_bf16 a[72:75], v[136:139], v[12:15], a[72:75]
	v_mfma_f32_16x16x32_bf16 a[184:187], v[136:139], v[16:19], a[184:187]
	buffer_load_dwordx4 v[136:139], v6, s[4:7], s42 offen offset:2048 sc1
	s_waitcnt vmcnt(27)
	v_mfma_f32_16x16x32_bf16 a[76:79], v[140:143], v[12:15], a[76:79]
	v_mfma_f32_16x16x32_bf16 a[188:191], v[140:143], v[16:19], a[188:191]
	buffer_load_dwordx4 v[140:143], v6, s[4:7], s42 offen offset:3072 sc1
	s_waitcnt vmcnt(27)
	v_mfma_f32_16x16x32_bf16 a[80:83], a[224:227], v[12:15], a[80:83]
	v_mfma_f32_16x16x32_bf16 a[192:195], a[224:227], v[16:19], a[192:195]
	s_add_u32 s42, s24, 77824
	buffer_load_dwordx4 a[224:227], v6, s[4:7], s42 offen offset:0 sc1
	s_waitcnt vmcnt(27)
	v_mfma_f32_16x16x32_bf16 a[84:87], a[228:231], v[12:15], a[84:87]
	v_mfma_f32_16x16x32_bf16 a[196:199], a[228:231], v[16:19], a[196:199]
	buffer_load_dwordx4 a[228:231], v6, s[4:7], s42 offen offset:1024 sc1
	s_waitcnt vmcnt(27)
	v_mfma_f32_16x16x32_bf16 a[88:91], a[232:235], v[12:15], a[88:91]
	v_mfma_f32_16x16x32_bf16 a[200:203], a[232:235], v[16:19], a[200:203]
	buffer_load_dwordx4 a[232:235], v6, s[4:7], s42 offen offset:2048 sc1
	s_waitcnt vmcnt(27)
	v_mfma_f32_16x16x32_bf16 a[92:95], a[236:239], v[12:15], a[92:95]
	v_mfma_f32_16x16x32_bf16 a[204:207], a[236:239], v[16:19], a[204:207]
	buffer_load_dwordx4 a[236:239], v6, s[4:7], s42 offen offset:3072 sc1
	s_waitcnt vmcnt(27)
	v_mfma_f32_16x16x32_bf16 a[96:99], a[240:243], v[12:15], a[96:99]
	v_mfma_f32_16x16x32_bf16 a[208:211], a[240:243], v[16:19], a[208:211]
	s_add_u32 s42, s24, 81920
	buffer_load_dwordx4 a[240:243], v6, s[4:7], s42 offen offset:0 sc1
	s_waitcnt vmcnt(27)
	v_mfma_f32_16x16x32_bf16 a[100:103], a[244:247], v[12:15], a[100:103]
	v_mfma_f32_16x16x32_bf16 a[212:215], a[244:247], v[16:19], a[212:215]
	buffer_load_dwordx4 a[244:247], v6, s[4:7], s42 offen offset:1024 sc1
	s_waitcnt vmcnt(27)
	v_mfma_f32_16x16x32_bf16 a[104:107], a[248:251], v[12:15], a[104:107]
	v_mfma_f32_16x16x32_bf16 a[216:219], a[248:251], v[16:19], a[216:219]
	buffer_load_dwordx4 a[248:251], v6, s[4:7], s42 offen offset:2048 sc1
	s_waitcnt vmcnt(27)
	v_mfma_f32_16x16x32_bf16 a[108:111], a[252:255], v[12:15], a[108:111]
	v_mfma_f32_16x16x32_bf16 a[220:223], a[252:255], v[16:19], a[220:223]
	buffer_load_dwordx4 a[252:255], v6, s[4:7], s42 offen offset:3072 sc1
	s_add_u32 s24, s24, 57344
	s_add_u32 s25, s25, 1
	s_cmp_lt_u32 s25, 14
	s_cbranch_scc1 Lm_loop
	s_mov_b32 s20, s66
	s_and_b32 s21, s67, 0xffff
	s_mov_b32 s22, 896
	s_mov_b32 s23, 0x00020000
	s_mul_i32 s40, s33, 224
	v_lshlrev_b32 v10, 3, v2
	s_waitcnt vmcnt(0)
	buffer_load_dwordx2 v[24:25], v10, s[20:23], s40 offen offset:0
	buffer_load_dwordx2 v[26:27], v10, s[20:23], s40 offen offset:32
	buffer_load_dwordx2 v[28:29], v10, s[20:23], s40 offen offset:64
	buffer_load_dwordx2 v[30:31], v10, s[20:23], s40 offen offset:96
	buffer_load_dwordx2 v[32:33], v10, s[20:23], s40 offen offset:128
	buffer_load_dwordx2 v[34:35], v10, s[20:23], s40 offen offset:160
	buffer_load_dwordx2 v[36:37], v10, s[20:23], s40 offen offset:192
	s_mul_i32 s40, s33, 28672
	v_add_u32 v12, s40, v6
	s_mul_i32 s40, s33, 7168
	v_add_u32 v13, s40, v6
	v_add_u32 v14, 57344, v13
	v_lshlrev_b32 v15, 2, v1
	v_add_u32 v15, 118784, v15
	ds_read_b32 v16, v15
	ds_read_b32 v17, v15 offset:64
	s_mul_i32 s41, s32, 57344
	s_mul_i32 s40, s33, 14336
	s_add_u32 s41, s41, s40
	s_add_u32 s41, s41, 56590336
	s_waitcnt vmcnt(0) lgkmcnt(0)
	v_sub_f32 v16, 1.0, v16
	v_sub_f32 v17, 1.0, v17
	v_lshlrev_b32 v180, 16, v24
	v_and_b32 v181, 0xffff0000, v24
	v_lshlrev_b32 v182, 16, v25
	v_and_b32 v183, 0xffff0000, v25
	v_lshlrev_b32 v184, 16, v26
	v_and_b32 v185, 0xffff0000, v26
	v_lshlrev_b32 v186, 16, v27
	v_and_b32 v187, 0xffff0000, v27
	v_lshlrev_b32 v188, 16, v28
	v_and_b32 v189, 0xffff0000, v28
	v_lshlrev_b32 v190, 16, v29
	v_and_b32 v191, 0xffff0000, v29
	v_lshlrev_b32 v192, 16, v30
	v_and_b32 v193, 0xffff0000, v30
	v_lshlrev_b32 v194, 16, v31
	v_and_b32 v195, 0xffff0000, v31
	v_lshlrev_b32 v196, 16, v32
	v_and_b32 v197, 0xffff0000, v32
	v_lshlrev_b32 v198, 16, v33
	v_and_b32 v199, 0xffff0000, v33
	v_lshlrev_b32 v200, 16, v34
	v_and_b32 v201, 0xffff0000, v34
	v_lshlrev_b32 v202, 16, v35
	v_and_b32 v203, 0xffff0000, v35
	v_lshlrev_b32 v204, 16, v36
	v_and_b32 v205, 0xffff0000, v36
	v_lshlrev_b32 v206, 16, v37
	v_and_b32 v207, 0xffff0000, v37
	s_barrier
	ds_write_b128 v12, a[0:3] offset:0
	ds_write_b128 v12, a[4:7] offset:1024
	ds_write_b128 v12, a[8:11] offset:2048
	ds_write_b128 v12, a[12:15] offset:3072
	ds_write_b128 v12, a[16:19] offset:4096
	ds_write_b128 v12, a[20:23] offset:5120
	ds_write_b128 v12, a[24:27] offset:6144
	ds_write_b128 v12, a[28:31] offset:7168
	ds_write_b128 v12, a[32:35] offset:8192
	ds_write_b128 v12, a[36:39] offset:9216
	ds_write_b128 v12, a[40:43] offset:10240
	ds_write_b128 v12, a[44:47] offset:11264
	ds_write_b128 v12, a[48:51] offset:12288
	ds_write_b128 v12, a[52:55] offset:13312
	ds_write_b128 v12, a[56:59] offset:14336
	ds_write_b128 v12, a[60:63] offset:15360
	ds_write_b128 v12, a[64:67] offset:16384
	ds_write_b128 v12, a[68:71] offset:17408
	ds_write_b128 v12, a[72:75] offset:18432
	ds_write_b128 v12, a[76:79] offset:19456
	ds_write_b128 v12, a[80:83] offset:20480
	ds_write_b128 v12, a[84:87] offset:21504
	ds_write_b128 v12, a[88:91] offset:22528
	ds_write_b128 v12, a[92:95] offset:23552
	ds_write_b128 v12, a[96:99] offset:24576
	ds_write_b128 v12, a[100:103] offset:25600
	ds_write_b128 v12, a[104:107] offset:26624
	ds_write_b128 v12, a[108:111] offset:27648
	s_waitcnt lgkmcnt(0)
	s_barrier
	ds_read_b128 v[64:67], v13 offset:0
	ds_read_b128 v[68:71], v13 offset:28672
	ds_read_b128 v[72:75], v14 offset:0
	ds_read_b128 v[76:79], v14 offset:28672
	ds_read_b128 v[80:83], v13 offset:1024
	ds_read_b128 v[84:87], v13 offset:29696
	ds_read_b128 v[88:91], v14 offset:1024
	ds_read_b128 v[92:95], v14 offset:29696
	ds_read_b128 v[96:99], v13 offset:2048
	ds_read_b128 v[100:103], v13 offset:30720
	ds_read_b128 v[104:107], v14 offset:2048
	ds_read_b128 v[108:111], v14 offset:30720
	ds_read_b128 v[112:115], v13 offset:3072
	ds_read_b128 v[116:119], v13 offset:31744
	ds_read_b128 v[120:123], v14 offset:3072
	ds_read_b128 v[124:127], v14 offset:31744
	ds_read_b128 v[128:131], v13 offset:4096
	ds_read_b128 v[132:135], v13 offset:32768
	ds_read_b128 v[136:139], v14 offset:4096
	ds_read_b128 v[140:143], v14 offset:32768
	ds_read_b128 v[144:147], v13 offset:5120
	ds_read_b128 v[148:151], v13 offset:33792
	ds_read_b128 v[152:155], v14 offset:5120
	ds_read_b128 v[156:159], v14 offset:33792
	ds_read_b128 v[160:163], v13 offset:6144
	ds_read_b128 v[164:167], v13 offset:34816
	ds_read_b128 v[168:171], v14 offset:6144
	ds_read_b128 v[172:175], v14 offset:34816
	s_waitcnt lgkmcnt(0)
	v_pk_add_f32 v[64:65], v[64:65], v[68:69]
	v_pk_add_f32 v[72:73], v[72:73], v[76:77]
	v_pk_add_f32 v[64:65], v[64:65], v[180:181]
	v_pk_add_f32 v[64:65], v[64:65], v[72:73]
	v_pk_add_f32 v[66:67], v[66:67], v[70:71]
	v_pk_add_f32 v[74:75], v[74:75], v[78:79]
	v_pk_add_f32 v[66:67], v[66:67], v[182:183]
	v_pk_add_f32 v[66:67], v[66:67], v[74:75]
	v_mul_f32 v64, v64, v16
	v_mul_f32 v65, v65, v16
	v_mul_f32 v66, v66, v16
	v_mul_f32 v67, v67, v16
	s_add_u32 s40, s41, 0
	buffer_store_dwordx4 v[64:67], v6, s[4:7], s40 offen sc1
	v_pk_add_f32 v[80:81], v[80:81], v[84:85]
	v_pk_add_f32 v[88:89], v[88:89], v[92:93]
	v_pk_add_f32 v[80:81], v[80:81], v[184:185]
	v_pk_add_f32 v[80:81], v[80:81], v[88:89]
	v_pk_add_f32 v[82:83], v[82:83], v[86:87]
	v_pk_add_f32 v[90:91], v[90:91], v[94:95]
	v_pk_add_f32 v[82:83], v[82:83], v[186:187]
	v_pk_add_f32 v[82:83], v[82:83], v[90:91]
	v_mul_f32 v80, v80, v16
	v_mul_f32 v81, v81, v16
	v_mul_f32 v82, v82, v16
	v_mul_f32 v83, v83, v16
	s_add_u32 s40, s41, 2048
	buffer_store_dwordx4 v[80:83], v6, s[4:7], s40 offen sc1
	v_pk_add_f32 v[96:97], v[96:97], v[100:101]
	v_pk_add_f32 v[104:105], v[104:105], v[108:109]
	v_pk_add_f32 v[96:97], v[96:97], v[188:189]
	v_pk_add_f32 v[96:97], v[96:97], v[104:105]
	v_pk_add_f32 v[98:99], v[98:99], v[102:103]
	v_pk_add_f32 v[106:107], v[106:107], v[110:111]
	v_pk_add_f32 v[98:99], v[98:99], v[190:191]
	v_pk_add_f32 v[98:99], v[98:99], v[106:107]
	v_mul_f32 v96, v96, v16
	v_mul_f32 v97, v97, v16
	v_mul_f32 v98, v98, v16
	v_mul_f32 v99, v99, v16
	s_add_u32 s40, s41, 4096
	buffer_store_dwordx4 v[96:99], v6, s[4:7], s40 offen sc1
	v_pk_add_f32 v[112:113], v[112:113], v[116:117]
	v_pk_add_f32 v[120:121], v[120:121], v[124:125]
	v_pk_add_f32 v[112:113], v[112:113], v[192:193]
	v_pk_add_f32 v[112:113], v[112:113], v[120:121]
	v_pk_add_f32 v[114:115], v[114:115], v[118:119]
	v_pk_add_f32 v[122:123], v[122:123], v[126:127]
	v_pk_add_f32 v[114:115], v[114:115], v[194:195]
	v_pk_add_f32 v[114:115], v[114:115], v[122:123]
	v_mul_f32 v112, v112, v16
	v_mul_f32 v113, v113, v16
	v_mul_f32 v114, v114, v16
	v_mul_f32 v115, v115, v16
	s_add_u32 s40, s41, 6144
	buffer_store_dwordx4 v[112:115], v6, s[4:7], s40 offen sc1
	v_pk_add_f32 v[128:129], v[128:129], v[132:133]
	v_pk_add_f32 v[136:137], v[136:137], v[140:141]
	v_pk_add_f32 v[128:129], v[128:129], v[196:197]
	v_pk_add_f32 v[128:129], v[128:129], v[136:137]
	v_pk_add_f32 v[130:131], v[130:131], v[134:135]
	v_pk_add_f32 v[138:139], v[138:139], v[142:143]
	v_pk_add_f32 v[130:131], v[130:131], v[198:199]
	v_pk_add_f32 v[130:131], v[130:131], v[138:139]
	v_mul_f32 v128, v128, v16
	v_mul_f32 v129, v129, v16
	v_mul_f32 v130, v130, v16
	v_mul_f32 v131, v131, v16
	s_add_u32 s40, s41, 8192
	buffer_store_dwordx4 v[128:131], v6, s[4:7], s40 offen sc1
	v_pk_add_f32 v[144:145], v[144:145], v[148:149]
	v_pk_add_f32 v[152:153], v[152:153], v[156:157]
	v_pk_add_f32 v[144:145], v[144:145], v[200:201]
	v_pk_add_f32 v[144:145], v[144:145], v[152:153]
	v_pk_add_f32 v[146:147], v[146:147], v[150:151]
	v_pk_add_f32 v[154:155], v[154:155], v[158:159]
	v_pk_add_f32 v[146:147], v[146:147], v[202:203]
	v_pk_add_f32 v[146:147], v[146:147], v[154:155]
	v_mul_f32 v144, v144, v16
	v_mul_f32 v145, v145, v16
	v_mul_f32 v146, v146, v16
	v_mul_f32 v147, v147, v16
	s_add_u32 s40, s41, 10240
	buffer_store_dwordx4 v[144:147], v6, s[4:7], s40 offen sc1
	v_pk_add_f32 v[160:161], v[160:161], v[164:165]
	v_pk_add_f32 v[168:169], v[168:169], v[172:173]
	v_pk_add_f32 v[160:161], v[160:161], v[204:205]
	v_pk_add_f32 v[160:161], v[160:161], v[168:169]
	v_pk_add_f32 v[162:163], v[162:163], v[166:167]
	v_pk_add_f32 v[170:171], v[170:171], v[174:175]
	v_pk_add_f32 v[162:163], v[162:163], v[206:207]
	v_pk_add_f32 v[162:163], v[162:163], v[170:171]
	v_mul_f32 v160, v160, v16
	v_mul_f32 v161, v161, v16
	v_mul_f32 v162, v162, v16
	v_mul_f32 v163, v163, v16
	s_add_u32 s40, s41, 12288
	buffer_store_dwordx4 v[160:163], v6, s[4:7], s40 offen sc1
	s_barrier
	ds_write_b128 v12, a[112:115] offset:0
	ds_write_b128 v12, a[116:119] offset:1024
	ds_write_b128 v12, a[120:123] offset:2048
	ds_write_b128 v12, a[124:127] offset:3072
	ds_write_b128 v12, a[128:131] offset:4096
	ds_write_b128 v12, a[132:135] offset:5120
	ds_write_b128 v12, a[136:139] offset:6144
	ds_write_b128 v12, a[140:143] offset:7168
	ds_write_b128 v12, a[144:147] offset:8192
	ds_write_b128 v12, a[148:151] offset:9216
	ds_write_b128 v12, a[152:155] offset:10240
	ds_write_b128 v12, a[156:159] offset:11264
	ds_write_b128 v12, a[160:163] offset:12288
	ds_write_b128 v12, a[164:167] offset:13312
	ds_write_b128 v12, a[168:171] offset:14336
	ds_write_b128 v12, a[172:175] offset:15360
	ds_write_b128 v12, a[176:179] offset:16384
	ds_write_b128 v12, a[180:183] offset:17408
	ds_write_b128 v12, a[184:187] offset:18432
	ds_write_b128 v12, a[188:191] offset:19456
	ds_write_b128 v12, a[192:195] offset:20480
	ds_write_b128 v12, a[196:199] offset:21504
	ds_write_b128 v12, a[200:203] offset:22528
	ds_write_b128 v12, a[204:207] offset:23552
	ds_write_b128 v12, a[208:211] offset:24576
	ds_write_b128 v12, a[212:215] offset:25600
	ds_write_b128 v12, a[216:219] offset:26624
	ds_write_b128 v12, a[220:223] offset:27648
	s_waitcnt lgkmcnt(0)
	s_barrier
	ds_read_b128 v[64:67], v13 offset:0
	ds_read_b128 v[68:71], v13 offset:28672
	ds_read_b128 v[72:75], v14 offset:0
	ds_read_b128 v[76:79], v14 offset:28672
	ds_read_b128 v[80:83], v13 offset:1024
	ds_read_b128 v[84:87], v13 offset:29696
	ds_read_b128 v[88:91], v14 offset:1024
	ds_read_b128 v[92:95], v14 offset:29696
	ds_read_b128 v[96:99], v13 offset:2048
	ds_read_b128 v[100:103], v13 offset:30720
	ds_read_b128 v[104:107], v14 offset:2048
	ds_read_b128 v[108:111], v14 offset:30720
	ds_read_b128 v[112:115], v13 offset:3072
	ds_read_b128 v[116:119], v13 offset:31744
	ds_read_b128 v[120:123], v14 offset:3072
	ds_read_b128 v[124:127], v14 offset:31744
	ds_read_b128 v[128:131], v13 offset:4096
	ds_read_b128 v[132:135], v13 offset:32768
	ds_read_b128 v[136:139], v14 offset:4096
	ds_read_b128 v[140:143], v14 offset:32768
	ds_read_b128 v[144:147], v13 offset:5120
	ds_read_b128 v[148:151], v13 offset:33792
	ds_read_b128 v[152:155], v14 offset:5120
	ds_read_b128 v[156:159], v14 offset:33792
	ds_read_b128 v[160:163], v13 offset:6144
	ds_read_b128 v[164:167], v13 offset:34816
	ds_read_b128 v[168:171], v14 offset:6144
	ds_read_b128 v[172:175], v14 offset:34816
	s_waitcnt lgkmcnt(0)
	v_pk_add_f32 v[64:65], v[64:65], v[68:69]
	v_pk_add_f32 v[72:73], v[72:73], v[76:77]
	v_pk_add_f32 v[64:65], v[64:65], v[180:181]
	v_pk_add_f32 v[64:65], v[64:65], v[72:73]
	v_pk_add_f32 v[66:67], v[66:67], v[70:71]
	v_pk_add_f32 v[74:75], v[74:75], v[78:79]
	v_pk_add_f32 v[66:67], v[66:67], v[182:183]
	v_pk_add_f32 v[66:67], v[66:67], v[74:75]
	v_mul_f32 v64, v64, v17
	v_mul_f32 v65, v65, v17
	v_mul_f32 v66, v66, v17
	v_mul_f32 v67, v67, v17
	s_add_u32 s40, s41, 1024
	buffer_store_dwordx4 v[64:67], v6, s[4:7], s40 offen sc1
	v_pk_add_f32 v[80:81], v[80:81], v[84:85]
	v_pk_add_f32 v[88:89], v[88:89], v[92:93]
	v_pk_add_f32 v[80:81], v[80:81], v[184:185]
	v_pk_add_f32 v[80:81], v[80:81], v[88:89]
	v_pk_add_f32 v[82:83], v[82:83], v[86:87]
	v_pk_add_f32 v[90:91], v[90:91], v[94:95]
	v_pk_add_f32 v[82:83], v[82:83], v[186:187]
	v_pk_add_f32 v[82:83], v[82:83], v[90:91]
	v_mul_f32 v80, v80, v17
	v_mul_f32 v81, v81, v17
	v_mul_f32 v82, v82, v17
	v_mul_f32 v83, v83, v17
	s_add_u32 s40, s41, 3072
	buffer_store_dwordx4 v[80:83], v6, s[4:7], s40 offen sc1
	v_pk_add_f32 v[96:97], v[96:97], v[100:101]
	v_pk_add_f32 v[104:105], v[104:105], v[108:109]
	v_pk_add_f32 v[96:97], v[96:97], v[188:189]
	v_pk_add_f32 v[96:97], v[96:97], v[104:105]
	v_pk_add_f32 v[98:99], v[98:99], v[102:103]
	v_pk_add_f32 v[106:107], v[106:107], v[110:111]
	v_pk_add_f32 v[98:99], v[98:99], v[190:191]
	v_pk_add_f32 v[98:99], v[98:99], v[106:107]
	v_mul_f32 v96, v96, v17
	v_mul_f32 v97, v97, v17
	v_mul_f32 v98, v98, v17
	v_mul_f32 v99, v99, v17
	s_add_u32 s40, s41, 5120
	buffer_store_dwordx4 v[96:99], v6, s[4:7], s40 offen sc1
	v_pk_add_f32 v[112:113], v[112:113], v[116:117]
	v_pk_add_f32 v[120:121], v[120:121], v[124:125]
	v_pk_add_f32 v[112:113], v[112:113], v[192:193]
	v_pk_add_f32 v[112:113], v[112:113], v[120:121]
	v_pk_add_f32 v[114:115], v[114:115], v[118:119]
	v_pk_add_f32 v[122:123], v[122:123], v[126:127]
	v_pk_add_f32 v[114:115], v[114:115], v[194:195]
	v_pk_add_f32 v[114:115], v[114:115], v[122:123]
	v_mul_f32 v112, v112, v17
	v_mul_f32 v113, v113, v17
	v_mul_f32 v114, v114, v17
	v_mul_f32 v115, v115, v17
	s_add_u32 s40, s41, 7168
	buffer_store_dwordx4 v[112:115], v6, s[4:7], s40 offen sc1
	v_pk_add_f32 v[128:129], v[128:129], v[132:133]
	v_pk_add_f32 v[136:137], v[136:137], v[140:141]
	v_pk_add_f32 v[128:129], v[128:129], v[196:197]
	v_pk_add_f32 v[128:129], v[128:129], v[136:137]
	v_pk_add_f32 v[130:131], v[130:131], v[134:135]
	v_pk_add_f32 v[138:139], v[138:139], v[142:143]
	v_pk_add_f32 v[130:131], v[130:131], v[198:199]
	v_pk_add_f32 v[130:131], v[130:131], v[138:139]
	v_mul_f32 v128, v128, v17
	v_mul_f32 v129, v129, v17
	v_mul_f32 v130, v130, v17
	v_mul_f32 v131, v131, v17
	s_add_u32 s40, s41, 9216
	buffer_store_dwordx4 v[128:131], v6, s[4:7], s40 offen sc1
	v_pk_add_f32 v[144:145], v[144:145], v[148:149]
	v_pk_add_f32 v[152:153], v[152:153], v[156:157]
	v_pk_add_f32 v[144:145], v[144:145], v[200:201]
	v_pk_add_f32 v[144:145], v[144:145], v[152:153]
	v_pk_add_f32 v[146:147], v[146:147], v[150:151]
	v_pk_add_f32 v[154:155], v[154:155], v[158:159]
	v_pk_add_f32 v[146:147], v[146:147], v[202:203]
	v_pk_add_f32 v[146:147], v[146:147], v[154:155]
	v_mul_f32 v144, v144, v17
	v_mul_f32 v145, v145, v17
	v_mul_f32 v146, v146, v17
	v_mul_f32 v147, v147, v17
	s_add_u32 s40, s41, 11264
	buffer_store_dwordx4 v[144:147], v6, s[4:7], s40 offen sc1
	v_pk_add_f32 v[160:161], v[160:161], v[164:165]
	v_pk_add_f32 v[168:169], v[168:169], v[172:173]
	v_pk_add_f32 v[160:161], v[160:161], v[204:205]
	v_pk_add_f32 v[160:161], v[160:161], v[168:169]
	v_pk_add_f32 v[162:163], v[162:163], v[166:167]
	v_pk_add_f32 v[170:171], v[170:171], v[174:175]
	v_pk_add_f32 v[162:163], v[162:163], v[206:207]
	v_pk_add_f32 v[162:163], v[162:163], v[170:171]
	v_mul_f32 v160, v160, v17
	v_mul_f32 v161, v161, v17
	v_mul_f32 v162, v162, v17
	v_mul_f32 v163, v163, v17
	s_add_u32 s40, s41, 13312
	buffer_store_dwordx4 v[160:163], v6, s[4:7], s40 offen sc1
	s_lshl_b32 s40, s32, 7
	s_add_u32 s40, s40, 60286976
	s_waitcnt vmcnt(0)
	v_mov_b32 v9, 1
	buffer_atomic_add v9, v8, s[4:7], s40 offen
	s_waitcnt vmcnt(0)
	s_barrier
	s_add_u32 s32, s32, 28
	s_cmp_lt_u32 s32, 56
	s_cbranch_scc1 Lfin_k
	s_endpgm
Lbw_j:
	s_sub_u32 s32, s32, 32
	v_and_b32 v1, 15, v0
	v_lshrrev_b32 v2, 4, v0
	v_lshlrev_b32 v6, 4, v0
	v_lshrrev_b32 v7, 3, v0
	s_lshl_b32 s40, s33, 3
	v_add_u32 v7, s40, v7
	v_bfe_u32 v8, v7, 2, 2
	v_lshlrev_b32 v8, 3, v8
	v_lshrrev_b32 v9, 4, v7
	v_lshl_add_u32 v8, v9, 2, v8
	v_and_b32 v9, 3, v7
	v_add_u32 v8, v8, v9
	s_mov_b32 s40, 896
	v_mul_lo_u32 v8, v8, s40
	v_bfe_u32 v9, v7, 1, 3
	v_and_b32 v10, 7, v0
	v_xor_b32 v9, v9, v10
	v_lshl_add_u32 v3, v9, 4, v8
	v_lshrrev_b32 v9, 1, v1
	v_xor_b32 v9, v9, v2
	v_lshlrev_b32 v9, 4, v9
	v_lshl_add_u32 v4, v1, 7, v9
	v_xor_b32 v5, 64, v4
	v_mov_b32 v7, 0
	v_mov_b32 v9, 0x80000000
	v_cmp_eq_u32 vcc, 0, v0
	s_nop 1
	v_cndmask_b32 v8, v9, v0, vcc
	s_mov_b32 s16, 0x200000
	s_lshr_b32 s20, s32, 2
	s_and_b32 s21, s32, 3
	s_mov_b32 s12, s8
	s_mov_b32 s13, s9
	s_mov_b32 s14, s10
	s_mov_b32 s15, 0x00020000
	s_lshl_b32 s17, s33, 10
	s_mov_b32 s18, 0
	s_add_u32 m0, s17, 0
	s_nop 0
	buffer_load_dwordx4 v3, s[12:15], s18 offen offset:0 lds
	s_add_u32 m0, s17, 3968
	s_nop 0
	buffer_load_dwordx4 v3, s[12:15], s18 offen offset:128 lds
	s_add_u32 m0, s17, 7936
	s_nop 0
	buffer_load_dwordx4 v3, s[12:15], s18 offen offset:256 lds
	s_add_u32 m0, s17, 11904
	s_nop 0
	buffer_load_dwordx4 v3, s[12:15], s18 offen offset:384 lds
	s_add_u32 m0, s17, 15872
	s_nop 0
	buffer_load_dwordx4 v3, s[12:15], s18 offen offset:512 lds
	s_add_u32 m0, s17, 19840
	s_nop 0
	buffer_load_dwordx4 v3, s[12:15], s18 offen offset:640 lds
	s_add_u32 m0, s17, 23808
	s_nop 0
	buffer_load_dwordx4 v3, s[12:15], s18 offen offset:768 lds
	s_add_u32 s17, s17, 0x8000
	s_mov_b32 s18, 28672
	s_add_u32 m0, s17, 0
	s_nop 0
	buffer_load_dwordx4 v3, s[12:15], s18 offen offset:0 lds
	s_add_u32 m0, s17, 3968
	s_nop 0
	buffer_load_dwordx4 v3, s[12:15], s18 offen offset:128 lds
	s_add_u32 m0, s17, 7936
	s_nop 0
	buffer_load_dwordx4 v3, s[12:15], s18 offen offset:256 lds
	s_add_u32 m0, s17, 11904
	s_nop 0
	buffer_load_dwordx4 v3, s[12:15], s18 offen offset:384 lds
	s_add_u32 m0, s17, 15872
	s_nop 0
	buffer_load_dwordx4 v3, s[12:15], s18 offen offset:512 lds
	s_add_u32 m0, s17, 19840
	s_nop 0
	buffer_load_dwordx4 v3, s[12:15], s18 offen offset:640 lds
	s_add_u32 m0, s17, 23808
	s_nop 0
	buffer_load_dwordx4 v3, s[12:15], s18 offen offset:768 lds
	s_add_u32 s17, s17, 0x8000
	s_mul_i32 s41, s33, 7
	s_lshl_b32 s49, s20, 7
	s_add_u32 s49, s49, 60297216
	s_lshl_b32 s40, s21, 1
	s_add_u32 s40, s40, 0
	s_sub_u32 s42, s40, 7
	s_cmp_ge_u32 s40, 7
	s_cselect_b32 s60, s42, s40
	s_add_u32 s40, s41, s60
	s_lshl_b32 s40, s40, 4
	s_add_u32 s40, s40, s20
	s_mul_i32 s40, s40, 14336
	s_add_u32 s52, s40, 6422528
	s_lshl_b32 s40, s21, 1
	s_add_u32 s40, s40, 1
	s_sub_u32 s42, s40, 7
	s_cmp_ge_u32 s40, 7
	s_cselect_b32 s61, s42, s40
	s_add_u32 s40, s41, s61
	s_lshl_b32 s40, s40, 4
	s_add_u32 s40, s40, s20
	s_mul_i32 s40, s40, 14336
	s_add_u32 s53, s40, 6422528
	s_lshl_b32 s40, s21, 1
	s_add_u32 s40, s40, 2
	s_sub_u32 s42, s40, 7
	s_cmp_ge_u32 s40, 7
	s_cselect_b32 s62, s42, s40
	s_add_u32 s40, s41, s62
	s_lshl_b32 s40, s40, 4
	s_add_u32 s40, s40, s20
	s_mul_i32 s40, s40, 14336
	s_add_u32 s54, s40, 6422528
	s_lshl_b32 s40, s21, 1
	s_add_u32 s40, s40, 3
	s_sub_u32 s42, s40, 7
	s_cmp_ge_u32 s40, 7
	s_cselect_b32 s63, s42, s40
	s_add_u32 s40, s41, s63
	s_lshl_b32 s40, s40, 4
	s_add_u32 s40, s40, s20
	s_mul_i32 s40, s40, 14336
	s_add_u32 s55, s40, 6422528
	s_lshl_b32 s40, s21, 1
	s_add_u32 s40, s40, 4
	s_sub_u32 s42, s40, 7
	s_cmp_ge_u32 s40, 7
	s_cselect_b32 s64, s42, s40
	s_add_u32 s40, s41, s64
	s_lshl_b32 s40, s40, 4
	s_add_u32 s40, s40, s20
	s_mul_i32 s40, s40, 14336
	s_add_u32 s56, s40, 6422528
	s_lshl_b32 s40, s21, 1
	s_add_u32 s40, s40, 5
	s_sub_u32 s42, s40, 7
	s_cmp_ge_u32 s40, 7
	s_cselect_b32 s65, s42, s40
	s_add_u32 s40, s41, s65
	s_lshl_b32 s40, s40, 4
	s_add_u32 s40, s40, s20
	s_mul_i32 s40, s40, 14336
	s_add_u32 s57, s40, 6422528
	s_lshl_b32 s40, s21, 1
	s_add_u32 s40, s40, 6
	s_sub_u32 s42, s40, 7
	s_cmp_ge_u32 s40, 7
	s_cselect_b32 s66, s42, s40
	s_add_u32 s40, s41, s66
	s_lshl_b32 s40, s40, 4
	s_add_u32 s40, s40, s20
	s_mul_i32 s40, s40, 14336
	s_add_u32 s58, s40, 6422528
	s_add_u32 s40, s49, 4
Lwc_15:
	buffer_load_dword v9, v7, s[4:7], s40 offen sc1
	s_waitcnt vmcnt(0)
	v_cmp_gt_u32 vcc, 7, v9
	s_cbranch_vccz Lwo_16
	s_sleep 1
	s_sub_u32 s16, s16, 1
	s_cbranch_scc0 Lwc_15
	s_mov_b32 s16, 0
Lwo_16:
	s_add_u32 s40, s52, 0
	buffer_load_dwordx4 a[0:3], v6, s[4:7], s40 offen offset:0 sc1
	buffer_load_dwordx4 a[4:7], v6, s[4:7], s40 offen offset:1024 sc1
	s_add_u32 s40, s52, 4096
	buffer_load_dwordx4 a[28:31], v6, s[4:7], s40 offen offset:3072 sc1
	s_add_u32 s40, s52, 8192
	buffer_load_dwordx4 a[32:35], v6, s[4:7], s40 offen offset:0 sc1
	s_add_u32 s40, s53, 0
	buffer_load_dwordx4 a[56:59], v6, s[4:7], s40 offen offset:0 sc1
	buffer_load_dwordx4 a[60:63], v6, s[4:7], s40 offen offset:1024 sc1
	s_add_u32 s40, s53, 4096
	buffer_load_dwordx4 a[84:87], v6, s[4:7], s40 offen offset:3072 sc1
	s_add_u32 s40, s53, 8192
	buffer_load_dwordx4 a[88:91], v6, s[4:7], s40 offen offset:0 sc1
	v_lshrrev_b32 v12, 3, v1
	v_lshlrev_b32 v12, 4, v12
	v_and_b32 v13, 3, v1
	v_lshl_add_u32 v12, v13, 2, v12
	v_bfe_u32 v13, v1, 2, 1
	v_lshl_add_u32 v12, v13, 1, v12
	s_and_b32 s40, s33, 1
	v_add_u32 v12, s40, v12
	v_bfe_u32 v13, v12, 2, 1
	v_lshlrev_b32 v13, 4, v13
	v_lshrrev_b32 v14, 3, v12
	v_lshl_add_u32 v13, v14, 2, v13
	v_and_b32 v14, 3, v12
	v_add_u32 v13, v13, v14
	v_bfe_u32 v12, v13, 1, 3
	s_lshr_b32 s27, s20, 2
	s_bitcmp1_b32 s20, 1
	s_cselect_b32 s29, 4, 0
	s_add_u32 s27, s27, s29
	s_and_b32 s28, s20, 1
	s_lshl_b32 s28, s28, 2
	v_add_u32 v14, s28, v2
	s_lshl_b32 s40, s27, 12
	v_mov_b32 v20, s40
	v_add_u32 v22, 4, v20
	s_cmp_lg_u32 s27, 7
	s_cbranch_scc1 Lbk_std
	v_or_b32 v14, 1, v14
	v_and_b32 v15, 1, v2
	v_lshlrev_b32 v20, 13, v15
	v_add_u32 v20, 16388, v20
	v_lshlrev_b32 v22, 12, v15
	v_add_u32 v22, 20484, v22
Lbk_std:
	v_xor_b32 v14, v14, v12
	v_lshlrev_b32 v14, 4, v14
	v_lshl_add_u32 v14, v13, 7, v14
	v_add_u32 v20, v20, v14
	v_add_u32 v22, v22, v14
	s_lshl_b32 s26, s20, 1
	s_add_u32 s26, s26, s33
	s_lshl_b32 s26, s26, 10
	s_mul_i32 s40, s21, 32768
	s_add_u32 s26, s26, s40
	s_add_u32 s26, s26, 60301312
	s_cmp_lt_u32 s33, 2
	s_cselect_b32 s40, 0, 0x80000000
	v_or_b32 v21, s40, v6
	s_cmp_eq_u32 s33, 0
	s_cselect_b32 s40, 0, 0x80000000
	v_or_b32 v23, s40, v8
	s_mul_i32 s22, s41, 16384
	s_lshl_b32 s40, s20, 10
	s_add_u32 s22, s22, s40
	s_add_u32 s22, s22, 12845056
	s_mov_b32 s23, 16384
	s_mov_b32 s24, 60268544
Lwc_17:
	buffer_load_dword v9, v7, s[4:7], s49 offen sc1
	s_waitcnt vmcnt(0)
	v_cmp_gt_u32 vcc, 7, v9
	s_cbranch_vccz Lwo_18
	s_sleep 1
	s_sub_u32 s16, s16, 1
	s_cbranch_scc0 Lwc_17
	s_mov_b32 s16, 0
Lwo_18:
	s_add_u32 s40, s52, 0
	buffer_load_dwordx4 a[8:11], v6, s[4:7], s40 offen offset:2048 sc1
	buffer_load_dwordx4 a[12:15], v6, s[4:7], s40 offen offset:3072 sc1
	s_add_u32 s40, s52, 4096
	buffer_load_dwordx4 a[16:19], v6, s[4:7], s40 offen offset:0 sc1
	buffer_load_dwordx4 a[20:23], v6, s[4:7], s40 offen offset:1024 sc1
	buffer_load_dwordx4 a[24:27], v6, s[4:7], s40 offen offset:2048 sc1
	s_add_u32 s40, s52, 8192
	buffer_load_dwordx4 a[36:39], v6, s[4:7], s40 offen offset:1024 sc1
	buffer_load_dwordx4 a[40:43], v6, s[4:7], s40 offen offset:2048 sc1
	buffer_load_dwordx4 a[44:47], v6, s[4:7], s40 offen offset:3072 sc1
	s_add_u32 s40, s52, 12288
	buffer_load_dwordx4 a[48:51], v6, s[4:7], s40 offen offset:0 sc1
	buffer_load_dwordx4 a[52:55], v6, s[4:7], s40 offen offset:1024 sc1
	s_add_u32 s40, s53, 0
	buffer_load_dwordx4 a[64:67], v6, s[4:7], s40 offen offset:2048 sc1
	buffer_load_dwordx4 a[68:71], v6, s[4:7], s40 offen offset:3072 sc1
	s_add_u32 s40, s53, 4096
	buffer_load_dwordx4 a[72:75], v6, s[4:7], s40 offen offset:0 sc1
	buffer_load_dwordx4 a[76:79], v6, s[4:7], s40 offen offset:1024 sc1
	buffer_load_dwordx4 a[80:83], v6, s[4:7], s40 offen offset:2048 sc1
	s_add_u32 s40, s53, 8192
	buffer_load_dwordx4 a[92:95], v6, s[4:7], s40 offen offset:1024 sc1
	buffer_load_dwordx4 a[96:99], v6, s[4:7], s40 offen offset:2048 sc1
	buffer_load_dwordx4 a[100:103], v6, s[4:7], s40 offen offset:3072 sc1
	s_add_u32 s40, s53, 12288
	buffer_load_dwordx4 a[104:107], v6, s[4:7], s40 offen offset:0 sc1
	buffer_load_dwordx4 a[108:111], v6, s[4:7], s40 offen offset:1024 sc1
	s_mov_b32 s18, 57344
	s_add_u32 m0, s17, 0
	s_nop 0
	buffer_load_dwordx4 v3, s[12:15], s18 offen offset:0 lds
	s_add_u32 m0, s17, 3968
	s_nop 0
	buffer_load_dwordx4 v3, s[12:15], s18 offen offset:128 lds
	s_add_u32 m0, s17, 7936
	s_nop 0
	buffer_load_dwordx4 v3, s[12:15], s18 offen offset:256 lds
	s_add_u32 m0, s17, 11904
	s_nop 0
	buffer_load_dwordx4 v3, s[12:15], s18 offen offset:384 lds
	s_add_u32 m0, s17, 15872
	s_nop 0
	buffer_load_dwordx4 v3, s[12:15], s18 offen offset:512 lds
	s_add_u32 m0, s17, 19840
	s_nop 0
	buffer_load_dwordx4 v3, s[12:15], s18 offen offset:640 lds
	s_add_u32 m0, s17, 23808
	s_nop 0
	buffer_load_dwordx4 v3, s[12:15], s18 offen offset:768 lds
	s_add_u32 s17, s17, 0x8000
	s_mov_b32 s18, 86016
	s_add_u32 m0, s17, 0
	s_nop 0
	buffer_load_dwordx4 v3, s[12:15], s18 offen offset:0 lds
	s_add_u32 m0, s17, 3968
	s_nop 0
	buffer_load_dwordx4 v3, s[12:15], s18 offen offset:128 lds
	s_add_u32 m0, s17, 7936
	s_nop 0
	buffer_load_dwordx4 v3, s[12:15], s18 offen offset:256 lds
	s_add_u32 m0, s17, 11904
	s_nop 0
	buffer_load_dwordx4 v3, s[12:15], s18 offen offset:384 lds
	s_add_u32 m0, s17, 15872
	s_nop 0
	buffer_load_dwordx4 v3, s[12:15], s18 offen offset:512 lds
	s_add_u32 m0, s17, 19840
	s_nop 0
	buffer_load_dwordx4 v3, s[12:15], s18 offen offset:640 lds
	s_add_u32 m0, s17, 23808
	s_nop 0
	buffer_load_dwordx4 v3, s[12:15], s18 offen offset:768 lds
	s_add_u32 s17, s17, 0x8000
	s_lshl_b32 s17, s33, 10
	s_barrier
	s_lshl_b32 s40, s21, 15
	v_add_u32 v12, s40, v20
	v_add_u32 v13, s40, v22
	v_mov_b32 v9, 1
	s_waitcnt vmcnt(14)
	ds_read_b128 v[40:43], v4 offset:0
	ds_read_b128 v[44:47], v4 offset:2048
	ds_read_b128 v[48:51], v5 offset:0
	ds_read_b128 v[52:55], v5 offset:2048
	ds_read_b128 v[56:59], v4 offset:4096
	ds_read_b128 v[60:63], v4 offset:6144
	s_waitcnt lgkmcnt(4)
	v_mfma_f32_16x16x32_bf16 v[64:67], v[40:43], a[0:3], 0
	v_mfma_f32_16x16x32_bf16 v[92:95], v[44:47], a[0:3], 0
	v_mfma_f32_16x16x32_bf16 v[68:71], v[40:43], a[56:59], 0
	v_mfma_f32_16x16x32_bf16 v[96:99], v[44:47], a[56:59], 0
	ds_read_b128 v[40:43], v5 offset:4096
	ds_read_b128 v[44:47], v5 offset:6144
	s_waitcnt lgkmcnt(4)
	v_mfma_f32_16x16x32_bf16 v[64:67], v[48:51], a[4:7], v[64:67]
	v_mfma_f32_16x16x32_bf16 v[92:95], v[52:55], a[4:7], v[92:95]
	v_mfma_f32_16x16x32_bf16 v[68:71], v[48:51], a[60:63], v[68:71]
	v_mfma_f32_16x16x32_bf16 v[96:99], v[52:55], a[60:63], v[96:99]
	ds_read_b128 v[48:51], v4 offset:8192
	ds_read_b128 v[52:55], v4 offset:10240
	s_waitcnt lgkmcnt(4)
	v_mfma_f32_16x16x32_bf16 v[64:67], v[56:59], a[8:11], v[64:67]
	v_mfma_f32_16x16x32_bf16 v[92:95], v[60:63], a[8:11], v[92:95]
	v_mfma_f32_16x16x32_bf16 v[68:71], v[56:59], a[64:67], v[68:71]
	v_mfma_f32_16x16x32_bf16 v[96:99], v[60:63], a[64:67], v[96:99]
	ds_read_b128 v[56:59], v5 offset:8192
	ds_read_b128 v[60:63], v5 offset:10240
	s_waitcnt lgkmcnt(4)
	v_mfma_f32_16x16x32_bf16 v[64:67], v[40:43], a[12:15], v[64:67]
	v_mfma_f32_16x16x32_bf16 v[92:95], v[44:47], a[12:15], v[92:95]
	v_mfma_f32_16x16x32_bf16 v[68:71], v[40:43], a[68:71], v[68:71]
	v_mfma_f32_16x16x32_bf16 v[96:99], v[44:47], a[68:71], v[96:99]
	ds_read_b128 v[40:43], v4 offset:12288
	ds_read_b128 v[44:47], v4 offset:14336
	s_waitcnt lgkmcnt(4)
	v_mfma_f32_16x16x32_bf16 v[64:67], v[48:51], a[16:19], v[64:67]
	v_mfma_f32_16x16x32_bf16 v[92:95], v[52:55], a[16:19], v[92:95]
	v_mfma_f32_16x16x32_bf16 v[68:71], v[48:51], a[72:75], v[68:71]
	v_mfma_f32_16x16x32_bf16 v[96:99], v[52:55], a[72:75], v[96:99]
	ds_read_b128 v[48:51], v5 offset:12288
	ds_read_b128 v[52:55], v5 offset:14336
	s_waitcnt lgkmcnt(4)
	v_mfma_f32_16x16x32_bf16 v[64:67], v[56:59], a[20:23], v[64:67]
	v_mfma_f32_16x16x32_bf16 v[92:95], v[60:63], a[20:23], v[92:95]
	v_mfma_f32_16x16x32_bf16 v[68:71], v[56:59], a[76:79], v[68:71]
	v_mfma_f32_16x16x32_bf16 v[96:99], v[60:63], a[76:79], v[96:99]
	ds_read_b128 v[56:59], v4 offset:16384
	ds_read_b128 v[60:63], v4 offset:18432
	s_waitcnt lgkmcnt(4)
	v_mfma_f32_16x16x32_bf16 v[64:67], v[40:43], a[24:27], v[64:67]
	v_mfma_f32_16x16x32_bf16 v[92:95], v[44:47], a[24:27], v[92:95]
	v_mfma_f32_16x16x32_bf16 v[68:71], v[40:43], a[80:83], v[68:71]
	v_mfma_f32_16x16x32_bf16 v[96:99], v[44:47], a[80:83], v[96:99]
	ds_read_b128 v[40:43], v5 offset:16384
	ds_read_b128 v[44:47], v5 offset:18432
	s_waitcnt lgkmcnt(4)
	v_mfma_f32_16x16x32_bf16 v[64:67], v[48:51], a[28:31], v[64:67]
	v_mfma_f32_16x16x32_bf16 v[92:95], v[52:55], a[28:31], v[92:95]
	v_mfma_f32_16x16x32_bf16 v[68:71], v[48:51], a[84:87], v[68:71]
	v_mfma_f32_16x16x32_bf16 v[96:99], v[52:55], a[84:87], v[96:99]
	ds_read_b128 v[48:51], v4 offset:20480
	ds_read_b128 v[52:55], v4 offset:22528
	s_waitcnt lgkmcnt(4)
	v_mfma_f32_16x16x32_bf16 v[64:67], v[56:59], a[32:35], v[64:67]
	v_mfma_f32_16x16x32_bf16 v[92:95], v[60:63], a[32:35], v[92:95]
	v_mfma_f32_16x16x32_bf16 v[68:71], v[56:59], a[88:91], v[68:71]
	v_mfma_f32_16x16x32_bf16 v[96:99], v[60:63], a[88:91], v[96:99]
	ds_read_b128 v[56:59], v5 offset:20480
	ds_read_b128 v[60:63], v5 offset:22528
	s_waitcnt lgkmcnt(4)
	v_mfma_f32_16x16x32_bf16 v[64:67], v[40:43], a[36:39], v[64:67]
	v_mfma_f32_16x16x32_bf16 v[92:95], v[44:47], a[36:39], v[92:95]
	v_mfma_f32_16x16x32_bf16 v[68:71], v[40:43], a[92:95], v[68:71]
	v_mfma_f32_16x16x32_bf16 v[96:99], v[44:47], a[92:95], v[96:99]
	ds_read_b128 v[40:43], v4 offset:24576
	ds_read_b128 v[44:47], v4 offset:26624
	s_waitcnt lgkmcnt(4)
	v_mfma_f32_16x16x32_bf16 v[64:67], v[48:51], a[40:43], v[64:67]
	v_mfma_f32_16x16x32_bf16 v[92:95], v[52:55], a[40:43], v[92:95]
	v_mfma_f32_16x16x32_bf16 v[68:71], v[48:51], a[96:99], v[68:71]
	v_mfma_f32_16x16x32_bf16 v[96:99], v[52:55], a[96:99], v[96:99]
	ds_read_b128 v[48:51], v5 offset:24576
	ds_read_b128 v[52:55], v5 offset:26624
	s_waitcnt lgkmcnt(4)
	v_mfma_f32_16x16x32_bf16 v[64:67], v[56:59], a[44:47], v[64:67]
	v_mfma_f32_16x16x32_bf16 v[92:95], v[60:63], a[44:47], v[92:95]
	v_mfma_f32_16x16x32_bf16 v[68:71], v[56:59], a[100:103], v[68:71]
	v_mfma_f32_16x16x32_bf16 v[96:99], v[60:63], a[100:103], v[96:99]
	s_waitcnt lgkmcnt(2)
	v_mfma_f32_16x16x32_bf16 v[64:67], v[40:43], a[48:51], v[64:67]
	v_mfma_f32_16x16x32_bf16 v[92:95], v[44:47], a[48:51], v[92:95]
	v_mfma_f32_16x16x32_bf16 v[68:71], v[40:43], a[104:107], v[68:71]
	v_mfma_f32_16x16x32_bf16 v[96:99], v[44:47], a[104:107], v[96:99]
	s_waitcnt lgkmcnt(0)
	v_mfma_f32_16x16x32_bf16 v[64:67], v[48:51], a[52:55], v[64:67]
	v_mfma_f32_16x16x32_bf16 v[92:95], v[52:55], a[52:55], v[92:95]
	v_mfma_f32_16x16x32_bf16 v[68:71], v[48:51], a[108:111], v[68:71]
	v_mfma_f32_16x16x32_bf16 v[96:99], v[52:55], a[108:111], v[96:99]
	s_mul_i32 s40, s60, s23
	s_add_u32 s40, s40, s22
	v_cvt_pk_bf16_f32 v40, v64, v65
	v_cvt_pk_bf16_f32 v41, v66, v67
	v_cvt_pk_bf16_f32 v42, v92, v93
	v_cvt_pk_bf16_f32 v43, v94, v95
	buffer_store_dwordx4 v[40:43], v6, s[4:7], s40 offen sc1
	s_mul_i32 s40, s61, s23
	s_add_u32 s40, s40, s22
	v_cvt_pk_bf16_f32 v48, v68, v69
	v_cvt_pk_bf16_f32 v49, v70, v71
	v_cvt_pk_bf16_f32 v50, v96, v97
	v_cvt_pk_bf16_f32 v51, v98, v99
	buffer_store_dwordx4 v[48:51], v6, s[4:7], s40 offen sc1
	v_add_u32 v4, 0x8000, v4
	v_add_u32 v5, 0x8000, v5
	s_waitcnt vmcnt(2)
	s_barrier
	ds_read2_b32 v[24:25], v12 offset0:0 offset1:2
	ds_read2_b32 v[26:27], v13 offset0:0 offset1:2
	ds_read_b128 v[40:43], v4 offset:0
	ds_read_b128 v[44:47], v4 offset:2048
	ds_read_b128 v[48:51], v5 offset:0
	ds_read_b128 v[52:55], v5 offset:2048
	ds_read_b128 v[56:59], v4 offset:4096
	ds_read_b128 v[60:63], v4 offset:6144
	s_waitcnt lgkmcnt(4)
	v_mfma_f32_16x16x32_bf16 v[64:67], v[40:43], a[0:3], 0
	v_mfma_f32_16x16x32_bf16 v[92:95], v[44:47], a[0:3], 0
	v_mfma_f32_16x16x32_bf16 v[68:71], v[40:43], a[56:59], 0
	v_mfma_f32_16x16x32_bf16 v[96:99], v[44:47], a[56:59], 0
	ds_read_b128 v[40:43], v5 offset:4096
	ds_read_b128 v[44:47], v5 offset:6144
	s_waitcnt lgkmcnt(4)
	v_mfma_f32_16x16x32_bf16 v[64:67], v[48:51], a[4:7], v[64:67]
	v_mfma_f32_16x16x32_bf16 v[92:95], v[52:55], a[4:7], v[92:95]
	v_mfma_f32_16x16x32_bf16 v[68:71], v[48:51], a[60:63], v[68:71]
	v_mfma_f32_16x16x32_bf16 v[96:99], v[52:55], a[60:63], v[96:99]
	ds_read_b128 v[48:51], v4 offset:8192
	ds_read_b128 v[52:55], v4 offset:10240
	s_waitcnt lgkmcnt(4)
	v_mfma_f32_16x16x32_bf16 v[64:67], v[56:59], a[8:11], v[64:67]
	v_mfma_f32_16x16x32_bf16 v[92:95], v[60:63], a[8:11], v[92:95]
	v_mfma_f32_16x16x32_bf16 v[68:71], v[56:59], a[64:67], v[68:71]
	v_mfma_f32_16x16x32_bf16 v[96:99], v[60:63], a[64:67], v[96:99]
	ds_read_b128 v[56:59], v5 offset:8192
	ds_read_b128 v[60:63], v5 offset:10240
	s_waitcnt lgkmcnt(4)
	v_mfma_f32_16x16x32_bf16 v[64:67], v[40:43], a[12:15], v[64:67]
	v_mfma_f32_16x16x32_bf16 v[92:95], v[44:47], a[12:15], v[92:95]
	v_mfma_f32_16x16x32_bf16 v[68:71], v[40:43], a[68:71], v[68:71]
	v_mfma_f32_16x16x32_bf16 v[96:99], v[44:47], a[68:71], v[96:99]
	ds_read_b128 v[40:43], v4 offset:12288
	ds_read_b128 v[44:47], v4 offset:14336
	s_waitcnt lgkmcnt(4)
	v_mfma_f32_16x16x32_bf16 v[64:67], v[48:51], a[16:19], v[64:67]
	v_mfma_f32_16x16x32_bf16 v[92:95], v[52:55], a[16:19], v[92:95]
	v_mfma_f32_16x16x32_bf16 v[68:71], v[48:51], a[72:75], v[68:71]
	v_mfma_f32_16x16x32_bf16 v[96:99], v[52:55], a[72:75], v[96:99]
	ds_read_b128 v[48:51], v5 offset:12288
	ds_read_b128 v[52:55], v5 offset:14336
	s_waitcnt lgkmcnt(4)
	v_mfma_f32_16x16x32_bf16 v[64:67], v[56:59], a[20:23], v[64:67]
	v_mfma_f32_16x16x32_bf16 v[92:95], v[60:63], a[20:23], v[92:95]
	v_mfma_f32_16x16x32_bf16 v[68:71], v[56:59], a[76:79], v[68:71]
	v_mfma_f32_16x16x32_bf16 v[96:99], v[60:63], a[76:79], v[96:99]
	ds_read_b128 v[56:59], v4 offset:16384
	ds_read_b128 v[60:63], v4 offset:18432
	s_waitcnt lgkmcnt(4)
	v_mfma_f32_16x16x32_bf16 v[64:67], v[40:43], a[24:27], v[64:67]
	v_mfma_f32_16x16x32_bf16 v[92:95], v[44:47], a[24:27], v[92:95]
	v_mfma_f32_16x16x32_bf16 v[68:71], v[40:43], a[80:83], v[68:71]
	v_mfma_f32_16x16x32_bf16 v[96:99], v[44:47], a[80:83], v[96:99]
	ds_read_b128 v[40:43], v5 offset:16384
	ds_read_b128 v[44:47], v5 offset:18432
	s_waitcnt lgkmcnt(4)
	v_mfma_f32_16x16x32_bf16 v[64:67], v[48:51], a[28:31], v[64:67]
	v_mfma_f32_16x16x32_bf16 v[92:95], v[52:55], a[28:31], v[92:95]
	v_mfma_f32_16x16x32_bf16 v[68:71], v[48:51], a[84:87], v[68:71]
	v_mfma_f32_16x16x32_bf16 v[96:99], v[52:55], a[84:87], v[96:99]
	ds_read_b128 v[48:51], v4 offset:20480
	ds_read_b128 v[52:55], v4 offset:22528
	s_waitcnt lgkmcnt(4)
	v_mfma_f32_16x16x32_bf16 v[64:67], v[56:59], a[32:35], v[64:67]
	v_mfma_f32_16x16x32_bf16 v[92:95], v[60:63], a[32:35], v[92:95]
	v_mfma_f32_16x16x32_bf16 v[68:71], v[56:59], a[88:91], v[68:71]
	v_mfma_f32_16x16x32_bf16 v[96:99], v[60:63], a[88:91], v[96:99]
	ds_read_b128 v[56:59], v5 offset:20480
	ds_read_b128 v[60:63], v5 offset:22528
	s_waitcnt lgkmcnt(4)
	v_mfma_f32_16x16x32_bf16 v[64:67], v[40:43], a[36:39], v[64:67]
	v_mfma_f32_16x16x32_bf16 v[92:95], v[44:47], a[36:39], v[92:95]
	v_mfma_f32_16x16x32_bf16 v[68:71], v[40:43], a[92:95], v[68:71]
	v_mfma_f32_16x16x32_bf16 v[96:99], v[44:47], a[92:95], v[96:99]
	ds_read_b128 v[40:43], v4 offset:24576
	ds_read_b128 v[44:47], v4 offset:26624
	s_waitcnt lgkmcnt(4)
	v_mfma_f32_16x16x32_bf16 v[64:67], v[48:51], a[40:43], v[64:67]
	v_mfma_f32_16x16x32_bf16 v[92:95], v[52:55], a[40:43], v[92:95]
	v_mfma_f32_16x16x32_bf16 v[68:71], v[48:51], a[96:99], v[68:71]
	v_mfma_f32_16x16x32_bf16 v[96:99], v[52:55], a[96:99], v[96:99]
	ds_read_b128 v[48:51], v5 offset:24576
	ds_read_b128 v[52:55], v5 offset:26624
	s_waitcnt lgkmcnt(4)
	v_mfma_f32_16x16x32_bf16 v[64:67], v[56:59], a[44:47], v[64:67]
	v_mfma_f32_16x16x32_bf16 v[92:95], v[60:63], a[44:47], v[92:95]
	v_mfma_f32_16x16x32_bf16 v[68:71], v[56:59], a[100:103], v[68:71]
	v_mfma_f32_16x16x32_bf16 v[96:99], v[60:63], a[100:103], v[96:99]
	s_waitcnt lgkmcnt(2)
	v_mfma_f32_16x16x32_bf16 v[64:67], v[40:43], a[48:51], v[64:67]
	v_mfma_f32_16x16x32_bf16 v[92:95], v[44:47], a[48:51], v[92:95]
	v_mfma_f32_16x16x32_bf16 v[68:71], v[40:43], a[104:107], v[68:71]
	v_mfma_f32_16x16x32_bf16 v[96:99], v[44:47], a[104:107], v[96:99]
	s_waitcnt lgkmcnt(0)
	v_mfma_f32_16x16x32_bf16 v[64:67], v[48:51], a[52:55], v[64:67]
	v_mfma_f32_16x16x32_bf16 v[92:95], v[52:55], a[52:55], v[92:95]
	v_mfma_f32_16x16x32_bf16 v[68:71], v[48:51], a[108:111], v[68:71]
	v_mfma_f32_16x16x32_bf16 v[96:99], v[52:55], a[108:111], v[96:99]
	s_mul_i32 s40, s60, s23
	s_add_u32 s40, s40, s22
	s_add_u32 s40, s40, 458752
	v_cvt_pk_bf16_f32 v40, v64, v65
	v_cvt_pk_bf16_f32 v41, v66, v67
	v_cvt_pk_bf16_f32 v42, v92, v93
	v_cvt_pk_bf16_f32 v43, v94, v95
	buffer_store_dwordx4 v[40:43], v6, s[4:7], s40 offen sc1
	s_mul_i32 s40, s61, s23
	s_add_u32 s40, s40, s22
	s_add_u32 s40, s40, 458752
	v_cvt_pk_bf16_f32 v48, v68, v69
	v_cvt_pk_bf16_f32 v49, v70, v71
	v_cvt_pk_bf16_f32 v50, v96, v97
	v_cvt_pk_bf16_f32 v51, v98, v99
	buffer_store_dwordx4 v[48:51], v6, s[4:7], s40 offen sc1
	v_add_u32 v4, 0x8000, v4
	v_add_u32 v5, 0x8000, v5
	v_swap_b32 v25, v26
	buffer_store_dwordx4 v[24:27], v21, s[4:7], s26 offen sc1
	ds_read_b128 v[40:43], v4 offset:0
	ds_read_b128 v[44:47], v4 offset:2048
	ds_read_b128 v[48:51], v5 offset:0
	ds_read_b128 v[52:55], v5 offset:2048
	ds_read_b128 v[56:59], v4 offset:4096
	ds_read_b128 v[60:63], v4 offset:6144
	s_waitcnt lgkmcnt(4)
	v_mfma_f32_16x16x32_bf16 v[64:67], v[40:43], a[0:3], 0
	v_mfma_f32_16x16x32_bf16 v[92:95], v[44:47], a[0:3], 0
	v_mfma_f32_16x16x32_bf16 v[68:71], v[40:43], a[56:59], 0
	v_mfma_f32_16x16x32_bf16 v[96:99], v[44:47], a[56:59], 0
	ds_read_b128 v[40:43], v5 offset:4096
	ds_read_b128 v[44:47], v5 offset:6144
	s_waitcnt lgkmcnt(4)
	v_mfma_f32_16x16x32_bf16 v[64:67], v[48:51], a[4:7], v[64:67]
	v_mfma_f32_16x16x32_bf16 v[92:95], v[52:55], a[4:7], v[92:95]
	v_mfma_f32_16x16x32_bf16 v[68:71], v[48:51], a[60:63], v[68:71]
	v_mfma_f32_16x16x32_bf16 v[96:99], v[52:55], a[60:63], v[96:99]
	ds_read_b128 v[48:51], v4 offset:8192
	ds_read_b128 v[52:55], v4 offset:10240
	s_waitcnt lgkmcnt(4)
	v_mfma_f32_16x16x32_bf16 v[64:67], v[56:59], a[8:11], v[64:67]
	v_mfma_f32_16x16x32_bf16 v[92:95], v[60:63], a[8:11], v[92:95]
	v_mfma_f32_16x16x32_bf16 v[68:71], v[56:59], a[64:67], v[68:71]
	v_mfma_f32_16x16x32_bf16 v[96:99], v[60:63], a[64:67], v[96:99]
	ds_read_b128 v[56:59], v5 offset:8192
	ds_read_b128 v[60:63], v5 offset:10240
	s_waitcnt lgkmcnt(4)
	v_mfma_f32_16x16x32_bf16 v[64:67], v[40:43], a[12:15], v[64:67]
	v_mfma_f32_16x16x32_bf16 v[92:95], v[44:47], a[12:15], v[92:95]
	v_mfma_f32_16x16x32_bf16 v[68:71], v[40:43], a[68:71], v[68:71]
	v_mfma_f32_16x16x32_bf16 v[96:99], v[44:47], a[68:71], v[96:99]
	ds_read_b128 v[40:43], v4 offset:12288
	ds_read_b128 v[44:47], v4 offset:14336
	s_waitcnt lgkmcnt(4)
	v_mfma_f32_16x16x32_bf16 v[64:67], v[48:51], a[16:19], v[64:67]
	v_mfma_f32_16x16x32_bf16 v[92:95], v[52:55], a[16:19], v[92:95]
	v_mfma_f32_16x16x32_bf16 v[68:71], v[48:51], a[72:75], v[68:71]
	v_mfma_f32_16x16x32_bf16 v[96:99], v[52:55], a[72:75], v[96:99]
	ds_read_b128 v[48:51], v5 offset:12288
	ds_read_b128 v[52:55], v5 offset:14336
	s_waitcnt lgkmcnt(4)
	v_mfma_f32_16x16x32_bf16 v[64:67], v[56:59], a[20:23], v[64:67]
	v_mfma_f32_16x16x32_bf16 v[92:95], v[60:63], a[20:23], v[92:95]
	v_mfma_f32_16x16x32_bf16 v[68:71], v[56:59], a[76:79], v[68:71]
	v_mfma_f32_16x16x32_bf16 v[96:99], v[60:63], a[76:79], v[96:99]
	ds_read_b128 v[56:59], v4 offset:16384
	ds_read_b128 v[60:63], v4 offset:18432
	s_waitcnt lgkmcnt(4)
	v_mfma_f32_16x16x32_bf16 v[64:67], v[40:43], a[24:27], v[64:67]
	v_mfma_f32_16x16x32_bf16 v[92:95], v[44:47], a[24:27], v[92:95]
	v_mfma_f32_16x16x32_bf16 v[68:71], v[40:43], a[80:83], v[68:71]
	v_mfma_f32_16x16x32_bf16 v[96:99], v[44:47], a[80:83], v[96:99]
	ds_read_b128 v[40:43], v5 offset:16384
	ds_read_b128 v[44:47], v5 offset:18432
	s_waitcnt lgkmcnt(4)
	v_mfma_f32_16x16x32_bf16 v[64:67], v[48:51], a[28:31], v[64:67]
	v_mfma_f32_16x16x32_bf16 v[92:95], v[52:55], a[28:31], v[92:95]
	v_mfma_f32_16x16x32_bf16 v[68:71], v[48:51], a[84:87], v[68:71]
	v_mfma_f32_16x16x32_bf16 v[96:99], v[52:55], a[84:87], v[96:99]
	ds_read_b128 v[48:51], v4 offset:20480
	ds_read_b128 v[52:55], v4 offset:22528
	s_waitcnt lgkmcnt(4)
	v_mfma_f32_16x16x32_bf16 v[64:67], v[56:59], a[32:35], v[64:67]
	v_mfma_f32_16x16x32_bf16 v[92:95], v[60:63], a[32:35], v[92:95]
	v_mfma_f32_16x16x32_bf16 v[68:71], v[56:59], a[88:91], v[68:71]
	v_mfma_f32_16x16x32_bf16 v[96:99], v[60:63], a[88:91], v[96:99]
	ds_read_b128 v[56:59], v5 offset:20480
	ds_read_b128 v[60:63], v5 offset:22528
	s_waitcnt lgkmcnt(4)
	v_mfma_f32_16x16x32_bf16 v[64:67], v[40:43], a[36:39], v[64:67]
	v_mfma_f32_16x16x32_bf16 v[92:95], v[44:47], a[36:39], v[92:95]
	v_mfma_f32_16x16x32_bf16 v[68:71], v[40:43], a[92:95], v[68:71]
	v_mfma_f32_16x16x32_bf16 v[96:99], v[44:47], a[92:95], v[96:99]
	ds_read_b128 v[40:43], v4 offset:24576
	ds_read_b128 v[44:47], v4 offset:26624
	s_waitcnt lgkmcnt(4)
	v_mfma_f32_16x16x32_bf16 v[64:67], v[48:51], a[40:43], v[64:67]
	v_mfma_f32_16x16x32_bf16 v[92:95], v[52:55], a[40:43], v[92:95]
	v_mfma_f32_16x16x32_bf16 v[68:71], v[48:51], a[96:99], v[68:71]
	v_mfma_f32_16x16x32_bf16 v[96:99], v[52:55], a[96:99], v[96:99]
	ds_read_b128 v[48:51], v5 offset:24576
	ds_read_b128 v[52:55], v5 offset:26624
	s_waitcnt lgkmcnt(4)
	v_mfma_f32_16x16x32_bf16 v[64:67], v[56:59], a[44:47], v[64:67]
	v_mfma_f32_16x16x32_bf16 v[92:95], v[60:63], a[44:47], v[92:95]
	v_mfma_f32_16x16x32_bf16 v[68:71], v[56:59], a[100:103], v[68:71]
	v_mfma_f32_16x16x32_bf16 v[96:99], v[60:63], a[100:103], v[96:99]
	s_waitcnt lgkmcnt(2)
	v_mfma_f32_16x16x32_bf16 v[64:67], v[40:43], a[48:51], v[64:67]
	v_mfma_f32_16x16x32_bf16 v[92:95], v[44:47], a[48:51], v[92:95]
	v_mfma_f32_16x16x32_bf16 v[68:71], v[40:43], a[104:107], v[68:71]
	v_mfma_f32_16x16x32_bf16 v[96:99], v[44:47], a[104:107], v[96:99]
	s_waitcnt lgkmcnt(0)
	v_mfma_f32_16x16x32_bf16 v[64:67], v[48:51], a[52:55], v[64:67]
	v_mfma_f32_16x16x32_bf16 v[92:95], v[52:55], a[52:55], v[92:95]
	v_mfma_f32_16x16x32_bf16 v[68:71], v[48:51], a[108:111], v[68:71]
	v_mfma_f32_16x16x32_bf16 v[96:99], v[52:55], a[108:111], v[96:99]
	s_waitcnt vmcnt(0)
	s_barrier
	buffer_atomic_add v9, v23, s[4:7], s24 offen offset:0
	buffer_atomic_add v9, v23, s[4:7], s24 offen offset:128
	s_mul_i32 s40, s60, s23
	s_add_u32 s40, s40, s22
	s_add_u32 s40, s40, 917504
	v_cvt_pk_bf16_f32 v40, v64, v65
	v_cvt_pk_bf16_f32 v41, v66, v67
	v_cvt_pk_bf16_f32 v42, v92, v93
	v_cvt_pk_bf16_f32 v43, v94, v95
	buffer_store_dwordx4 v[40:43], v6, s[4:7], s40 offen sc1
	s_mul_i32 s40, s61, s23
	s_add_u32 s40, s40, s22
	s_add_u32 s40, s40, 917504
	v_cvt_pk_bf16_f32 v48, v68, v69
	v_cvt_pk_bf16_f32 v49, v70, v71
	v_cvt_pk_bf16_f32 v50, v96, v97
	v_cvt_pk_bf16_f32 v51, v98, v99
	buffer_store_dwordx4 v[48:51], v6, s[4:7], s40 offen sc1
	v_add_u32 v4, 0x8000, v4
	v_add_u32 v5, 0x8000, v5
	s_add_u32 s40, s54, 0
	buffer_load_dwordx4 a[112:115], v6, s[4:7], s40 offen offset:0 sc1
	s_add_u32 s40, s54, 0
	buffer_load_dwordx4 a[116:119], v6, s[4:7], s40 offen offset:1024 sc1
	s_add_u32 s40, s54, 0
	buffer_load_dwordx4 a[120:123], v6, s[4:7], s40 offen offset:2048 sc1
	s_add_u32 s40, s54, 0
	buffer_load_dwordx4 a[124:127], v6, s[4:7], s40 offen offset:3072 sc1
	s_add_u32 s40, s54, 4096
	buffer_load_dwordx4 a[128:131], v6, s[4:7], s40 offen offset:0 sc1
	s_add_u32 s40, s54, 4096
	buffer_load_dwordx4 a[132:135], v6, s[4:7], s40 offen offset:1024 sc1
	s_add_u32 s40, s54, 4096
	buffer_load_dwordx4 a[136:139], v6, s[4:7], s40 offen offset:2048 sc1
	s_add_u32 s40, s54, 4096
	buffer_load_dwordx4 a[140:143], v6, s[4:7], s40 offen offset:3072 sc1
	s_add_u32 s40, s54, 8192
	buffer_load_dwordx4 a[144:147], v6, s[4:7], s40 offen offset:0 sc1
	s_add_u32 s40, s54, 8192
	buffer_load_dwordx4 a[148:151], v6, s[4:7], s40 offen offset:1024 sc1
	s_add_u32 s40, s54, 8192
	buffer_load_dwordx4 a[152:155], v6, s[4:7], s40 offen offset:2048 sc1
	s_add_u32 s40, s54, 8192
	buffer_load_dwordx4 a[156:159], v6, s[4:7], s40 offen offset:3072 sc1
	s_add_u32 s40, s54, 12288
	buffer_load_dwordx4 a[160:163], v6, s[4:7], s40 offen offset:0 sc1
	s_add_u32 s40, s54, 12288
	buffer_load_dwordx4 a[164:167], v6, s[4:7], s40 offen offset:1024 sc1
	ds_read_b128 v[40:43], v4 offset:0
	ds_read_b128 v[44:47], v4 offset:2048
	ds_read_b128 v[48:51], v5 offset:0
	ds_read_b128 v[52:55], v5 offset:2048
	ds_read_b128 v[56:59], v4 offset:4096
	ds_read_b128 v[60:63], v4 offset:6144
	s_add_u32 s40, s55, 0
	buffer_load_dwordx4 a[168:171], v6, s[4:7], s40 offen offset:0 sc1
	s_add_u32 s40, s55, 0
	buffer_load_dwordx4 a[172:175], v6, s[4:7], s40 offen offset:1024 sc1
	s_waitcnt lgkmcnt(4)
	v_mfma_f32_16x16x32_bf16 v[64:67], v[40:43], a[0:3], 0
	v_mfma_f32_16x16x32_bf16 v[92:95], v[44:47], a[0:3], 0
	v_mfma_f32_16x16x32_bf16 v[68:71], v[40:43], a[56:59], 0
	v_mfma_f32_16x16x32_bf16 v[96:99], v[44:47], a[56:59], 0
	ds_read_b128 v[40:43], v5 offset:4096
	ds_read_b128 v[44:47], v5 offset:6144
	s_add_u32 s40, s55, 0
	buffer_load_dwordx4 a[176:179], v6, s[4:7], s40 offen offset:2048 sc1
	s_add_u32 s40, s55, 0
	buffer_load_dwordx4 a[180:183], v6, s[4:7], s40 offen offset:3072 sc1
	s_waitcnt lgkmcnt(4)
	v_mfma_f32_16x16x32_bf16 v[64:67], v[48:51], a[4:7], v[64:67]
	v_mfma_f32_16x16x32_bf16 v[92:95], v[52:55], a[4:7], v[92:95]
	v_mfma_f32_16x16x32_bf16 v[68:71], v[48:51], a[60:63], v[68:71]
	v_mfma_f32_16x16x32_bf16 v[96:99], v[52:55], a[60:63], v[96:99]
	ds_read_b128 v[48:51], v4 offset:8192
	ds_read_b128 v[52:55], v4 offset:10240
	s_add_u32 s40, s55, 4096
	buffer_load_dwordx4 a[184:187], v6, s[4:7], s40 offen offset:0 sc1
	s_add_u32 s40, s55, 4096
	buffer_load_dwordx4 a[188:191], v6, s[4:7], s40 offen offset:1024 sc1
	s_waitcnt lgkmcnt(4)
	v_mfma_f32_16x16x32_bf16 v[64:67], v[56:59], a[8:11], v[64:67]
	v_mfma_f32_16x16x32_bf16 v[92:95], v[60:63], a[8:11], v[92:95]
	v_mfma_f32_16x16x32_bf16 v[68:71], v[56:59], a[64:67], v[68:71]
	v_mfma_f32_16x16x32_bf16 v[96:99], v[60:63], a[64:67], v[96:99]
	ds_read_b128 v[56:59], v5 offset:8192
	ds_read_b128 v[60:63], v5 offset:10240
	s_add_u32 s40, s55, 4096
	buffer_load_dwordx4 a[192:195], v6, s[4:7], s40 offen offset:2048 sc1
	s_add_u32 s40, s55, 4096
	buffer_load_dwordx4 a[196:199], v6, s[4:7], s40 offen offset:3072 sc1
	s_waitcnt lgkmcnt(4)
	v_mfma_f32_16x16x32_bf16 v[64:67], v[40:43], a[12:15], v[64:67]
	v_mfma_f32_16x16x32_bf16 v[92:95], v[44:47], a[12:15], v[92:95]
	v_mfma_f32_16x16x32_bf16 v[68:71], v[40:43], a[68:71], v[68:71]
	v_mfma_f32_16x16x32_bf16 v[96:99], v[44:47], a[68:71], v[96:99]
	ds_read_b128 v[40:43], v4 offset:12288
	ds_read_b128 v[44:47], v4 offset:14336
	s_add_u32 s40, s55, 8192
	buffer_load_dwordx4 a[200:203], v6, s[4:7], s40 offen offset:0 sc1
	s_add_u32 s40, s55, 8192
	buffer_load_dwordx4 a[204:207], v6, s[4:7], s40 offen offset:1024 sc1
	s_waitcnt lgkmcnt(4)
	v_mfma_f32_16x16x32_bf16 v[64:67], v[48:51], a[16:19], v[64:67]
	v_mfma_f32_16x16x32_bf16 v[92:95], v[52:55], a[16:19], v[92:95]
	v_mfma_f32_16x16x32_bf16 v[68:71], v[48:51], a[72:75], v[68:71]
	v_mfma_f32_16x16x32_bf16 v[96:99], v[52:55], a[72:75], v[96:99]
	ds_read_b128 v[48:51], v5 offset:12288
	ds_read_b128 v[52:55], v5 offset:14336
	s_add_u32 s40, s55, 8192
	buffer_load_dwordx4 a[208:211], v6, s[4:7], s40 offen offset:2048 sc1
	s_add_u32 s40, s55, 8192
	buffer_load_dwordx4 a[212:215], v6, s[4:7], s40 offen offset:3072 sc1
	s_waitcnt lgkmcnt(4)
	v_mfma_f32_16x16x32_bf16 v[64:67], v[56:59], a[20:23], v[64:67]
	v_mfma_f32_16x16x32_bf16 v[92:95], v[60:63], a[20:23], v[92:95]
	v_mfma_f32_16x16x32_bf16 v[68:71], v[56:59], a[76:79], v[68:71]
	v_mfma_f32_16x16x32_bf16 v[96:99], v[60:63], a[76:79], v[96:99]
	ds_read_b128 v[56:59], v4 offset:16384
	ds_read_b128 v[60:63], v4 offset:18432
	s_add_u32 s40, s55, 12288
	buffer_load_dwordx4 a[216:219], v6, s[4:7], s40 offen offset:0 sc1
	s_add_u32 s40, s55, 12288
	buffer_load_dwordx4 a[220:223], v6, s[4:7], s40 offen offset:1024 sc1
	s_waitcnt lgkmcnt(4)
	v_mfma_f32_16x16x32_bf16 v[64:67], v[40:43], a[24:27], v[64:67]
	v_mfma_f32_16x16x32_bf16 v[92:95], v[44:47], a[24:27], v[92:95]
	v_mfma_f32_16x16x32_bf16 v[68:71], v[40:43], a[80:83], v[68:71]
	v_mfma_f32_16x16x32_bf16 v[96:99], v[44:47], a[80:83], v[96:99]
	ds_read_b128 v[40:43], v5 offset:16384
	ds_read_b128 v[44:47], v5 offset:18432
	s_add_u32 s40, s56, 0
	buffer_load_dwordx4 a[224:227], v6, s[4:7], s40 offen offset:0 sc1
	s_add_u32 s40, s56, 0
	buffer_load_dwordx4 a[228:231], v6, s[4:7], s40 offen offset:1024 sc1
	s_waitcnt lgkmcnt(4)
	v_mfma_f32_16x16x32_bf16 v[64:67], v[48:51], a[28:31], v[64:67]
	v_mfma_f32_16x16x32_bf16 v[92:95], v[52:55], a[28:31], v[92:95]
	v_mfma_f32_16x16x32_bf16 v[68:71], v[48:51], a[84:87], v[68:71]
	v_mfma_f32_16x16x32_bf16 v[96:99], v[52:55], a[84:87], v[96:99]
	ds_read_b128 v[48:51], v4 offset:20480
	ds_read_b128 v[52:55], v4 offset:22528
	s_add_u32 s40, s56, 0
	buffer_load_dwordx4 a[232:235], v6, s[4:7], s40 offen offset:2048 sc1
	s_add_u32 s40, s56, 0
	buffer_load_dwordx4 a[236:239], v6, s[4:7], s40 offen offset:3072 sc1
	s_waitcnt lgkmcnt(4)
	v_mfma_f32_16x16x32_bf16 v[64:67], v[56:59], a[32:35], v[64:67]
	v_mfma_f32_16x16x32_bf16 v[92:95], v[60:63], a[32:35], v[92:95]
	v_mfma_f32_16x16x32_bf16 v[68:71], v[56:59], a[88:91], v[68:71]
	v_mfma_f32_16x16x32_bf16 v[96:99], v[60:63], a[88:91], v[96:99]
	ds_read_b128 v[56:59], v5 offset:20480
	ds_read_b128 v[60:63], v5 offset:22528
	s_add_u32 s40, s56, 4096
	buffer_load_dwordx4 a[240:243], v6, s[4:7], s40 offen offset:0 sc1
	s_add_u32 s40, s56, 4096
	buffer_load_dwordx4 a[244:247], v6, s[4:7], s40 offen offset:1024 sc1
	s_waitcnt lgkmcnt(4)
	v_mfma_f32_16x16x32_bf16 v[64:67], v[40:43], a[36:39], v[64:67]
	v_mfma_f32_16x16x32_bf16 v[92:95], v[44:47], a[36:39], v[92:95]
	v_mfma_f32_16x16x32_bf16 v[68:71], v[40:43], a[92:95], v[68:71]
	v_mfma_f32_16x16x32_bf16 v[96:99], v[44:47], a[92:95], v[96:99]
	ds_read_b128 v[40:43], v4 offset:24576
	ds_read_b128 v[44:47], v4 offset:26624
	s_add_u32 s40, s56, 4096
	buffer_load_dwordx4 a[248:251], v6, s[4:7], s40 offen offset:2048 sc1
	s_add_u32 s40, s56, 4096
	buffer_load_dwordx4 a[252:255], v6, s[4:7], s40 offen offset:3072 sc1
	s_waitcnt lgkmcnt(4)
	v_mfma_f32_16x16x32_bf16 v[64:67], v[48:51], a[40:43], v[64:67]
	v_mfma_f32_16x16x32_bf16 v[92:95], v[52:55], a[40:43], v[92:95]
	v_mfma_f32_16x16x32_bf16 v[68:71], v[48:51], a[96:99], v[68:71]
	v_mfma_f32_16x16x32_bf16 v[96:99], v[52:55], a[96:99], v[96:99]
	ds_read_b128 v[48:51], v5 offset:24576
	ds_read_b128 v[52:55], v5 offset:26624
	s_add_u32 s40, s56, 8192
	buffer_load_dwordx4 v[120:123], v6, s[4:7], s40 offen offset:0 sc1
	s_add_u32 s40, s56, 8192
	buffer_load_dwordx4 v[124:127], v6, s[4:7], s40 offen offset:1024 sc1
	s_waitcnt lgkmcnt(4)
	v_mfma_f32_16x16x32_bf16 v[64:67], v[56:59], a[44:47], v[64:67]
	v_mfma_f32_16x16x32_bf16 v[92:95], v[60:63], a[44:47], v[92:95]
	v_mfma_f32_16x16x32_bf16 v[68:71], v[56:59], a[100:103], v[68:71]
	v_mfma_f32_16x16x32_bf16 v[96:99], v[60:63], a[100:103], v[96:99]
	s_add_u32 s40, s56, 8192
	buffer_load_dwordx4 v[128:131], v6, s[4:7], s40 offen offset:2048 sc1
	s_add_u32 s40, s56, 8192
	buffer_load_dwordx4 v[132:135], v6, s[4:7], s40 offen offset:3072 sc1
	s_waitcnt lgkmcnt(2)
	v_mfma_f32_16x16x32_bf16 v[64:67], v[40:43], a[48:51], v[64:67]
	v_mfma_f32_16x16x32_bf16 v[92:95], v[44:47], a[48:51], v[92:95]
	v_mfma_f32_16x16x32_bf16 v[68:71], v[40:43], a[104:107], v[68:71]
	v_mfma_f32_16x16x32_bf16 v[96:99], v[44:47], a[104:107], v[96:99]
	s_add_u32 s40, s56, 12288
	buffer_load_dwordx4 v[136:139], v6, s[4:7], s40 offen offset:0 sc1
	s_add_u32 s40, s56, 12288
	buffer_load_dwordx4 v[140:143], v6, s[4:7], s40 offen offset:1024 sc1
	s_waitcnt lgkmcnt(0)
	v_mfma_f32_16x16x32_bf16 v[64:67], v[48:51], a[52:55], v[64:67]
	v_mfma_f32_16x16x32_bf16 v[92:95], v[52:55], a[52:55], v[92:95]
	v_mfma_f32_16x16x32_bf16 v[68:71], v[48:51], a[108:111], v[68:71]
	v_mfma_f32_16x16x32_bf16 v[96:99], v[52:55], a[108:111], v[96:99]
	s_mul_i32 s40, s60, s23
	s_add_u32 s40, s40, s22
	s_add_u32 s40, s40, 1376256
	v_cvt_pk_bf16_f32 v40, v64, v65
	v_cvt_pk_bf16_f32 v41, v66, v67
	v_cvt_pk_bf16_f32 v42, v92, v93
	v_cvt_pk_bf16_f32 v43, v94, v95
	buffer_store_dwordx4 v[40:43], v6, s[4:7], s40 offen sc1
	s_mul_i32 s40, s61, s23
	s_add_u32 s40, s40, s22
	s_add_u32 s40, s40, 1376256
	v_cvt_pk_bf16_f32 v48, v68, v69
	v_cvt_pk_bf16_f32 v49, v70, v71
	v_cvt_pk_bf16_f32 v50, v96, v97
	v_cvt_pk_bf16_f32 v51, v98, v99
	buffer_store_dwordx4 v[48:51], v6, s[4:7], s40 offen sc1
	s_mul_i32 s18, s21, 28672
	s_add_u32 s18, s18, 114688
	s_waitcnt vmcnt(20)
	s_add_u32 m0, s17, 0
	s_nop 0
	buffer_load_dwordx4 v3, s[12:15], s18 offen offset:0 lds
	s_add_u32 m0, s17, 3968
	s_nop 0
	buffer_load_dwordx4 v3, s[12:15], s18 offen offset:128 lds
	s_add_u32 m0, s17, 7936
	s_nop 0
	buffer_load_dwordx4 v3, s[12:15], s18 offen offset:256 lds
	s_add_u32 m0, s17, 11904
	s_nop 0
	buffer_load_dwordx4 v3, s[12:15], s18 offen offset:384 lds
	s_add_u32 m0, s17, 15872
	s_nop 0
	buffer_load_dwordx4 v3, s[12:15], s18 offen offset:512 lds
	s_add_u32 m0, s17, 19840
	s_nop 0
	buffer_load_dwordx4 v3, s[12:15], s18 offen offset:640 lds
	s_add_u32 m0, s17, 23808
	s_nop 0
	buffer_load_dwordx4 v3, s[12:15], s18 offen offset:768 lds
	s_add_u32 s40, s57, 0
	buffer_load_dwordx4 v[144:147], v6, s[4:7], s40 offen offset:0 sc1
	s_add_u32 s40, s57, 0
	buffer_load_dwordx4 v[148:151], v6, s[4:7], s40 offen offset:1024 sc1
	s_add_u32 s40, s57, 0
	buffer_load_dwordx4 v[152:155], v6, s[4:7], s40 offen offset:2048 sc1
	s_add_u32 s40, s57, 0
	buffer_load_dwordx4 v[156:159], v6, s[4:7], s40 offen offset:3072 sc1
	s_add_u32 s40, s57, 4096
	buffer_load_dwordx4 v[160:163], v6, s[4:7], s40 offen offset:0 sc1
	s_add_u32 s40, s57, 4096
	buffer_load_dwordx4 v[164:167], v6, s[4:7], s40 offen offset:1024 sc1
	s_add_u32 s40, s57, 4096
	buffer_load_dwordx4 v[168:171], v6, s[4:7], s40 offen offset:2048 sc1
	s_add_u32 s40, s57, 4096
	buffer_load_dwordx4 v[172:175], v6, s[4:7], s40 offen offset:3072 sc1
	s_add_u32 s40, s57, 8192
	buffer_load_dwordx4 v[176:179], v6, s[4:7], s40 offen offset:0 sc1
	s_add_u32 s40, s57, 8192
	buffer_load_dwordx4 v[180:183], v6, s[4:7], s40 offen offset:1024 sc1
	s_add_u32 s40, s57, 8192
	buffer_load_dwordx4 v[184:187], v6, s[4:7], s40 offen offset:2048 sc1
	s_add_u32 s40, s57, 8192
	buffer_load_dwordx4 v[188:191], v6, s[4:7], s40 offen offset:3072 sc1
	s_add_u32 s40, s57, 12288
	buffer_load_dwordx4 v[192:195], v6, s[4:7], s40 offen offset:0 sc1
	s_add_u32 s40, s57, 12288
	buffer_load_dwordx4 v[196:199], v6, s[4:7], s40 offen offset:1024 sc1
	s_add_u32 s40, s58, 0
	buffer_load_dwordx4 v[200:203], v6, s[4:7], s40 offen offset:0 sc1
	s_add_u32 s40, s58, 0
	buffer_load_dwordx4 v[204:207], v6, s[4:7], s40 offen offset:1024 sc1
	s_add_u32 s40, s58, 0
	buffer_load_dwordx4 v[208:211], v6, s[4:7], s40 offen offset:2048 sc1
	s_add_u32 s40, s58, 0
	buffer_load_dwordx4 v[212:215], v6, s[4:7], s40 offen offset:3072 sc1
	s_add_u32 s40, s58, 4096
	buffer_load_dwordx4 v[216:219], v6, s[4:7], s40 offen offset:0 sc1
	s_add_u32 s40, s58, 4096
	buffer_load_dwordx4 v[220:223], v6, s[4:7], s40 offen offset:1024 sc1
	s_add_u32 s40, s58, 4096
	buffer_load_dwordx4 v[224:227], v6, s[4:7], s40 offen offset:2048 sc1
	s_add_u32 s40, s58, 4096
	buffer_load_dwordx4 v[228:231], v6, s[4:7], s40 offen offset:3072 sc1
	s_add_u32 s40, s58, 8192
	buffer_load_dwordx4 v[232:235], v6, s[4:7], s40 offen offset:0 sc1
	s_add_u32 s40, s58, 8192
	buffer_load_dwordx4 v[236:239], v6, s[4:7], s40 offen offset:1024 sc1
	s_add_u32 s40, s58, 8192
	buffer_load_dwordx4 v[240:243], v6, s[4:7], s40 offen offset:2048 sc1
	s_add_u32 s40, s58, 8192
	buffer_load_dwordx4 v[244:247], v6, s[4:7], s40 offen offset:3072 sc1
	s_add_u32 s40, s58, 12288
	buffer_load_dwordx4 v[248:251], v6, s[4:7], s40 offen offset:0 sc1
	s_add_u32 s40, s58, 12288
	buffer_load_dwordx4 v[252:255], v6, s[4:7], s40 offen offset:1024 sc1
	s_waitcnt vmcnt(0)
	s_barrier
	buffer_atomic_add v9, v23, s[4:7], s24 offen offset:256
	buffer_atomic_add v9, v23, s[4:7], s24 offen offset:384
	v_subrev_u32 v4, 0x18000, v4
	v_subrev_u32 v5, 0x18000, v5
	s_add_u32 s40, s21, 4
	s_mul_i32 s42, s40, 458752
	s_add_u32 s22, s22, s42
	s_lshl_b32 s40, s40, 7
	s_add_u32 s24, s24, s40
	s_add_u32 s26, s26, 131072
	s_mov_b32 s25, 1
Lbu_loop:
	s_xor_b32 s17, s17, 0x8000
	s_add_u32 s18, s18, 114688
	s_add_u32 m0, s17, 0
	s_nop 0
	buffer_load_dwordx4 v3, s[12:15], s18 offen offset:0 lds
	s_add_u32 m0, s17, 3968
	s_nop 0
	buffer_load_dwordx4 v3, s[12:15], s18 offen offset:128 lds
	s_add_u32 m0, s17, 7936
	s_nop 0
	buffer_load_dwordx4 v3, s[12:15], s18 offen offset:256 lds
	s_add_u32 m0, s17, 11904
	s_nop 0
	buffer_load_dwordx4 v3, s[12:15], s18 offen offset:384 lds
	s_add_u32 m0, s17, 15872
	s_nop 0
	buffer_load_dwordx4 v3, s[12:15], s18 offen offset:512 lds
	s_add_u32 m0, s17, 19840
	s_nop 0
	buffer_load_dwordx4 v3, s[12:15], s18 offen offset:640 lds
	s_add_u32 m0, s17, 23808
	s_nop 0
	buffer_load_dwordx4 v3, s[12:15], s18 offen offset:768 lds
	s_xor_b32 s17, s17, 0x8000
	ds_read2_b32 v[24:25], v20 offset0:0 offset1:2
	ds_read2_b32 v[26:27], v22 offset0:0 offset1:2
	ds_read_b128 v[40:43], v4 offset:0
	ds_read_b128 v[44:47], v4 offset:2048
	ds_read_b128 v[48:51], v5 offset:0
	ds_read_b128 v[52:55], v5 offset:2048
	ds_read_b128 v[56:59], v4 offset:4096
	ds_read_b128 v[60:63], v4 offset:6144
	s_waitcnt lgkmcnt(4)
	v_mfma_f32_16x16x32_bf16 v[64:67], v[40:43], a[0:3], 0
	v_mfma_f32_16x16x32_bf16 v[92:95], v[44:47], a[0:3], 0
	v_mfma_f32_16x16x32_bf16 v[68:71], v[40:43], a[56:59], 0
	v_mfma_f32_16x16x32_bf16 v[96:99], v[44:47], a[56:59], 0
	v_mfma_f32_16x16x32_bf16 v[72:75], v[40:43], a[112:115], 0
	v_mfma_f32_16x16x32_bf16 v[100:103], v[44:47], a[112:115], 0
	v_mfma_f32_16x16x32_bf16 v[76:79], v[40:43], a[168:171], 0
	v_mfma_f32_16x16x32_bf16 v[104:107], v[44:47], a[168:171], 0
	v_mfma_f32_16x16x32_bf16 v[80:83], v[40:43], a[224:227], 0
	v_mfma_f32_16x16x32_bf16 v[108:111], v[44:47], a[224:227], 0
	v_mfma_f32_16x16x32_bf16 v[84:87], v[40:43], v[144:147], 0
	v_mfma_f32_16x16x32_bf16 v[112:115], v[44:47], v[144:147], 0
	v_mfma_f32_16x16x32_bf16 v[88:91], v[40:43], v[200:203], 0
	v_mfma_f32_16x16x32_bf16 v[116:119], v[44:47], v[200:203], 0
	ds_read_b128 v[40:43], v5 offset:4096
	ds_read_b128 v[44:47], v5 offset:6144
	s_waitcnt lgkmcnt(4)
	v_mfma_f32_16x16x32_bf16 v[64:67], v[48:51], a[4:7], v[64:67]
	v_mfma_f32_16x16x32_bf16 v[92:95], v[52:55], a[4:7], v[92:95]
	v_mfma_f32_16x16x32_bf16 v[68:71], v[48:51], a[60:63], v[68:71]
	v_mfma_f32_16x16x32_bf16 v[96:99], v[52:55], a[60:63], v[96:99]
	v_mfma_f32_16x16x32_bf16 v[72:75], v[48:51], a[116:119], v[72:75]
	v_mfma_f32_16x16x32_bf16 v[100:103], v[52:55], a[116:119], v[100:103]
	v_mfma_f32_16x16x32_bf16 v[76:79], v[48:51], a[172:175], v[76:79]
	v_mfma_f32_16x16x32_bf16 v[104:107], v[52:55], a[172:175], v[104:107]
	v_mfma_f32_16x16x32_bf16 v[80:83], v[48:51], a[228:231], v[80:83]
	v_mfma_f32_16x16x32_bf16 v[108:111], v[52:55], a[228:231], v[108:111]
	v_mfma_f32_16x16x32_bf16 v[84:87], v[48:51], v[148:151], v[84:87]
	v_mfma_f32_16x16x32_bf16 v[112:115], v[52:55], v[148:151], v[112:115]
	v_mfma_f32_16x16x32_bf16 v[88:91], v[48:51], v[204:207], v[88:91]
	v_mfma_f32_16x16x32_bf16 v[116:119], v[52:55], v[204:207], v[116:119]
	ds_read_b128 v[48:51], v4 offset:8192
	ds_read_b128 v[52:55], v4 offset:10240
	s_waitcnt lgkmcnt(4)
	v_mfma_f32_16x16x32_bf16 v[64:67], v[56:59], a[8:11], v[64:67]
	v_mfma_f32_16x16x32_bf16 v[92:95], v[60:63], a[8:11], v[92:95]
	v_mfma_f32_16x16x32_bf16 v[68:71], v[56:59], a[64:67], v[68:71]
	v_mfma_f32_16x16x32_bf16 v[96:99], v[60:63], a[64:67], v[96:99]
	v_mfma_f32_16x16x32_bf16 v[72:75], v[56:59], a[120:123], v[72:75]
	v_mfma_f32_16x16x32_bf16 v[100:103], v[60:63], a[120:123], v[100:103]
	v_mfma_f32_16x16x32_bf16 v[76:79], v[56:59], a[176:179], v[76:79]
	v_mfma_f32_16x16x32_bf16 v[104:107], v[60:63], a[176:179], v[104:107]
	v_mfma_f32_16x16x32_bf16 v[80:83], v[56:59], a[232:235], v[80:83]
	v_mfma_f32_16x16x32_bf16 v[108:111], v[60:63], a[232:235], v[108:111]
	v_mfma_f32_16x16x32_bf16 v[84:87], v[56:59], v[152:155], v[84:87]
	v_mfma_f32_16x16x32_bf16 v[112:115], v[60:63], v[152:155], v[112:115]
	v_mfma_f32_16x16x32_bf16 v[88:91], v[56:59], v[208:211], v[88:91]
	v_mfma_f32_16x16x32_bf16 v[116:119], v[60:63], v[208:211], v[116:119]
	ds_read_b128 v[56:59], v5 offset:8192
	ds_read_b128 v[60:63], v5 offset:10240
	s_waitcnt lgkmcnt(4)
	v_mfma_f32_16x16x32_bf16 v[64:67], v[40:43], a[12:15], v[64:67]
	v_mfma_f32_16x16x32_bf16 v[92:95], v[44:47], a[12:15], v[92:95]
	v_mfma_f32_16x16x32_bf16 v[68:71], v[40:43], a[68:71], v[68:71]
	v_mfma_f32_16x16x32_bf16 v[96:99], v[44:47], a[68:71], v[96:99]
	v_mfma_f32_16x16x32_bf16 v[72:75], v[40:43], a[124:127], v[72:75]
	v_mfma_f32_16x16x32_bf16 v[100:103], v[44:47], a[124:127], v[100:103]
	v_mfma_f32_16x16x32_bf16 v[76:79], v[40:43], a[180:183], v[76:79]
	v_mfma_f32_16x16x32_bf16 v[104:107], v[44:47], a[180:183], v[104:107]
	v_mfma_f32_16x16x32_bf16 v[80:83], v[40:43], a[236:239], v[80:83]
	v_mfma_f32_16x16x32_bf16 v[108:111], v[44:47], a[236:239], v[108:111]
	v_mfma_f32_16x16x32_bf16 v[84:87], v[40:43], v[156:159], v[84:87]
	v_mfma_f32_16x16x32_bf16 v[112:115], v[44:47], v[156:159], v[112:115]
	v_mfma_f32_16x16x32_bf16 v[88:91], v[40:43], v[212:215], v[88:91]
	v_mfma_f32_16x16x32_bf16 v[116:119], v[44:47], v[212:215], v[116:119]
	ds_read_b128 v[40:43], v4 offset:12288
	ds_read_b128 v[44:47], v4 offset:14336
	s_waitcnt lgkmcnt(4)
	v_mfma_f32_16x16x32_bf16 v[64:67], v[48:51], a[16:19], v[64:67]
	v_mfma_f32_16x16x32_bf16 v[92:95], v[52:55], a[16:19], v[92:95]
	v_mfma_f32_16x16x32_bf16 v[68:71], v[48:51], a[72:75], v[68:71]
	v_mfma_f32_16x16x32_bf16 v[96:99], v[52:55], a[72:75], v[96:99]
	v_mfma_f32_16x16x32_bf16 v[72:75], v[48:51], a[128:131], v[72:75]
	v_mfma_f32_16x16x32_bf16 v[100:103], v[52:55], a[128:131], v[100:103]
	v_mfma_f32_16x16x32_bf16 v[76:79], v[48:51], a[184:187], v[76:79]
	v_mfma_f32_16x16x32_bf16 v[104:107], v[52:55], a[184:187], v[104:107]
	v_mfma_f32_16x16x32_bf16 v[80:83], v[48:51], a[240:243], v[80:83]
	v_mfma_f32_16x16x32_bf16 v[108:111], v[52:55], a[240:243], v[108:111]
	v_mfma_f32_16x16x32_bf16 v[84:87], v[48:51], v[160:163], v[84:87]
	v_mfma_f32_16x16x32_bf16 v[112:115], v[52:55], v[160:163], v[112:115]
	v_mfma_f32_16x16x32_bf16 v[88:91], v[48:51], v[216:219], v[88:91]
	v_mfma_f32_16x16x32_bf16 v[116:119], v[52:55], v[216:219], v[116:119]
	ds_read_b128 v[48:51], v5 offset:12288
	ds_read_b128 v[52:55], v5 offset:14336
	s_waitcnt lgkmcnt(4)
	v_mfma_f32_16x16x32_bf16 v[64:67], v[56:59], a[20:23], v[64:67]
	v_mfma_f32_16x16x32_bf16 v[92:95], v[60:63], a[20:23], v[92:95]
	v_mfma_f32_16x16x32_bf16 v[68:71], v[56:59], a[76:79], v[68:71]
	v_mfma_f32_16x16x32_bf16 v[96:99], v[60:63], a[76:79], v[96:99]
	v_mfma_f32_16x16x32_bf16 v[72:75], v[56:59], a[132:135], v[72:75]
	v_mfma_f32_16x16x32_bf16 v[100:103], v[60:63], a[132:135], v[100:103]
	v_mfma_f32_16x16x32_bf16 v[76:79], v[56:59], a[188:191], v[76:79]
	v_mfma_f32_16x16x32_bf16 v[104:107], v[60:63], a[188:191], v[104:107]
	v_mfma_f32_16x16x32_bf16 v[80:83], v[56:59], a[244:247], v[80:83]
	v_mfma_f32_16x16x32_bf16 v[108:111], v[60:63], a[244:247], v[108:111]
	v_mfma_f32_16x16x32_bf16 v[84:87], v[56:59], v[164:167], v[84:87]
	v_mfma_f32_16x16x32_bf16 v[112:115], v[60:63], v[164:167], v[112:115]
	v_mfma_f32_16x16x32_bf16 v[88:91], v[56:59], v[220:223], v[88:91]
	v_mfma_f32_16x16x32_bf16 v[116:119], v[60:63], v[220:223], v[116:119]
	ds_read_b128 v[56:59], v4 offset:16384
	ds_read_b128 v[60:63], v4 offset:18432
	s_waitcnt lgkmcnt(4)
	v_mfma_f32_16x16x32_bf16 v[64:67], v[40:43], a[24:27], v[64:67]
	v_mfma_f32_16x16x32_bf16 v[92:95], v[44:47], a[24:27], v[92:95]
	v_mfma_f32_16x16x32_bf16 v[68:71], v[40:43], a[80:83], v[68:71]
	v_mfma_f32_16x16x32_bf16 v[96:99], v[44:47], a[80:83], v[96:99]
	v_mfma_f32_16x16x32_bf16 v[72:75], v[40:43], a[136:139], v[72:75]
	v_mfma_f32_16x16x32_bf16 v[100:103], v[44:47], a[136:139], v[100:103]
	v_mfma_f32_16x16x32_bf16 v[76:79], v[40:43], a[192:195], v[76:79]
	v_mfma_f32_16x16x32_bf16 v[104:107], v[44:47], a[192:195], v[104:107]
	v_mfma_f32_16x16x32_bf16 v[80:83], v[40:43], a[248:251], v[80:83]
	v_mfma_f32_16x16x32_bf16 v[108:111], v[44:47], a[248:251], v[108:111]
	v_mfma_f32_16x16x32_bf16 v[84:87], v[40:43], v[168:171], v[84:87]
	v_mfma_f32_16x16x32_bf16 v[112:115], v[44:47], v[168:171], v[112:115]
	v_mfma_f32_16x16x32_bf16 v[88:91], v[40:43], v[224:227], v[88:91]
	v_mfma_f32_16x16x32_bf16 v[116:119], v[44:47], v[224:227], v[116:119]
	ds_read_b128 v[40:43], v5 offset:16384
	ds_read_b128 v[44:47], v5 offset:18432
	s_waitcnt lgkmcnt(4)
	v_mfma_f32_16x16x32_bf16 v[64:67], v[48:51], a[28:31], v[64:67]
	v_mfma_f32_16x16x32_bf16 v[92:95], v[52:55], a[28:31], v[92:95]
	v_mfma_f32_16x16x32_bf16 v[68:71], v[48:51], a[84:87], v[68:71]
	v_mfma_f32_16x16x32_bf16 v[96:99], v[52:55], a[84:87], v[96:99]
	v_mfma_f32_16x16x32_bf16 v[72:75], v[48:51], a[140:143], v[72:75]
	v_mfma_f32_16x16x32_bf16 v[100:103], v[52:55], a[140:143], v[100:103]
	v_mfma_f32_16x16x32_bf16 v[76:79], v[48:51], a[196:199], v[76:79]
	v_mfma_f32_16x16x32_bf16 v[104:107], v[52:55], a[196:199], v[104:107]
	v_mfma_f32_16x16x32_bf16 v[80:83], v[48:51], a[252:255], v[80:83]
	v_mfma_f32_16x16x32_bf16 v[108:111], v[52:55], a[252:255], v[108:111]
	v_mfma_f32_16x16x32_bf16 v[84:87], v[48:51], v[172:175], v[84:87]
	v_mfma_f32_16x16x32_bf16 v[112:115], v[52:55], v[172:175], v[112:115]
	v_mfma_f32_16x16x32_bf16 v[88:91], v[48:51], v[228:231], v[88:91]
	v_mfma_f32_16x16x32_bf16 v[116:119], v[52:55], v[228:231], v[116:119]
	ds_read_b128 v[48:51], v4 offset:20480
	ds_read_b128 v[52:55], v4 offset:22528
	s_waitcnt lgkmcnt(4)
	v_mfma_f32_16x16x32_bf16 v[64:67], v[56:59], a[32:35], v[64:67]
	v_mfma_f32_16x16x32_bf16 v[92:95], v[60:63], a[32:35], v[92:95]
	v_mfma_f32_16x16x32_bf16 v[68:71], v[56:59], a[88:91], v[68:71]
	v_mfma_f32_16x16x32_bf16 v[96:99], v[60:63], a[88:91], v[96:99]
	v_mfma_f32_16x16x32_bf16 v[72:75], v[56:59], a[144:147], v[72:75]
	v_mfma_f32_16x16x32_bf16 v[100:103], v[60:63], a[144:147], v[100:103]
	v_mfma_f32_16x16x32_bf16 v[76:79], v[56:59], a[200:203], v[76:79]
	v_mfma_f32_16x16x32_bf16 v[104:107], v[60:63], a[200:203], v[104:107]
	v_mfma_f32_16x16x32_bf16 v[80:83], v[56:59], v[120:123], v[80:83]
	v_mfma_f32_16x16x32_bf16 v[108:111], v[60:63], v[120:123], v[108:111]
	v_mfma_f32_16x16x32_bf16 v[84:87], v[56:59], v[176:179], v[84:87]
	v_mfma_f32_16x16x32_bf16 v[112:115], v[60:63], v[176:179], v[112:115]
	v_mfma_f32_16x16x32_bf16 v[88:91], v[56:59], v[232:235], v[88:91]
	v_mfma_f32_16x16x32_bf16 v[116:119], v[60:63], v[232:235], v[116:119]
	ds_read_b128 v[56:59], v5 offset:20480
	ds_read_b128 v[60:63], v5 offset:22528
	s_waitcnt lgkmcnt(4)
	v_mfma_f32_16x16x32_bf16 v[64:67], v[40:43], a[36:39], v[64:67]
	v_mfma_f32_16x16x32_bf16 v[92:95], v[44:47], a[36:39], v[92:95]
	v_mfma_f32_16x16x32_bf16 v[68:71], v[40:43], a[92:95], v[68:71]
	v_mfma_f32_16x16x32_bf16 v[96:99], v[44:47], a[92:95], v[96:99]
	v_mfma_f32_16x16x32_bf16 v[72:75], v[40:43], a[148:151], v[72:75]
	v_mfma_f32_16x16x32_bf16 v[100:103], v[44:47], a[148:151], v[100:103]
	v_mfma_f32_16x16x32_bf16 v[76:79], v[40:43], a[204:207], v[76:79]
	v_mfma_f32_16x16x32_bf16 v[104:107], v[44:47], a[204:207], v[104:107]
	v_mfma_f32_16x16x32_bf16 v[80:83], v[40:43], v[124:127], v[80:83]
	v_mfma_f32_16x16x32_bf16 v[108:111], v[44:47], v[124:127], v[108:111]
	v_mfma_f32_16x16x32_bf16 v[84:87], v[40:43], v[180:183], v[84:87]
	v_mfma_f32_16x16x32_bf16 v[112:115], v[44:47], v[180:183], v[112:115]
	v_mfma_f32_16x16x32_bf16 v[88:91], v[40:43], v[236:239], v[88:91]
	v_mfma_f32_16x16x32_bf16 v[116:119], v[44:47], v[236:239], v[116:119]
	ds_read_b128 v[40:43], v4 offset:24576
	ds_read_b128 v[44:47], v4 offset:26624
	s_waitcnt lgkmcnt(4)
	v_mfma_f32_16x16x32_bf16 v[64:67], v[48:51], a[40:43], v[64:67]
	v_mfma_f32_16x16x32_bf16 v[92:95], v[52:55], a[40:43], v[92:95]
	v_mfma_f32_16x16x32_bf16 v[68:71], v[48:51], a[96:99], v[68:71]
	v_mfma_f32_16x16x32_bf16 v[96:99], v[52:55], a[96:99], v[96:99]
	v_mfma_f32_16x16x32_bf16 v[72:75], v[48:51], a[152:155], v[72:75]
	v_mfma_f32_16x16x32_bf16 v[100:103], v[52:55], a[152:155], v[100:103]
	v_mfma_f32_16x16x32_bf16 v[76:79], v[48:51], a[208:211], v[76:79]
	v_mfma_f32_16x16x32_bf16 v[104:107], v[52:55], a[208:211], v[104:107]
	v_mfma_f32_16x16x32_bf16 v[80:83], v[48:51], v[128:131], v[80:83]
	v_mfma_f32_16x16x32_bf16 v[108:111], v[52:55], v[128:131], v[108:111]
	v_mfma_f32_16x16x32_bf16 v[84:87], v[48:51], v[184:187], v[84:87]
	v_mfma_f32_16x16x32_bf16 v[112:115], v[52:55], v[184:187], v[112:115]
	v_mfma_f32_16x16x32_bf16 v[88:91], v[48:51], v[240:243], v[88:91]
	v_mfma_f32_16x16x32_bf16 v[116:119], v[52:55], v[240:243], v[116:119]
	ds_read_b128 v[48:51], v5 offset:24576
	ds_read_b128 v[52:55], v5 offset:26624
	s_waitcnt lgkmcnt(4)
	v_mfma_f32_16x16x32_bf16 v[64:67], v[56:59], a[44:47], v[64:67]
	v_mfma_f32_16x16x32_bf16 v[92:95], v[60:63], a[44:47], v[92:95]
	v_mfma_f32_16x16x32_bf16 v[68:71], v[56:59], a[100:103], v[68:71]
	v_mfma_f32_16x16x32_bf16 v[96:99], v[60:63], a[100:103], v[96:99]
	v_mfma_f32_16x16x32_bf16 v[72:75], v[56:59], a[156:159], v[72:75]
	v_mfma_f32_16x16x32_bf16 v[100:103], v[60:63], a[156:159], v[100:103]
	v_mfma_f32_16x16x32_bf16 v[76:79], v[56:59], a[212:215], v[76:79]
	v_mfma_f32_16x16x32_bf16 v[104:107], v[60:63], a[212:215], v[104:107]
	v_mfma_f32_16x16x32_bf16 v[80:83], v[56:59], v[132:135], v[80:83]
	v_mfma_f32_16x16x32_bf16 v[108:111], v[60:63], v[132:135], v[108:111]
	v_mfma_f32_16x16x32_bf16 v[84:87], v[56:59], v[188:191], v[84:87]
	v_mfma_f32_16x16x32_bf16 v[112:115], v[60:63], v[188:191], v[112:115]
	v_mfma_f32_16x16x32_bf16 v[88:91], v[56:59], v[244:247], v[88:91]
	v_mfma_f32_16x16x32_bf16 v[116:119], v[60:63], v[244:247], v[116:119]
	s_waitcnt lgkmcnt(2)
	v_mfma_f32_16x16x32_bf16 v[64:67], v[40:43], a[48:51], v[64:67]
	v_mfma_f32_16x16x32_bf16 v[92:95], v[44:47], a[48:51], v[92:95]
	v_mfma_f32_16x16x32_bf16 v[68:71], v[40:43], a[104:107], v[68:71]
	v_mfma_f32_16x16x32_bf16 v[96:99], v[44:47], a[104:107], v[96:99]
	v_mfma_f32_16x16x32_bf16 v[72:75], v[40:43], a[160:163], v[72:75]
	v_mfma_f32_16x16x32_bf16 v[100:103], v[44:47], a[160:163], v[100:103]
	v_mfma_f32_16x16x32_bf16 v[76:79], v[40:43], a[216:219], v[76:79]
	v_mfma_f32_16x16x32_bf16 v[104:107], v[44:47], a[216:219], v[104:107]
	v_mfma_f32_16x16x32_bf16 v[80:83], v[40:43], v[136:139], v[80:83]
	v_mfma_f32_16x16x32_bf16 v[108:111], v[44:47], v[136:139], v[108:111]
	v_mfma_f32_16x16x32_bf16 v[84:87], v[40:43], v[192:195], v[84:87]
	v_mfma_f32_16x16x32_bf16 v[112:115], v[44:47], v[192:195], v[112:115]
	v_mfma_f32_16x16x32_bf16 v[88:91], v[40:43], v[248:251], v[88:91]
	v_mfma_f32_16x16x32_bf16 v[116:119], v[44:47], v[248:251], v[116:119]
	s_waitcnt lgkmcnt(0)
	v_mfma_f32_16x16x32_bf16 v[64:67], v[48:51], a[52:55], v[64:67]
	v_mfma_f32_16x16x32_bf16 v[92:95], v[52:55], a[52:55], v[92:95]
	v_mfma_f32_16x16x32_bf16 v[68:71], v[48:51], a[108:111], v[68:71]
	v_mfma_f32_16x16x32_bf16 v[96:99], v[52:55], a[108:111], v[96:99]
	v_mfma_f32_16x16x32_bf16 v[72:75], v[48:51], a[164:167], v[72:75]
	v_mfma_f32_16x16x32_bf16 v[100:103], v[52:55], a[164:167], v[100:103]
	v_mfma_f32_16x16x32_bf16 v[76:79], v[48:51], a[220:223], v[76:79]
	v_mfma_f32_16x16x32_bf16 v[104:107], v[52:55], a[220:223], v[104:107]
	v_mfma_f32_16x16x32_bf16 v[80:83], v[48:51], v[140:143], v[80:83]
	v_mfma_f32_16x16x32_bf16 v[108:111], v[52:55], v[140:143], v[108:111]
	v_mfma_f32_16x16x32_bf16 v[84:87], v[48:51], v[196:199], v[84:87]
	v_mfma_f32_16x16x32_bf16 v[112:115], v[52:55], v[196:199], v[112:115]
	v_mfma_f32_16x16x32_bf16 v[88:91], v[48:51], v[252:255], v[88:91]
	v_mfma_f32_16x16x32_bf16 v[116:119], v[52:55], v[252:255], v[116:119]
	v_swap_b32 v25, v26
	buffer_store_dwordx4 v[24:27], v21, s[4:7], s26 offen sc1
	s_mul_i32 s40, s60, s23
	s_add_u32 s40, s40, s22
	v_cvt_pk_bf16_f32 v40, v64, v65
	v_cvt_pk_bf16_f32 v41, v66, v67
	v_cvt_pk_bf16_f32 v42, v92, v93
	v_cvt_pk_bf16_f32 v43, v94, v95
	buffer_store_dwordx4 v[40:43], v6, s[4:7], s40 offen sc1
	s_mul_i32 s40, s61, s23
	s_add_u32 s40, s40, s22
	v_cvt_pk_bf16_f32 v48, v68, v69
	v_cvt_pk_bf16_f32 v49, v70, v71
	v_cvt_pk_bf16_f32 v50, v96, v97
	v_cvt_pk_bf16_f32 v51, v98, v99
	buffer_store_dwordx4 v[48:51], v6, s[4:7], s40 offen sc1
	s_mul_i32 s40, s62, s23
	s_add_u32 s40, s40, s22
	v_cvt_pk_bf16_f32 v56, v72, v73
	v_cvt_pk_bf16_f32 v57, v74, v75
	v_cvt_pk_bf16_f32 v58, v100, v101
	v_cvt_pk_bf16_f32 v59, v102, v103
	buffer_store_dwordx4 v[56:59], v6, s[4:7], s40 offen sc1
	s_mul_i32 s40, s63, s23
	s_add_u32 s40, s40, s22
	v_cvt_pk_bf16_f32 v40, v76, v77
	v_cvt_pk_bf16_f32 v41, v78, v79
	v_cvt_pk_bf16_f32 v42, v104, v105
	v_cvt_pk_bf16_f32 v43, v106, v107
	buffer_store_dwordx4 v[40:43], v6, s[4:7], s40 offen sc1
	s_mul_i32 s40, s64, s23
	s_add_u32 s40, s40, s22
	v_cvt_pk_bf16_f32 v48, v80, v81
	v_cvt_pk_bf16_f32 v49, v82, v83
	v_cvt_pk_bf16_f32 v50, v108, v109
	v_cvt_pk_bf16_f32 v51, v110, v111
	buffer_store_dwordx4 v[48:51], v6, s[4:7], s40 offen sc1
	s_mul_i32 s40, s65, s23
	s_add_u32 s40, s40, s22
	v_cvt_pk_bf16_f32 v56, v84, v85
	v_cvt_pk_bf16_f32 v57, v86, v87
	v_cvt_pk_bf16_f32 v58, v112, v113
	v_cvt_pk_bf16_f32 v59, v114, v115
	buffer_store_dwordx4 v[56:59], v6, s[4:7], s40 offen sc1
	s_mul_i32 s40, s66, s23
	s_add_u32 s40, s40, s22
	v_cvt_pk_bf16_f32 v40, v88, v89
	v_cvt_pk_bf16_f32 v41, v90, v91
	v_cvt_pk_bf16_f32 v42, v116, v117
	v_cvt_pk_bf16_f32 v43, v118, v119
	buffer_store_dwordx4 v[40:43], v6, s[4:7], s40 offen sc1
	s_waitcnt vmcnt(0)
	s_barrier
	v_mov_b32 v9, 4
	buffer_atomic_add v9, v23, s[4:7], s24 offen
	v_xor_b32 v4, 0x8000, v4
	v_xor_b32 v5, 0x8000, v5
	s_xor_b32 s17, s17, 0x8000
	v_xor_b32 v20, 0x8000, v20
	v_xor_b32 v22, 0x8000, v22
	s_add_u32 s26, s26, 131072
	s_add_u32 s22, s22, 1835008
	s_add_u32 s24, s24, 512
	s_add_u32 s25, s25, 1
	s_cmp_lt_u32 s25, 16
	s_cbranch_scc1 Lbu_loop
	s_mov_b32 s12, s4
	s_mov_b32 s13, s5
	s_mov_b32 s14, s6
	s_mov_b32 s15, 0x00020000
	s_mul_i32 s18, s21, 28672
	s_add_u32 s18, s18, 49545216
	s_mul_i32 s22, s21, 458752
	s_lshl_b32 s40, s41, 12
	s_add_u32 s22, s22, s40
	s_lshl_b32 s40, s20, 8
	s_add_u32 s22, s22, s40
	s_add_u32 s22, s22, 42205184
	s_mov_b32 s23, 4096
	s_lshl_b32 s24, s21, 7
	s_add_u32 s24, s24, 60284928
	s_mov_b32 s40, 114688
	v_mul_lo_u32 v10, v2, s40
	v_lshl_add_u32 v10, v1, 4, v10
	v_min_u32 v11, 55, v0
	v_lshlrev_b32 v11, 4, v11
	s_mul_i32 s40, s33, 1792
	s_add_u32 s40, s40, 21504
	v_add_u32 v11, s40, v11
	s_mov_b32 s25, 0
Lbv_loop:
	buffer_load_dwordx4 v[12:15], v11, s[4:7], s18 offen sc1
	buffer_load_dwordx4 v[16:19], v11, s[4:7], s18 offen offset:896 sc1
	s_waitcnt vmcnt(0)
	v_dot2_f32_bf16 v9, v12, v13, 0
	v_dot2_f32_bf16 v9, v14, v15, v9
	v_dot2_f32_bf16 v9, v16, v17, v9
	v_dot2_f32_bf16 v9, v18, v19, v9
	s_nop 2
	v_cmp_u_f32 vcc, v9, v9
	s_cbranch_vccz Lbv_go
	s_sleep 2
	s_sub_u32 s16, s16, 1
	s_cbranch_scc0 Lbv_loop
	s_mov_b32 s16, 0
Lbv_go:
	s_barrier
	s_add_u32 m0, s17, 0
	s_nop 0
	buffer_load_dwordx4 v3, s[12:15], s18 offen offset:0 sc1 lds
	s_add_u32 m0, s17, 3968
	s_nop 0
	buffer_load_dwordx4 v3, s[12:15], s18 offen offset:128 sc1 lds
	s_add_u32 m0, s17, 7936
	s_nop 0
	buffer_load_dwordx4 v3, s[12:15], s18 offen offset:256 sc1 lds
	s_add_u32 m0, s17, 11904
	s_nop 0
	buffer_load_dwordx4 v3, s[12:15], s18 offen offset:384 sc1 lds
	s_add_u32 m0, s17, 15872
	s_nop 0
	buffer_load_dwordx4 v3, s[12:15], s18 offen offset:512 sc1 lds
	s_add_u32 m0, s17, 19840
	s_nop 0
	buffer_load_dwordx4 v3, s[12:15], s18 offen offset:640 sc1 lds
	s_add_u32 m0, s17, 23808
	s_nop 0
	buffer_load_dwordx4 v3, s[12:15], s18 offen offset:768 sc1 lds
	s_waitcnt vmcnt(0)
	s_barrier
	ds_read_b128 v[40:43], v4 offset:0
	ds_read_b128 v[44:47], v4 offset:2048
	ds_read_b128 v[48:51], v5 offset:0
	ds_read_b128 v[52:55], v5 offset:2048
	ds_read_b128 v[56:59], v4 offset:4096
	ds_read_b128 v[60:63], v4 offset:6144
	s_waitcnt lgkmcnt(4)
	v_mfma_f32_16x16x32_bf16 v[64:67], v[40:43], a[0:3], 0
	v_mfma_f32_16x16x32_bf16 v[92:95], v[44:47], a[0:3], 0
	v_mfma_f32_16x16x32_bf16 v[68:71], v[40:43], a[56:59], 0
	v_mfma_f32_16x16x32_bf16 v[96:99], v[44:47], a[56:59], 0
	v_mfma_f32_16x16x32_bf16 v[72:75], v[40:43], a[112:115], 0
	v_mfma_f32_16x16x32_bf16 v[100:103], v[44:47], a[112:115], 0
	v_mfma_f32_16x16x32_bf16 v[76:79], v[40:43], a[168:171], 0
	v_mfma_f32_16x16x32_bf16 v[104:107], v[44:47], a[168:171], 0
	v_mfma_f32_16x16x32_bf16 v[80:83], v[40:43], a[224:227], 0
	v_mfma_f32_16x16x32_bf16 v[108:111], v[44:47], a[224:227], 0
	v_mfma_f32_16x16x32_bf16 v[84:87], v[40:43], v[144:147], 0
	v_mfma_f32_16x16x32_bf16 v[112:115], v[44:47], v[144:147], 0
	v_mfma_f32_16x16x32_bf16 v[88:91], v[40:43], v[200:203], 0
	v_mfma_f32_16x16x32_bf16 v[116:119], v[44:47], v[200:203], 0
	ds_read_b128 v[40:43], v5 offset:4096
	ds_read_b128 v[44:47], v5 offset:6144
	s_waitcnt lgkmcnt(4)
	v_mfma_f32_16x16x32_bf16 v[64:67], v[48:51], a[4:7], v[64:67]
	v_mfma_f32_16x16x32_bf16 v[92:95], v[52:55], a[4:7], v[92:95]
	v_mfma_f32_16x16x32_bf16 v[68:71], v[48:51], a[60:63], v[68:71]
	v_mfma_f32_16x16x32_bf16 v[96:99], v[52:55], a[60:63], v[96:99]
	v_mfma_f32_16x16x32_bf16 v[72:75], v[48:51], a[116:119], v[72:75]
	v_mfma_f32_16x16x32_bf16 v[100:103], v[52:55], a[116:119], v[100:103]
	v_mfma_f32_16x16x32_bf16 v[76:79], v[48:51], a[172:175], v[76:79]
	v_mfma_f32_16x16x32_bf16 v[104:107], v[52:55], a[172:175], v[104:107]
	v_mfma_f32_16x16x32_bf16 v[80:83], v[48:51], a[228:231], v[80:83]
	v_mfma_f32_16x16x32_bf16 v[108:111], v[52:55], a[228:231], v[108:111]
	v_mfma_f32_16x16x32_bf16 v[84:87], v[48:51], v[148:151], v[84:87]
	v_mfma_f32_16x16x32_bf16 v[112:115], v[52:55], v[148:151], v[112:115]
	v_mfma_f32_16x16x32_bf16 v[88:91], v[48:51], v[204:207], v[88:91]
	v_mfma_f32_16x16x32_bf16 v[116:119], v[52:55], v[204:207], v[116:119]
	ds_read_b128 v[48:51], v4 offset:8192
	ds_read_b128 v[52:55], v4 offset:10240
	s_waitcnt lgkmcnt(4)
	v_mfma_f32_16x16x32_bf16 v[64:67], v[56:59], a[8:11], v[64:67]
	v_mfma_f32_16x16x32_bf16 v[92:95], v[60:63], a[8:11], v[92:95]
	v_mfma_f32_16x16x32_bf16 v[68:71], v[56:59], a[64:67], v[68:71]
	v_mfma_f32_16x16x32_bf16 v[96:99], v[60:63], a[64:67], v[96:99]
	v_mfma_f32_16x16x32_bf16 v[72:75], v[56:59], a[120:123], v[72:75]
	v_mfma_f32_16x16x32_bf16 v[100:103], v[60:63], a[120:123], v[100:103]
	v_mfma_f32_16x16x32_bf16 v[76:79], v[56:59], a[176:179], v[76:79]
	v_mfma_f32_16x16x32_bf16 v[104:107], v[60:63], a[176:179], v[104:107]
	v_mfma_f32_16x16x32_bf16 v[80:83], v[56:59], a[232:235], v[80:83]
	v_mfma_f32_16x16x32_bf16 v[108:111], v[60:63], a[232:235], v[108:111]
	v_mfma_f32_16x16x32_bf16 v[84:87], v[56:59], v[152:155], v[84:87]
	v_mfma_f32_16x16x32_bf16 v[112:115], v[60:63], v[152:155], v[112:115]
	v_mfma_f32_16x16x32_bf16 v[88:91], v[56:59], v[208:211], v[88:91]
	v_mfma_f32_16x16x32_bf16 v[116:119], v[60:63], v[208:211], v[116:119]
	ds_read_b128 v[56:59], v5 offset:8192
	ds_read_b128 v[60:63], v5 offset:10240
	s_waitcnt lgkmcnt(4)
	v_mfma_f32_16x16x32_bf16 v[64:67], v[40:43], a[12:15], v[64:67]
	v_mfma_f32_16x16x32_bf16 v[92:95], v[44:47], a[12:15], v[92:95]
	v_mfma_f32_16x16x32_bf16 v[68:71], v[40:43], a[68:71], v[68:71]
	v_mfma_f32_16x16x32_bf16 v[96:99], v[44:47], a[68:71], v[96:99]
	v_mfma_f32_16x16x32_bf16 v[72:75], v[40:43], a[124:127], v[72:75]
	v_mfma_f32_16x16x32_bf16 v[100:103], v[44:47], a[124:127], v[100:103]
	v_mfma_f32_16x16x32_bf16 v[76:79], v[40:43], a[180:183], v[76:79]
	v_mfma_f32_16x16x32_bf16 v[104:107], v[44:47], a[180:183], v[104:107]
	v_mfma_f32_16x16x32_bf16 v[80:83], v[40:43], a[236:239], v[80:83]
	v_mfma_f32_16x16x32_bf16 v[108:111], v[44:47], a[236:239], v[108:111]
	v_mfma_f32_16x16x32_bf16 v[84:87], v[40:43], v[156:159], v[84:87]
	v_mfma_f32_16x16x32_bf16 v[112:115], v[44:47], v[156:159], v[112:115]
	v_mfma_f32_16x16x32_bf16 v[88:91], v[40:43], v[212:215], v[88:91]
	v_mfma_f32_16x16x32_bf16 v[116:119], v[44:47], v[212:215], v[116:119]
	ds_read_b128 v[40:43], v4 offset:12288
	ds_read_b128 v[44:47], v4 offset:14336
	s_waitcnt lgkmcnt(4)
	v_mfma_f32_16x16x32_bf16 v[64:67], v[48:51], a[16:19], v[64:67]
	v_mfma_f32_16x16x32_bf16 v[92:95], v[52:55], a[16:19], v[92:95]
	v_mfma_f32_16x16x32_bf16 v[68:71], v[48:51], a[72:75], v[68:71]
	v_mfma_f32_16x16x32_bf16 v[96:99], v[52:55], a[72:75], v[96:99]
	v_mfma_f32_16x16x32_bf16 v[72:75], v[48:51], a[128:131], v[72:75]
	v_mfma_f32_16x16x32_bf16 v[100:103], v[52:55], a[128:131], v[100:103]
	v_mfma_f32_16x16x32_bf16 v[76:79], v[48:51], a[184:187], v[76:79]
	v_mfma_f32_16x16x32_bf16 v[104:107], v[52:55], a[184:187], v[104:107]
	v_mfma_f32_16x16x32_bf16 v[80:83], v[48:51], a[240:243], v[80:83]
	v_mfma_f32_16x16x32_bf16 v[108:111], v[52:55], a[240:243], v[108:111]
	v_mfma_f32_16x16x32_bf16 v[84:87], v[48:51], v[160:163], v[84:87]
	v_mfma_f32_16x16x32_bf16 v[112:115], v[52:55], v[160:163], v[112:115]
	v_mfma_f32_16x16x32_bf16 v[88:91], v[48:51], v[216:219], v[88:91]
	v_mfma_f32_16x16x32_bf16 v[116:119], v[52:55], v[216:219], v[116:119]
	ds_read_b128 v[48:51], v5 offset:12288
	ds_read_b128 v[52:55], v5 offset:14336
	s_waitcnt lgkmcnt(4)
	v_mfma_f32_16x16x32_bf16 v[64:67], v[56:59], a[20:23], v[64:67]
	v_mfma_f32_16x16x32_bf16 v[92:95], v[60:63], a[20:23], v[92:95]
	v_mfma_f32_16x16x32_bf16 v[68:71], v[56:59], a[76:79], v[68:71]
	v_mfma_f32_16x16x32_bf16 v[96:99], v[60:63], a[76:79], v[96:99]
	v_mfma_f32_16x16x32_bf16 v[72:75], v[56:59], a[132:135], v[72:75]
	v_mfma_f32_16x16x32_bf16 v[100:103], v[60:63], a[132:135], v[100:103]
	v_mfma_f32_16x16x32_bf16 v[76:79], v[56:59], a[188:191], v[76:79]
	v_mfma_f32_16x16x32_bf16 v[104:107], v[60:63], a[188:191], v[104:107]
	v_mfma_f32_16x16x32_bf16 v[80:83], v[56:59], a[244:247], v[80:83]
	v_mfma_f32_16x16x32_bf16 v[108:111], v[60:63], a[244:247], v[108:111]
	v_mfma_f32_16x16x32_bf16 v[84:87], v[56:59], v[164:167], v[84:87]
	v_mfma_f32_16x16x32_bf16 v[112:115], v[60:63], v[164:167], v[112:115]
	v_mfma_f32_16x16x32_bf16 v[88:91], v[56:59], v[220:223], v[88:91]
	v_mfma_f32_16x16x32_bf16 v[116:119], v[60:63], v[220:223], v[116:119]
	ds_read_b128 v[56:59], v4 offset:16384
	ds_read_b128 v[60:63], v4 offset:18432
	s_waitcnt lgkmcnt(4)
	v_mfma_f32_16x16x32_bf16 v[64:67], v[40:43], a[24:27], v[64:67]
	v_mfma_f32_16x16x32_bf16 v[92:95], v[44:47], a[24:27], v[92:95]
	v_mfma_f32_16x16x32_bf16 v[68:71], v[40:43], a[80:83], v[68:71]
	v_mfma_f32_16x16x32_bf16 v[96:99], v[44:47], a[80:83], v[96:99]
	v_mfma_f32_16x16x32_bf16 v[72:75], v[40:43], a[136:139], v[72:75]
	v_mfma_f32_16x16x32_bf16 v[100:103], v[44:47], a[136:139], v[100:103]
	v_mfma_f32_16x16x32_bf16 v[76:79], v[40:43], a[192:195], v[76:79]
	v_mfma_f32_16x16x32_bf16 v[104:107], v[44:47], a[192:195], v[104:107]
	v_mfma_f32_16x16x32_bf16 v[80:83], v[40:43], a[248:251], v[80:83]
	v_mfma_f32_16x16x32_bf16 v[108:111], v[44:47], a[248:251], v[108:111]
	v_mfma_f32_16x16x32_bf16 v[84:87], v[40:43], v[168:171], v[84:87]
	v_mfma_f32_16x16x32_bf16 v[112:115], v[44:47], v[168:171], v[112:115]
	v_mfma_f32_16x16x32_bf16 v[88:91], v[40:43], v[224:227], v[88:91]
	v_mfma_f32_16x16x32_bf16 v[116:119], v[44:47], v[224:227], v[116:119]
	ds_read_b128 v[40:43], v5 offset:16384
	ds_read_b128 v[44:47], v5 offset:18432
	s_waitcnt lgkmcnt(4)
	v_mfma_f32_16x16x32_bf16 v[64:67], v[48:51], a[28:31], v[64:67]
	v_mfma_f32_16x16x32_bf16 v[92:95], v[52:55], a[28:31], v[92:95]
	v_mfma_f32_16x16x32_bf16 v[68:71], v[48:51], a[84:87], v[68:71]
	v_mfma_f32_16x16x32_bf16 v[96:99], v[52:55], a[84:87], v[96:99]
	v_mfma_f32_16x16x32_bf16 v[72:75], v[48:51], a[140:143], v[72:75]
	v_mfma_f32_16x16x32_bf16 v[100:103], v[52:55], a[140:143], v[100:103]
	v_mfma_f32_16x16x32_bf16 v[76:79], v[48:51], a[196:199], v[76:79]
	v_mfma_f32_16x16x32_bf16 v[104:107], v[52:55], a[196:199], v[104:107]
	v_mfma_f32_16x16x32_bf16 v[80:83], v[48:51], a[252:255], v[80:83]
	v_mfma_f32_16x16x32_bf16 v[108:111], v[52:55], a[252:255], v[108:111]
	v_mfma_f32_16x16x32_bf16 v[84:87], v[48:51], v[172:175], v[84:87]
	v_mfma_f32_16x16x32_bf16 v[112:115], v[52:55], v[172:175], v[112:115]
	v_mfma_f32_16x16x32_bf16 v[88:91], v[48:51], v[228:231], v[88:91]
	v_mfma_f32_16x16x32_bf16 v[116:119], v[52:55], v[228:231], v[116:119]
	ds_read_b128 v[48:51], v4 offset:20480
	ds_read_b128 v[52:55], v4 offset:22528
	s_waitcnt lgkmcnt(4)
	v_mfma_f32_16x16x32_bf16 v[64:67], v[56:59], a[32:35], v[64:67]
	v_mfma_f32_16x16x32_bf16 v[92:95], v[60:63], a[32:35], v[92:95]
	v_mfma_f32_16x16x32_bf16 v[68:71], v[56:59], a[88:91], v[68:71]
	v_mfma_f32_16x16x32_bf16 v[96:99], v[60:63], a[88:91], v[96:99]
	v_mfma_f32_16x16x32_bf16 v[72:75], v[56:59], a[144:147], v[72:75]
	v_mfma_f32_16x16x32_bf16 v[100:103], v[60:63], a[144:147], v[100:103]
	v_mfma_f32_16x16x32_bf16 v[76:79], v[56:59], a[200:203], v[76:79]
	v_mfma_f32_16x16x32_bf16 v[104:107], v[60:63], a[200:203], v[104:107]
	v_mfma_f32_16x16x32_bf16 v[80:83], v[56:59], v[120:123], v[80:83]
	v_mfma_f32_16x16x32_bf16 v[108:111], v[60:63], v[120:123], v[108:111]
	v_mfma_f32_16x16x32_bf16 v[84:87], v[56:59], v[176:179], v[84:87]
	v_mfma_f32_16x16x32_bf16 v[112:115], v[60:63], v[176:179], v[112:115]
	v_mfma_f32_16x16x32_bf16 v[88:91], v[56:59], v[232:235], v[88:91]
	v_mfma_f32_16x16x32_bf16 v[116:119], v[60:63], v[232:235], v[116:119]
	ds_read_b128 v[56:59], v5 offset:20480
	ds_read_b128 v[60:63], v5 offset:22528
	s_waitcnt lgkmcnt(4)
	v_mfma_f32_16x16x32_bf16 v[64:67], v[40:43], a[36:39], v[64:67]
	v_mfma_f32_16x16x32_bf16 v[92:95], v[44:47], a[36:39], v[92:95]
	v_mfma_f32_16x16x32_bf16 v[68:71], v[40:43], a[92:95], v[68:71]
	v_mfma_f32_16x16x32_bf16 v[96:99], v[44:47], a[92:95], v[96:99]
	v_mfma_f32_16x16x32_bf16 v[72:75], v[40:43], a[148:151], v[72:75]
	v_mfma_f32_16x16x32_bf16 v[100:103], v[44:47], a[148:151], v[100:103]
	v_mfma_f32_16x16x32_bf16 v[76:79], v[40:43], a[204:207], v[76:79]
	v_mfma_f32_16x16x32_bf16 v[104:107], v[44:47], a[204:207], v[104:107]
	v_mfma_f32_16x16x32_bf16 v[80:83], v[40:43], v[124:127], v[80:83]
	v_mfma_f32_16x16x32_bf16 v[108:111], v[44:47], v[124:127], v[108:111]
	v_mfma_f32_16x16x32_bf16 v[84:87], v[40:43], v[180:183], v[84:87]
	v_mfma_f32_16x16x32_bf16 v[112:115], v[44:47], v[180:183], v[112:115]
	v_mfma_f32_16x16x32_bf16 v[88:91], v[40:43], v[236:239], v[88:91]
	v_mfma_f32_16x16x32_bf16 v[116:119], v[44:47], v[236:239], v[116:119]
	ds_read_b128 v[40:43], v4 offset:24576
	ds_read_b128 v[44:47], v4 offset:26624
	s_waitcnt lgkmcnt(4)
	v_mfma_f32_16x16x32_bf16 v[64:67], v[48:51], a[40:43], v[64:67]
	v_mfma_f32_16x16x32_bf16 v[92:95], v[52:55], a[40:43], v[92:95]
	v_mfma_f32_16x16x32_bf16 v[68:71], v[48:51], a[96:99], v[68:71]
	v_mfma_f32_16x16x32_bf16 v[96:99], v[52:55], a[96:99], v[96:99]
	v_mfma_f32_16x16x32_bf16 v[72:75], v[48:51], a[152:155], v[72:75]
	v_mfma_f32_16x16x32_bf16 v[100:103], v[52:55], a[152:155], v[100:103]
	v_mfma_f32_16x16x32_bf16 v[76:79], v[48:51], a[208:211], v[76:79]
	v_mfma_f32_16x16x32_bf16 v[104:107], v[52:55], a[208:211], v[104:107]
	v_mfma_f32_16x16x32_bf16 v[80:83], v[48:51], v[128:131], v[80:83]
	v_mfma_f32_16x16x32_bf16 v[108:111], v[52:55], v[128:131], v[108:111]
	v_mfma_f32_16x16x32_bf16 v[84:87], v[48:51], v[184:187], v[84:87]
	v_mfma_f32_16x16x32_bf16 v[112:115], v[52:55], v[184:187], v[112:115]
	v_mfma_f32_16x16x32_bf16 v[88:91], v[48:51], v[240:243], v[88:91]
	v_mfma_f32_16x16x32_bf16 v[116:119], v[52:55], v[240:243], v[116:119]
	ds_read_b128 v[48:51], v5 offset:24576
	ds_read_b128 v[52:55], v5 offset:26624
	s_waitcnt lgkmcnt(4)
	v_mfma_f32_16x16x32_bf16 v[64:67], v[56:59], a[44:47], v[64:67]
	v_mfma_f32_16x16x32_bf16 v[92:95], v[60:63], a[44:47], v[92:95]
	v_mfma_f32_16x16x32_bf16 v[68:71], v[56:59], a[100:103], v[68:71]
	v_mfma_f32_16x16x32_bf16 v[96:99], v[60:63], a[100:103], v[96:99]
	v_mfma_f32_16x16x32_bf16 v[72:75], v[56:59], a[156:159], v[72:75]
	v_mfma_f32_16x16x32_bf16 v[100:103], v[60:63], a[156:159], v[100:103]
	v_mfma_f32_16x16x32_bf16 v[76:79], v[56:59], a[212:215], v[76:79]
	v_mfma_f32_16x16x32_bf16 v[104:107], v[60:63], a[212:215], v[104:107]
	v_mfma_f32_16x16x32_bf16 v[80:83], v[56:59], v[132:135], v[80:83]
	v_mfma_f32_16x16x32_bf16 v[108:111], v[60:63], v[132:135], v[108:111]
	v_mfma_f32_16x16x32_bf16 v[84:87], v[56:59], v[188:191], v[84:87]
	v_mfma_f32_16x16x32_bf16 v[112:115], v[60:63], v[188:191], v[112:115]
	v_mfma_f32_16x16x32_bf16 v[88:91], v[56:59], v[244:247], v[88:91]
	v_mfma_f32_16x16x32_bf16 v[116:119], v[60:63], v[244:247], v[116:119]
	s_waitcnt lgkmcnt(2)
	v_mfma_f32_16x16x32_bf16 v[64:67], v[40:43], a[48:51], v[64:67]
	v_mfma_f32_16x16x32_bf16 v[92:95], v[44:47], a[48:51], v[92:95]
	v_mfma_f32_16x16x32_bf16 v[68:71], v[40:43], a[104:107], v[68:71]
	v_mfma_f32_16x16x32_bf16 v[96:99], v[44:47], a[104:107], v[96:99]
	v_mfma_f32_16x16x32_bf16 v[72:75], v[40:43], a[160:163], v[72:75]
	v_mfma_f32_16x16x32_bf16 v[100:103], v[44:47], a[160:163], v[100:103]
	v_mfma_f32_16x16x32_bf16 v[76:79], v[40:43], a[216:219], v[76:79]
	v_mfma_f32_16x16x32_bf16 v[104:107], v[44:47], a[216:219], v[104:107]
	v_mfma_f32_16x16x32_bf16 v[80:83], v[40:43], v[136:139], v[80:83]
	v_mfma_f32_16x16x32_bf16 v[108:111], v[44:47], v[136:139], v[108:111]
	v_mfma_f32_16x16x32_bf16 v[84:87], v[40:43], v[192:195], v[84:87]
	v_mfma_f32_16x16x32_bf16 v[112:115], v[44:47], v[192:195], v[112:115]
	v_mfma_f32_16x16x32_bf16 v[88:91], v[40:43], v[248:251], v[88:91]
	v_mfma_f32_16x16x32_bf16 v[116:119], v[44:47], v[248:251], v[116:119]
	s_waitcnt lgkmcnt(0)
	v_mfma_f32_16x16x32_bf16 v[64:67], v[48:51], a[52:55], v[64:67]
	v_mfma_f32_16x16x32_bf16 v[92:95], v[52:55], a[52:55], v[92:95]
	v_mfma_f32_16x16x32_bf16 v[68:71], v[48:51], a[108:111], v[68:71]
	v_mfma_f32_16x16x32_bf16 v[96:99], v[52:55], a[108:111], v[96:99]
	v_mfma_f32_16x16x32_bf16 v[72:75], v[48:51], a[164:167], v[72:75]
	v_mfma_f32_16x16x32_bf16 v[100:103], v[52:55], a[164:167], v[100:103]
	v_mfma_f32_16x16x32_bf16 v[76:79], v[48:51], a[220:223], v[76:79]
	v_mfma_f32_16x16x32_bf16 v[104:107], v[52:55], a[220:223], v[104:107]
	v_mfma_f32_16x16x32_bf16 v[80:83], v[48:51], v[140:143], v[80:83]
	v_mfma_f32_16x16x32_bf16 v[108:111], v[52:55], v[140:143], v[108:111]
	v_mfma_f32_16x16x32_bf16 v[84:87], v[48:51], v[196:199], v[84:87]
	v_mfma_f32_16x16x32_bf16 v[112:115], v[52:55], v[196:199], v[112:115]
	v_mfma_f32_16x16x32_bf16 v[88:91], v[48:51], v[252:255], v[88:91]
	v_mfma_f32_16x16x32_bf16 v[116:119], v[52:55], v[252:255], v[116:119]
	s_mul_i32 s40, s60, s23
	s_add_u32 s40, s40, s22
	v_cvt_pk_bf16_f32 v40, v64, v65
	v_cvt_pk_bf16_f32 v41, v66, v67
	v_cvt_pk_bf16_f32 v42, v92, v93
	v_cvt_pk_bf16_f32 v43, v94, v95
	buffer_store_dwordx4 v[40:43], v10, s[4:7], s40 offen sc1
	s_mul_i32 s40, s61, s23
	s_add_u32 s40, s40, s22
	v_cvt_pk_bf16_f32 v48, v68, v69
	v_cvt_pk_bf16_f32 v49, v70, v71
	v_cvt_pk_bf16_f32 v50, v96, v97
	v_cvt_pk_bf16_f32 v51, v98, v99
	buffer_store_dwordx4 v[48:51], v10, s[4:7], s40 offen sc1
	s_mul_i32 s40, s62, s23
	s_add_u32 s40, s40, s22
	v_cvt_pk_bf16_f32 v56, v72, v73
	v_cvt_pk_bf16_f32 v57, v74, v75
	v_cvt_pk_bf16_f32 v58, v100, v101
	v_cvt_pk_bf16_f32 v59, v102, v103
	buffer_store_dwordx4 v[56:59], v10, s[4:7], s40 offen sc1
	s_mul_i32 s40, s63, s23
	s_add_u32 s40, s40, s22
	v_cvt_pk_bf16_f32 v40, v76, v77
	v_cvt_pk_bf16_f32 v41, v78, v79
	v_cvt_pk_bf16_f32 v42, v104, v105
	v_cvt_pk_bf16_f32 v43, v106, v107
	buffer_store_dwordx4 v[40:43], v10, s[4:7], s40 offen sc1
	s_mul_i32 s40, s64, s23
	s_add_u32 s40, s40, s22
	v_cvt_pk_bf16_f32 v48, v80, v81
	v_cvt_pk_bf16_f32 v49, v82, v83
	v_cvt_pk_bf16_f32 v50, v108, v109
	v_cvt_pk_bf16_f32 v51, v110, v111
	buffer_store_dwordx4 v[48:51], v10, s[4:7], s40 offen sc1
	s_mul_i32 s40, s65, s23
	s_add_u32 s40, s40, s22
	v_cvt_pk_bf16_f32 v56, v84, v85
	v_cvt_pk_bf16_f32 v57, v86, v87
	v_cvt_pk_bf16_f32 v58, v112, v113
	v_cvt_pk_bf16_f32 v59, v114, v115
	buffer_store_dwordx4 v[56:59], v10, s[4:7], s40 offen sc1
	s_mul_i32 s40, s66, s23
	s_add_u32 s40, s40, s22
	v_cvt_pk_bf16_f32 v40, v88, v89
	v_cvt_pk_bf16_f32 v41, v90, v91
	v_cvt_pk_bf16_f32 v42, v116, v117
	v_cvt_pk_bf16_f32 v43, v118, v119
	buffer_store_dwordx4 v[40:43], v10, s[4:7], s40 offen sc1
	s_waitcnt vmcnt(0)
	v_mov_b32 v9, 1
	buffer_atomic_add v9, v8, s[4:7], s24 offen
	s_add_u32 s18, s18, 114688
	s_add_u32 s22, s22, 1835008
	s_add_u32 s24, s24, 512
	s_add_u32 s25, s25, 1
	s_lshl_b32 s40, s25, 2
	s_add_u32 s40, s40, s21
	s_cmp_lt_u32 s40, 15
	s_cbranch_scc1 Lbv_loop
	s_waitcnt vmcnt(0)
	s_endpgm
Law_j:
	s_sub_u32 s32, s32, 160
	v_and_b32 v1, 15, v0
	v_lshrrev_b32 v2, 4, v0
	v_lshlrev_b32 v6, 4, v0
	v_lshrrev_b32 v7, 3, v0
	s_lshl_b32 s40, s33, 3
	v_add_u32 v7, s40, v7
	v_bfe_u32 v8, v7, 2, 2
	v_lshlrev_b32 v8, 3, v8
	v_lshrrev_b32 v9, 4, v7
	v_lshl_add_u32 v8, v9, 2, v8
	v_and_b32 v9, 3, v7
	v_add_u32 v8, v8, v9
	s_mov_b32 s40, 896
	v_mul_lo_u32 v8, v8, s40
	v_bfe_u32 v9, v7, 1, 3
	v_and_b32 v10, 7, v0
	v_xor_b32 v9, v9, v10
	v_lshl_add_u32 v3, v9, 4, v8
	v_lshrrev_b32 v9, 1, v1
	v_xor_b32 v9, v9, v2
	v_lshlrev_b32 v9, 4, v9
	v_lshl_add_u32 v4, v1, 7, v9
	v_xor_b32 v5, 64, v4
	v_mov_b32 v7, 0
	v_mov_b32 v9, 0x80000000
	v_cmp_eq_u32 vcc, 0, v0
	s_nop 1
	v_cndmask_b32 v8, v9, v0, vcc
	s_mov_b32 s16, 0x200000
	s_lshr_b32 s20, s32, 2
	s_and_b32 s21, s32, 3
	s_mov_b32 s12, s8
	s_mov_b32 s13, s9
	s_mov_b32 s14, s10
	s_mov_b32 s15, 0x00020000
	s_lshl_b32 s17, s33, 10
	s_mul_i32 s18, s21, 28672
	s_add_u32 m0, s17, 0
	s_nop 0
	buffer_load_dwordx4 v3, s[12:15], s18 offen offset:0 lds
	s_add_u32 m0, s17, 3968
	s_nop 0
	buffer_load_dwordx4 v3, s[12:15], s18 offen offset:128 lds
	s_add_u32 m0, s17, 7936
	s_nop 0
	buffer_load_dwordx4 v3, s[12:15], s18 offen offset:256 lds
	s_add_u32 m0, s17, 11904
	s_nop 0
	buffer_load_dwordx4 v3, s[12:15], s18 offen offset:384 lds
	s_add_u32 m0, s17, 15872
	s_nop 0
	buffer_load_dwordx4 v3, s[12:15], s18 offen offset:512 lds
	s_add_u32 m0, s17, 19840
	s_nop 0
	buffer_load_dwordx4 v3, s[12:15], s18 offen offset:640 lds
	s_add_u32 m0, s17, 23808
	s_nop 0
	buffer_load_dwordx4 v3, s[12:15], s18 offen offset:768 lds
	s_and_b32 s42, s33, 1
	s_mul_i32 s41, s33, 7
	s_add_u32 s43, s41, s42
	s_cmp_eq_u32 s42, 0
	s_cselect_b32 s44, 6, 0
	s_add_u32 s44, s44, s41
	s_lshl_b32 s49, s20, 7
	s_add_u32 s49, s49, 60295168
	s_add_u32 s40, s49, 4
Lwc_19:
	buffer_load_dword v9, v7, s[4:7], s40 offen sc1
	s_waitcnt vmcnt(0)
	v_cmp_gt_u32 vcc, 7, v9
	s_cbranch_vccz Lwo_20
	s_sleep 1
	s_sub_u32 s16, s16, 1
	s_cbranch_scc0 Lwc_19
	s_mov_b32 s16, 0
Lwo_20:
	s_add_u32 s40, s43, 0
	s_mul_i32 s45, s20, 28
	s_add_u32 s40, s40, s45
	s_mul_i32 s40, s40, 14336
	s_add_u32 s40, s40, 0
	buffer_load_dwordx4 a[0:3], v6, s[4:7], s40 offen offset:0 sc1
	buffer_load_dwordx4 a[4:7], v6, s[4:7], s40 offen offset:1024 sc1
	s_add_u32 s40, s40, 4096
	buffer_load_dwordx4 a[28:31], v6, s[4:7], s40 offen offset:3072 sc1
	s_add_u32 s40, s40, 4096
	buffer_load_dwordx4 a[32:35], v6, s[4:7], s40 offen offset:0 sc1
	s_add_u32 s40, s43, 1
	s_mul_i32 s45, s20, 28
	s_add_u32 s40, s40, s45
	s_mul_i32 s40, s40, 14336
	s_add_u32 s40, s40, 0
	buffer_load_dwordx4 a[56:59], v6, s[4:7], s40 offen offset:0 sc1
	buffer_load_dwordx4 a[60:63], v6, s[4:7], s40 offen offset:1024 sc1
	s_add_u32 s40, s40, 4096
	buffer_load_dwordx4 a[84:87], v6, s[4:7], s40 offen offset:3072 sc1
	s_add_u32 s40, s40, 4096
	buffer_load_dwordx4 a[88:91], v6, s[4:7], s40 offen offset:0 sc1
	s_add_u32 s40, s43, 2
	s_mul_i32 s45, s20, 28
	s_add_u32 s40, s40, s45
	s_mul_i32 s40, s40, 14336
	s_add_u32 s40, s40, 0
	buffer_load_dwordx4 a[112:115], v6, s[4:7], s40 offen offset:0 sc1
	buffer_load_dwordx4 a[116:119], v6, s[4:7], s40 offen offset:1024 sc1
	s_add_u32 s40, s40, 4096
	buffer_load_dwordx4 a[140:143], v6, s[4:7], s40 offen offset:3072 sc1
	s_add_u32 s40, s40, 4096
	buffer_load_dwordx4 a[144:147], v6, s[4:7], s40 offen offset:0 sc1
	s_add_u32 s40, s43, 3
	s_mul_i32 s45, s20, 28
	s_add_u32 s40, s40, s45
	s_mul_i32 s40, s40, 14336
	s_add_u32 s40, s40, 0
	buffer_load_dwordx4 a[168:171], v6, s[4:7], s40 offen offset:0 sc1
	buffer_load_dwordx4 a[172:175], v6, s[4:7], s40 offen offset:1024 sc1
	s_add_u32 s40, s40, 4096
	buffer_load_dwordx4 a[196:199], v6, s[4:7], s40 offen offset:3072 sc1
	s_add_u32 s40, s40, 4096
	buffer_load_dwordx4 a[200:203], v6, s[4:7], s40 offen offset:0 sc1
	s_add_u32 s40, s43, 4
	s_mul_i32 s45, s20, 28
	s_add_u32 s40, s40, s45
	s_mul_i32 s40, s40, 14336
	s_add_u32 s40, s40, 0
	buffer_load_dwordx4 a[224:227], v6, s[4:7], s40 offen offset:0 sc1
	buffer_load_dwordx4 a[228:231], v6, s[4:7], s40 offen offset:1024 sc1
	s_add_u32 s40, s40, 4096
	buffer_load_dwordx4 a[252:255], v6, s[4:7], s40 offen offset:3072 sc1
	s_add_u32 s40, s40, 4096
	buffer_load_dwordx4 v[120:123], v6, s[4:7], s40 offen offset:0 sc1
	s_add_u32 s40, s43, 5
	s_mul_i32 s45, s20, 28
	s_add_u32 s40, s40, s45
	s_mul_i32 s40, s40, 14336
	s_add_u32 s40, s40, 0
	buffer_load_dwordx4 v[144:147], v6, s[4:7], s40 offen offset:0 sc1
	buffer_load_dwordx4 v[148:151], v6, s[4:7], s40 offen offset:1024 sc1
	s_add_u32 s40, s40, 4096
	buffer_load_dwordx4 v[172:175], v6, s[4:7], s40 offen offset:3072 sc1
	s_add_u32 s40, s40, 4096
	buffer_load_dwordx4 v[176:179], v6, s[4:7], s40 offen offset:0 sc1
	s_mov_b32 s40, s44
	s_mul_i32 s45, s20, 28
	s_add_u32 s40, s40, s45
	s_mul_i32 s40, s40, 14336
	s_add_u32 s40, s40, 0
	buffer_load_dwordx4 v[200:203], v6, s[4:7], s40 offen offset:0 sc1
	buffer_load_dwordx4 v[204:207], v6, s[4:7], s40 offen offset:1024 sc1
	s_add_u32 s40, s40, 4096
	buffer_load_dwordx4 v[228:231], v6, s[4:7], s40 offen offset:3072 sc1
	s_add_u32 s40, s40, 4096
	buffer_load_dwordx4 v[232:235], v6, s[4:7], s40 offen offset:0 sc1
	s_add_u32 s40, s49, 0
Lwc_21:
	buffer_load_dword v9, v7, s[4:7], s40 offen sc1
	s_waitcnt vmcnt(0)
	v_cmp_gt_u32 vcc, 7, v9
	s_cbranch_vccz Lwo_22
	s_sleep 1
	s_sub_u32 s16, s16, 1
	s_cbranch_scc0 Lwc_21
	s_mov_b32 s16, 0
Lwo_22:
	s_add_u32 s40, s43, 0
	s_mul_i32 s45, s20, 28
	s_add_u32 s40, s40, s45
	s_mul_i32 s40, s40, 14336
	s_add_u32 s40, s40, 0
	buffer_load_dwordx4 a[8:11], v6, s[4:7], s40 offen offset:2048 sc1
	buffer_load_dwordx4 a[12:15], v6, s[4:7], s40 offen offset:3072 sc1
	s_add_u32 s40, s40, 4096
	buffer_load_dwordx4 a[16:19], v6, s[4:7], s40 offen offset:0 sc1
	buffer_load_dwordx4 a[20:23], v6, s[4:7], s40 offen offset:1024 sc1
	buffer_load_dwordx4 a[24:27], v6, s[4:7], s40 offen offset:2048 sc1
	s_add_u32 s40, s40, 4096
	buffer_load_dwordx4 a[36:39], v6, s[4:7], s40 offen offset:1024 sc1
	buffer_load_dwordx4 a[40:43], v6, s[4:7], s40 offen offset:2048 sc1
	buffer_load_dwordx4 a[44:47], v6, s[4:7], s40 offen offset:3072 sc1
	s_add_u32 s40, s40, 4096
	buffer_load_dwordx4 a[48:51], v6, s[4:7], s40 offen offset:0 sc1
	buffer_load_dwordx4 a[52:55], v6, s[4:7], s40 offen offset:1024 sc1
	s_add_u32 s40, s43, 1
	s_mul_i32 s45, s20, 28
	s_add_u32 s40, s40, s45
	s_mul_i32 s40, s40, 14336
	s_add_u32 s40, s40, 0
	buffer_load_dwordx4 a[64:67], v6, s[4:7], s40 offen offset:2048 sc1
	buffer_load_dwordx4 a[68:71], v6, s[4:7], s40 offen offset:3072 sc1
	s_add_u32 s40, s40, 4096
	buffer_load_dwordx4 a[72:75], v6, s[4:7], s40 offen offset:0 sc1
	buffer_load_dwordx4 a[76:79], v6, s[4:7], s40 offen offset:1024 sc1
	buffer_load_dwordx4 a[80:83], v6, s[4:7], s40 offen offset:2048 sc1
	s_add_u32 s40, s40, 4096
	buffer_load_dwordx4 a[92:95], v6, s[4:7], s40 offen offset:1024 sc1
	buffer_load_dwordx4 a[96:99], v6, s[4:7], s40 offen offset:2048 sc1
	buffer_load_dwordx4 a[100:103], v6, s[4:7], s40 offen offset:3072 sc1
	s_add_u32 s40, s40, 4096
	buffer_load_dwordx4 a[104:107], v6, s[4:7], s40 offen offset:0 sc1
	buffer_load_dwordx4 a[108:111], v6, s[4:7], s40 offen offset:1024 sc1
	s_add_u32 s40, s43, 2
	s_mul_i32 s45, s20, 28
	s_add_u32 s40, s40, s45
	s_mul_i32 s40, s40, 14336
	s_add_u32 s40, s40, 0
	buffer_load_dwordx4 a[120:123], v6, s[4:7], s40 offen offset:2048 sc1
	buffer_load_dwordx4 a[124:127], v6, s[4:7], s40 offen offset:3072 sc1
	s_add_u32 s40, s40, 4096
	buffer_load_dwordx4 a[128:131], v6, s[4:7], s40 offen offset:0 sc1
	buffer_load_dwordx4 a[132:135], v6, s[4:7], s40 offen offset:1024 sc1
	buffer_load_dwordx4 a[136:139], v6, s[4:7], s40 offen offset:2048 sc1
	s_add_u32 s40, s40, 4096
	buffer_load_dwordx4 a[148:151], v6, s[4:7], s40 offen offset:1024 sc1
	buffer_load_dwordx4 a[152:155], v6, s[4:7], s40 offen offset:2048 sc1
	buffer_load_dwordx4 a[156:159], v6, s[4:7], s40 offen offset:3072 sc1
	s_add_u32 s40, s40, 4096
	buffer_load_dwordx4 a[160:163], v6, s[4:7], s40 offen offset:0 sc1
	buffer_load_dwordx4 a[164:167], v6, s[4:7], s40 offen offset:1024 sc1
	s_add_u32 s40, s43, 3
	s_mul_i32 s45, s20, 28
	s_add_u32 s40, s40, s45
	s_mul_i32 s40, s40, 14336
	s_add_u32 s40, s40, 0
	buffer_load_dwordx4 a[176:179], v6, s[4:7], s40 offen offset:2048 sc1
	buffer_load_dwordx4 a[180:183], v6, s[4:7], s40 offen offset:3072 sc1
	s_add_u32 s40, s40, 4096
	buffer_load_dwordx4 a[184:187], v6, s[4:7], s40 offen offset:0 sc1
	buffer_load_dwordx4 a[188:191], v6, s[4:7], s40 offen offset:1024 sc1
	buffer_load_dwordx4 a[192:195], v6, s[4:7], s40 offen offset:2048 sc1
	s_add_u32 s40, s40, 4096
	buffer_load_dwordx4 a[204:207], v6, s[4:7], s40 offen offset:1024 sc1
	buffer_load_dwordx4 a[208:211], v6, s[4:7], s40 offen offset:2048 sc1
	buffer_load_dwordx4 a[212:215], v6, s[4:7], s40 offen offset:3072 sc1
	s_add_u32 s40, s40, 4096
	buffer_load_dwordx4 a[216:219], v6, s[4:7], s40 offen offset:0 sc1
	buffer_load_dwordx4 a[220:223], v6, s[4:7], s40 offen offset:1024 sc1
	s_add_u32 s40, s43, 4
	s_mul_i32 s45, s20, 28
	s_add_u32 s40, s40, s45
	s_mul_i32 s40, s40, 14336
	s_add_u32 s40, s40, 0
	buffer_load_dwordx4 a[232:235], v6, s[4:7], s40 offen offset:2048 sc1
	buffer_load_dwordx4 a[236:239], v6, s[4:7], s40 offen offset:3072 sc1
	s_add_u32 s40, s40, 4096
	buffer_load_dwordx4 a[240:243], v6, s[4:7], s40 offen offset:0 sc1
	buffer_load_dwordx4 a[244:247], v6, s[4:7], s40 offen offset:1024 sc1
	buffer_load_dwordx4 a[248:251], v6, s[4:7], s40 offen offset:2048 sc1
	s_add_u32 s40, s40, 4096
	buffer_load_dwordx4 v[124:127], v6, s[4:7], s40 offen offset:1024 sc1
	buffer_load_dwordx4 v[128:131], v6, s[4:7], s40 offen offset:2048 sc1
	buffer_load_dwordx4 v[132:135], v6, s[4:7], s40 offen offset:3072 sc1
	s_add_u32 s40, s40, 4096
	buffer_load_dwordx4 v[136:139], v6, s[4:7], s40 offen offset:0 sc1
	s_waitcnt vmcnt(48)
	buffer_load_dwordx4 v[140:143], v6, s[4:7], s40 offen offset:1024 sc1
	s_waitcnt vmcnt(48)
	s_add_u32 s40, s43, 5
	s_mul_i32 s45, s20, 28
	s_add_u32 s40, s40, s45
	s_mul_i32 s40, s40, 14336
	s_add_u32 s40, s40, 0
	buffer_load_dwordx4 v[152:155], v6, s[4:7], s40 offen offset:2048 sc1
	s_waitcnt vmcnt(48)
	buffer_load_dwordx4 v[156:159], v6, s[4:7], s40 offen offset:3072 sc1
	s_waitcnt vmcnt(48)
	s_add_u32 s40, s40, 4096
	buffer_load_dwordx4 v[160:163], v6, s[4:7], s40 offen offset:0 sc1
	s_waitcnt vmcnt(48)
	buffer_load_dwordx4 v[164:167], v6, s[4:7], s40 offen offset:1024 sc1
	s_waitcnt vmcnt(48)
	buffer_load_dwordx4 v[168:171], v6, s[4:7], s40 offen offset:2048 sc1
	s_waitcnt vmcnt(48)
	s_add_u32 s40, s40, 4096
	buffer_load_dwordx4 v[180:183], v6, s[4:7], s40 offen offset:1024 sc1
	s_waitcnt vmcnt(48)
	buffer_load_dwordx4 v[184:187], v6, s[4:7], s40 offen offset:2048 sc1
	s_waitcnt vmcnt(48)
	buffer_load_dwordx4 v[188:191], v6, s[4:7], s40 offen offset:3072 sc1
	s_waitcnt vmcnt(48)
	s_add_u32 s40, s40, 4096
	buffer_load_dwordx4 v[192:195], v6, s[4:7], s40 offen offset:0 sc1
	s_waitcnt vmcnt(48)
	buffer_load_dwordx4 v[196:199], v6, s[4:7], s40 offen offset:1024 sc1
	s_waitcnt vmcnt(48)
	s_mov_b32 s40, s44
	s_mul_i32 s45, s20, 28
	s_add_u32 s40, s40, s45
	s_mul_i32 s40, s40, 14336
	s_add_u32 s40, s40, 0
	buffer_load_dwordx4 v[208:211], v6, s[4:7], s40 offen offset:2048 sc1
	s_waitcnt vmcnt(48)
	buffer_load_dwordx4 v[212:215], v6, s[4:7], s40 offen offset:3072 sc1
	s_waitcnt vmcnt(48)
	s_add_u32 s40, s40, 4096
	buffer_load_dwordx4 v[216:219], v6, s[4:7], s40 offen offset:0 sc1
	s_waitcnt vmcnt(48)
	buffer_load_dwordx4 v[220:223], v6, s[4:7], s40 offen offset:1024 sc1
	s_waitcnt vmcnt(48)
	buffer_load_dwordx4 v[224:227], v6, s[4:7], s40 offen offset:2048 sc1
	s_waitcnt vmcnt(48)
	s_add_u32 s40, s40, 4096
	buffer_load_dwordx4 v[236:239], v6, s[4:7], s40 offen offset:1024 sc1
	s_waitcnt vmcnt(48)
	buffer_load_dwordx4 v[240:243], v6, s[4:7], s40 offen offset:2048 sc1
	s_waitcnt vmcnt(48)
	buffer_load_dwordx4 v[244:247], v6, s[4:7], s40 offen offset:3072 sc1
	s_waitcnt vmcnt(48)
	s_add_u32 s40, s40, 4096
	buffer_load_dwordx4 v[248:251], v6, s[4:7], s40 offen offset:0 sc1
	s_waitcnt vmcnt(48)
	buffer_load_dwordx4 v[252:255], v6, s[4:7], s40 offen offset:1024 sc1
	s_waitcnt vmcnt(48)
	v_lshrrev_b32 v21, 2, v1
	v_lshlrev_b32 v21, 1, v21
	v_and_b32 v22, 1, v1
	v_add_u32 v21, v21, v22
	v_mul_u32_u24 v21, 912, v21
	v_lshl_add_u32 v21, v2, 5, v21
	v_add_u32 v21, 98304, v21
	v_lshrrev_b32 v22, 1, v1
	v_lshlrev_b32 v23, 1, v2
	v_xor_b32 v22, v22, v23
	v_lshlrev_b32 v22, 4, v22
	v_lshl_add_u32 v22, v1, 7, v22
	s_lshr_b32 s40, s43, 1
	s_add_u32 s40, s40, 0
	s_lshr_b32 s47, s40, 1
	s_lshl_b32 s45, s47, 12
	s_and_b32 s46, s40, 1
	s_lshl_b32 s46, s46, 4
	s_lshl_b32 s47, s47, 7
	s_add_u32 s47, s47, s46
	v_xor_b32 v10, s46, v22
	v_add_u32 v10, s45, v10
	v_add_u32 v14, s47, v21
	s_lshr_b32 s40, s43, 1
	s_add_u32 s40, s40, 1
	s_lshr_b32 s47, s40, 1
	s_lshl_b32 s45, s47, 12
	s_and_b32 s46, s40, 1
	s_lshl_b32 s46, s46, 4
	s_lshl_b32 s47, s47, 7
	s_add_u32 s47, s47, s46
	v_xor_b32 v11, s46, v22
	v_add_u32 v11, s45, v11
	v_add_u32 v15, s47, v21
	s_lshr_b32 s40, s43, 1
	s_add_u32 s40, s40, 2
	s_lshr_b32 s47, s40, 1
	s_lshl_b32 s45, s47, 12
	s_and_b32 s46, s40, 1
	s_lshl_b32 s46, s46, 4
	s_lshl_b32 s47, s47, 7
	s_add_u32 s47, s47, s46
	v_xor_b32 v12, s46, v22
	v_add_u32 v12, s45, v12
	v_add_u32 v16, s47, v21
	s_lshr_b32 s40, s44, 1
	s_lshr_b32 s47, s40, 1
	s_lshl_b32 s45, s47, 12
	s_and_b32 s46, s40, 1
	s_lshl_b32 s46, s46, 4
	s_lshl_b32 s47, s47, 7
	s_add_u32 s47, s47, s46
	s_lshl_b32 s48, s42, 2
	s_add_u32 s45, s45, s48
	s_add_u32 s47, s47, s48
	v_xor_b32 v13, s46, v22
	v_add_u32 v13, s45, v13
	v_add_u32 v17, s47, v21
	s_mul_i32 s40, s33, 6144
	s_add_u32 s40, s40, 65536
	v_add_u32 v18, s40, v6
	s_mul_i32 s40, s42, 3072
	s_add_u32 s40, s40, 65536
	v_add_u32 v19, s40, v6
	v_lshrrev_b32 v21, 2, v1
	v_sub_u32 v21, v21, v2
	v_lshlrev_b32 v21, 3, v21
	v_and_b32 v22, 3, v1
	v_add_u32 v21, v21, v22
	s_lshl_b32 s40, s42, 2
	v_add_u32 v21, s40, v21
	v_cmp_le_i32 s[60:61], 0, v21
	v_cmp_le_i32 s[62:63], 1, v21
	v_cmp_le_i32 s[64:65], 2, v21
	v_cmp_le_i32 s[66:67], 3, v21
	v_cmp_le_i32 s[68:69], 4, v21
	v_cmp_le_i32 s[70:71], 5, v21
	v_cmp_le_i32 s[72:73], 6, v21
	v_cmp_le_i32 s[74:75], 7, v21
	v_min_u32 v23, 55, v0
	v_lshlrev_b32 v23, 4, v23
	s_mul_i32 s40, s33, 1792
	v_add_u32 v22, s40, v23
	s_mul_i32 s40, s33, 1824
	s_add_u32 s40, s40, 98304
	v_add_u32 v23, s40, v23
	v_lshlrev_b32 v20, 4, v1
	v_lshl_add_u32 v20, v2, 2, v20
	s_mul_i32 s40, s21, 40960
	s_mul_i32 s45, s42, 20480
	s_add_u32 s40, s40, s45
	s_add_u32 s40, s40, 53968896
	s_lshl_b32 s45, s20, 10
	s_add_u32 s22, s40, s45
	s_lshl_b32 s45, s20, 8
	s_add_u32 s23, s40, s45
	s_add_u32 s23, s23, 16384
	s_lshl_b32 s24, s21, 7
	s_add_u32 s24, s24, 60276736
	s_mul_i32 s26, s21, 7168
	s_add_u32 s26, s26, 49545216
	s_mov_b32 s25, 0
	s_mov_b32 s27, 0xceabfb8f
La_loop:
	s_waitcnt vmcnt(0)
	s_barrier
	s_xor_b32 s17, s17, 0x8000
	s_add_u32 s18, s18, 114688
	s_add_u32 m0, s17, 0
	s_nop 0
	buffer_load_dwordx4 v3, s[12:15], s18 offen offset:0 lds
	s_add_u32 m0, s17, 3968
	s_nop 0
	buffer_load_dwordx4 v3, s[12:15], s18 offen offset:128 lds
	s_add_u32 m0, s17, 7936
	s_nop 0
	buffer_load_dwordx4 v3, s[12:15], s18 offen offset:256 lds
	s_add_u32 m0, s17, 11904
	s_nop 0
	buffer_load_dwordx4 v3, s[12:15], s18 offen offset:384 lds
	s_add_u32 m0, s17, 15872
	s_nop 0
	buffer_load_dwordx4 v3, s[12:15], s18 offen offset:512 lds
	s_add_u32 m0, s17, 19840
	s_nop 0
	buffer_load_dwordx4 v3, s[12:15], s18 offen offset:640 lds
	s_add_u32 m0, s17, 23808
	s_nop 0
	buffer_load_dwordx4 v3, s[12:15], s18 offen offset:768 lds
	s_xor_b32 s17, s17, 0x8000
	ds_read_b128 v[40:43], v4 offset:0
	ds_read_b128 v[44:47], v4 offset:2048
	ds_read_b128 v[48:51], v5 offset:0
	ds_read_b128 v[52:55], v5 offset:2048
	ds_read_b128 v[56:59], v4 offset:4096
	ds_read_b128 v[60:63], v4 offset:6144
	s_waitcnt lgkmcnt(4)
	v_mfma_f32_16x16x32_bf16 v[64:67], a[0:3], v[40:43], 0
	v_mfma_f32_16x16x32_bf16 v[92:95], a[0:3], v[44:47], 0
	v_mfma_f32_16x16x32_bf16 v[68:71], a[56:59], v[40:43], 0
	v_mfma_f32_16x16x32_bf16 v[96:99], a[56:59], v[44:47], 0
	v_mfma_f32_16x16x32_bf16 v[72:75], a[112:115], v[40:43], 0
	v_mfma_f32_16x16x32_bf16 v[100:103], a[112:115], v[44:47], 0
	v_mfma_f32_16x16x32_bf16 v[76:79], a[168:171], v[40:43], 0
	v_mfma_f32_16x16x32_bf16 v[104:107], a[168:171], v[44:47], 0
	v_mfma_f32_16x16x32_bf16 v[80:83], a[224:227], v[40:43], 0
	v_mfma_f32_16x16x32_bf16 v[108:111], a[224:227], v[44:47], 0
	v_mfma_f32_16x16x32_bf16 v[84:87], v[144:147], v[40:43], 0
	v_mfma_f32_16x16x32_bf16 v[112:115], v[144:147], v[44:47], 0
	v_mfma_f32_16x16x32_bf16 v[88:91], v[200:203], v[40:43], 0
	v_mfma_f32_16x16x32_bf16 v[116:119], v[200:203], v[44:47], 0
	ds_read_b128 v[40:43], v5 offset:4096
	ds_read_b128 v[44:47], v5 offset:6144
	s_waitcnt lgkmcnt(4)
	v_mfma_f32_16x16x32_bf16 v[64:67], a[4:7], v[48:51], v[64:67]
	v_mfma_f32_16x16x32_bf16 v[92:95], a[4:7], v[52:55], v[92:95]
	v_mfma_f32_16x16x32_bf16 v[68:71], a[60:63], v[48:51], v[68:71]
	v_mfma_f32_16x16x32_bf16 v[96:99], a[60:63], v[52:55], v[96:99]
	v_mfma_f32_16x16x32_bf16 v[72:75], a[116:119], v[48:51], v[72:75]
	v_mfma_f32_16x16x32_bf16 v[100:103], a[116:119], v[52:55], v[100:103]
	v_mfma_f32_16x16x32_bf16 v[76:79], a[172:175], v[48:51], v[76:79]
	v_mfma_f32_16x16x32_bf16 v[104:107], a[172:175], v[52:55], v[104:107]
	v_mfma_f32_16x16x32_bf16 v[80:83], a[228:231], v[48:51], v[80:83]
	v_mfma_f32_16x16x32_bf16 v[108:111], a[228:231], v[52:55], v[108:111]
	v_mfma_f32_16x16x32_bf16 v[84:87], v[148:151], v[48:51], v[84:87]
	v_mfma_f32_16x16x32_bf16 v[112:115], v[148:151], v[52:55], v[112:115]
	v_mfma_f32_16x16x32_bf16 v[88:91], v[204:207], v[48:51], v[88:91]
	v_mfma_f32_16x16x32_bf16 v[116:119], v[204:207], v[52:55], v[116:119]
	ds_read_b128 v[48:51], v4 offset:8192
	ds_read_b128 v[52:55], v4 offset:10240
	s_waitcnt lgkmcnt(4)
	v_mfma_f32_16x16x32_bf16 v[64:67], a[8:11], v[56:59], v[64:67]
	v_mfma_f32_16x16x32_bf16 v[92:95], a[8:11], v[60:63], v[92:95]
	v_mfma_f32_16x16x32_bf16 v[68:71], a[64:67], v[56:59], v[68:71]
	v_mfma_f32_16x16x32_bf16 v[96:99], a[64:67], v[60:63], v[96:99]
	v_mfma_f32_16x16x32_bf16 v[72:75], a[120:123], v[56:59], v[72:75]
	v_mfma_f32_16x16x32_bf16 v[100:103], a[120:123], v[60:63], v[100:103]
	v_mfma_f32_16x16x32_bf16 v[76:79], a[176:179], v[56:59], v[76:79]
	v_mfma_f32_16x16x32_bf16 v[104:107], a[176:179], v[60:63], v[104:107]
	v_mfma_f32_16x16x32_bf16 v[80:83], a[232:235], v[56:59], v[80:83]
	v_mfma_f32_16x16x32_bf16 v[108:111], a[232:235], v[60:63], v[108:111]
	v_mfma_f32_16x16x32_bf16 v[84:87], v[152:155], v[56:59], v[84:87]
	v_mfma_f32_16x16x32_bf16 v[112:115], v[152:155], v[60:63], v[112:115]
	v_mfma_f32_16x16x32_bf16 v[88:91], v[208:211], v[56:59], v[88:91]
	v_mfma_f32_16x16x32_bf16 v[116:119], v[208:211], v[60:63], v[116:119]
	ds_read_b128 v[56:59], v5 offset:8192
	ds_read_b128 v[60:63], v5 offset:10240
	s_waitcnt lgkmcnt(4)
	v_mfma_f32_16x16x32_bf16 v[64:67], a[12:15], v[40:43], v[64:67]
	v_mfma_f32_16x16x32_bf16 v[92:95], a[12:15], v[44:47], v[92:95]
	v_mfma_f32_16x16x32_bf16 v[68:71], a[68:71], v[40:43], v[68:71]
	v_mfma_f32_16x16x32_bf16 v[96:99], a[68:71], v[44:47], v[96:99]
	v_mfma_f32_16x16x32_bf16 v[72:75], a[124:127], v[40:43], v[72:75]
	v_mfma_f32_16x16x32_bf16 v[100:103], a[124:127], v[44:47], v[100:103]
	v_mfma_f32_16x16x32_bf16 v[76:79], a[180:183], v[40:43], v[76:79]
	v_mfma_f32_16x16x32_bf16 v[104:107], a[180:183], v[44:47], v[104:107]
	v_mfma_f32_16x16x32_bf16 v[80:83], a[236:239], v[40:43], v[80:83]
	v_mfma_f32_16x16x32_bf16 v[108:111], a[236:239], v[44:47], v[108:111]
	v_mfma_f32_16x16x32_bf16 v[84:87], v[156:159], v[40:43], v[84:87]
	v_mfma_f32_16x16x32_bf16 v[112:115], v[156:159], v[44:47], v[112:115]
	v_mfma_f32_16x16x32_bf16 v[88:91], v[212:215], v[40:43], v[88:91]
	v_mfma_f32_16x16x32_bf16 v[116:119], v[212:215], v[44:47], v[116:119]
	ds_read_b128 v[40:43], v4 offset:12288
	ds_read_b128 v[44:47], v4 offset:14336
	s_waitcnt lgkmcnt(4)
	v_mfma_f32_16x16x32_bf16 v[64:67], a[16:19], v[48:51], v[64:67]
	v_mfma_f32_16x16x32_bf16 v[92:95], a[16:19], v[52:55], v[92:95]
	v_mfma_f32_16x16x32_bf16 v[68:71], a[72:75], v[48:51], v[68:71]
	v_mfma_f32_16x16x32_bf16 v[96:99], a[72:75], v[52:55], v[96:99]
	v_mfma_f32_16x16x32_bf16 v[72:75], a[128:131], v[48:51], v[72:75]
	v_mfma_f32_16x16x32_bf16 v[100:103], a[128:131], v[52:55], v[100:103]
	v_mfma_f32_16x16x32_bf16 v[76:79], a[184:187], v[48:51], v[76:79]
	v_mfma_f32_16x16x32_bf16 v[104:107], a[184:187], v[52:55], v[104:107]
	v_mfma_f32_16x16x32_bf16 v[80:83], a[240:243], v[48:51], v[80:83]
	v_mfma_f32_16x16x32_bf16 v[108:111], a[240:243], v[52:55], v[108:111]
	v_mfma_f32_16x16x32_bf16 v[84:87], v[160:163], v[48:51], v[84:87]
	v_mfma_f32_16x16x32_bf16 v[112:115], v[160:163], v[52:55], v[112:115]
	v_mfma_f32_16x16x32_bf16 v[88:91], v[216:219], v[48:51], v[88:91]
	v_mfma_f32_16x16x32_bf16 v[116:119], v[216:219], v[52:55], v[116:119]
	ds_read_b128 v[48:51], v5 offset:12288
	ds_read_b128 v[52:55], v5 offset:14336
	s_waitcnt lgkmcnt(4)
	v_mfma_f32_16x16x32_bf16 v[64:67], a[20:23], v[56:59], v[64:67]
	v_mfma_f32_16x16x32_bf16 v[92:95], a[20:23], v[60:63], v[92:95]
	v_mfma_f32_16x16x32_bf16 v[68:71], a[76:79], v[56:59], v[68:71]
	v_mfma_f32_16x16x32_bf16 v[96:99], a[76:79], v[60:63], v[96:99]
	v_mfma_f32_16x16x32_bf16 v[72:75], a[132:135], v[56:59], v[72:75]
	v_mfma_f32_16x16x32_bf16 v[100:103], a[132:135], v[60:63], v[100:103]
	v_mfma_f32_16x16x32_bf16 v[76:79], a[188:191], v[56:59], v[76:79]
	v_mfma_f32_16x16x32_bf16 v[104:107], a[188:191], v[60:63], v[104:107]
	v_mfma_f32_16x16x32_bf16 v[80:83], a[244:247], v[56:59], v[80:83]
	v_mfma_f32_16x16x32_bf16 v[108:111], a[244:247], v[60:63], v[108:111]
	v_mfma_f32_16x16x32_bf16 v[84:87], v[164:167], v[56:59], v[84:87]
	v_mfma_f32_16x16x32_bf16 v[112:115], v[164:167], v[60:63], v[112:115]
	v_mfma_f32_16x16x32_bf16 v[88:91], v[220:223], v[56:59], v[88:91]
	v_mfma_f32_16x16x32_bf16 v[116:119], v[220:223], v[60:63], v[116:119]
	ds_read_b128 v[56:59], v4 offset:16384
	ds_read_b128 v[60:63], v4 offset:18432
	s_waitcnt lgkmcnt(4)
	v_mfma_f32_16x16x32_bf16 v[64:67], a[24:27], v[40:43], v[64:67]
	v_mfma_f32_16x16x32_bf16 v[92:95], a[24:27], v[44:47], v[92:95]
	v_mfma_f32_16x16x32_bf16 v[68:71], a[80:83], v[40:43], v[68:71]
	v_mfma_f32_16x16x32_bf16 v[96:99], a[80:83], v[44:47], v[96:99]
	v_mfma_f32_16x16x32_bf16 v[72:75], a[136:139], v[40:43], v[72:75]
	v_mfma_f32_16x16x32_bf16 v[100:103], a[136:139], v[44:47], v[100:103]
	v_mfma_f32_16x16x32_bf16 v[76:79], a[192:195], v[40:43], v[76:79]
	v_mfma_f32_16x16x32_bf16 v[104:107], a[192:195], v[44:47], v[104:107]
	v_mfma_f32_16x16x32_bf16 v[80:83], a[248:251], v[40:43], v[80:83]
	v_mfma_f32_16x16x32_bf16 v[108:111], a[248:251], v[44:47], v[108:111]
	v_mfma_f32_16x16x32_bf16 v[84:87], v[168:171], v[40:43], v[84:87]
	v_mfma_f32_16x16x32_bf16 v[112:115], v[168:171], v[44:47], v[112:115]
	v_mfma_f32_16x16x32_bf16 v[88:91], v[224:227], v[40:43], v[88:91]
	v_mfma_f32_16x16x32_bf16 v[116:119], v[224:227], v[44:47], v[116:119]
	ds_read_b128 v[40:43], v5 offset:16384
	ds_read_b128 v[44:47], v5 offset:18432
	s_waitcnt lgkmcnt(4)
	v_mfma_f32_16x16x32_bf16 v[64:67], a[28:31], v[48:51], v[64:67]
	v_mfma_f32_16x16x32_bf16 v[92:95], a[28:31], v[52:55], v[92:95]
	v_mfma_f32_16x16x32_bf16 v[68:71], a[84:87], v[48:51], v[68:71]
	v_mfma_f32_16x16x32_bf16 v[96:99], a[84:87], v[52:55], v[96:99]
	v_mfma_f32_16x16x32_bf16 v[72:75], a[140:143], v[48:51], v[72:75]
	v_mfma_f32_16x16x32_bf16 v[100:103], a[140:143], v[52:55], v[100:103]
	v_mfma_f32_16x16x32_bf16 v[76:79], a[196:199], v[48:51], v[76:79]
	v_mfma_f32_16x16x32_bf16 v[104:107], a[196:199], v[52:55], v[104:107]
	v_mfma_f32_16x16x32_bf16 v[80:83], a[252:255], v[48:51], v[80:83]
	v_mfma_f32_16x16x32_bf16 v[108:111], a[252:255], v[52:55], v[108:111]
	v_mfma_f32_16x16x32_bf16 v[84:87], v[172:175], v[48:51], v[84:87]
	v_mfma_f32_16x16x32_bf16 v[112:115], v[172:175], v[52:55], v[112:115]
	v_mfma_f32_16x16x32_bf16 v[88:91], v[228:231], v[48:51], v[88:91]
	v_mfma_f32_16x16x32_bf16 v[116:119], v[228:231], v[52:55], v[116:119]
	ds_read_b128 v[48:51], v4 offset:20480
	ds_read_b128 v[52:55], v4 offset:22528
	s_waitcnt lgkmcnt(4)
	v_mfma_f32_16x16x32_bf16 v[64:67], a[32:35], v[56:59], v[64:67]
	v_mfma_f32_16x16x32_bf16 v[92:95], a[32:35], v[60:63], v[92:95]
	v_mfma_f32_16x16x32_bf16 v[68:71], a[88:91], v[56:59], v[68:71]
	v_mfma_f32_16x16x32_bf16 v[96:99], a[88:91], v[60:63], v[96:99]
	v_mfma_f32_16x16x32_bf16 v[72:75], a[144:147], v[56:59], v[72:75]
	v_mfma_f32_16x16x32_bf16 v[100:103], a[144:147], v[60:63], v[100:103]
	v_mfma_f32_16x16x32_bf16 v[76:79], a[200:203], v[56:59], v[76:79]
	v_mfma_f32_16x16x32_bf16 v[104:107], a[200:203], v[60:63], v[104:107]
	v_mfma_f32_16x16x32_bf16 v[80:83], v[120:123], v[56:59], v[80:83]
	v_mfma_f32_16x16x32_bf16 v[108:111], v[120:123], v[60:63], v[108:111]
	v_mfma_f32_16x16x32_bf16 v[84:87], v[176:179], v[56:59], v[84:87]
	v_mfma_f32_16x16x32_bf16 v[112:115], v[176:179], v[60:63], v[112:115]
	v_mfma_f32_16x16x32_bf16 v[88:91], v[232:235], v[56:59], v[88:91]
	v_mfma_f32_16x16x32_bf16 v[116:119], v[232:235], v[60:63], v[116:119]
	ds_read_b128 v[56:59], v5 offset:20480
	ds_read_b128 v[60:63], v5 offset:22528
	s_waitcnt lgkmcnt(4)
	v_mfma_f32_16x16x32_bf16 v[64:67], a[36:39], v[40:43], v[64:67]
	v_mfma_f32_16x16x32_bf16 v[92:95], a[36:39], v[44:47], v[92:95]
	v_mfma_f32_16x16x32_bf16 v[68:71], a[92:95], v[40:43], v[68:71]
	v_mfma_f32_16x16x32_bf16 v[96:99], a[92:95], v[44:47], v[96:99]
	v_mfma_f32_16x16x32_bf16 v[72:75], a[148:151], v[40:43], v[72:75]
	v_mfma_f32_16x16x32_bf16 v[100:103], a[148:151], v[44:47], v[100:103]
	v_mfma_f32_16x16x32_bf16 v[76:79], a[204:207], v[40:43], v[76:79]
	v_mfma_f32_16x16x32_bf16 v[104:107], a[204:207], v[44:47], v[104:107]
	v_mfma_f32_16x16x32_bf16 v[80:83], v[124:127], v[40:43], v[80:83]
	v_mfma_f32_16x16x32_bf16 v[108:111], v[124:127], v[44:47], v[108:111]
	v_mfma_f32_16x16x32_bf16 v[84:87], v[180:183], v[40:43], v[84:87]
	v_mfma_f32_16x16x32_bf16 v[112:115], v[180:183], v[44:47], v[112:115]
	v_mfma_f32_16x16x32_bf16 v[88:91], v[236:239], v[40:43], v[88:91]
	v_mfma_f32_16x16x32_bf16 v[116:119], v[236:239], v[44:47], v[116:119]
	ds_read_b128 v[40:43], v4 offset:24576
	ds_read_b128 v[44:47], v4 offset:26624
	s_waitcnt lgkmcnt(4)
	v_mfma_f32_16x16x32_bf16 v[64:67], a[40:43], v[48:51], v[64:67]
	v_mfma_f32_16x16x32_bf16 v[92:95], a[40:43], v[52:55], v[92:95]
	v_mfma_f32_16x16x32_bf16 v[68:71], a[96:99], v[48:51], v[68:71]
	v_mfma_f32_16x16x32_bf16 v[96:99], a[96:99], v[52:55], v[96:99]
	v_mfma_f32_16x16x32_bf16 v[72:75], a[152:155], v[48:51], v[72:75]
	v_mfma_f32_16x16x32_bf16 v[100:103], a[152:155], v[52:55], v[100:103]
	v_mfma_f32_16x16x32_bf16 v[76:79], a[208:211], v[48:51], v[76:79]
	v_mfma_f32_16x16x32_bf16 v[104:107], a[208:211], v[52:55], v[104:107]
	v_mfma_f32_16x16x32_bf16 v[80:83], v[128:131], v[48:51], v[80:83]
	v_mfma_f32_16x16x32_bf16 v[108:111], v[128:131], v[52:55], v[108:111]
	v_mfma_f32_16x16x32_bf16 v[84:87], v[184:187], v[48:51], v[84:87]
	v_mfma_f32_16x16x32_bf16 v[112:115], v[184:187], v[52:55], v[112:115]
	v_mfma_f32_16x16x32_bf16 v[88:91], v[240:243], v[48:51], v[88:91]
	v_mfma_f32_16x16x32_bf16 v[116:119], v[240:243], v[52:55], v[116:119]
	ds_read_b128 v[48:51], v5 offset:24576
	ds_read_b128 v[52:55], v5 offset:26624
	s_waitcnt lgkmcnt(4)
	v_mfma_f32_16x16x32_bf16 v[64:67], a[44:47], v[56:59], v[64:67]
	v_mfma_f32_16x16x32_bf16 v[92:95], a[44:47], v[60:63], v[92:95]
	v_mfma_f32_16x16x32_bf16 v[68:71], a[100:103], v[56:59], v[68:71]
	v_mfma_f32_16x16x32_bf16 v[96:99], a[100:103], v[60:63], v[96:99]
	v_mfma_f32_16x16x32_bf16 v[72:75], a[156:159], v[56:59], v[72:75]
	v_mfma_f32_16x16x32_bf16 v[100:103], a[156:159], v[60:63], v[100:103]
	v_mfma_f32_16x16x32_bf16 v[76:79], a[212:215], v[56:59], v[76:79]
	v_mfma_f32_16x16x32_bf16 v[104:107], a[212:215], v[60:63], v[104:107]
	v_mfma_f32_16x16x32_bf16 v[80:83], v[132:135], v[56:59], v[80:83]
	v_mfma_f32_16x16x32_bf16 v[108:111], v[132:135], v[60:63], v[108:111]
	v_mfma_f32_16x16x32_bf16 v[84:87], v[188:191], v[56:59], v[84:87]
	v_mfma_f32_16x16x32_bf16 v[112:115], v[188:191], v[60:63], v[112:115]
	v_mfma_f32_16x16x32_bf16 v[88:91], v[244:247], v[56:59], v[88:91]
	v_mfma_f32_16x16x32_bf16 v[116:119], v[244:247], v[60:63], v[116:119]
	s_waitcnt lgkmcnt(2)
	v_mfma_f32_16x16x32_bf16 v[64:67], a[48:51], v[40:43], v[64:67]
	v_mfma_f32_16x16x32_bf16 v[92:95], a[48:51], v[44:47], v[92:95]
	v_mfma_f32_16x16x32_bf16 v[68:71], a[104:107], v[40:43], v[68:71]
	v_mfma_f32_16x16x32_bf16 v[96:99], a[104:107], v[44:47], v[96:99]
	v_mfma_f32_16x16x32_bf16 v[72:75], a[160:163], v[40:43], v[72:75]
	v_mfma_f32_16x16x32_bf16 v[100:103], a[160:163], v[44:47], v[100:103]
	v_mfma_f32_16x16x32_bf16 v[76:79], a[216:219], v[40:43], v[76:79]
	v_mfma_f32_16x16x32_bf16 v[104:107], a[216:219], v[44:47], v[104:107]
	v_mfma_f32_16x16x32_bf16 v[80:83], v[136:139], v[40:43], v[80:83]
	v_mfma_f32_16x16x32_bf16 v[108:111], v[136:139], v[44:47], v[108:111]
	v_mfma_f32_16x16x32_bf16 v[84:87], v[192:195], v[40:43], v[84:87]
	v_mfma_f32_16x16x32_bf16 v[112:115], v[192:195], v[44:47], v[112:115]
	v_mfma_f32_16x16x32_bf16 v[88:91], v[248:251], v[40:43], v[88:91]
	v_mfma_f32_16x16x32_bf16 v[116:119], v[248:251], v[44:47], v[116:119]
	s_waitcnt lgkmcnt(0)
	v_mfma_f32_16x16x32_bf16 v[64:67], a[52:55], v[48:51], v[64:67]
	v_mfma_f32_16x16x32_bf16 v[92:95], a[52:55], v[52:55], v[92:95]
	v_mfma_f32_16x16x32_bf16 v[68:71], a[108:111], v[48:51], v[68:71]
	v_mfma_f32_16x16x32_bf16 v[96:99], a[108:111], v[52:55], v[96:99]
	v_mfma_f32_16x16x32_bf16 v[72:75], a[164:167], v[48:51], v[72:75]
	v_mfma_f32_16x16x32_bf16 v[100:103], a[164:167], v[52:55], v[100:103]
	v_mfma_f32_16x16x32_bf16 v[76:79], a[220:223], v[48:51], v[76:79]
	v_mfma_f32_16x16x32_bf16 v[104:107], a[220:223], v[52:55], v[104:107]
	v_mfma_f32_16x16x32_bf16 v[80:83], v[140:143], v[48:51], v[80:83]
	v_mfma_f32_16x16x32_bf16 v[108:111], v[140:143], v[52:55], v[108:111]
	v_mfma_f32_16x16x32_bf16 v[84:87], v[196:199], v[48:51], v[84:87]
	v_mfma_f32_16x16x32_bf16 v[112:115], v[196:199], v[52:55], v[112:115]
	v_mfma_f32_16x16x32_bf16 v[88:91], v[252:255], v[48:51], v[88:91]
	v_mfma_f32_16x16x32_bf16 v[116:119], v[252:255], v[52:55], v[116:119]
	v_cvt_pk_bf16_f32 v32, v64, v65
	v_cvt_pk_bf16_f32 v34, v66, v67
	v_cvt_pk_bf16_f32 v46, v92, v93
	v_cvt_pk_bf16_f32 v48, v94, v95
	v_cvt_pk_bf16_f32 v33, v68, v69
	v_cvt_pk_bf16_f32 v35, v70, v71
	v_cvt_pk_bf16_f32 v47, v96, v97
	v_cvt_pk_bf16_f32 v49, v98, v99
	v_cvt_pk_bf16_f32 v36, v72, v73
	v_cvt_pk_bf16_f32 v38, v74, v75
	v_cvt_pk_bf16_f32 v50, v100, v101
	v_cvt_pk_bf16_f32 v52, v102, v103
	v_cvt_pk_bf16_f32 v37, v76, v77
	v_cvt_pk_bf16_f32 v39, v78, v79
	v_cvt_pk_bf16_f32 v51, v104, v105
	v_cvt_pk_bf16_f32 v53, v106, v107
	v_cvt_pk_bf16_f32 v40, v80, v81
	v_cvt_pk_bf16_f32 v42, v82, v83
	v_cvt_pk_bf16_f32 v54, v108, v109
	v_cvt_pk_bf16_f32 v56, v110, v111
	v_cvt_pk_bf16_f32 v41, v84, v85
	v_cvt_pk_bf16_f32 v43, v86, v87
	v_cvt_pk_bf16_f32 v55, v112, v113
	v_cvt_pk_bf16_f32 v57, v114, v115
	v_cvt_pk_bf16_f32 v44, v88, v89
	v_cvt_pk_bf16_f32 v45, v90, v91
	v_cvt_pk_bf16_f32 v58, v116, v117
	v_cvt_pk_bf16_f32 v59, v118, v119
	ds_read_b128 v[64:67], v10 offset:0
	ds_read_b128 v[68:71], v10 offset:2048
	ds_read_b128 v[72:75], v11 offset:0
	ds_read_b128 v[76:79], v11 offset:2048
	ds_read_b128 v[80:83], v12 offset:0
	ds_read_b128 v[84:87], v12 offset:2048
	ds_read_b32 v88, v13 offset:0
	ds_read_b32 v89, v13 offset:8
	ds_read_b32 v92, v13 offset:2048
	ds_read_b32 v93, v13 offset:2056
	s_waitcnt lgkmcnt(8)
	v_mfma_f32_16x16x32_bf16 v[96:99], v[64:67], v[32:35], 0
	v_mfma_f32_16x16x32_bf16 v[108:111], v[64:67], v[46:49], 0
	v_mfma_f32_16x16x32_bf16 v[100:103], v[68:71], v[32:35], 0
	v_mfma_f32_16x16x32_bf16 v[112:115], v[68:71], v[46:49], 0
	s_waitcnt lgkmcnt(6)
	v_mfma_f32_16x16x32_bf16 v[96:99], v[72:75], v[36:39], v[96:99]
	v_mfma_f32_16x16x32_bf16 v[108:111], v[72:75], v[50:53], v[108:111]
	v_mfma_f32_16x16x32_bf16 v[100:103], v[76:79], v[36:39], v[100:103]
	v_mfma_f32_16x16x32_bf16 v[112:115], v[76:79], v[50:53], v[112:115]
	s_waitcnt lgkmcnt(4)
	v_mfma_f32_16x16x32_bf16 v[96:99], v[80:83], v[40:43], v[96:99]
	v_mfma_f32_16x16x32_bf16 v[108:111], v[80:83], v[54:57], v[108:111]
	v_mfma_f32_16x16x32_bf16 v[100:103], v[84:87], v[40:43], v[100:103]
	v_mfma_f32_16x16x32_bf16 v[112:115], v[84:87], v[54:57], v[112:115]
	s_waitcnt lgkmcnt(0)
	v_mfma_f32_16x16x16_bf16 v[96:99], v[88:89], v[44:45], v[96:99]
	v_mfma_f32_16x16x16_bf16 v[108:111], v[88:89], v[58:59], v[108:111]
	v_mfma_f32_16x16x16_bf16 v[100:103], v[92:93], v[44:45], v[100:103]
	v_mfma_f32_16x16x16_bf16 v[112:115], v[92:93], v[58:59], v[112:115]
La_mw:
	buffer_load_dwordx4 v[80:83], v22, s[4:7], s26 offen sc1
	buffer_load_dwordx4 v[84:87], v22, s[4:7], s26 offen offset:896 sc1
	s_waitcnt vmcnt(0)
	ds_write_b128 v23, v[80:83]
	ds_write_b128 v23, v[84:87] offset:912
	v_dot2_f32_bf16 v9, v80, v81, 0
	v_dot2_f32_bf16 v9, v82, v83, v9
	v_dot2_f32_bf16 v9, v84, v85, v9
	v_dot2_f32_bf16 v9, v86, v87, v9
	s_nop 2
	v_cmp_u_f32 vcc, v9, v9
	s_cbranch_vccz La_mo
	s_sleep 1
	s_sub_u32 s16, s16, 1
	s_cbranch_scc0 La_mw
	s_mov_b32 s16, 0
La_mo:
	s_waitcnt lgkmcnt(0)
	s_barrier
	ds_read_b128 v[64:67], v14
	ds_read_b128 v[68:71], v15
	ds_read_b128 v[72:75], v16
	ds_read2_b32 v[76:77], v17 offset0:0 offset1:2
	s_waitcnt lgkmcnt(0)
	v_mfma_f32_16x16x32_bf16 v[104:107], v[64:67], v[32:35], 0
	v_mfma_f32_16x16x32_bf16 v[116:119], v[64:67], v[46:49], 0
	v_mfma_f32_16x16x32_bf16 v[104:107], v[68:71], v[36:39], v[104:107]
	v_mfma_f32_16x16x32_bf16 v[116:119], v[68:71], v[50:53], v[116:119]
	v_mfma_f32_16x16x32_bf16 v[104:107], v[72:75], v[40:43], v[104:107]
	v_mfma_f32_16x16x32_bf16 v[116:119], v[72:75], v[54:57], v[116:119]
	v_mfma_f32_16x16x16_bf16 v[104:107], v[76:77], v[44:45], v[104:107]
	v_mfma_f32_16x16x16_bf16 v[116:119], v[76:77], v[58:59], v[116:119]
	ds_write_b128 v18, v[96:99] offset:0
	ds_write_b128 v18, v[100:103] offset:1024
	ds_write_b128 v18, v[108:111] offset:3072
	ds_write_b128 v18, v[112:115] offset:4096
	s_nop 0
	ds_write_b64 v18, v[104:105] offset:2048
	s_nop 1
	ds_write_b64 v18, v[116:117] offset:5120
	s_waitcnt lgkmcnt(0)
	s_barrier
	s_cmp_ge_u32 s33, 2
	s_cbranch_scc1 La_next
	ds_read_b128 v[64:67], v19 offset:0
	ds_read_b128 v[68:71], v19 offset:1024
	ds_read_b64 v[72:73], v19 offset:2048
	ds_read_b128 v[76:79], v19 offset:6144
	ds_read_b128 v[80:83], v19 offset:7168
	ds_read_b64 v[84:85], v19 offset:8192
	ds_read_b128 v[88:91], v19 offset:12288
	ds_read_b128 v[92:95], v19 offset:13312
	ds_read_b64 v[96:97], v19 offset:14336
	ds_read_b128 v[100:103], v19 offset:18432
	ds_read_b128 v[104:107], v19 offset:19456
	ds_read_b64 v[108:109], v19 offset:20480
	s_waitcnt lgkmcnt(6)
	v_pk_add_f32 v[64:65], v[64:65], v[76:77]
	v_pk_add_f32 v[66:67], v[66:67], v[78:79]
	v_pk_add_f32 v[68:69], v[68:69], v[80:81]
	v_pk_add_f32 v[70:71], v[70:71], v[82:83]
	v_pk_add_f32 v[72:73], v[72:73], v[84:85]
	s_waitcnt lgkmcnt(3)
	v_pk_add_f32 v[64:65], v[64:65], v[88:89]
	v_pk_add_f32 v[66:67], v[66:67], v[90:91]
	v_pk_add_f32 v[68:69], v[68:69], v[92:93]
	v_pk_add_f32 v[70:71], v[70:71], v[94:95]
	v_pk_add_f32 v[72:73], v[72:73], v[96:97]
	s_waitcnt lgkmcnt(0)
	v_pk_add_f32 v[64:65], v[64:65], v[100:101]
	v_pk_add_f32 v[66:67], v[66:67], v[102:103]
	v_pk_add_f32 v[68:69], v[68:69], v[104:105]
	v_pk_add_f32 v[70:71], v[70:71], v[106:107]
	v_pk_add_f32 v[72:73], v[72:73], v[108:109]
	v_mov_b32 v9, s27
	v_cndmask_b32 v64, v9, v64, s[60:61]
	v_cndmask_b32 v65, v9, v65, s[62:63]
	v_cndmask_b32 v66, v9, v66, s[64:65]
	v_cndmask_b32 v67, v9, v67, s[66:67]
	v_cndmask_b32 v68, v9, v68, s[68:69]
	v_cndmask_b32 v69, v9, v69, s[70:71]
	v_cndmask_b32 v70, v9, v70, s[72:73]
	v_cndmask_b32 v71, v9, v71, s[74:75]
	v_max3_f32 v76, v64, v65, v66
	v_max3_f32 v76, v76, v67, v68
	v_max3_f32 v76, v76, v69, v70
	v_max3_f32 v76, v76, v71, v72
	v_max_f32 v76, v76, v73
	v_mov_b32 v77, v76
	s_nop 1
	v_permlane16_swap_b32 v76, v77
	v_max_f32 v76, v76, v77
	v_mov_b32 v77, v76
	s_nop 1
	v_permlane32_swap_b32 v76, v77
	v_max_f32 v76, v76, v77
	v_sub_f32 v64, v64, v76
	v_sub_f32 v65, v65, v76
	v_sub_f32 v66, v66, v76
	v_sub_f32 v67, v67, v76
	v_sub_f32 v68, v68, v76
	v_sub_f32 v69, v69, v76
	v_sub_f32 v70, v70, v76
	v_sub_f32 v71, v71, v76
	v_sub_f32 v72, v72, v76
	v_sub_f32 v73, v73, v76
	v_exp_f32 v64, v64
	v_exp_f32 v65, v65
	v_exp_f32 v66, v66
	v_exp_f32 v67, v67
	v_exp_f32 v68, v68
	v_exp_f32 v69, v69
	v_exp_f32 v70, v70
	v_exp_f32 v71, v71
	v_exp_f32 v72, v72
	v_exp_f32 v73, v73
	v_pk_add_f32 v[76:77], v[64:65], v[66:67]
	v_pk_add_f32 v[76:77], v[76:77], v[68:69]
	v_pk_add_f32 v[76:77], v[76:77], v[70:71]
	v_pk_add_f32 v[76:77], v[76:77], v[72:73]
	v_add_f32 v76, v76, v77
	v_mov_b32 v77, v76
	s_nop 1
	v_permlane16_swap_b32 v76, v77
	v_add_f32 v76, v76, v77
	v_mov_b32 v77, v76
	s_nop 1
	v_permlane32_swap_b32 v76, v77
	v_add_f32 v76, v76, v77
	v_rcp_f32 v76, v76
	s_nop 0
	v_pk_mul_f32 v[64:65], v[64:65], v[76:77] op_sel_hi:[1,0]
	v_pk_mul_f32 v[66:67], v[66:67], v[76:77] op_sel_hi:[1,0]
	v_pk_mul_f32 v[68:69], v[68:69], v[76:77] op_sel_hi:[1,0]
	v_pk_mul_f32 v[70:71], v[70:71], v[76:77] op_sel_hi:[1,0]
	v_pk_mul_f32 v[72:73], v[72:73], v[76:77] op_sel_hi:[1,0]
	v_cvt_pk_bf16_f32 v80, v64, v65
	v_cvt_pk_bf16_f32 v81, v66, v67
	v_cvt_pk_bf16_f32 v82, v68, v69
	v_cvt_pk_bf16_f32 v83, v70, v71
	v_cvt_pk_bf16_f32 v84, v72, v73
	buffer_store_dwordx4 v[80:83], v6, s[4:7], s22 offen sc1
	buffer_store_dword v84, v20, s[4:7], s23 offen sc1
	s_waitcnt vmcnt(0)
	v_mov_b32 v9, 1
	buffer_atomic_add v9, v8, s[4:7], s24 offen
La_next:
	v_xor_b32 v4, 0x8000, v4
	v_xor_b32 v5, 0x8000, v5
	s_xor_b32 s17, s17, 0x8000
	v_xor_b32 v10, 0x8000, v10
	v_xor_b32 v11, 0x8000, v11
	v_xor_b32 v12, 0x8000, v12
	v_xor_b32 v13, 0x8000, v13
	s_add_u32 s22, s22, 163840
	s_add_u32 s23, s23, 163840
	s_add_u32 s26, s26, 28672
	s_add_u32 s24, s24, 512
	s_add_u32 s25, s25, 1
	s_cmp_lt_u32 s25, 16
	s_cbranch_scc1 La_loop
	s_waitcnt vmcnt(0)
	s_endpgm
Lca_j:
	v_lshlrev_b32 v4, 4, v0
	v_lshlrev_b32 v5, 2, v0
	v_and_b32 v20, 15, v0
	v_lshrrev_b32 v21, 4, v0
	v_mov_b32 v1, 0x4444
	v_mov_b32 v22, 0xeeee
	v_and_b32 v24, 2, v20
	v_cmp_ne_u32 vcc, 0, v24
	s_nop 1
	v_cndmask_b32 v1, v1, v22, vcc
	v_mov_b32 v25, 0x80000000
	v_cmp_eq_u32 vcc, 0, v0
	s_nop 1
	v_cndmask_b32 v6, v25, v0, vcc
	v_mul_u32_u24 v24, 1280, v0
	v_cmp_gt_u32 vcc, 8, v0
	s_nop 1
	v_cndmask_b32 v9, v25, v24, vcc
	v_mov_b32 v7, -1
	s_mov_b32 s20, 50604032
	s_mov_b32 s21, 50608128
	s_mov_b32 s22, 50612224
	s_mov_b32 s23, 0
	s_mov_b32 s24, 16384
	s_mov_b32 s26, 50003968
	s_mov_b32 s27, 50008064
	s_mov_b32 s18, 50003968
	s_mov_b32 s19, 50028544
	s_and_b32 s40, s32, 7
	s_mul_i32 s40, s40, 1280
	s_add_u32 s30, s40, 50675712
	s_lshl_b32 s40, s32, 2
	s_add_u32 s31, s40, 50675712
	s_mov_b32 s16, 0
	s_mov_b32 s29, 0x42800000
	s_mov_b32 s17, 0x40000
	s_mov_b32 s80, 0
	s_mov_b32 s81, 0
	s_mov_b32 s82, 0
	s_mov_b32 s13, 0x20000
	v_lshlrev_b32 v22, 2, v21
	v_sub_u32 v22, v20, v22
	v_mov_b32 v24, 0x3f80
	v_mov_b32 v25, 0x3f800000
	v_mov_b32 v12, 0
	v_cmp_eq_u32 vcc, 0, v22
	s_nop 1
	v_cndmask_b32 v12, v12, v24, vcc
	v_cmp_eq_u32 vcc, 1, v22
	s_nop 1
	v_cndmask_b32 v12, v12, v25, vcc
	v_mov_b32 v13, 0
	v_cmp_eq_u32 vcc, 0, v22
	s_nop 1
	v_cndmask_b32 v13, v13, v24, vcc
	v_cmp_eq_u32 vcc, 1, v22
	s_nop 1
	v_cndmask_b32 v13, v13, v25, vcc
	v_mov_b32 v14, 0
	v_cmp_eq_u32 vcc, 2, v22
	s_nop 1
	v_cndmask_b32 v14, v14, v24, vcc
	v_cmp_eq_u32 vcc, 3, v22
	s_nop 1
	v_cndmask_b32 v14, v14, v25, vcc
	v_mov_b32 v15, 0
	v_cmp_eq_u32 vcc, 2, v22
	s_nop 1
	v_cndmask_b32 v15, v15, v24, vcc
	v_cmp_eq_u32 vcc, 3, v22
	s_nop 1
	v_cndmask_b32 v15, v15, v25, vcc
	v_mov_b32 v118, 0
	v_mov_b32 v119, 0
	v_lshrrev_b32 v29, 1, v21
	v_and_b32 v28, 1, v21
	s_mov_b32 s92, 0xff00ff00
	s_mov_b32 s93, 0xff00ff00
	s_mov_b32 s90, 0xcccccccc
	s_mov_b32 s91, 0xcccccccc
	v_cndmask_b32 v2, 1.0, 0, s[90:91]
	v_cndmask_b32 v3, 0, 1.0, s[90:91]
	v_bfe_u32 v24, v20, 2, 1
	v_lshlrev_b32 v24, 5, v24
	v_lshl_add_u32 v24, v21, 6, v24
	v_lshrrev_b32 v25, 3, v20
	v_lshl_add_u32 v27, v25, 8, v24
	v_and_b32 v26, 3, v20
	v_lshl_add_u32 v27, v26, 2, v27
	s_lshl_b32 s40, s32, 9
	v_add_u32 v11, s40, v27
	v_lshl_add_u32 v27, v25, 2, v24
	v_bfe_u32 v26, v20, 1, 1
	v_lshl_add_u32 v27, v26, 4, v27
	v_and_b32 v26, 1, v20
	v_lshl_add_u32 v27, v26, 1, v27
	s_lshr_b32 s40, s32, 1
	s_lshl_b32 s40, s40, 8
	s_and_b32 s41, s32, 1
	s_lshl_b32 s41, s41, 3
	s_add_u32 s40, s40, s41
	s_add_u32 s40, s40, 8192
	v_add_u32 v10, s40, v27
	s_mov_b32 s15, 60301312
	s_lshl_b32 s34, s32, 7
	s_add_u32 s34, s34, 60295168
	s_add_u32 s35, s34, 4
	v_mov_b32 v24, 0
	s_mov_b32 s40, 0x100000
Lww_23:
	buffer_load_dword v25, v24, s[4:7], s35 offen sc1
	s_sub_u32 s40, s40, 1
	s_cbranch_scc1 Lwx_24
	s_waitcnt vmcnt(0)
	v_cmp_gt_u32 vcc, 7, v25
	s_cbranch_vccnz Lww_23
Lwx_24:
	s_waitcnt vmcnt(0)
	s_cmp_eq_u32 s33, 1
	s_cbranch_scc1 Lca_w1
	s_cmp_eq_u32 s33, 2
	s_cbranch_scc1 Lca_w2
	s_cmp_eq_u32 s33, 3
	s_cbranch_scc1 Lca_w3
Lca_w0:
	s_mul_i32 s41, s32, 401408
	s_add_u32 s40, s41, 0
	s_add_u32 s42, s40, 0
	buffer_load_dwordx4 a[0:3], v4, s[4:7], s42 offen offset:0 sc1
	buffer_load_dwordx4 a[4:7], v4, s[4:7], s42 offen offset:1024 sc1
	s_add_u32 s42, s40, 4096
	buffer_load_dwordx4 a[28:31], v4, s[4:7], s42 offen offset:3072 sc1
	s_add_u32 s42, s40, 8192
	buffer_load_dwordx4 a[32:35], v4, s[4:7], s42 offen offset:0 sc1
	s_add_u32 s40, s41, 28672
	s_add_u32 s42, s40, 0
	buffer_load_dwordx4 a[56:59], v4, s[4:7], s42 offen offset:0 sc1
	buffer_load_dwordx4 a[60:63], v4, s[4:7], s42 offen offset:1024 sc1
	s_add_u32 s42, s40, 4096
	buffer_load_dwordx4 a[84:87], v4, s[4:7], s42 offen offset:3072 sc1
	s_add_u32 s42, s40, 8192
	buffer_load_dwordx4 a[88:91], v4, s[4:7], s42 offen offset:0 sc1
	s_add_u32 s40, s41, 14336
	s_add_u32 s42, s40, 0
	buffer_load_dwordx4 a[112:115], v4, s[4:7], s42 offen offset:0 sc1
	buffer_load_dwordx4 a[116:119], v4, s[4:7], s42 offen offset:1024 sc1
	s_add_u32 s42, s40, 4096
	buffer_load_dwordx4 a[140:143], v4, s[4:7], s42 offen offset:3072 sc1
	s_waitcnt vmcnt(10)
	s_add_u32 s42, s40, 8192
	buffer_load_dwordx4 a[144:147], v4, s[4:7], s42 offen offset:0 sc1
	s_add_u32 s40, s41, 43008
	s_add_u32 s42, s40, 0
	buffer_load_dwordx4 a[168:171], v4, s[4:7], s42 offen offset:0 sc1
	s_waitcnt vmcnt(10)
	buffer_load_dwordx4 a[172:175], v4, s[4:7], s42 offen offset:1024 sc1
	s_add_u32 s42, s40, 4096
	buffer_load_dwordx4 a[196:199], v4, s[4:7], s42 offen offset:3072 sc1
	s_waitcnt vmcnt(10)
	s_add_u32 s42, s40, 8192
	buffer_load_dwordx4 a[200:203], v4, s[4:7], s42 offen offset:0 sc1
	s_add_u32 s40, s41, 229376
	s_add_u32 s42, s40, 0
	buffer_load_dwordx4 a[224:227], v4, s[4:7], s42 offen offset:0 sc1
	s_waitcnt vmcnt(10)
	buffer_load_dwordx4 a[228:231], v4, s[4:7], s42 offen offset:1024 sc1
	s_add_u32 s42, s40, 4096
	buffer_load_dwordx4 a[252:255], v4, s[4:7], s42 offen offset:3072 sc1
	s_waitcnt vmcnt(10)
	s_add_u32 s42, s40, 8192
	buffer_load_dwordx4 v[120:123], v4, s[4:7], s42 offen offset:0 sc1
	s_add_u32 s40, s41, 258048
	s_add_u32 s42, s40, 0
	buffer_load_dwordx4 v[144:147], v4, s[4:7], s42 offen offset:0 sc1
	s_waitcnt vmcnt(10)
	buffer_load_dwordx4 v[148:151], v4, s[4:7], s42 offen offset:1024 sc1
	s_add_u32 s42, s40, 4096
	buffer_load_dwordx4 v[172:175], v4, s[4:7], s42 offen offset:3072 sc1
	s_waitcnt vmcnt(10)
	s_add_u32 s42, s40, 8192
	buffer_load_dwordx4 v[176:179], v4, s[4:7], s42 offen offset:0 sc1
	s_add_u32 s40, s41, 243712
	s_add_u32 s42, s40, 0
	buffer_load_dwordx4 v[200:203], v4, s[4:7], s42 offen offset:0 sc1
	s_waitcnt vmcnt(10)
	buffer_load_dwordx4 v[204:207], v4, s[4:7], s42 offen offset:1024 sc1
	s_add_u32 s42, s40, 4096
	buffer_load_dwordx4 v[228:231], v4, s[4:7], s42 offen offset:3072 sc1
	s_waitcnt vmcnt(10)
	s_add_u32 s42, s40, 8192
	buffer_load_dwordx4 v[232:235], v4, s[4:7], s42 offen offset:0 sc1
	s_mov_b32 s40, 0x100000
Lww_25:
	buffer_load_dword v25, v24, s[4:7], s34 offen sc1
	s_sub_u32 s40, s40, 1
	s_cbranch_scc1 Lwx_26
	s_waitcnt vmcnt(0)
	v_cmp_gt_u32 vcc, 7, v25
	s_cbranch_vccnz Lww_25
Lwx_26:
	s_waitcnt vmcnt(0)
	s_add_u32 s40, s41, 0
	s_add_u32 s42, s40, 0
	buffer_load_dwordx4 a[8:11], v4, s[4:7], s42 offen offset:2048 sc1
	s_waitcnt vmcnt(10)
	buffer_load_dwordx4 a[12:15], v4, s[4:7], s42 offen offset:3072 sc1
	s_add_u32 s42, s40, 4096
	buffer_load_dwordx4 a[16:19], v4, s[4:7], s42 offen offset:0 sc1
	s_waitcnt vmcnt(10)
	buffer_load_dwordx4 a[20:23], v4, s[4:7], s42 offen offset:1024 sc1
	buffer_load_dwordx4 a[24:27], v4, s[4:7], s42 offen offset:2048 sc1
	s_waitcnt vmcnt(10)
	s_add_u32 s42, s40, 8192
	buffer_load_dwordx4 a[36:39], v4, s[4:7], s42 offen offset:1024 sc1
	buffer_load_dwordx4 a[40:43], v4, s[4:7], s42 offen offset:2048 sc1
	s_waitcnt vmcnt(10)
	buffer_load_dwordx4 a[44:47], v4, s[4:7], s42 offen offset:3072 sc1
	s_add_u32 s42, s40, 12288
	buffer_load_dwordx4 a[48:51], v4, s[4:7], s42 offen offset:0 sc1
	s_waitcnt vmcnt(10)
	buffer_load_dwordx4 a[52:55], v4, s[4:7], s42 offen offset:1024 sc1
	s_add_u32 s40, s41, 28672
	s_add_u32 s42, s40, 0
	buffer_load_dwordx4 a[64:67], v4, s[4:7], s42 offen offset:2048 sc1
	s_waitcnt vmcnt(10)
	buffer_load_dwordx4 a[68:71], v4, s[4:7], s42 offen offset:3072 sc1
	s_add_u32 s42, s40, 4096
	buffer_load_dwordx4 a[72:75], v4, s[4:7], s42 offen offset:0 sc1
	s_waitcnt vmcnt(10)
	buffer_load_dwordx4 a[76:79], v4, s[4:7], s42 offen offset:1024 sc1
	buffer_load_dwordx4 a[80:83], v4, s[4:7], s42 offen offset:2048 sc1
	s_waitcnt vmcnt(10)
	s_add_u32 s42, s40, 8192
	buffer_load_dwordx4 a[92:95], v4, s[4:7], s42 offen offset:1024 sc1
	buffer_load_dwordx4 a[96:99], v4, s[4:7], s42 offen offset:2048 sc1
	s_waitcnt vmcnt(10)
	buffer_load_dwordx4 a[100:103], v4, s[4:7], s42 offen offset:3072 sc1
	s_add_u32 s42, s40, 12288
	buffer_load_dwordx4 a[104:107], v4, s[4:7], s42 offen offset:0 sc1
	s_waitcnt vmcnt(10)
	buffer_load_dwordx4 a[108:111], v4, s[4:7], s42 offen offset:1024 sc1
	s_add_u32 s40, s41, 14336
	s_add_u32 s42, s40, 0
	buffer_load_dwordx4 a[120:123], v4, s[4:7], s42 offen offset:2048 sc1
	s_waitcnt vmcnt(10)
	buffer_load_dwordx4 a[124:127], v4, s[4:7], s42 offen offset:3072 sc1
	s_add_u32 s42, s40, 4096
	buffer_load_dwordx4 a[128:131], v4, s[4:7], s42 offen offset:0 sc1
	s_waitcnt vmcnt(10)
	buffer_load_dwordx4 a[132:135], v4, s[4:7], s42 offen offset:1024 sc1
	buffer_load_dwordx4 a[136:139], v4, s[4:7], s42 offen offset:2048 sc1
	s_waitcnt vmcnt(10)
	s_add_u32 s42, s40, 8192
	buffer_load_dwordx4 a[148:151], v4, s[4:7], s42 offen offset:1024 sc1
	buffer_load_dwordx4 a[152:155], v4, s[4:7], s42 offen offset:2048 sc1
	s_waitcnt vmcnt(10)
	buffer_load_dwordx4 a[156:159], v4, s[4:7], s42 offen offset:3072 sc1
	s_add_u32 s42, s40, 12288
	buffer_load_dwordx4 a[160:163], v4, s[4:7], s42 offen offset:0 sc1
	s_waitcnt vmcnt(10)
	buffer_load_dwordx4 a[164:167], v4, s[4:7], s42 offen offset:1024 sc1
	s_add_u32 s40, s41, 43008
	s_add_u32 s42, s40, 0
	buffer_load_dwordx4 a[176:179], v4, s[4:7], s42 offen offset:2048 sc1
	s_waitcnt vmcnt(10)
	buffer_load_dwordx4 a[180:183], v4, s[4:7], s42 offen offset:3072 sc1
	s_add_u32 s42, s40, 4096
	buffer_load_dwordx4 a[184:187], v4, s[4:7], s42 offen offset:0 sc1
	s_waitcnt vmcnt(10)
	buffer_load_dwordx4 a[188:191], v4, s[4:7], s42 offen offset:1024 sc1
	buffer_load_dwordx4 a[192:195], v4, s[4:7], s42 offen offset:2048 sc1
	s_waitcnt vmcnt(10)
	s_add_u32 s42, s40, 8192
	buffer_load_dwordx4 a[204:207], v4, s[4:7], s42 offen offset:1024 sc1
	buffer_load_dwordx4 a[208:211], v4, s[4:7], s42 offen offset:2048 sc1
	s_waitcnt vmcnt(10)
	buffer_load_dwordx4 a[212:215], v4, s[4:7], s42 offen offset:3072 sc1
	s_add_u32 s42, s40, 12288
	buffer_load_dwordx4 a[216:219], v4, s[4:7], s42 offen offset:0 sc1
	s_waitcnt vmcnt(10)
	buffer_load_dwordx4 a[220:223], v4, s[4:7], s42 offen offset:1024 sc1
	s_add_u32 s40, s41, 229376
	s_add_u32 s42, s40, 0
	buffer_load_dwordx4 a[232:235], v4, s[4:7], s42 offen offset:2048 sc1
	s_waitcnt vmcnt(10)
	buffer_load_dwordx4 a[236:239], v4, s[4:7], s42 offen offset:3072 sc1
	s_add_u32 s42, s40, 4096
	buffer_load_dwordx4 a[240:243], v4, s[4:7], s42 offen offset:0 sc1
	s_waitcnt vmcnt(10)
	buffer_load_dwordx4 a[244:247], v4, s[4:7], s42 offen offset:1024 sc1
	buffer_load_dwordx4 a[248:251], v4, s[4:7], s42 offen offset:2048 sc1
	s_waitcnt vmcnt(10)
	s_add_u32 s42, s40, 8192
	buffer_load_dwordx4 v[124:127], v4, s[4:7], s42 offen offset:1024 sc1
	buffer_load_dwordx4 v[128:131], v4, s[4:7], s42 offen offset:2048 sc1
	s_waitcnt vmcnt(10)
	buffer_load_dwordx4 v[132:135], v4, s[4:7], s42 offen offset:3072 sc1
	s_add_u32 s42, s40, 12288
	buffer_load_dwordx4 v[136:139], v4, s[4:7], s42 offen offset:0 sc1
	s_waitcnt vmcnt(10)
	buffer_load_dwordx4 v[140:143], v4, s[4:7], s42 offen offset:1024 sc1
	s_add_u32 s40, s41, 258048
	s_add_u32 s42, s40, 0
	buffer_load_dwordx4 v[152:155], v4, s[4:7], s42 offen offset:2048 sc1
	s_waitcnt vmcnt(10)
	buffer_load_dwordx4 v[156:159], v4, s[4:7], s42 offen offset:3072 sc1
	s_add_u32 s42, s40, 4096
	buffer_load_dwordx4 v[160:163], v4, s[4:7], s42 offen offset:0 sc1
	s_waitcnt vmcnt(10)
	buffer_load_dwordx4 v[164:167], v4, s[4:7], s42 offen offset:1024 sc1
	buffer_load_dwordx4 v[168:171], v4, s[4:7], s42 offen offset:2048 sc1
	s_waitcnt vmcnt(10)
	s_add_u32 s42, s40, 8192
	buffer_load_dwordx4 v[180:183], v4, s[4:7], s42 offen offset:1024 sc1
	buffer_load_dwordx4 v[184:187], v4, s[4:7], s42 offen offset:2048 sc1
	s_waitcnt vmcnt(10)
	buffer_load_dwordx4 v[188:191], v4, s[4:7], s42 offen offset:3072 sc1
	s_add_u32 s42, s40, 12288
	buffer_load_dwordx4 v[192:195], v4, s[4:7], s42 offen offset:0 sc1
	s_waitcnt vmcnt(10)
	buffer_load_dwordx4 v[196:199], v4, s[4:7], s42 offen offset:1024 sc1
	s_add_u32 s40, s41, 243712
	s_add_u32 s42, s40, 0
	buffer_load_dwordx4 v[208:211], v4, s[4:7], s42 offen offset:2048 sc1
	s_waitcnt vmcnt(10)
	buffer_load_dwordx4 v[212:215], v4, s[4:7], s42 offen offset:3072 sc1
	s_add_u32 s42, s40, 4096
	buffer_load_dwordx4 v[216:219], v4, s[4:7], s42 offen offset:0 sc1
	s_waitcnt vmcnt(10)
	buffer_load_dwordx4 v[220:223], v4, s[4:7], s42 offen offset:1024 sc1
	buffer_load_dwordx4 v[224:227], v4, s[4:7], s42 offen offset:2048 sc1
	s_waitcnt vmcnt(10)
	s_add_u32 s42, s40, 8192
	buffer_load_dwordx4 v[236:239], v4, s[4:7], s42 offen offset:1024 sc1
	buffer_load_dwordx4 v[240:243], v4, s[4:7], s42 offen offset:2048 sc1
	s_waitcnt vmcnt(10)
	buffer_load_dwordx4 v[244:247], v4, s[4:7], s42 offen offset:3072 sc1
	s_add_u32 s42, s40, 12288
	buffer_load_dwordx4 v[248:251], v4, s[4:7], s42 offen offset:0 sc1
	s_waitcnt vmcnt(10)
	buffer_load_dwordx4 v[252:255], v4, s[4:7], s42 offen offset:1024 sc1
	s_mov_b32 s41, 60268544
	s_mov_b32 s40, 0x100000
Lww_27:
	buffer_load_dword v25, v24, s[4:7], s41 offen sc1
	s_sub_u32 s40, s40, 1
	s_cbranch_scc1 Lwx_28
	s_waitcnt vmcnt(0)
	v_cmp_gt_u32 vcc, 64, v25
	s_cbranch_vccnz Lww_27
Lwx_28:
	s_waitcnt vmcnt(0)
	s_add_u32 s86, s15, 0
	s_add_u32 s87, s15, 4096
	buffer_load_dwordx4 v[84:87], v4, s[4:7], s86 offen offset:0 sc1
	buffer_load_dwordx4 v[88:91], v4, s[4:7], s86 offen offset:2048 sc1
	buffer_load_dwordx4 v[100:103], v4, s[4:7], s87 offen offset:0 sc1
	buffer_load_dwordx4 v[104:107], v4, s[4:7], s87 offen offset:2048 sc1
	buffer_load_dwordx4 v[92:95], v4, s[4:7], s86 offen offset:1024 sc1
	buffer_load_dwordx4 v[96:99], v4, s[4:7], s86 offen offset:3072 sc1
	buffer_load_dwordx4 v[108:111], v4, s[4:7], s87 offen offset:1024 sc1
	buffer_load_dwordx4 v[112:115], v4, s[4:7], s87 offen offset:3072 sc1
	s_mov_b32 s88, s87
	s_add_u32 s86, s86, 32768
	s_add_u32 s87, s87, 32768
	v_mov_b64 v[48:49], 0
	v_mov_b64 v[50:51], 0
	v_mov_b64 v[52:53], 0
	v_mov_b64 v[54:55], 0
	v_mov_b64 v[56:57], 0
	v_mov_b64 v[58:59], 0
	v_mov_b64 v[60:61], 0
	v_mov_b64 v[62:63], 0
	v_mov_b64 v[64:65], 0
	v_mov_b64 v[66:67], 0
	v_mov_b64 v[68:69], 0
	v_mov_b64 v[70:71], 0
	v_mov_b64 v[72:73], 0
	v_mov_b64 v[74:75], 0
	v_mov_b64 v[80:81], 0
	v_mov_b64 v[82:83], 0
	s_waitcnt vmcnt(0)
	s_barrier
.p2align 6
Lca_loop0:
	buffer_load_dwordx4 v[20:23], v4, s[4:7], s26 offen offset:0
	s_nop 2
	buffer_load_dwordx4 v[24:27], v4, s[4:7], s26 offen offset:1024
	s_nop 2
	buffer_load_dwordx4 v[28:31], v4, s[4:7], s26 offen offset:2048
	s_nop 15
	s_nop 13
	buffer_load_dwordx4 v[32:35], v4, s[4:7], s26 offen offset:3072
	s_add_u32 s16, s16, 1
	v_mov_b32 v8, s16
Lg_29:
	s_waitcnt vmcnt(3)
	v_smfmac_f32_16x16x64_bf16 v[48:51], v[20:23], a[0:7], v1
	v_smfmac_f32_16x16x64_bf16 v[52:55], v[20:23], a[56:63], v1
	buffer_load_dwordx4 v[36:39], v4, s[4:7], s27 offen offset:0 sc1
	v_smfmac_f32_16x16x64_bf16 v[56:59], v[20:23], a[112:119], v1
	v_smfmac_f32_16x16x64_bf16 v[60:63], v[20:23], a[168:175], v1
	buffer_load_dwordx4 v[40:43], v4, s[4:7], s27 offen offset:1024 sc1
	v_smfmac_f32_16x16x64_bf16 v[64:67], v[20:23], a[224:231], v1
	v_smfmac_f32_16x16x64_bf16 v[68:71], v[20:23], v[144:151], v1
	buffer_load_dwordx4 v[44:47], v4, s[4:7], s27 offen offset:2048 sc1
	v_smfmac_f32_16x16x64_bf16 v[72:75], v[20:23], v[200:207], v1
	s_waitcnt vmcnt(5)
	v_smfmac_f32_16x16x64_bf16 v[48:51], v[24:27], a[8:15], v1
	v_smfmac_f32_16x16x64_bf16 v[52:55], v[24:27], a[64:71], v1
	v_smfmac_f32_16x16x64_bf16 v[56:59], v[24:27], a[120:127], v1
	s_nop 0
	v_cmp_u_f32 vcc, v48, v49
	v_smfmac_f32_16x16x64_bf16 v[60:63], v[24:27], a[176:183], v1
	v_cmp_u_f32 s[38:39], v50, v51
	v_smfmac_f32_16x16x64_bf16 v[64:67], v[24:27], a[232:239], v1
	v_smfmac_f32_16x16x64_bf16 v[68:71], v[24:27], v[152:159], v1
	v_smfmac_f32_16x16x64_bf16 v[72:75], v[24:27], v[208:215], v1
	s_waitcnt vmcnt(4)
	v_smfmac_f32_16x16x64_bf16 v[48:51], v[28:31], a[16:23], v1
	s_or_b64 vcc, vcc, s[38:39]
	s_cbranch_vccnz Lge_32
Lgeo_33:
	v_smfmac_f32_16x16x64_bf16 v[52:55], v[28:31], a[72:79], v1
	v_smfmac_f32_16x16x64_bf16 v[56:59], v[28:31], a[128:135], v1
	s_mov_b32 m0, 4096
	s_nop 0
	buffer_load_dwordx4 v4, s[4:7], s86 offen offset:0 sc1 lds
	v_smfmac_f32_16x16x64_bf16 v[60:63], v[28:31], a[184:191], v1
	v_smfmac_f32_16x16x64_bf16 v[64:67], v[28:31], a[240:247], v1
	v_smfmac_f32_16x16x64_bf16 v[68:71], v[28:31], v[160:167], v1
	v_smfmac_f32_16x16x64_bf16 v[72:75], v[28:31], v[216:223], v1
	buffer_load_dwordx4 v4, s[4:7], s86 offen offset:1024 sc1 lds
	s_waitcnt vmcnt(5)
	v_smfmac_f32_16x16x64_bf16 v[48:51], v[32:35], a[24:31], v1
	v_smfmac_f32_16x16x64_bf16 v[52:55], v[32:35], a[80:87], v1
	v_smfmac_f32_16x16x64_bf16 v[56:59], v[32:35], a[136:143], v1
	buffer_load_dwordx4 v4, s[4:7], s86 offen offset:2048 sc1 lds
	v_smfmac_f32_16x16x64_bf16 v[60:63], v[32:35], a[192:199], v1
	s_waitcnt vmcnt(5)
	v_smfmac_f32_16x16x64_bf16 v[48:51], v[36:39], a[32:39], v1
	v_smfmac_f32_16x16x64_bf16 v[52:55], v[36:39], a[88:95], v1
	v_mov_b64 v[28:29], 0
	v_smfmac_f32_16x16x64_bf16 v[56:59], v[36:39], a[144:151], v1
	buffer_load_dwordx4 v4, s[4:7], s86 offen offset:3072 sc1 lds
	v_smfmac_f32_16x16x64_bf16 v[60:63], v[36:39], a[200:207], v1
	v_mov_b64 v[30:31], 0
	s_waitcnt vmcnt(5)
	v_smfmac_f32_16x16x64_bf16 v[48:51], v[40:43], a[40:47], v1
	v_smfmac_f32_16x16x64_bf16 v[52:55], v[40:43], a[96:103], v1
	v_smfmac_f32_16x16x64_bf16 v[56:59], v[40:43], a[152:159], v1
	s_mov_b32 m0, 8192
	s_nop 0
	buffer_load_dwordx4 v4, s[4:7], s87 offen offset:0 sc1 lds
	v_smfmac_f32_16x16x64_bf16 v[60:63], v[40:43], a[208:215], v1
	s_waitcnt vmcnt(5)
	v_smfmac_f32_16x16x64_bf16 v[48:51], v[44:47], a[48:55], v1
	v_smfmac_f32_16x16x64_bf16 v[52:55], v[44:47], a[104:111], v1
	buffer_load_dwordx4 v4, s[4:7], s87 offen offset:1024 sc1 lds
	v_smfmac_f32_16x16x64_bf16 v[56:59], v[44:47], a[160:167], v1
	s_nop 0
	v_cmp_u_f32 vcc, v48, v49
	v_smfmac_f32_16x16x64_bf16 v[60:63], v[44:47], a[216:223], v1
	v_cmp_u_f32 s[38:39], v50, v51
	v_smfmac_f32_16x16x64_bf16 v[68:71], v[32:35], v[168:175], v1
	s_or_b64 vcc, vcc, s[38:39]
	s_cbranch_vccnz Lgr_30
Lgo_31:
	v_cvt_pk_bf16_f32 v48, v48, v49
	v_smfmac_f32_16x16x64_bf16 v[68:71], v[36:39], v[176:183], v1
	buffer_load_dwordx4 v4, s[4:7], s87 offen offset:2048 sc1 lds
	v_cvt_pk_bf16_f32 v49, v50, v51
	v_smfmac_f32_16x16x64_bf16 v[68:71], v[40:43], v[184:191], v1
	v_cvt_pk_bf16_f32 v50, v56, v57
	v_smfmac_f32_16x16x64_bf16 v[68:71], v[44:47], v[192:199], v1
	v_cvt_pk_bf16_f32 v51, v58, v59
	v_smfmac_f32_16x16x64_bf16 v[64:67], v[32:35], a[248:255], v1
	buffer_load_dwordx4 v4, s[4:7], s87 offen offset:3072 sc1 lds
	v_cvt_pk_bf16_f32 v52, v52, v53
	v_mfma_f32_16x16x32_bf16 v[16:19], v[48:51], v[12:15], 0
	v_cvt_pk_bf16_f32 v53, v54, v55
	v_cvt_pk_bf16_f32 v54, v60, v61
	v_smfmac_f32_16x16x64_bf16 v[64:67], v[36:39], v[120:127], v1
	v_cvt_pk_bf16_f32 v55, v62, v63
	v_smfmac_f32_16x16x64_bf16 v[64:67], v[40:43], v[128:135], v1
	v_cvt_pk_bf16_f32 v116, v68, v69
	v_mfma_f32_16x16x32_bf16 v[60:63], v[52:55], v[12:15], 0
	v_cvt_pk_bf16_f32 v117, v70, v71
	v_cvt_pk_bf16_f32 v76, v16, v17
	v_smfmac_f32_16x16x64_bf16 v[64:67], v[44:47], v[136:143], v1
	v_cvt_pk_bf16_f32 v77, v18, v19
	v_mfma_f32_16x16x32_bf16 v[68:71], v[116:119], v[12:15], 0
	v_smfmac_f32_16x16x64_bf16 v[72:75], v[32:35], v[224:231], v1
	v_cvt_pk_bf16_f32 v78, v60, v61
	v_smfmac_f32_16x16x64_bf16 v[72:75], v[36:39], v[232:239], v1
	v_cvt_pk_bf16_f32 v79, v62, v63
	v_smfmac_f32_16x16x64_bf16 v[72:75], v[40:43], v[240:247], v1
	v_cvt_pk_bf16_f32 v64, v64, v65
	v_smfmac_f32_16x16x64_bf16 v[72:75], v[44:47], v[248:255], v1
	v_cvt_pk_bf16_f32 v65, v66, v67
	v_smfmac_f32_16x16x64_bf16 v[80:83], v[76:79], v[84:91], v1
	v_cvt_pk_bf16_f32 v26, v68, v69
	v_mfma_f32_16x16x32_bf16 v[48:51], v[76:79], v[20:23], 0
	s_nop 0
	v_cvt_pk_bf16_f32 v66, v72, v73
	v_cvt_pk_bf16_f32 v67, v74, v75
	v_cvt_pk_bf16_f32 v27, v70, v71
	s_nop 0
	v_mfma_f32_16x16x32_bf16 v[16:19], v[64:67], v[12:15], 0
	v_smfmac_f32_16x16x64_bf16 v[28:31], v[76:79], v[92:99], v1
	s_nop 4
	v_cvt_pk_bf16_f32 v24, v16, v17
	v_cvt_pk_bf16_f32 v25, v18, v19
	s_nop 1
	v_mfma_f32_16x16x32_bf16 v[48:51], v[24:27], v[36:39], v[48:51]
	v_smfmac_f32_16x16x64_bf16 v[80:83], v[24:27], v[100:107], v1
	v_smfmac_f32_16x16x64_bf16 v[28:31], v[24:27], v[108:115], v1
	s_nop 0
	v_add_f32_dpp v48, v50, v48 quad_perm:[2,3,0,1] row_mask:0xf bank_mask:0xf
	v_add_f32_dpp v51, v49, v51 quad_perm:[2,3,0,1] row_mask:0xf bank_mask:0xf
	v_cndmask_b32 v48, v48, v51, s[90:91]
	s_nop 0
	v_pk_add_f32 v[52:53], v[80:81], v[82:83]
	s_nop 1
	v_pk_add_f32 v[54:55], v[28:29], v[30:31]
	s_barrier
	ds_read_b128 v[24:27], v4 offset:0
	ds_read_b32 v28, v5 offset:1024
	ds_read_b128 v[30:33], v4 offset:1280
	ds_read_b32 v34, v5 offset:2304
	ds_read_b128 v[36:39], v4 offset:2560
	ds_read_b32 v40, v5 offset:3584
	buffer_store_dword v8, v9, s[4:7], s31 offen
	s_mov_b32 s25, 0
	s_waitcnt lgkmcnt(4)
	v_pk_add_f32 v[60:61], v[52:53], v[24:25]
	v_pk_add_f32 v[62:63], v[54:55], v[26:27]
	v_add_f32 v64, v48, v28
	s_waitcnt lgkmcnt(2)
	v_pk_add_f32 v[60:61], v[60:61], v[30:31]
	v_pk_add_f32 v[62:63], v[62:63], v[32:33]
	v_add_f32 v64, v64, v34
	s_waitcnt lgkmcnt(0)
	v_pk_add_f32 v[60:61], v[60:61], v[36:37]
	v_pk_add_f32 v[62:63], v[62:63], v[38:39]
	v_add_f32 v64, v64, v40
Lexp_36:
	v_exp_f32 v68, v60
	v_exp_f32 v69, v61
	v_exp_f32 v70, v62
	v_exp_f32 v71, v63
	v_exp_f32 v72, v64
	v_pk_add_f32 v[66:67], v[68:69], v[70:71]
	v_pk_fma_f32 v[66:67], v[72:73], v[2:3], v[66:67] op_sel_hi:[0,1,1]
	v_maximum3_f32 v65, |v60|, |v61|, |v62|
	v_maximum3_f32 v65, v65, |v63|, |v64|
	v_add_f32_dpp v66, v66, v66 row_ror:8 row_mask:0xf bank_mask:0xf
	v_add_f32_dpp v67, v67, v67 row_ror:8 row_mask:0xf bank_mask:0xf
	v_cmp_nge_f32 vcc, s29, v65
	v_add_f32_dpp v66, v66, v66 row_ror:4 row_mask:0xf bank_mask:0xf
	v_add_f32_dpp v67, v67, v67 row_ror:4 row_mask:0xf bank_mask:0xf
	s_nop 0
	v_add_f32_dpp v66, v66, v66 quad_perm:[2,3,0,1] row_mask:0xf bank_mask:0xf
	v_add_f32_dpp v67, v67, v67 quad_perm:[2,3,0,1] row_mask:0xf bank_mask:0xf
	s_nop 0
	v_add_f32_dpp v66, v66, v66 quad_perm:[1,0,3,2] row_mask:0xf bank_mask:0xf
	v_add_f32_dpp v67, v67, v67 quad_perm:[1,0,3,2] row_mask:0xf bank_mask:0xf
	v_rcp_f32 v66, v66
	v_rcp_f32 v67, v67
	s_cbranch_vccnz Lsr_34
Lso_35:
	v_pk_mul_f32 v[68:69], v[68:69], v[66:67]
	v_pk_mul_f32 v[70:71], v[70:71], v[66:67]
	v_cvt_pk_bf16_f32 v68, v68, v70
	buffer_store_dword v68, v11, s[4:7], s20 offen
	v_cvt_pk_bf16_f32 v69, v69, v71
	buffer_store_dword v69, v11, s[4:7], s20 offen offset:16
	v_cndmask_b32 v66, v66, v67, s[90:91]
	v_mul_f32 v72, v72, v66
	v_cvt_pk_bf16_f32 v72, v72, v72
	buffer_store_short v72, v10, s[4:7], s20 offen
	s_waitcnt vmcnt(4)
	ds_read_b128 v[84:87], v4 offset:4096
	ds_read_b128 v[92:95], v4 offset:5120
	ds_read_b128 v[88:91], v4 offset:6144
	ds_read_b128 v[96:99], v4 offset:7168
	ds_read_b128 v[100:103], v4 offset:8192
	ds_read_b128 v[108:111], v4 offset:9216
	ds_read_b128 v[104:107], v4 offset:10240
	ds_read_b128 v[112:115], v4 offset:11264
	s_waitcnt lgkmcnt(0)
	s_add_u32 s26, s26, 8192
	s_add_u32 s27, s27, 8192
	s_add_u32 s86, s86, 32768
	s_add_u32 s87, s87, 32768
	s_add_u32 s88, s88, 32768
	s_add_u32 s14, s14, 458752
	s_and_b32 s23, s16, 3
	s_cselect_b32 s23, s24, -49152
	s_add_u32 s20, s20, s23
	v_mov_b64 v[48:49], 0
	v_mov_b64 v[50:51], 0
	v_mov_b64 v[52:53], 0
	v_mov_b64 v[54:55], 0
	v_mov_b64 v[56:57], 0
	v_mov_b64 v[58:59], 0
	v_mov_b64 v[60:61], 0
	v_mov_b64 v[62:63], 0
	v_mov_b64 v[64:65], 0
	v_mov_b64 v[66:67], 0
	v_mov_b64 v[68:69], 0
	v_mov_b64 v[70:71], 0
	v_mov_b64 v[72:73], 0
	v_mov_b64 v[74:75], 0
	v_mov_b64 v[80:81], 0
	v_mov_b64 v[82:83], 0
	s_barrier
	s_cmp_lg_u32 s16, 63
	s_cbranch_scc1 Lca_loop0
	s_waitcnt vmcnt(0)
	s_endpgm
Lgr_30:
	s_cmp_eq_u32 s13, 0
	s_cbranch_scc1 Lgo_31
	s_sub_u32 s13, s13, 1
	s_waitcnt vmcnt(0)
	s_nop 7
	buffer_load_dwordx4 v[20:23], v4, s[4:7], s26 offen offset:0 sc1
	buffer_load_dwordx4 v[24:27], v4, s[4:7], s26 offen offset:1024 sc1
	buffer_load_dwordx4 v[28:31], v4, s[4:7], s26 offen offset:2048 sc1
	buffer_load_dwordx4 v[32:35], v4, s[4:7], s26 offen offset:3072 sc1
	v_mov_b64 v[48:49], 0
	v_mov_b64 v[50:51], 0
	v_mov_b64 v[52:53], 0
	v_mov_b64 v[54:55], 0
	v_mov_b64 v[56:57], 0
	v_mov_b64 v[58:59], 0
	v_mov_b64 v[60:61], 0
	v_mov_b64 v[62:63], 0
	v_mov_b64 v[64:65], 0
	v_mov_b64 v[66:67], 0
	v_mov_b64 v[68:69], 0
	v_mov_b64 v[70:71], 0
	v_mov_b64 v[72:73], 0
	v_mov_b64 v[74:75], 0
	s_nop 1
	s_branch Lg_29
Lge_32:
	s_cmp_eq_u32 s13, 0
	s_cbranch_scc1 Lgeo_33
	s_sub_u32 s13, s13, 1
	s_waitcnt vmcnt(0)
	s_nop 7
	buffer_load_dwordx4 v[20:23], v4, s[4:7], s26 offen offset:0 sc1
	buffer_load_dwordx4 v[24:27], v4, s[4:7], s26 offen offset:1024 sc1
	buffer_load_dwordx4 v[28:31], v4, s[4:7], s26 offen offset:2048 sc1
	buffer_load_dwordx4 v[32:35], v4, s[4:7], s26 offen offset:3072 sc1
	v_mov_b64 v[48:49], 0
	v_mov_b64 v[50:51], 0
	v_mov_b64 v[52:53], 0
	v_mov_b64 v[54:55], 0
	v_mov_b64 v[56:57], 0
	v_mov_b64 v[58:59], 0
	v_mov_b64 v[60:61], 0
	v_mov_b64 v[62:63], 0
	v_mov_b64 v[64:65], 0
	v_mov_b64 v[66:67], 0
	v_mov_b64 v[68:69], 0
	v_mov_b64 v[70:71], 0
	v_mov_b64 v[72:73], 0
	v_mov_b64 v[74:75], 0
	s_nop 1
	s_branch Lg_29
Lsr_34:
	s_cmp_lg_u32 s25, 0
	s_cbranch_scc1 Lso_35
	v_cndmask_b32 v66, v64, v60, s[90:91]
	v_cndmask_b32 v67, v61, v64, s[90:91]
	v_max3_f32 v66, v66, v60, v62
	v_max3_f32 v67, v67, v61, v63
	s_nop 0
	v_max_f32_dpp v66, v66, v66 row_ror:8 row_mask:0xf bank_mask:0xf
	v_max_f32_dpp v67, v67, v67 row_ror:8 row_mask:0xf bank_mask:0xf
	s_nop 0
	v_max_f32_dpp v66, v66, v66 row_ror:4 row_mask:0xf bank_mask:0xf
	v_max_f32_dpp v67, v67, v67 row_ror:4 row_mask:0xf bank_mask:0xf
	s_nop 0
	v_max_f32_dpp v66, v66, v66 quad_perm:[2,3,0,1] row_mask:0xf bank_mask:0xf
	v_max_f32_dpp v67, v67, v67 quad_perm:[2,3,0,1] row_mask:0xf bank_mask:0xf
	s_nop 0
	v_max_f32_dpp v66, v66, v66 quad_perm:[1,0,3,2] row_mask:0xf bank_mask:0xf
	v_max_f32_dpp v67, v67, v67 quad_perm:[1,0,3,2] row_mask:0xf bank_mask:0xf
	v_sub_f32 v60, v60, v66
	v_sub_f32 v61, v61, v67
	v_sub_f32 v62, v62, v66
	v_sub_f32 v63, v63, v67
	v_cndmask_b32 v66, v66, v67, s[90:91]
	v_sub_f32 v64, v64, v66
	s_mov_b32 s25, 1
	s_branch Lexp_36
Lca_w1:
	s_mul_i32 s41, s32, 401408
	s_add_u32 s40, s41, 57344
	s_add_u32 s42, s40, 0
	buffer_load_dwordx4 a[8:11], v4, s[4:7], s42 offen offset:0 sc1
	buffer_load_dwordx4 a[12:15], v4, s[4:7], s42 offen offset:1024 sc1
	s_add_u32 s42, s40, 4096
	buffer_load_dwordx4 a[36:39], v4, s[4:7], s42 offen offset:3072 sc1
	s_add_u32 s42, s40, 8192
	buffer_load_dwordx4 a[24:27], v4, s[4:7], s42 offen offset:0 sc1
	s_add_u32 s40, s41, 86016
	s_add_u32 s42, s40, 0
	buffer_load_dwordx4 a[64:67], v4, s[4:7], s42 offen offset:0 sc1
	buffer_load_dwordx4 a[68:71], v4, s[4:7], s42 offen offset:1024 sc1
	s_add_u32 s42, s40, 4096
	buffer_load_dwordx4 a[92:95], v4, s[4:7], s42 offen offset:3072 sc1
	s_add_u32 s42, s40, 8192
	buffer_load_dwordx4 a[80:83], v4, s[4:7], s42 offen offset:0 sc1
	s_add_u32 s40, s41, 71680
	s_add_u32 s42, s40, 0
	buffer_load_dwordx4 a[120:123], v4, s[4:7], s42 offen offset:0 sc1
	buffer_load_dwordx4 a[124:127], v4, s[4:7], s42 offen offset:1024 sc1
	s_add_u32 s42, s40, 4096
	buffer_load_dwordx4 a[148:151], v4, s[4:7], s42 offen offset:3072 sc1
	s_waitcnt vmcnt(10)
	s_add_u32 s42, s40, 8192
	buffer_load_dwordx4 a[136:139], v4, s[4:7], s42 offen offset:0 sc1
	s_add_u32 s40, s41, 100352
	s_add_u32 s42, s40, 0
	buffer_load_dwordx4 a[176:179], v4, s[4:7], s42 offen offset:0 sc1
	s_waitcnt vmcnt(10)
	buffer_load_dwordx4 a[180:183], v4, s[4:7], s42 offen offset:1024 sc1
	s_add_u32 s42, s40, 4096
	buffer_load_dwordx4 a[204:207], v4, s[4:7], s42 offen offset:3072 sc1
	s_waitcnt vmcnt(10)
	s_add_u32 s42, s40, 8192
	buffer_load_dwordx4 a[192:195], v4, s[4:7], s42 offen offset:0 sc1
	s_add_u32 s40, s41, 286720
	s_add_u32 s42, s40, 0
	buffer_load_dwordx4 a[232:235], v4, s[4:7], s42 offen offset:0 sc1
	s_waitcnt vmcnt(10)
	buffer_load_dwordx4 a[236:239], v4, s[4:7], s42 offen offset:1024 sc1
	s_add_u32 s42, s40, 4096
	buffer_load_dwordx4 v[124:127], v4, s[4:7], s42 offen offset:3072 sc1
	s_waitcnt vmcnt(10)
	s_add_u32 s42, s40, 8192
	buffer_load_dwordx4 a[248:251], v4, s[4:7], s42 offen offset:0 sc1
	s_add_u32 s40, s41, 315392
	s_add_u32 s42, s40, 0
	buffer_load_dwordx4 v[152:155], v4, s[4:7], s42 offen offset:0 sc1
	s_waitcnt vmcnt(10)
	buffer_load_dwordx4 v[156:159], v4, s[4:7], s42 offen offset:1024 sc1
	s_add_u32 s42, s40, 4096
	buffer_load_dwordx4 v[180:183], v4, s[4:7], s42 offen offset:3072 sc1
	s_waitcnt vmcnt(10)
	s_add_u32 s42, s40, 8192
	buffer_load_dwordx4 v[168:171], v4, s[4:7], s42 offen offset:0 sc1
	s_add_u32 s40, s41, 301056
	s_add_u32 s42, s40, 0
	buffer_load_dwordx4 v[208:211], v4, s[4:7], s42 offen offset:0 sc1
	s_waitcnt vmcnt(10)
	buffer_load_dwordx4 v[212:215], v4, s[4:7], s42 offen offset:1024 sc1
	s_add_u32 s42, s40, 4096
	buffer_load_dwordx4 v[236:239], v4, s[4:7], s42 offen offset:3072 sc1
	s_waitcnt vmcnt(10)
	s_add_u32 s42, s40, 8192
	buffer_load_dwordx4 v[224:227], v4, s[4:7], s42 offen offset:0 sc1
	s_mov_b32 s40, 0x100000
Lww_37:
	buffer_load_dword v25, v24, s[4:7], s34 offen sc1
	s_sub_u32 s40, s40, 1
	s_cbranch_scc1 Lwx_38
	s_waitcnt vmcnt(0)
	v_cmp_gt_u32 vcc, 7, v25
	s_cbranch_vccnz Lww_37
Lwx_38:
	s_waitcnt vmcnt(0)
	s_add_u32 s40, s41, 57344
	s_add_u32 s42, s40, 0
	buffer_load_dwordx4 a[0:3], v4, s[4:7], s42 offen offset:2048 sc1
	s_waitcnt vmcnt(10)
	buffer_load_dwordx4 a[4:7], v4, s[4:7], s42 offen offset:3072 sc1
	s_add_u32 s42, s40, 4096
	buffer_load_dwordx4 a[16:19], v4, s[4:7], s42 offen offset:0 sc1
	s_waitcnt vmcnt(10)
	buffer_load_dwordx4 a[20:23], v4, s[4:7], s42 offen offset:1024 sc1
	buffer_load_dwordx4 a[32:35], v4, s[4:7], s42 offen offset:2048 sc1
	s_waitcnt vmcnt(10)
	s_add_u32 s42, s40, 8192
	buffer_load_dwordx4 a[28:31], v4, s[4:7], s42 offen offset:1024 sc1
	buffer_load_dwordx4 a[40:43], v4, s[4:7], s42 offen offset:2048 sc1
	s_waitcnt vmcnt(10)
	buffer_load_dwordx4 a[44:47], v4, s[4:7], s42 offen offset:3072 sc1
	s_add_u32 s42, s40, 12288
	buffer_load_dwordx4 a[48:51], v4, s[4:7], s42 offen offset:0 sc1
	s_waitcnt vmcnt(10)
	buffer_load_dwordx4 a[52:55], v4, s[4:7], s42 offen offset:1024 sc1
	s_add_u32 s40, s41, 86016
	s_add_u32 s42, s40, 0
	buffer_load_dwordx4 a[56:59], v4, s[4:7], s42 offen offset:2048 sc1
	s_waitcnt vmcnt(10)
	buffer_load_dwordx4 a[60:63], v4, s[4:7], s42 offen offset:3072 sc1
	s_add_u32 s42, s40, 4096
	buffer_load_dwordx4 a[72:75], v4, s[4:7], s42 offen offset:0 sc1
	s_waitcnt vmcnt(10)
	buffer_load_dwordx4 a[76:79], v4, s[4:7], s42 offen offset:1024 sc1
	buffer_load_dwordx4 a[88:91], v4, s[4:7], s42 offen offset:2048 sc1
	s_waitcnt vmcnt(10)
	s_add_u32 s42, s40, 8192
	buffer_load_dwordx4 a[84:87], v4, s[4:7], s42 offen offset:1024 sc1
	buffer_load_dwordx4 a[96:99], v4, s[4:7], s42 offen offset:2048 sc1
	s_waitcnt vmcnt(10)
	buffer_load_dwordx4 a[100:103], v4, s[4:7], s42 offen offset:3072 sc1
	s_add_u32 s42, s40, 12288
	buffer_load_dwordx4 a[104:107], v4, s[4:7], s42 offen offset:0 sc1
	s_waitcnt vmcnt(10)
	buffer_load_dwordx4 a[108:111], v4, s[4:7], s42 offen offset:1024 sc1
	s_add_u32 s40, s41, 71680
	s_add_u32 s42, s40, 0
	buffer_load_dwordx4 a[112:115], v4, s[4:7], s42 offen offset:2048 sc1
	s_waitcnt vmcnt(10)
	buffer_load_dwordx4 a[116:119], v4, s[4:7], s42 offen offset:3072 sc1
	s_add_u32 s42, s40, 4096
	buffer_load_dwordx4 a[128:131], v4, s[4:7], s42 offen offset:0 sc1
	s_waitcnt vmcnt(10)
	buffer_load_dwordx4 a[132:135], v4, s[4:7], s42 offen offset:1024 sc1
	buffer_load_dwordx4 a[144:147], v4, s[4:7], s42 offen offset:2048 sc1
	s_waitcnt vmcnt(10)
	s_add_u32 s42, s40, 8192
	buffer_load_dwordx4 a[140:143], v4, s[4:7], s42 offen offset:1024 sc1
	buffer_load_dwordx4 a[152:155], v4, s[4:7], s42 offen offset:2048 sc1
	s_waitcnt vmcnt(10)
	buffer_load_dwordx4 a[156:159], v4, s[4:7], s42 offen offset:3072 sc1
	s_add_u32 s42, s40, 12288
	buffer_load_dwordx4 a[160:163], v4, s[4:7], s42 offen offset:0 sc1
	s_waitcnt vmcnt(10)
	buffer_load_dwordx4 a[164:167], v4, s[4:7], s42 offen offset:1024 sc1
	s_add_u32 s40, s41, 100352
	s_add_u32 s42, s40, 0
	buffer_load_dwordx4 a[168:171], v4, s[4:7], s42 offen offset:2048 sc1
	s_waitcnt vmcnt(10)
	buffer_load_dwordx4 a[172:175], v4, s[4:7], s42 offen offset:3072 sc1
	s_add_u32 s42, s40, 4096
	buffer_load_dwordx4 a[184:187], v4, s[4:7], s42 offen offset:0 sc1
	s_waitcnt vmcnt(10)
	buffer_load_dwordx4 a[188:191], v4, s[4:7], s42 offen offset:1024 sc1
	buffer_load_dwordx4 a[200:203], v4, s[4:7], s42 offen offset:2048 sc1
	s_waitcnt vmcnt(10)
	s_add_u32 s42, s40, 8192
	buffer_load_dwordx4 a[196:199], v4, s[4:7], s42 offen offset:1024 sc1
	buffer_load_dwordx4 a[208:211], v4, s[4:7], s42 offen offset:2048 sc1
	s_waitcnt vmcnt(10)
	buffer_load_dwordx4 a[212:215], v4, s[4:7], s42 offen offset:3072 sc1
	s_add_u32 s42, s40, 12288
	buffer_load_dwordx4 a[216:219], v4, s[4:7], s42 offen offset:0 sc1
	s_waitcnt vmcnt(10)
	buffer_load_dwordx4 a[220:223], v4, s[4:7], s42 offen offset:1024 sc1
	s_add_u32 s40, s41, 286720
	s_add_u32 s42, s40, 0
	buffer_load_dwordx4 a[224:227], v4, s[4:7], s42 offen offset:2048 sc1
	s_waitcnt vmcnt(10)
	buffer_load_dwordx4 a[228:231], v4, s[4:7], s42 offen offset:3072 sc1
	s_add_u32 s42, s40, 4096
	buffer_load_dwordx4 a[240:243], v4, s[4:7], s42 offen offset:0 sc1
	s_waitcnt vmcnt(10)
	buffer_load_dwordx4 a[244:247], v4, s[4:7], s42 offen offset:1024 sc1
	buffer_load_dwordx4 v[120:123], v4, s[4:7], s42 offen offset:2048 sc1
	s_waitcnt vmcnt(10)
	s_add_u32 s42, s40, 8192
	buffer_load_dwordx4 a[252:255], v4, s[4:7], s42 offen offset:1024 sc1
	buffer_load_dwordx4 v[128:131], v4, s[4:7], s42 offen offset:2048 sc1
	s_waitcnt vmcnt(10)
	buffer_load_dwordx4 v[132:135], v4, s[4:7], s42 offen offset:3072 sc1
	s_add_u32 s42, s40, 12288
	buffer_load_dwordx4 v[136:139], v4, s[4:7], s42 offen offset:0 sc1
	s_waitcnt vmcnt(10)
	buffer_load_dwordx4 v[140:143], v4, s[4:7], s42 offen offset:1024 sc1
	v_mov_b32 v24, 0
	s_mov_b32 s40, 0x100000
Lrw_39:
	buffer_load_dword v25, v24, s[44:47], 0 offen offset:128 sc1
	s_sub_u32 s40, s40, 1
	s_cbranch_scc1 Lrx_40
	s_waitcnt vmcnt(0)
	v_cmp_gt_u32 vcc, 8, v25
	s_cbranch_vccnz Lrw_39
Lrx_40:
	s_waitcnt vmcnt(0)
	s_add_u32 s40, s41, 315392
	s_add_u32 s42, s40, 0
	buffer_load_dwordx4 v[144:147], v4, s[4:7], s42 offen offset:2048 sc1
	s_waitcnt vmcnt(10)
	buffer_load_dwordx4 v[148:151], v4, s[4:7], s42 offen offset:3072 sc1
	s_add_u32 s42, s40, 4096
	buffer_load_dwordx4 v[160:163], v4, s[4:7], s42 offen offset:0 sc1
	s_waitcnt vmcnt(10)
	buffer_load_dwordx4 v[164:167], v4, s[4:7], s42 offen offset:1024 sc1
	buffer_load_dwordx4 v[176:179], v4, s[4:7], s42 offen offset:2048 sc1
	s_waitcnt vmcnt(10)
	s_add_u32 s42, s40, 8192
	buffer_load_dwordx4 v[172:175], v4, s[4:7], s42 offen offset:1024 sc1
	buffer_load_dwordx4 v[184:187], v4, s[4:7], s42 offen offset:2048 sc1
	s_waitcnt vmcnt(10)
	buffer_load_dwordx4 v[188:191], v4, s[4:7], s42 offen offset:3072 sc1
	s_add_u32 s42, s40, 12288
	buffer_load_dwordx4 v[192:195], v4, s[4:7], s42 offen offset:0 sc1
	s_waitcnt vmcnt(10)
	buffer_load_dwordx4 v[196:199], v4, s[4:7], s42 offen offset:1024 sc1
	s_add_u32 s40, s41, 301056
	s_add_u32 s42, s40, 0
	buffer_load_dwordx4 v[200:203], v4, s[4:7], s42 offen offset:2048 sc1
	s_waitcnt vmcnt(10)
	buffer_load_dwordx4 v[204:207], v4, s[4:7], s42 offen offset:3072 sc1
	s_add_u32 s42, s40, 4096
	buffer_load_dwordx4 v[216:219], v4, s[4:7], s42 offen offset:0 sc1
	s_waitcnt vmcnt(10)
	buffer_load_dwordx4 v[220:223], v4, s[4:7], s42 offen offset:1024 sc1
	buffer_load_dwordx4 v[232:235], v4, s[4:7], s42 offen offset:2048 sc1
	s_waitcnt vmcnt(10)
	s_add_u32 s42, s40, 8192
	buffer_load_dwordx4 v[228:231], v4, s[4:7], s42 offen offset:1024 sc1
	buffer_load_dwordx4 v[240:243], v4, s[4:7], s42 offen offset:2048 sc1
	s_waitcnt vmcnt(10)
	buffer_load_dwordx4 v[244:247], v4, s[4:7], s42 offen offset:3072 sc1
	s_add_u32 s42, s40, 12288
	buffer_load_dwordx4 v[248:251], v4, s[4:7], s42 offen offset:0 sc1
	s_waitcnt vmcnt(10)
	buffer_load_dwordx4 v[252:255], v4, s[4:7], s42 offen offset:1024 sc1
	s_mov_b32 s41, 60268544
	s_mov_b32 s40, 0x100000
Lww_41:
	buffer_load_dword v25, v24, s[4:7], s41 offen sc1
	s_sub_u32 s40, s40, 1
	s_cbranch_scc1 Lwx_42
	s_waitcnt vmcnt(0)
	v_cmp_gt_u32 vcc, 64, v25
	s_cbranch_vccnz Lww_41
Lwx_42:
	s_waitcnt vmcnt(0)
	s_add_u32 s86, s15, 8192
	s_add_u32 s87, s15, 12288
	buffer_load_dwordx4 v[84:87], v4, s[4:7], s86 offen offset:0 sc1
	buffer_load_dwordx4 v[88:91], v4, s[4:7], s86 offen offset:2048 sc1
	buffer_load_dwordx4 v[100:103], v4, s[4:7], s87 offen offset:0 sc1
	buffer_load_dwordx4 v[104:107], v4, s[4:7], s87 offen offset:2048 sc1
	buffer_load_dwordx4 v[92:95], v4, s[4:7], s86 offen offset:1024 sc1
	buffer_load_dwordx4 v[96:99], v4, s[4:7], s86 offen offset:3072 sc1
	buffer_load_dwordx4 v[108:111], v4, s[4:7], s87 offen offset:1024 sc1
	buffer_load_dwordx4 v[112:115], v4, s[4:7], s87 offen offset:3072 sc1
	s_mov_b32 s88, s87
	s_add_u32 s86, s86, 32768
	s_add_u32 s87, s87, 32768
	v_mov_b64 v[48:49], 0
	v_mov_b64 v[50:51], 0
	v_mov_b64 v[52:53], 0
	v_mov_b64 v[54:55], 0
	v_mov_b64 v[56:57], 0
	v_mov_b64 v[58:59], 0
	v_mov_b64 v[60:61], 0
	v_mov_b64 v[62:63], 0
	v_mov_b64 v[64:65], 0
	v_mov_b64 v[66:67], 0
	v_mov_b64 v[68:69], 0
	v_mov_b64 v[70:71], 0
	v_mov_b64 v[72:73], 0
	v_mov_b64 v[74:75], 0
	v_mov_b64 v[80:81], 0
	v_mov_b64 v[82:83], 0
	s_mov_b64 exec, 0x7fff
Lfl_43:
	buffer_load_dword v7, v5, s[4:7], s30 offen offset:256 sc1
	v_cmp_gt_i32 vcc, s16, v7
	s_cbranch_vccz Lfo_44
	buffer_load_dword v7, v5, s[4:7], s30 offen offset:256 sc1
	v_cmp_gt_i32 vcc, s16, v7
	s_cbranch_vccz Lfo_44
	buffer_load_dword v7, v5, s[4:7], s30 offen offset:256 sc1
	v_cmp_gt_i32 vcc, s16, v7
	s_cbranch_vccz Lfo_44
	buffer_load_dword v7, v5, s[4:7], s30 offen offset:256 sc1
	v_cmp_gt_i32 vcc, s16, v7
	s_cbranch_vccz Lfo_44
	buffer_load_dword v7, v5, s[4:7], s30 offen offset:256 sc1
	v_cmp_gt_i32 vcc, s16, v7
	s_cbranch_vccz Lfo_44
	buffer_load_dword v7, v5, s[4:7], s30 offen offset:256 sc1
	v_cmp_gt_i32 vcc, s16, v7
	s_cbranch_vccz Lfo_44
	buffer_load_dword v7, v5, s[4:7], s30 offen offset:256 sc1
	v_cmp_gt_i32 vcc, s16, v7
	s_cbranch_vccz Lfo_44
	buffer_load_dword v7, v5, s[4:7], s30 offen offset:256 sc1
	v_cmp_gt_i32 vcc, s16, v7
	s_cbranch_vccz Lfo_44
	s_waitcnt vmcnt(40)
	buffer_load_dword v7, v5, s[4:7], s30 offen offset:256 sc1
	v_cmp_gt_i32 vcc, s16, v7
	s_cbranch_vccz Lfo_44
	buffer_load_dword v7, v5, s[4:7], s30 offen offset:256 sc1
	v_cmp_gt_i32 vcc, s16, v7
	s_cbranch_vccz Lfo_44
	buffer_load_dword v7, v5, s[4:7], s30 offen offset:256 sc1
	v_cmp_gt_i32 vcc, s16, v7
	s_cbranch_vccz Lfo_44
	buffer_load_dword v7, v5, s[4:7], s30 offen offset:256 sc1
	v_cmp_gt_i32 vcc, s16, v7
	s_cbranch_vccz Lfo_44
	buffer_load_dword v7, v5, s[4:7], s30 offen offset:256 sc1
	v_cmp_gt_i32 vcc, s16, v7
	s_cbranch_vccz Lfo_44
	buffer_load_dword v7, v5, s[4:7], s30 offen offset:256 sc1
	v_cmp_gt_i32 vcc, s16, v7
	s_cbranch_vccz Lfo_44
	buffer_load_dword v7, v5, s[4:7], s30 offen offset:256 sc1
	v_cmp_gt_i32 vcc, s16, v7
	s_cbranch_vccz Lfo_44
	buffer_load_dword v7, v5, s[4:7], s30 offen offset:256 sc1
	v_cmp_gt_i32 vcc, s16, v7
	s_cbranch_vccz Lfo_44
	s_waitcnt vmcnt(40)
	buffer_load_dword v7, v5, s[4:7], s30 offen offset:256 sc1
	v_cmp_gt_i32 vcc, s16, v7
	s_cbranch_vccz Lfo_44
	buffer_load_dword v7, v5, s[4:7], s30 offen offset:256 sc1
	v_cmp_gt_i32 vcc, s16, v7
	s_cbranch_vccz Lfo_44
	buffer_load_dword v7, v5, s[4:7], s30 offen offset:256 sc1
	v_cmp_gt_i32 vcc, s16, v7
	s_cbranch_vccz Lfo_44
	buffer_load_dword v7, v5, s[4:7], s30 offen offset:256 sc1
	v_cmp_gt_i32 vcc, s16, v7
	s_cbranch_vccz Lfo_44
	buffer_load_dword v7, v5, s[4:7], s30 offen offset:256 sc1
	v_cmp_gt_i32 vcc, s16, v7
	s_cbranch_vccz Lfo_44
	buffer_load_dword v7, v5, s[4:7], s30 offen offset:256 sc1
	v_cmp_gt_i32 vcc, s16, v7
	s_cbranch_vccz Lfo_44
	buffer_load_dword v7, v5, s[4:7], s30 offen offset:256 sc1
	v_cmp_gt_i32 vcc, s16, v7
	s_cbranch_vccz Lfo_44
	buffer_load_dword v7, v5, s[4:7], s30 offen offset:256 sc1
	v_cmp_gt_i32 vcc, s16, v7
	s_cbranch_vccz Lfo_44
	s_waitcnt vmcnt(40)
	s_waitcnt vmcnt(24)
	s_sub_u32 s17, s17, 1
	s_cbranch_scc0 Lfl_43
	s_mov_b32 s17, 0
Lfo_44:
	s_mov_b64 exec, -1
	s_waitcnt vmcnt(0)
	s_barrier
.p2align 6
Lca_loop1:
	buffer_load_dwordx4 v[20:23], v4, s[4:7], s26 offen offset:1024
	s_nop 2
	buffer_load_dwordx4 v[24:27], v4, s[4:7], s26 offen offset:0
	s_nop 2
	buffer_load_dwordx4 v[28:31], v4, s[4:7], s26 offen offset:2048
	s_nop 15
	s_nop 13
	buffer_load_dwordx4 v[32:35], v4, s[4:7], s27 offen offset:0
	s_add_u32 s16, s16, 1
	v_mov_b32 v8, s16
Lg_45:
	s_waitcnt vmcnt(3)
	v_smfmac_f32_16x16x64_bf16 v[48:51], v[20:23], a[0:7], v1
	v_smfmac_f32_16x16x64_bf16 v[52:55], v[20:23], a[56:63], v1
	buffer_load_dwordx4 v[36:39], v4, s[4:7], s26 offen offset:3072 sc1
	v_smfmac_f32_16x16x64_bf16 v[56:59], v[20:23], a[112:119], v1
	v_smfmac_f32_16x16x64_bf16 v[60:63], v[20:23], a[168:175], v1
	buffer_load_dwordx4 v[40:43], v4, s[4:7], s27 offen offset:1024 sc1
	v_smfmac_f32_16x16x64_bf16 v[64:67], v[20:23], a[224:231], v1
	v_smfmac_f32_16x16x64_bf16 v[68:71], v[20:23], v[144:151], v1
	buffer_load_dwordx4 v[44:47], v4, s[4:7], s27 offen offset:2048 sc1
	v_smfmac_f32_16x16x64_bf16 v[72:75], v[20:23], v[200:207], v1
	s_waitcnt vmcnt(5)
	v_smfmac_f32_16x16x64_bf16 v[48:51], v[24:27], a[8:15], v1
	v_smfmac_f32_16x16x64_bf16 v[52:55], v[24:27], a[64:71], v1
	v_smfmac_f32_16x16x64_bf16 v[56:59], v[24:27], a[120:127], v1
	s_nop 0
	v_cmp_u_f32 vcc, v48, v49
	v_smfmac_f32_16x16x64_bf16 v[60:63], v[24:27], a[176:183], v1
	v_cmp_u_f32 s[38:39], v50, v51
	v_smfmac_f32_16x16x64_bf16 v[64:67], v[24:27], a[232:239], v1
	v_smfmac_f32_16x16x64_bf16 v[68:71], v[24:27], v[152:159], v1
	v_smfmac_f32_16x16x64_bf16 v[72:75], v[24:27], v[208:215], v1
	s_waitcnt vmcnt(4)
	v_smfmac_f32_16x16x64_bf16 v[48:51], v[28:31], a[16:23], v1
	s_or_b64 vcc, vcc, s[38:39]
	s_cbranch_vccnz Lge_48
Lgeo_49:
	v_smfmac_f32_16x16x64_bf16 v[52:55], v[28:31], a[72:79], v1
	v_smfmac_f32_16x16x64_bf16 v[56:59], v[28:31], a[128:135], v1
	s_mov_b32 m0, 12288
	s_nop 0
	buffer_load_dwordx4 v4, s[4:7], s86 offen offset:0 sc1 lds
	v_smfmac_f32_16x16x64_bf16 v[60:63], v[28:31], a[184:191], v1
	v_smfmac_f32_16x16x64_bf16 v[64:67], v[28:31], a[240:247], v1
	v_smfmac_f32_16x16x64_bf16 v[68:71], v[28:31], v[160:167], v1
	v_smfmac_f32_16x16x64_bf16 v[72:75], v[28:31], v[216:223], v1
	buffer_load_dwordx4 v4, s[4:7], s86 offen offset:1024 sc1 lds
	s_waitcnt vmcnt(5)
	v_smfmac_f32_16x16x64_bf16 v[48:51], v[32:35], a[24:31], v1
	v_smfmac_f32_16x16x64_bf16 v[52:55], v[32:35], a[80:87], v1
	v_smfmac_f32_16x16x64_bf16 v[56:59], v[32:35], a[136:143], v1
	buffer_load_dwordx4 v4, s[4:7], s86 offen offset:2048 sc1 lds
	v_smfmac_f32_16x16x64_bf16 v[60:63], v[32:35], a[192:199], v1
	s_waitcnt vmcnt(5)
	v_smfmac_f32_16x16x64_bf16 v[48:51], v[36:39], a[32:39], v1
	v_smfmac_f32_16x16x64_bf16 v[52:55], v[36:39], a[88:95], v1
	v_mov_b64 v[28:29], 0
	v_smfmac_f32_16x16x64_bf16 v[56:59], v[36:39], a[144:151], v1
	buffer_load_dwordx4 v4, s[4:7], s86 offen offset:3072 sc1 lds
	v_smfmac_f32_16x16x64_bf16 v[60:63], v[36:39], a[200:207], v1
	v_mov_b64 v[30:31], 0
	s_waitcnt vmcnt(5)
	v_smfmac_f32_16x16x64_bf16 v[48:51], v[40:43], a[40:47], v1
	v_smfmac_f32_16x16x64_bf16 v[52:55], v[40:43], a[96:103], v1
	v_smfmac_f32_16x16x64_bf16 v[56:59], v[40:43], a[152:159], v1
	s_mov_b32 m0, 16384
	s_nop 0
	buffer_load_dwordx4 v4, s[4:7], s87 offen offset:0 sc1 lds
	v_smfmac_f32_16x16x64_bf16 v[60:63], v[40:43], a[208:215], v1
	s_waitcnt vmcnt(5)
	v_smfmac_f32_16x16x64_bf16 v[48:51], v[44:47], a[48:55], v1
	v_smfmac_f32_16x16x64_bf16 v[52:55], v[44:47], a[104:111], v1
	buffer_load_dwordx4 v4, s[4:7], s87 offen offset:1024 sc1 lds
	v_smfmac_f32_16x16x64_bf16 v[56:59], v[44:47], a[160:167], v1
	s_nop 0
	v_cmp_u_f32 vcc, v48, v49
	v_smfmac_f32_16x16x64_bf16 v[60:63], v[44:47], a[216:223], v1
	v_cmp_u_f32 s[38:39], v50, v51
	v_smfmac_f32_16x16x64_bf16 v[68:71], v[32:35], v[168:175], v1
	s_or_b64 vcc, vcc, s[38:39]
	s_cbranch_vccnz Lgr_46
Lgo_47:
	v_cvt_pk_bf16_f32 v48, v48, v49
	v_smfmac_f32_16x16x64_bf16 v[68:71], v[36:39], v[176:183], v1
	buffer_load_dwordx4 v4, s[4:7], s87 offen offset:2048 sc1 lds
	v_cvt_pk_bf16_f32 v49, v50, v51
	v_smfmac_f32_16x16x64_bf16 v[68:71], v[40:43], v[184:191], v1
	v_cvt_pk_bf16_f32 v50, v56, v57
	v_smfmac_f32_16x16x64_bf16 v[68:71], v[44:47], v[192:199], v1
	v_cvt_pk_bf16_f32 v51, v58, v59
	v_smfmac_f32_16x16x64_bf16 v[64:67], v[32:35], a[248:255], v1
	buffer_load_dwordx4 v4, s[4:7], s87 offen offset:3072 sc1 lds
	v_cvt_pk_bf16_f32 v52, v52, v53
	v_mfma_f32_16x16x32_bf16 v[16:19], v[48:51], v[12:15], 0
	v_cvt_pk_bf16_f32 v53, v54, v55
	v_cvt_pk_bf16_f32 v54, v60, v61
	v_smfmac_f32_16x16x64_bf16 v[64:67], v[36:39], v[120:127], v1
	v_cvt_pk_bf16_f32 v55, v62, v63
	v_smfmac_f32_16x16x64_bf16 v[64:67], v[40:43], v[128:135], v1
	v_cvt_pk_bf16_f32 v116, v68, v69
	v_mfma_f32_16x16x32_bf16 v[60:63], v[52:55], v[12:15], 0
	v_cvt_pk_bf16_f32 v117, v70, v71
	v_cvt_pk_bf16_f32 v76, v16, v17
	v_smfmac_f32_16x16x64_bf16 v[64:67], v[44:47], v[136:143], v1
	v_cvt_pk_bf16_f32 v77, v18, v19
	v_mfma_f32_16x16x32_bf16 v[68:71], v[116:119], v[12:15], 0
	v_smfmac_f32_16x16x64_bf16 v[72:75], v[32:35], v[224:231], v1
	v_cvt_pk_bf16_f32 v78, v60, v61
	v_smfmac_f32_16x16x64_bf16 v[72:75], v[36:39], v[232:239], v1
	v_cvt_pk_bf16_f32 v79, v62, v63
	v_smfmac_f32_16x16x64_bf16 v[72:75], v[40:43], v[240:247], v1
	v_cvt_pk_bf16_f32 v64, v64, v65
	v_smfmac_f32_16x16x64_bf16 v[72:75], v[44:47], v[248:255], v1
	v_cvt_pk_bf16_f32 v65, v66, v67
	v_smfmac_f32_16x16x64_bf16 v[80:83], v[76:79], v[84:91], v1
	v_cvt_pk_bf16_f32 v26, v68, v69
	v_mfma_f32_16x16x32_bf16 v[48:51], v[76:79], v[20:23], 0
	s_nop 0
	v_cvt_pk_bf16_f32 v66, v72, v73
	v_cvt_pk_bf16_f32 v67, v74, v75
	v_cvt_pk_bf16_f32 v27, v70, v71
	s_nop 0
	v_mfma_f32_16x16x32_bf16 v[16:19], v[64:67], v[12:15], 0
	v_smfmac_f32_16x16x64_bf16 v[28:31], v[76:79], v[92:99], v1
	s_nop 4
	v_cvt_pk_bf16_f32 v24, v16, v17
	v_cvt_pk_bf16_f32 v25, v18, v19
	s_nop 1
	v_mfma_f32_16x16x32_bf16 v[48:51], v[24:27], v[40:43], v[48:51]
	v_smfmac_f32_16x16x64_bf16 v[80:83], v[24:27], v[100:107], v1
	v_smfmac_f32_16x16x64_bf16 v[28:31], v[24:27], v[108:115], v1
	s_nop 0
	v_add_f32_dpp v48, v50, v48 quad_perm:[2,3,0,1] row_mask:0xf bank_mask:0xf
	v_add_f32_dpp v51, v49, v51 quad_perm:[2,3,0,1] row_mask:0xf bank_mask:0xf
	v_cndmask_b32 v48, v48, v51, s[90:91]
	ds_write_b32 v5, v48 offset:1024
	v_pk_add_f32 v[52:53], v[80:81], v[82:83]
	s_nop 1
	v_pk_add_f32 v[54:55], v[28:29], v[30:31]
	ds_write_b128 v4, v[52:55] offset:0
	s_waitcnt lgkmcnt(0)
	s_barrier
	s_nop 15
	s_nop 15
	s_nop 15
	s_waitcnt vmcnt(0)
	ds_read_b128 v[84:87], v4 offset:12288
	ds_read_b128 v[92:95], v4 offset:13312
	ds_read_b128 v[88:91], v4 offset:14336
	ds_read_b128 v[96:99], v4 offset:15360
	ds_read_b128 v[100:103], v4 offset:16384
	ds_read_b128 v[108:111], v4 offset:17408
	ds_read_b128 v[104:107], v4 offset:18432
	ds_read_b128 v[112:115], v4 offset:19456
	s_waitcnt lgkmcnt(0)
	s_add_u32 s26, s26, 8192
	s_add_u32 s27, s27, 8192
	s_add_u32 s86, s86, 32768
	s_add_u32 s87, s87, 32768
	s_add_u32 s88, s88, 32768
	s_add_u32 s14, s14, 458752
	v_mov_b64 v[48:49], 0
	v_mov_b64 v[50:51], 0
	v_mov_b64 v[52:53], 0
	v_mov_b64 v[54:55], 0
	v_mov_b64 v[56:57], 0
	v_mov_b64 v[58:59], 0
	v_mov_b64 v[60:61], 0
	v_mov_b64 v[62:63], 0
	v_mov_b64 v[64:65], 0
	v_mov_b64 v[66:67], 0
	v_mov_b64 v[68:69], 0
	v_mov_b64 v[70:71], 0
	v_mov_b64 v[72:73], 0
	v_mov_b64 v[74:75], 0
	v_mov_b64 v[80:81], 0
	v_mov_b64 v[82:83], 0
	s_nop 15
	s_nop 15
	s_nop 15
	s_nop 1
	s_mov_b64 exec, 0x7fff
Lfl_50:
	buffer_load_dword v7, v5, s[4:7], s30 offen offset:256 sc1
	v_cmp_gt_i32 vcc, s16, v7
	s_cbranch_vccz Lfo_51
	buffer_load_dword v7, v5, s[4:7], s30 offen offset:256 sc1
	v_cmp_gt_i32 vcc, s16, v7
	s_cbranch_vccz Lfo_51
	buffer_load_dword v7, v5, s[4:7], s30 offen offset:256 sc1
	v_cmp_gt_i32 vcc, s16, v7
	s_cbranch_vccz Lfo_51
	buffer_load_dword v7, v5, s[4:7], s30 offen offset:256 sc1
	v_cmp_gt_i32 vcc, s16, v7
	s_cbranch_vccz Lfo_51
	buffer_load_dword v7, v5, s[4:7], s30 offen offset:256 sc1
	v_cmp_gt_i32 vcc, s16, v7
	s_cbranch_vccz Lfo_51
	buffer_load_dword v7, v5, s[4:7], s30 offen offset:256 sc1
	v_cmp_gt_i32 vcc, s16, v7
	s_cbranch_vccz Lfo_51
	buffer_load_dword v7, v5, s[4:7], s30 offen offset:256 sc1
	v_cmp_gt_i32 vcc, s16, v7
	s_cbranch_vccz Lfo_51
	buffer_load_dword v7, v5, s[4:7], s30 offen offset:256 sc1
	v_cmp_gt_i32 vcc, s16, v7
	s_cbranch_vccz Lfo_51
	s_waitcnt vmcnt(40)
	buffer_load_dword v7, v5, s[4:7], s30 offen offset:256 sc1
	v_cmp_gt_i32 vcc, s16, v7
	s_cbranch_vccz Lfo_51
	buffer_load_dword v7, v5, s[4:7], s30 offen offset:256 sc1
	v_cmp_gt_i32 vcc, s16, v7
	s_cbranch_vccz Lfo_51
	buffer_load_dword v7, v5, s[4:7], s30 offen offset:256 sc1
	v_cmp_gt_i32 vcc, s16, v7
	s_cbranch_vccz Lfo_51
	buffer_load_dword v7, v5, s[4:7], s30 offen offset:256 sc1
	v_cmp_gt_i32 vcc, s16, v7
	s_cbranch_vccz Lfo_51
	buffer_load_dword v7, v5, s[4:7], s30 offen offset:256 sc1
	v_cmp_gt_i32 vcc, s16, v7
	s_cbranch_vccz Lfo_51
	buffer_load_dword v7, v5, s[4:7], s30 offen offset:256 sc1
	v_cmp_gt_i32 vcc, s16, v7
	s_cbranch_vccz Lfo_51
	buffer_load_dword v7, v5, s[4:7], s30 offen offset:256 sc1
	v_cmp_gt_i32 vcc, s16, v7
	s_cbranch_vccz Lfo_51
	buffer_load_dword v7, v5, s[4:7], s30 offen offset:256 sc1
	v_cmp_gt_i32 vcc, s16, v7
	s_cbranch_vccz Lfo_51
	s_waitcnt vmcnt(40)
	buffer_load_dword v7, v5, s[4:7], s30 offen offset:256 sc1
	v_cmp_gt_i32 vcc, s16, v7
	s_cbranch_vccz Lfo_51
	buffer_load_dword v7, v5, s[4:7], s30 offen offset:256 sc1
	v_cmp_gt_i32 vcc, s16, v7
	s_cbranch_vccz Lfo_51
	buffer_load_dword v7, v5, s[4:7], s30 offen offset:256 sc1
	v_cmp_gt_i32 vcc, s16, v7
	s_cbranch_vccz Lfo_51
	buffer_load_dword v7, v5, s[4:7], s30 offen offset:256 sc1
	v_cmp_gt_i32 vcc, s16, v7
	s_cbranch_vccz Lfo_51
	buffer_load_dword v7, v5, s[4:7], s30 offen offset:256 sc1
	v_cmp_gt_i32 vcc, s16, v7
	s_cbranch_vccz Lfo_51
	buffer_load_dword v7, v5, s[4:7], s30 offen offset:256 sc1
	v_cmp_gt_i32 vcc, s16, v7
	s_cbranch_vccz Lfo_51
	buffer_load_dword v7, v5, s[4:7], s30 offen offset:256 sc1
	v_cmp_gt_i32 vcc, s16, v7
	s_cbranch_vccz Lfo_51
	buffer_load_dword v7, v5, s[4:7], s30 offen offset:256 sc1
	v_cmp_gt_i32 vcc, s16, v7
	s_cbranch_vccz Lfo_51
	s_waitcnt vmcnt(40)
	s_waitcnt vmcnt(24)
	s_sub_u32 s17, s17, 1
	s_cbranch_scc0 Lfl_50
	s_mov_b32 s17, 0
Lfo_51:
	s_mov_b64 exec, -1
	s_barrier
	s_cmp_lg_u32 s16, 63
	s_cbranch_scc1 Lca_loop1
	s_waitcnt vmcnt(0)
	s_endpgm
Lgr_46:
	s_cmp_eq_u32 s13, 0
	s_cbranch_scc1 Lgo_47
	s_sub_u32 s13, s13, 1
	s_waitcnt vmcnt(0)
	s_nop 7
	buffer_load_dwordx4 v[20:23], v4, s[4:7], s26 offen offset:1024 sc1
	buffer_load_dwordx4 v[24:27], v4, s[4:7], s26 offen offset:0 sc1
	buffer_load_dwordx4 v[28:31], v4, s[4:7], s26 offen offset:2048 sc1
	buffer_load_dwordx4 v[32:35], v4, s[4:7], s27 offen offset:0 sc1
	v_mov_b64 v[48:49], 0
	v_mov_b64 v[50:51], 0
	v_mov_b64 v[52:53], 0
	v_mov_b64 v[54:55], 0
	v_mov_b64 v[56:57], 0
	v_mov_b64 v[58:59], 0
	v_mov_b64 v[60:61], 0
	v_mov_b64 v[62:63], 0
	v_mov_b64 v[64:65], 0
	v_mov_b64 v[66:67], 0
	v_mov_b64 v[68:69], 0
	v_mov_b64 v[70:71], 0
	v_mov_b64 v[72:73], 0
	v_mov_b64 v[74:75], 0
	s_nop 1
	s_branch Lg_45
Lge_48:
	s_cmp_eq_u32 s13, 0
	s_cbranch_scc1 Lgeo_49
	s_sub_u32 s13, s13, 1
	s_waitcnt vmcnt(0)
	s_nop 7
	buffer_load_dwordx4 v[20:23], v4, s[4:7], s26 offen offset:1024 sc1
	buffer_load_dwordx4 v[24:27], v4, s[4:7], s26 offen offset:0 sc1
	buffer_load_dwordx4 v[28:31], v4, s[4:7], s26 offen offset:2048 sc1
	buffer_load_dwordx4 v[32:35], v4, s[4:7], s27 offen offset:0 sc1
	v_mov_b64 v[48:49], 0
	v_mov_b64 v[50:51], 0
	v_mov_b64 v[52:53], 0
	v_mov_b64 v[54:55], 0
	v_mov_b64 v[56:57], 0
	v_mov_b64 v[58:59], 0
	v_mov_b64 v[60:61], 0
	v_mov_b64 v[62:63], 0
	v_mov_b64 v[64:65], 0
	v_mov_b64 v[66:67], 0
	v_mov_b64 v[68:69], 0
	v_mov_b64 v[70:71], 0
	v_mov_b64 v[72:73], 0
	v_mov_b64 v[74:75], 0
	s_nop 1
	s_branch Lg_45
Lca_w2:
	s_mul_i32 s41, s32, 401408
	s_add_u32 s40, s41, 114688
	s_add_u32 s42, s40, 0
	buffer_load_dwordx4 a[0:3], v4, s[4:7], s42 offen offset:0 sc1
	buffer_load_dwordx4 a[4:7], v4, s[4:7], s42 offen offset:1024 sc1
	s_add_u32 s42, s40, 4096
	buffer_load_dwordx4 a[28:31], v4, s[4:7], s42 offen offset:3072 sc1
	s_add_u32 s42, s40, 8192
	buffer_load_dwordx4 a[32:35], v4, s[4:7], s42 offen offset:0 sc1
	s_add_u32 s40, s41, 143360
	s_add_u32 s42, s40, 0
	buffer_load_dwordx4 a[56:59], v4, s[4:7], s42 offen offset:0 sc1
	buffer_load_dwordx4 a[60:63], v4, s[4:7], s42 offen offset:1024 sc1
	s_add_u32 s42, s40, 4096
	buffer_load_dwordx4 a[84:87], v4, s[4:7], s42 offen offset:3072 sc1
	s_add_u32 s42, s40, 8192
	buffer_load_dwordx4 a[88:91], v4, s[4:7], s42 offen offset:0 sc1
	s_add_u32 s40, s41, 129024
	s_add_u32 s42, s40, 0
	buffer_load_dwordx4 a[112:115], v4, s[4:7], s42 offen offset:0 sc1
	buffer_load_dwordx4 a[116:119], v4, s[4:7], s42 offen offset:1024 sc1
	s_add_u32 s42, s40, 4096
	buffer_load_dwordx4 a[140:143], v4, s[4:7], s42 offen offset:3072 sc1
	s_waitcnt vmcnt(10)
	s_add_u32 s42, s40, 8192
	buffer_load_dwordx4 a[144:147], v4, s[4:7], s42 offen offset:0 sc1
	s_add_u32 s40, s41, 157696
	s_add_u32 s42, s40, 0
	buffer_load_dwordx4 a[168:171], v4, s[4:7], s42 offen offset:0 sc1
	s_waitcnt vmcnt(10)
	buffer_load_dwordx4 a[172:175], v4, s[4:7], s42 offen offset:1024 sc1
	s_add_u32 s42, s40, 4096
	buffer_load_dwordx4 a[196:199], v4, s[4:7], s42 offen offset:3072 sc1
	s_waitcnt vmcnt(10)
	s_add_u32 s42, s40, 8192
	buffer_load_dwordx4 a[200:203], v4, s[4:7], s42 offen offset:0 sc1
	s_add_u32 s40, s41, 344064
	s_add_u32 s42, s40, 0
	buffer_load_dwordx4 a[224:227], v4, s[4:7], s42 offen offset:0 sc1
	s_waitcnt vmcnt(10)
	buffer_load_dwordx4 a[228:231], v4, s[4:7], s42 offen offset:1024 sc1
	s_add_u32 s42, s40, 4096
	buffer_load_dwordx4 a[252:255], v4, s[4:7], s42 offen offset:3072 sc1
	s_waitcnt vmcnt(10)
	s_add_u32 s42, s40, 8192
	buffer_load_dwordx4 v[120:123], v4, s[4:7], s42 offen offset:0 sc1
	s_add_u32 s40, s41, 372736
	s_add_u32 s42, s40, 0
	buffer_load_dwordx4 v[144:147], v4, s[4:7], s42 offen offset:0 sc1
	s_waitcnt vmcnt(10)
	buffer_load_dwordx4 v[148:151], v4, s[4:7], s42 offen offset:1024 sc1
	s_add_u32 s42, s40, 4096
	buffer_load_dwordx4 v[172:175], v4, s[4:7], s42 offen offset:3072 sc1
	s_waitcnt vmcnt(10)
	s_add_u32 s42, s40, 8192
	buffer_load_dwordx4 v[176:179], v4, s[4:7], s42 offen offset:0 sc1
	s_add_u32 s40, s41, 358400
	s_add_u32 s42, s40, 0
	buffer_load_dwordx4 v[200:203], v4, s[4:7], s42 offen offset:0 sc1
	s_waitcnt vmcnt(10)
	buffer_load_dwordx4 v[204:207], v4, s[4:7], s42 offen offset:1024 sc1
	s_add_u32 s42, s40, 4096
	buffer_load_dwordx4 v[228:231], v4, s[4:7], s42 offen offset:3072 sc1
	s_waitcnt vmcnt(10)
	s_add_u32 s42, s40, 8192
	buffer_load_dwordx4 v[232:235], v4, s[4:7], s42 offen offset:0 sc1
	s_mov_b32 s40, 0x100000
Lww_52:
	buffer_load_dword v25, v24, s[4:7], s34 offen sc1
	s_sub_u32 s40, s40, 1
	s_cbranch_scc1 Lwx_53
	s_waitcnt vmcnt(0)
	v_cmp_gt_u32 vcc, 7, v25
	s_cbranch_vccnz Lww_52
Lwx_53:
	s_waitcnt vmcnt(0)
	s_add_u32 s40, s41, 114688
	s_add_u32 s42, s40, 0
	buffer_load_dwordx4 a[8:11], v4, s[4:7], s42 offen offset:2048 sc1
	s_waitcnt vmcnt(10)
	buffer_load_dwordx4 a[12:15], v4, s[4:7], s42 offen offset:3072 sc1
	s_add_u32 s42, s40, 4096
	buffer_load_dwordx4 a[16:19], v4, s[4:7], s42 offen offset:0 sc1
	s_waitcnt vmcnt(10)
	buffer_load_dwordx4 a[20:23], v4, s[4:7], s42 offen offset:1024 sc1
	buffer_load_dwordx4 a[24:27], v4, s[4:7], s42 offen offset:2048 sc1
	s_waitcnt vmcnt(10)
	s_add_u32 s42, s40, 8192
	buffer_load_dwordx4 a[36:39], v4, s[4:7], s42 offen offset:1024 sc1
	buffer_load_dwordx4 a[40:43], v4, s[4:7], s42 offen offset:2048 sc1
	s_waitcnt vmcnt(10)
	buffer_load_dwordx4 a[44:47], v4, s[4:7], s42 offen offset:3072 sc1
	s_add_u32 s42, s40, 12288
	buffer_load_dwordx4 a[48:51], v4, s[4:7], s42 offen offset:0 sc1
	s_waitcnt vmcnt(10)
	buffer_load_dwordx4 a[52:55], v4, s[4:7], s42 offen offset:1024 sc1
	s_add_u32 s40, s41, 143360
	s_add_u32 s42, s40, 0
	buffer_load_dwordx4 a[64:67], v4, s[4:7], s42 offen offset:2048 sc1
	s_waitcnt vmcnt(10)
	buffer_load_dwordx4 a[68:71], v4, s[4:7], s42 offen offset:3072 sc1
	s_add_u32 s42, s40, 4096
	buffer_load_dwordx4 a[72:75], v4, s[4:7], s42 offen offset:0 sc1
	s_waitcnt vmcnt(10)
	buffer_load_dwordx4 a[76:79], v4, s[4:7], s42 offen offset:1024 sc1
	buffer_load_dwordx4 a[80:83], v4, s[4:7], s42 offen offset:2048 sc1
	s_waitcnt vmcnt(10)
	s_add_u32 s42, s40, 8192
	buffer_load_dwordx4 a[92:95], v4, s[4:7], s42 offen offset:1024 sc1
	buffer_load_dwordx4 a[96:99], v4, s[4:7], s42 offen offset:2048 sc1
	s_waitcnt vmcnt(10)
	buffer_load_dwordx4 a[100:103], v4, s[4:7], s42 offen offset:3072 sc1
	s_add_u32 s42, s40, 12288
	buffer_load_dwordx4 a[104:107], v4, s[4:7], s42 offen offset:0 sc1
	s_waitcnt vmcnt(10)
	buffer_load_dwordx4 a[108:111], v4, s[4:7], s42 offen offset:1024 sc1
	s_add_u32 s40, s41, 129024
	s_add_u32 s42, s40, 0
	buffer_load_dwordx4 a[120:123], v4, s[4:7], s42 offen offset:2048 sc1
	s_waitcnt vmcnt(10)
	buffer_load_dwordx4 a[124:127], v4, s[4:7], s42 offen offset:3072 sc1
	s_add_u32 s42, s40, 4096
	buffer_load_dwordx4 a[128:131], v4, s[4:7], s42 offen offset:0 sc1
	s_waitcnt vmcnt(10)
	buffer_load_dwordx4 a[132:135], v4, s[4:7], s42 offen offset:1024 sc1
	buffer_load_dwordx4 a[136:139], v4, s[4:7], s42 offen offset:2048 sc1
	s_waitcnt vmcnt(10)
	s_add_u32 s42, s40, 8192
	buffer_load_dwordx4 a[148:151], v4, s[4:7], s42 offen offset:1024 sc1
	buffer_load_dwordx4 a[152:155], v4, s[4:7], s42 offen offset:2048 sc1
	s_waitcnt vmcnt(10)
	buffer_load_dwordx4 a[156:159], v4, s[4:7], s42 offen offset:3072 sc1
	s_add_u32 s42, s40, 12288
	buffer_load_dwordx4 a[160:163], v4, s[4:7], s42 offen offset:0 sc1
	s_waitcnt vmcnt(10)
	buffer_load_dwordx4 a[164:167], v4, s[4:7], s42 offen offset:1024 sc1
	s_add_u32 s40, s41, 157696
	s_add_u32 s42, s40, 0
	buffer_load_dwordx4 a[176:179], v4, s[4:7], s42 offen offset:2048 sc1
	s_waitcnt vmcnt(10)
	buffer_load_dwordx4 a[180:183], v4, s[4:7], s42 offen offset:3072 sc1
	s_add_u32 s42, s40, 4096
	buffer_load_dwordx4 a[184:187], v4, s[4:7], s42 offen offset:0 sc1
	s_waitcnt vmcnt(10)
	buffer_load_dwordx4 a[188:191], v4, s[4:7], s42 offen offset:1024 sc1
	buffer_load_dwordx4 a[192:195], v4, s[4:7], s42 offen offset:2048 sc1
	s_waitcnt vmcnt(10)
	s_add_u32 s42, s40, 8192
	buffer_load_dwordx4 a[204:207], v4, s[4:7], s42 offen offset:1024 sc1
	buffer_load_dwordx4 a[208:211], v4, s[4:7], s42 offen offset:2048 sc1
	s_waitcnt vmcnt(10)
	buffer_load_dwordx4 a[212:215], v4, s[4:7], s42 offen offset:3072 sc1
	s_add_u32 s42, s40, 12288
	buffer_load_dwordx4 a[216:219], v4, s[4:7], s42 offen offset:0 sc1
	s_waitcnt vmcnt(10)
	buffer_load_dwordx4 a[220:223], v4, s[4:7], s42 offen offset:1024 sc1
	s_add_u32 s40, s41, 344064
	s_add_u32 s42, s40, 0
	buffer_load_dwordx4 a[232:235], v4, s[4:7], s42 offen offset:2048 sc1
	s_waitcnt vmcnt(10)
	buffer_load_dwordx4 a[236:239], v4, s[4:7], s42 offen offset:3072 sc1
	s_add_u32 s42, s40, 4096
	buffer_load_dwordx4 a[240:243], v4, s[4:7], s42 offen offset:0 sc1
	s_waitcnt vmcnt(10)
	buffer_load_dwordx4 a[244:247], v4, s[4:7], s42 offen offset:1024 sc1
	buffer_load_dwordx4 a[248:251], v4, s[4:7], s42 offen offset:2048 sc1
	s_waitcnt vmcnt(10)
	s_add_u32 s42, s40, 8192
	buffer_load_dwordx4 v[124:127], v4, s[4:7], s42 offen offset:1024 sc1
	buffer_load_dwordx4 v[128:131], v4, s[4:7], s42 offen offset:2048 sc1
	s_waitcnt vmcnt(10)
	buffer_load_dwordx4 v[132:135], v4, s[4:7], s42 offen offset:3072 sc1
	s_add_u32 s42, s40, 12288
	buffer_load_dwordx4 v[136:139], v4, s[4:7], s42 offen offset:0 sc1
	s_waitcnt vmcnt(10)
	buffer_load_dwordx4 v[140:143], v4, s[4:7], s42 offen offset:1024 sc1
	s_add_u32 s40, s41, 372736
	s_add_u32 s42, s40, 0
	buffer_load_dwordx4 v[152:155], v4, s[4:7], s42 offen offset:2048 sc1
	s_waitcnt vmcnt(10)
	buffer_load_dwordx4 v[156:159], v4, s[4:7], s42 offen offset:3072 sc1
	s_add_u32 s42, s40, 4096
	buffer_load_dwordx4 v[160:163], v4, s[4:7], s42 offen offset:0 sc1
	s_waitcnt vmcnt(10)
	buffer_load_dwordx4 v[164:167], v4, s[4:7], s42 offen offset:1024 sc1
	buffer_load_dwordx4 v[168:171], v4, s[4:7], s42 offen offset:2048 sc1
	s_waitcnt vmcnt(10)
	s_add_u32 s42, s40, 8192
	buffer_load_dwordx4 v[180:183], v4, s[4:7], s42 offen offset:1024 sc1
	buffer_load_dwordx4 v[184:187], v4, s[4:7], s42 offen offset:2048 sc1
	s_waitcnt vmcnt(10)
	buffer_load_dwordx4 v[188:191], v4, s[4:7], s42 offen offset:3072 sc1
	s_add_u32 s42, s40, 12288
	buffer_load_dwordx4 v[192:195], v4, s[4:7], s42 offen offset:0 sc1
	s_waitcnt vmcnt(10)
	buffer_load_dwordx4 v[196:199], v4, s[4:7], s42 offen offset:1024 sc1
	s_add_u32 s40, s41, 358400
	s_add_u32 s42, s40, 0
	buffer_load_dwordx4 v[208:211], v4, s[4:7], s42 offen offset:2048 sc1
	s_waitcnt vmcnt(10)
	buffer_load_dwordx4 v[212:215], v4, s[4:7], s42 offen offset:3072 sc1
	s_add_u32 s42, s40, 4096
	buffer_load_dwordx4 v[216:219], v4, s[4:7], s42 offen offset:0 sc1
	s_waitcnt vmcnt(10)
	buffer_load_dwordx4 v[220:223], v4, s[4:7], s42 offen offset:1024 sc1
	buffer_load_dwordx4 v[224:227], v4, s[4:7], s42 offen offset:2048 sc1
	s_waitcnt vmcnt(10)
	s_add_u32 s42, s40, 8192
	buffer_load_dwordx4 v[236:239], v4, s[4:7], s42 offen offset:1024 sc1
	buffer_load_dwordx4 v[240:243], v4, s[4:7], s42 offen offset:2048 sc1
	s_waitcnt vmcnt(10)
	buffer_load_dwordx4 v[244:247], v4, s[4:7], s42 offen offset:3072 sc1
	s_add_u32 s42, s40, 12288
	buffer_load_dwordx4 v[248:251], v4, s[4:7], s42 offen offset:0 sc1
	s_waitcnt vmcnt(10)
	buffer_load_dwordx4 v[252:255], v4, s[4:7], s42 offen offset:1024 sc1
	s_mov_b32 s41, 60268544
	s_mov_b32 s40, 0x100000
Lww_54:
	buffer_load_dword v25, v24, s[4:7], s41 offen sc1
	s_sub_u32 s40, s40, 1
	s_cbranch_scc1 Lwx_55
	s_waitcnt vmcnt(0)
	v_cmp_gt_u32 vcc, 64, v25
	s_cbranch_vccnz Lww_54
Lwx_55:
	s_waitcnt vmcnt(0)
	s_add_u32 s86, s15, 16384
	s_add_u32 s87, s15, 20480
	buffer_load_dwordx4 v[84:87], v4, s[4:7], s86 offen offset:0 sc1
	buffer_load_dwordx4 v[88:91], v4, s[4:7], s86 offen offset:2048 sc1
	buffer_load_dwordx4 v[100:103], v4, s[4:7], s87 offen offset:0 sc1
	buffer_load_dwordx4 v[104:107], v4, s[4:7], s87 offen offset:2048 sc1
	buffer_load_dwordx4 v[92:95], v4, s[4:7], s86 offen offset:1024 sc1
	buffer_load_dwordx4 v[96:99], v4, s[4:7], s86 offen offset:3072 sc1
	buffer_load_dwordx4 v[108:111], v4, s[4:7], s87 offen offset:1024 sc1
	buffer_load_dwordx4 v[112:115], v4, s[4:7], s87 offen offset:3072 sc1
	s_mov_b32 s88, s87
	s_add_u32 s86, s86, 32768
	s_add_u32 s87, s87, 32768
	v_mov_b64 v[48:49], 0
	v_mov_b64 v[50:51], 0
	v_mov_b64 v[52:53], 0
	v_mov_b64 v[54:55], 0
	v_mov_b64 v[56:57], 0
	v_mov_b64 v[58:59], 0
	v_mov_b64 v[60:61], 0
	v_mov_b64 v[62:63], 0
	v_mov_b64 v[64:65], 0
	v_mov_b64 v[66:67], 0
	v_mov_b64 v[68:69], 0
	v_mov_b64 v[70:71], 0
	v_mov_b64 v[72:73], 0
	v_mov_b64 v[74:75], 0
	v_mov_b64 v[80:81], 0
	v_mov_b64 v[82:83], 0
	s_waitcnt vmcnt(0)
	s_barrier
.p2align 6
Lca_loop2:
	buffer_load_dwordx4 v[20:23], v4, s[4:7], s26 offen offset:0
	s_nop 2
	buffer_load_dwordx4 v[24:27], v4, s[4:7], s26 offen offset:1024
	s_nop 2
	buffer_load_dwordx4 v[28:31], v4, s[4:7], s26 offen offset:2048
	s_nop 15
	s_nop 13
	buffer_load_dwordx4 v[32:35], v4, s[4:7], s26 offen offset:3072
	s_add_u32 s16, s16, 1
	v_mov_b32 v8, s16
Lg_56:
	s_waitcnt vmcnt(3)
	v_smfmac_f32_16x16x64_bf16 v[48:51], v[20:23], a[0:7], v1
	v_smfmac_f32_16x16x64_bf16 v[52:55], v[20:23], a[56:63], v1
	buffer_load_dwordx4 v[36:39], v4, s[4:7], s27 offen offset:0 sc1
	v_smfmac_f32_16x16x64_bf16 v[56:59], v[20:23], a[112:119], v1
	v_smfmac_f32_16x16x64_bf16 v[60:63], v[20:23], a[168:175], v1
	buffer_load_dwordx4 v[40:43], v4, s[4:7], s27 offen offset:1024 sc1
	v_smfmac_f32_16x16x64_bf16 v[64:67], v[20:23], a[224:231], v1
	v_smfmac_f32_16x16x64_bf16 v[68:71], v[20:23], v[144:151], v1
	buffer_load_dwordx4 v[44:47], v4, s[4:7], s27 offen offset:2048 sc1
	v_smfmac_f32_16x16x64_bf16 v[72:75], v[20:23], v[200:207], v1
	s_waitcnt vmcnt(5)
	v_smfmac_f32_16x16x64_bf16 v[48:51], v[24:27], a[8:15], v1
	v_smfmac_f32_16x16x64_bf16 v[52:55], v[24:27], a[64:71], v1
	v_smfmac_f32_16x16x64_bf16 v[56:59], v[24:27], a[120:127], v1
	s_nop 0
	v_cmp_u_f32 vcc, v48, v49
	v_smfmac_f32_16x16x64_bf16 v[60:63], v[24:27], a[176:183], v1
	v_cmp_u_f32 s[38:39], v50, v51
	v_smfmac_f32_16x16x64_bf16 v[64:67], v[24:27], a[232:239], v1
	v_smfmac_f32_16x16x64_bf16 v[68:71], v[24:27], v[152:159], v1
	v_smfmac_f32_16x16x64_bf16 v[72:75], v[24:27], v[208:215], v1
	s_waitcnt vmcnt(4)
	v_smfmac_f32_16x16x64_bf16 v[48:51], v[28:31], a[16:23], v1
	s_or_b64 vcc, vcc, s[38:39]
	s_cbranch_vccnz Lge_59
Lgeo_60:
	v_smfmac_f32_16x16x64_bf16 v[52:55], v[28:31], a[72:79], v1
	v_smfmac_f32_16x16x64_bf16 v[56:59], v[28:31], a[128:135], v1
	s_mov_b32 m0, 20480
	s_nop 0
	buffer_load_dwordx4 v4, s[4:7], s86 offen offset:0 sc1 lds
	v_smfmac_f32_16x16x64_bf16 v[60:63], v[28:31], a[184:191], v1
	v_smfmac_f32_16x16x64_bf16 v[64:67], v[28:31], a[240:247], v1
	v_smfmac_f32_16x16x64_bf16 v[68:71], v[28:31], v[160:167], v1
	v_smfmac_f32_16x16x64_bf16 v[72:75], v[28:31], v[216:223], v1
	buffer_load_dwordx4 v4, s[4:7], s86 offen offset:1024 sc1 lds
	s_waitcnt vmcnt(5)
	v_smfmac_f32_16x16x64_bf16 v[48:51], v[32:35], a[24:31], v1
	v_smfmac_f32_16x16x64_bf16 v[52:55], v[32:35], a[80:87], v1
	v_smfmac_f32_16x16x64_bf16 v[56:59], v[32:35], a[136:143], v1
	buffer_load_dwordx4 v4, s[4:7], s86 offen offset:2048 sc1 lds
	v_smfmac_f32_16x16x64_bf16 v[60:63], v[32:35], a[192:199], v1
	s_waitcnt vmcnt(5)
	v_smfmac_f32_16x16x64_bf16 v[48:51], v[36:39], a[32:39], v1
	v_smfmac_f32_16x16x64_bf16 v[52:55], v[36:39], a[88:95], v1
	v_mov_b64 v[24:25], 0
	v_smfmac_f32_16x16x64_bf16 v[56:59], v[36:39], a[144:151], v1
	buffer_load_dwordx4 v4, s[4:7], s86 offen offset:3072 sc1 lds
	v_smfmac_f32_16x16x64_bf16 v[60:63], v[36:39], a[200:207], v1
	v_mov_b64 v[26:27], 0
	s_waitcnt vmcnt(5)
	v_smfmac_f32_16x16x64_bf16 v[48:51], v[40:43], a[40:47], v1
	v_smfmac_f32_16x16x64_bf16 v[52:55], v[40:43], a[96:103], v1
	v_smfmac_f32_16x16x64_bf16 v[56:59], v[40:43], a[152:159], v1
	s_mov_b32 m0, 24576
	s_nop 0
	buffer_load_dwordx4 v4, s[4:7], s87 offen offset:0 sc1 lds
	v_smfmac_f32_16x16x64_bf16 v[60:63], v[40:43], a[208:215], v1
	s_waitcnt vmcnt(5)
	v_smfmac_f32_16x16x64_bf16 v[48:51], v[44:47], a[48:55], v1
	v_smfmac_f32_16x16x64_bf16 v[52:55], v[44:47], a[104:111], v1
	buffer_load_dwordx4 v4, s[4:7], s87 offen offset:1024 sc1 lds
	v_smfmac_f32_16x16x64_bf16 v[56:59], v[44:47], a[160:167], v1
	s_nop 0
	v_cmp_u_f32 vcc, v48, v49
	v_smfmac_f32_16x16x64_bf16 v[60:63], v[44:47], a[216:223], v1
	v_cmp_u_f32 s[38:39], v50, v51
	v_smfmac_f32_16x16x64_bf16 v[68:71], v[32:35], v[168:175], v1
	s_or_b64 vcc, vcc, s[38:39]
	s_cbranch_vccnz Lgr_57
Lgo_58:
	v_cvt_pk_bf16_f32 v48, v48, v49
	v_smfmac_f32_16x16x64_bf16 v[68:71], v[36:39], v[176:183], v1
	buffer_load_dwordx4 v4, s[4:7], s87 offen offset:2048 sc1 lds
	v_cvt_pk_bf16_f32 v49, v50, v51
	v_smfmac_f32_16x16x64_bf16 v[68:71], v[40:43], v[184:191], v1
	v_cvt_pk_bf16_f32 v50, v56, v57
	v_smfmac_f32_16x16x64_bf16 v[68:71], v[44:47], v[192:199], v1
	v_cvt_pk_bf16_f32 v51, v58, v59
	v_smfmac_f32_16x16x64_bf16 v[64:67], v[32:35], a[248:255], v1
	buffer_load_dwordx4 v4, s[4:7], s87 offen offset:3072 sc1 lds
	v_cvt_pk_bf16_f32 v52, v52, v53
	v_mfma_f32_16x16x32_bf16 v[16:19], v[48:51], v[12:15], 0
	v_cvt_pk_bf16_f32 v53, v54, v55
	v_cvt_pk_bf16_f32 v54, v60, v61
	v_smfmac_f32_16x16x64_bf16 v[64:67], v[36:39], v[120:127], v1
	v_cvt_pk_bf16_f32 v55, v62, v63
	v_smfmac_f32_16x16x64_bf16 v[64:67], v[40:43], v[128:135], v1
	v_cvt_pk_bf16_f32 v116, v68, v69
	v_mfma_f32_16x16x32_bf16 v[60:63], v[52:55], v[12:15], 0
	v_cvt_pk_bf16_f32 v117, v70, v71
	v_cvt_pk_bf16_f32 v76, v16, v17
	v_smfmac_f32_16x16x64_bf16 v[64:67], v[44:47], v[136:143], v1
	v_cvt_pk_bf16_f32 v77, v18, v19
	v_mfma_f32_16x16x32_bf16 v[68:71], v[116:119], v[12:15], 0
	v_smfmac_f32_16x16x64_bf16 v[72:75], v[32:35], v[224:231], v1
	v_cvt_pk_bf16_f32 v78, v60, v61
	v_smfmac_f32_16x16x64_bf16 v[72:75], v[36:39], v[232:239], v1
	v_cvt_pk_bf16_f32 v79, v62, v63
	v_smfmac_f32_16x16x64_bf16 v[72:75], v[40:43], v[240:247], v1
	v_cvt_pk_bf16_f32 v64, v64, v65
	v_smfmac_f32_16x16x64_bf16 v[72:75], v[44:47], v[248:255], v1
	v_cvt_pk_bf16_f32 v65, v66, v67
	v_smfmac_f32_16x16x64_bf16 v[80:83], v[76:79], v[84:91], v1
	v_cvt_pk_bf16_f32 v22, v68, v69
	v_mfma_f32_16x16x32_bf16 v[48:51], v[76:79], v[28:31], 0
	s_nop 0
	v_cvt_pk_bf16_f32 v66, v72, v73
	v_cvt_pk_bf16_f32 v67, v74, v75
	v_cvt_pk_bf16_f32 v23, v70, v71
	s_nop 0
	v_mfma_f32_16x16x32_bf16 v[16:19], v[64:67], v[12:15], 0
	v_smfmac_f32_16x16x64_bf16 v[24:27], v[76:79], v[92:99], v1
	s_nop 4
	v_cvt_pk_bf16_f32 v20, v16, v17
	v_cvt_pk_bf16_f32 v21, v18, v19
	s_nop 1
	v_mfma_f32_16x16x32_bf16 v[48:51], v[20:23], v[44:47], v[48:51]
	v_smfmac_f32_16x16x64_bf16 v[80:83], v[20:23], v[100:107], v1
	v_smfmac_f32_16x16x64_bf16 v[24:27], v[20:23], v[108:115], v1
	s_nop 0
	v_add_f32_dpp v48, v50, v48 quad_perm:[2,3,0,1] row_mask:0xf bank_mask:0xf
	v_add_f32_dpp v51, v49, v51 quad_perm:[2,3,0,1] row_mask:0xf bank_mask:0xf
	v_cndmask_b32 v48, v48, v51, s[90:91]
	ds_write_b32 v5, v48 offset:2304
	v_pk_add_f32 v[52:53], v[80:81], v[82:83]
	s_nop 1
	v_pk_add_f32 v[54:55], v[24:25], v[26:27]
	ds_write_b128 v4, v[52:55] offset:1280
	s_waitcnt lgkmcnt(0)
	s_barrier
	s_nop 15
	s_nop 15
	s_nop 15
	s_waitcnt vmcnt(0)
	ds_read_b128 v[84:87], v4 offset:20480
	ds_read_b128 v[92:95], v4 offset:21504
	ds_read_b128 v[88:91], v4 offset:22528
	ds_read_b128 v[96:99], v4 offset:23552
	ds_read_b128 v[100:103], v4 offset:24576
	ds_read_b128 v[108:111], v4 offset:25600
	ds_read_b128 v[104:107], v4 offset:26624
	ds_read_b128 v[112:115], v4 offset:27648
	s_waitcnt lgkmcnt(0)
	s_add_u32 s26, s26, 8192
	s_add_u32 s27, s27, 8192
	s_add_u32 s86, s86, 32768
	s_add_u32 s87, s87, 32768
	s_add_u32 s88, s88, 32768
	s_add_u32 s14, s14, 458752
	v_mov_b64 v[48:49], 0
	v_mov_b64 v[50:51], 0
	v_mov_b64 v[52:53], 0
	v_mov_b64 v[54:55], 0
	v_mov_b64 v[56:57], 0
	v_mov_b64 v[58:59], 0
	v_mov_b64 v[60:61], 0
	v_mov_b64 v[62:63], 0
	v_mov_b64 v[64:65], 0
	v_mov_b64 v[66:67], 0
	v_mov_b64 v[68:69], 0
	v_mov_b64 v[70:71], 0
	v_mov_b64 v[72:73], 0
	v_mov_b64 v[74:75], 0
	v_mov_b64 v[80:81], 0
	v_mov_b64 v[82:83], 0
	s_barrier
	s_cmp_lg_u32 s16, 63
	s_cbranch_scc1 Lca_loop2
	s_waitcnt vmcnt(0)
	s_endpgm
Lgr_57:
	s_cmp_eq_u32 s13, 0
	s_cbranch_scc1 Lgo_58
	s_sub_u32 s13, s13, 1
	s_waitcnt vmcnt(0)
	s_nop 7
	buffer_load_dwordx4 v[20:23], v4, s[4:7], s26 offen offset:0 sc1
	buffer_load_dwordx4 v[24:27], v4, s[4:7], s26 offen offset:1024 sc1
	buffer_load_dwordx4 v[28:31], v4, s[4:7], s26 offen offset:2048 sc1
	buffer_load_dwordx4 v[32:35], v4, s[4:7], s26 offen offset:3072 sc1
	v_mov_b64 v[48:49], 0
	v_mov_b64 v[50:51], 0
	v_mov_b64 v[52:53], 0
	v_mov_b64 v[54:55], 0
	v_mov_b64 v[56:57], 0
	v_mov_b64 v[58:59], 0
	v_mov_b64 v[60:61], 0
	v_mov_b64 v[62:63], 0
	v_mov_b64 v[64:65], 0
	v_mov_b64 v[66:67], 0
	v_mov_b64 v[68:69], 0
	v_mov_b64 v[70:71], 0
	v_mov_b64 v[72:73], 0
	v_mov_b64 v[74:75], 0
	s_nop 1
	s_branch Lg_56
Lge_59:
	s_cmp_eq_u32 s13, 0
	s_cbranch_scc1 Lgeo_60
	s_sub_u32 s13, s13, 1
	s_waitcnt vmcnt(0)
	s_nop 7
	buffer_load_dwordx4 v[20:23], v4, s[4:7], s26 offen offset:0 sc1
	buffer_load_dwordx4 v[24:27], v4, s[4:7], s26 offen offset:1024 sc1
	buffer_load_dwordx4 v[28:31], v4, s[4:7], s26 offen offset:2048 sc1
	buffer_load_dwordx4 v[32:35], v4, s[4:7], s26 offen offset:3072 sc1
	v_mov_b64 v[48:49], 0
	v_mov_b64 v[50:51], 0
	v_mov_b64 v[52:53], 0
	v_mov_b64 v[54:55], 0
	v_mov_b64 v[56:57], 0
	v_mov_b64 v[58:59], 0
	v_mov_b64 v[60:61], 0
	v_mov_b64 v[62:63], 0
	v_mov_b64 v[64:65], 0
	v_mov_b64 v[66:67], 0
	v_mov_b64 v[68:69], 0
	v_mov_b64 v[70:71], 0
	v_mov_b64 v[72:73], 0
	v_mov_b64 v[74:75], 0
	s_nop 1
	s_branch Lg_56
Lca_w3:
	s_mul_i32 s41, s32, 401408
	s_add_u32 s40, s41, 172032
	s_add_u32 s42, s40, 0
	buffer_load_dwordx4 a[8:11], v4, s[4:7], s42 offen offset:0 sc1
	buffer_load_dwordx4 a[12:15], v4, s[4:7], s42 offen offset:1024 sc1
	s_add_u32 s42, s40, 4096
	buffer_load_dwordx4 a[36:39], v4, s[4:7], s42 offen offset:3072 sc1
	s_add_u32 s42, s40, 8192
	buffer_load_dwordx4 a[24:27], v4, s[4:7], s42 offen offset:0 sc1
	s_add_u32 s40, s41, 200704
	s_add_u32 s42, s40, 0
	buffer_load_dwordx4 a[64:67], v4, s[4:7], s42 offen offset:0 sc1
	buffer_load_dwordx4 a[68:71], v4, s[4:7], s42 offen offset:1024 sc1
	s_add_u32 s42, s40, 4096
	buffer_load_dwordx4 a[92:95], v4, s[4:7], s42 offen offset:3072 sc1
	s_add_u32 s42, s40, 8192
	buffer_load_dwordx4 a[80:83], v4, s[4:7], s42 offen offset:0 sc1
	s_add_u32 s40, s41, 186368
	s_add_u32 s42, s40, 0
	buffer_load_dwordx4 a[120:123], v4, s[4:7], s42 offen offset:0 sc1
	buffer_load_dwordx4 a[124:127], v4, s[4:7], s42 offen offset:1024 sc1
	s_add_u32 s42, s40, 4096
	buffer_load_dwordx4 a[148:151], v4, s[4:7], s42 offen offset:3072 sc1
	s_waitcnt vmcnt(10)
	s_add_u32 s42, s40, 8192
	buffer_load_dwordx4 a[136:139], v4, s[4:7], s42 offen offset:0 sc1
	s_add_u32 s40, s41, 215040
	s_add_u32 s42, s40, 0
	buffer_load_dwordx4 a[176:179], v4, s[4:7], s42 offen offset:0 sc1
	s_waitcnt vmcnt(10)
	buffer_load_dwordx4 a[180:183], v4, s[4:7], s42 offen offset:1024 sc1
	s_add_u32 s42, s40, 4096
	buffer_load_dwordx4 a[204:207], v4, s[4:7], s42 offen offset:3072 sc1
	s_waitcnt vmcnt(10)
	s_add_u32 s42, s40, 8192
	buffer_load_dwordx4 a[192:195], v4, s[4:7], s42 offen offset:0 sc1
	s_add_u32 s40, s41, 272384
	s_add_u32 s42, s40, 0
	buffer_load_dwordx4 a[232:235], v4, s[4:7], s42 offen offset:0 sc1
	s_waitcnt vmcnt(10)
	buffer_load_dwordx4 a[236:239], v4, s[4:7], s42 offen offset:1024 sc1
	s_add_u32 s42, s40, 4096
	buffer_load_dwordx4 v[124:127], v4, s[4:7], s42 offen offset:3072 sc1
	s_waitcnt vmcnt(10)
	s_add_u32 s42, s40, 8192
	buffer_load_dwordx4 a[248:251], v4, s[4:7], s42 offen offset:0 sc1
	s_add_u32 s40, s41, 387072
	s_add_u32 s42, s40, 0
	buffer_load_dwordx4 v[152:155], v4, s[4:7], s42 offen offset:0 sc1
	s_waitcnt vmcnt(10)
	buffer_load_dwordx4 v[156:159], v4, s[4:7], s42 offen offset:1024 sc1
	s_add_u32 s42, s40, 4096
	buffer_load_dwordx4 v[180:183], v4, s[4:7], s42 offen offset:3072 sc1
	s_waitcnt vmcnt(10)
	s_add_u32 s42, s40, 8192
	buffer_load_dwordx4 v[168:171], v4, s[4:7], s42 offen offset:0 sc1
	s_add_u32 s40, s41, 329728
	s_add_u32 s42, s40, 0
	buffer_load_dwordx4 v[208:211], v4, s[4:7], s42 offen offset:0 sc1
	s_waitcnt vmcnt(10)
	buffer_load_dwordx4 v[212:215], v4, s[4:7], s42 offen offset:1024 sc1
	s_add_u32 s42, s40, 4096
	buffer_load_dwordx4 v[236:239], v4, s[4:7], s42 offen offset:3072 sc1
	s_waitcnt vmcnt(10)
	s_add_u32 s42, s40, 8192
	buffer_load_dwordx4 v[224:227], v4, s[4:7], s42 offen offset:0 sc1
	s_mov_b32 s40, 0x100000
Lww_61:
	buffer_load_dword v25, v24, s[4:7], s34 offen sc1
	s_sub_u32 s40, s40, 1
	s_cbranch_scc1 Lwx_62
	s_waitcnt vmcnt(0)
	v_cmp_gt_u32 vcc, 7, v25
	s_cbranch_vccnz Lww_61
Lwx_62:
	s_waitcnt vmcnt(0)
	s_add_u32 s40, s41, 172032
	s_add_u32 s42, s40, 0
	buffer_load_dwordx4 a[0:3], v4, s[4:7], s42 offen offset:2048 sc1
	s_waitcnt vmcnt(10)
	buffer_load_dwordx4 a[4:7], v4, s[4:7], s42 offen offset:3072 sc1
	s_add_u32 s42, s40, 4096
	buffer_load_dwordx4 a[16:19], v4, s[4:7], s42 offen offset:0 sc1
	s_waitcnt vmcnt(10)
	buffer_load_dwordx4 a[20:23], v4, s[4:7], s42 offen offset:1024 sc1
	buffer_load_dwordx4 a[32:35], v4, s[4:7], s42 offen offset:2048 sc1
	s_waitcnt vmcnt(10)
	s_add_u32 s42, s40, 8192
	buffer_load_dwordx4 a[28:31], v4, s[4:7], s42 offen offset:1024 sc1
	buffer_load_dwordx4 a[40:43], v4, s[4:7], s42 offen offset:2048 sc1
	s_waitcnt vmcnt(10)
	buffer_load_dwordx4 a[44:47], v4, s[4:7], s42 offen offset:3072 sc1
	s_add_u32 s42, s40, 12288
	buffer_load_dwordx4 a[48:51], v4, s[4:7], s42 offen offset:0 sc1
	s_waitcnt vmcnt(10)
	buffer_load_dwordx4 a[52:55], v4, s[4:7], s42 offen offset:1024 sc1
	s_add_u32 s40, s41, 200704
	s_add_u32 s42, s40, 0
	buffer_load_dwordx4 a[56:59], v4, s[4:7], s42 offen offset:2048 sc1
	s_waitcnt vmcnt(10)
	buffer_load_dwordx4 a[60:63], v4, s[4:7], s42 offen offset:3072 sc1
	s_add_u32 s42, s40, 4096
	buffer_load_dwordx4 a[72:75], v4, s[4:7], s42 offen offset:0 sc1
	s_waitcnt vmcnt(10)
	buffer_load_dwordx4 a[76:79], v4, s[4:7], s42 offen offset:1024 sc1
	buffer_load_dwordx4 a[88:91], v4, s[4:7], s42 offen offset:2048 sc1
	s_waitcnt vmcnt(10)
	s_add_u32 s42, s40, 8192
	buffer_load_dwordx4 a[84:87], v4, s[4:7], s42 offen offset:1024 sc1
	buffer_load_dwordx4 a[96:99], v4, s[4:7], s42 offen offset:2048 sc1
	s_waitcnt vmcnt(10)
	buffer_load_dwordx4 a[100:103], v4, s[4:7], s42 offen offset:3072 sc1
	s_add_u32 s42, s40, 12288
	buffer_load_dwordx4 a[104:107], v4, s[4:7], s42 offen offset:0 sc1
	s_waitcnt vmcnt(10)
	buffer_load_dwordx4 a[108:111], v4, s[4:7], s42 offen offset:1024 sc1
	s_add_u32 s40, s41, 186368
	s_add_u32 s42, s40, 0
	buffer_load_dwordx4 a[112:115], v4, s[4:7], s42 offen offset:2048 sc1
	s_waitcnt vmcnt(10)
	buffer_load_dwordx4 a[116:119], v4, s[4:7], s42 offen offset:3072 sc1
	s_add_u32 s42, s40, 4096
	buffer_load_dwordx4 a[128:131], v4, s[4:7], s42 offen offset:0 sc1
	s_waitcnt vmcnt(10)
	buffer_load_dwordx4 a[132:135], v4, s[4:7], s42 offen offset:1024 sc1
	buffer_load_dwordx4 a[144:147], v4, s[4:7], s42 offen offset:2048 sc1
	s_waitcnt vmcnt(10)
	s_add_u32 s42, s40, 8192
	buffer_load_dwordx4 a[140:143], v4, s[4:7], s42 offen offset:1024 sc1
	buffer_load_dwordx4 a[152:155], v4, s[4:7], s42 offen offset:2048 sc1
	s_waitcnt vmcnt(10)
	buffer_load_dwordx4 a[156:159], v4, s[4:7], s42 offen offset:3072 sc1
	s_add_u32 s42, s40, 12288
	buffer_load_dwordx4 a[160:163], v4, s[4:7], s42 offen offset:0 sc1
	s_waitcnt vmcnt(10)
	buffer_load_dwordx4 a[164:167], v4, s[4:7], s42 offen offset:1024 sc1
	s_add_u32 s40, s41, 215040
	s_add_u32 s42, s40, 0
	buffer_load_dwordx4 a[168:171], v4, s[4:7], s42 offen offset:2048 sc1
	s_waitcnt vmcnt(10)
	buffer_load_dwordx4 a[172:175], v4, s[4:7], s42 offen offset:3072 sc1
	s_add_u32 s42, s40, 4096
	buffer_load_dwordx4 a[184:187], v4, s[4:7], s42 offen offset:0 sc1
	s_waitcnt vmcnt(10)
	buffer_load_dwordx4 a[188:191], v4, s[4:7], s42 offen offset:1024 sc1
	buffer_load_dwordx4 a[200:203], v4, s[4:7], s42 offen offset:2048 sc1
	s_waitcnt vmcnt(10)
	s_add_u32 s42, s40, 8192
	buffer_load_dwordx4 a[196:199], v4, s[4:7], s42 offen offset:1024 sc1
	buffer_load_dwordx4 a[208:211], v4, s[4:7], s42 offen offset:2048 sc1
	s_waitcnt vmcnt(10)
	buffer_load_dwordx4 a[212:215], v4, s[4:7], s42 offen offset:3072 sc1
	s_add_u32 s42, s40, 12288
	buffer_load_dwordx4 a[216:219], v4, s[4:7], s42 offen offset:0 sc1
	s_waitcnt vmcnt(10)
	buffer_load_dwordx4 a[220:223], v4, s[4:7], s42 offen offset:1024 sc1
	s_add_u32 s40, s41, 272384
	s_add_u32 s42, s40, 0
	buffer_load_dwordx4 a[224:227], v4, s[4:7], s42 offen offset:2048 sc1
	s_waitcnt vmcnt(10)
	buffer_load_dwordx4 a[228:231], v4, s[4:7], s42 offen offset:3072 sc1
	s_add_u32 s42, s40, 4096
	buffer_load_dwordx4 a[240:243], v4, s[4:7], s42 offen offset:0 sc1
	s_waitcnt vmcnt(10)
	buffer_load_dwordx4 a[244:247], v4, s[4:7], s42 offen offset:1024 sc1
	buffer_load_dwordx4 v[120:123], v4, s[4:7], s42 offen offset:2048 sc1
	s_waitcnt vmcnt(10)
	s_add_u32 s42, s40, 8192
	buffer_load_dwordx4 a[252:255], v4, s[4:7], s42 offen offset:1024 sc1
	buffer_load_dwordx4 v[128:131], v4, s[4:7], s42 offen offset:2048 sc1
	s_waitcnt vmcnt(10)
	buffer_load_dwordx4 v[132:135], v4, s[4:7], s42 offen offset:3072 sc1
	s_add_u32 s42, s40, 12288
	buffer_load_dwordx4 v[136:139], v4, s[4:7], s42 offen offset:0 sc1
	s_waitcnt vmcnt(10)
	buffer_load_dwordx4 v[140:143], v4, s[4:7], s42 offen offset:1024 sc1
	s_add_u32 s40, s41, 387072
	s_add_u32 s42, s40, 0
	buffer_load_dwordx4 v[144:147], v4, s[4:7], s42 offen offset:2048 sc1
	s_waitcnt vmcnt(10)
	buffer_load_dwordx4 v[148:151], v4, s[4:7], s42 offen offset:3072 sc1
	s_add_u32 s42, s40, 4096
	buffer_load_dwordx4 v[160:163], v4, s[4:7], s42 offen offset:0 sc1
	s_waitcnt vmcnt(10)
	buffer_load_dwordx4 v[164:167], v4, s[4:7], s42 offen offset:1024 sc1
	buffer_load_dwordx4 v[176:179], v4, s[4:7], s42 offen offset:2048 sc1
	s_waitcnt vmcnt(10)
	s_add_u32 s42, s40, 8192
	buffer_load_dwordx4 v[172:175], v4, s[4:7], s42 offen offset:1024 sc1
	buffer_load_dwordx4 v[184:187], v4, s[4:7], s42 offen offset:2048 sc1
	s_waitcnt vmcnt(10)
	buffer_load_dwordx4 v[188:191], v4, s[4:7], s42 offen offset:3072 sc1
	s_add_u32 s42, s40, 12288
	buffer_load_dwordx4 v[192:195], v4, s[4:7], s42 offen offset:0 sc1
	s_waitcnt vmcnt(10)
	buffer_load_dwordx4 v[196:199], v4, s[4:7], s42 offen offset:1024 sc1
	s_add_u32 s40, s41, 329728
	s_add_u32 s42, s40, 0
	buffer_load_dwordx4 v[200:203], v4, s[4:7], s42 offen offset:2048 sc1
	s_waitcnt vmcnt(10)
	buffer_load_dwordx4 v[204:207], v4, s[4:7], s42 offen offset:3072 sc1
	s_add_u32 s42, s40, 4096
	buffer_load_dwordx4 v[216:219], v4, s[4:7], s42 offen offset:0 sc1
	s_waitcnt vmcnt(10)
	buffer_load_dwordx4 v[220:223], v4, s[4:7], s42 offen offset:1024 sc1
	buffer_load_dwordx4 v[232:235], v4, s[4:7], s42 offen offset:2048 sc1
	s_waitcnt vmcnt(10)
	s_add_u32 s42, s40, 8192
	buffer_load_dwordx4 v[228:231], v4, s[4:7], s42 offen offset:1024 sc1
	buffer_load_dwordx4 v[240:243], v4, s[4:7], s42 offen offset:2048 sc1
	s_waitcnt vmcnt(10)
	buffer_load_dwordx4 v[244:247], v4, s[4:7], s42 offen offset:3072 sc1
	s_add_u32 s42, s40, 12288
	buffer_load_dwordx4 v[248:251], v4, s[4:7], s42 offen offset:0 sc1
	s_waitcnt vmcnt(10)
	buffer_load_dwordx4 v[252:255], v4, s[4:7], s42 offen offset:1024 sc1
	s_mov_b32 s41, 60268544
	s_mov_b32 s40, 0x100000
Lww_63:
	buffer_load_dword v25, v24, s[4:7], s41 offen sc1
	s_sub_u32 s40, s40, 1
	s_cbranch_scc1 Lwx_64
	s_waitcnt vmcnt(0)
	v_cmp_gt_u32 vcc, 64, v25
	s_cbranch_vccnz Lww_63
Lwx_64:
	s_waitcnt vmcnt(0)
	s_add_u32 s86, s15, 24576
	s_add_u32 s87, s15, 28672
	buffer_load_dwordx4 v[84:87], v4, s[4:7], s86 offen offset:0 sc1
	buffer_load_dwordx4 v[88:91], v4, s[4:7], s86 offen offset:2048 sc1
	buffer_load_dwordx4 v[100:103], v4, s[4:7], s87 offen offset:0 sc1
	buffer_load_dwordx4 v[104:107], v4, s[4:7], s87 offen offset:2048 sc1
	buffer_load_dwordx4 v[92:95], v4, s[4:7], s86 offen offset:1024 sc1
	buffer_load_dwordx4 v[96:99], v4, s[4:7], s86 offen offset:3072 sc1
	buffer_load_dwordx4 v[108:111], v4, s[4:7], s87 offen offset:1024 sc1
	buffer_load_dwordx4 v[112:115], v4, s[4:7], s87 offen offset:3072 sc1
	s_mov_b32 s88, s87
	s_add_u32 s86, s86, 32768
	s_add_u32 s87, s87, 32768
	v_mov_b64 v[48:49], 0
	v_mov_b64 v[50:51], 0
	v_mov_b64 v[52:53], 0
	v_mov_b64 v[54:55], 0
	v_mov_b64 v[56:57], 0
	v_mov_b64 v[58:59], 0
	v_mov_b64 v[60:61], 0
	v_mov_b64 v[62:63], 0
	v_mov_b64 v[64:65], 0
	v_mov_b64 v[66:67], 0
	v_mov_b64 v[68:69], 0
	v_mov_b64 v[70:71], 0
	v_mov_b64 v[72:73], 0
	v_mov_b64 v[74:75], 0
	v_mov_b64 v[80:81], 0
	v_mov_b64 v[82:83], 0
	s_waitcnt vmcnt(0)
	s_barrier
.p2align 6
Lca_loop3:
	buffer_load_dwordx4 v[20:23], v4, s[4:7], s26 offen offset:1024
	s_nop 2
	buffer_load_dwordx4 v[24:27], v4, s[4:7], s26 offen offset:0
	s_nop 2
	buffer_load_dwordx4 v[28:31], v4, s[4:7], s26 offen offset:2048
	s_nop 15
	s_nop 13
	buffer_load_dwordx4 v[32:35], v4, s[4:7], s27 offen offset:0
	s_add_u32 s16, s16, 1
	v_mov_b32 v8, s16
Lg_65:
	s_waitcnt vmcnt(3)
	v_smfmac_f32_16x16x64_bf16 v[48:51], v[20:23], a[0:7], v1
	v_smfmac_f32_16x16x64_bf16 v[52:55], v[20:23], a[56:63], v1
	buffer_load_dwordx4 v[36:39], v4, s[4:7], s26 offen offset:3072 sc1
	v_smfmac_f32_16x16x64_bf16 v[56:59], v[20:23], a[112:119], v1
	v_smfmac_f32_16x16x64_bf16 v[60:63], v[20:23], a[168:175], v1
	buffer_load_dwordx4 v[40:43], v4, s[4:7], s27 offen offset:1024 sc1
	v_smfmac_f32_16x16x64_bf16 v[64:67], v[20:23], a[224:231], v1
	v_smfmac_f32_16x16x64_bf16 v[68:71], v[20:23], v[144:151], v1
	buffer_load_dwordx4 v[44:47], v4, s[4:7], s27 offen offset:2048 sc1
	v_smfmac_f32_16x16x64_bf16 v[72:75], v[20:23], v[200:207], v1
	s_waitcnt vmcnt(5)
	v_smfmac_f32_16x16x64_bf16 v[48:51], v[24:27], a[8:15], v1
	v_smfmac_f32_16x16x64_bf16 v[52:55], v[24:27], a[64:71], v1
	v_smfmac_f32_16x16x64_bf16 v[56:59], v[24:27], a[120:127], v1
	s_nop 0
	v_cmp_u_f32 vcc, v48, v49
	v_smfmac_f32_16x16x64_bf16 v[60:63], v[24:27], a[176:183], v1
	v_cmp_u_f32 s[38:39], v50, v51
	v_smfmac_f32_16x16x64_bf16 v[64:67], v[24:27], a[232:239], v1
	v_smfmac_f32_16x16x64_bf16 v[68:71], v[24:27], v[152:159], v1
	v_smfmac_f32_16x16x64_bf16 v[72:75], v[24:27], v[208:215], v1
	s_waitcnt vmcnt(4)
	v_smfmac_f32_16x16x64_bf16 v[48:51], v[28:31], a[16:23], v1
	s_or_b64 vcc, vcc, s[38:39]
	s_cbranch_vccnz Lge_68
Lgeo_69:
	v_smfmac_f32_16x16x64_bf16 v[52:55], v[28:31], a[72:79], v1
	v_smfmac_f32_16x16x64_bf16 v[56:59], v[28:31], a[128:135], v1
	s_mov_b32 m0, 28672
	s_nop 0
	buffer_load_dwordx4 v4, s[4:7], s86 offen offset:0 sc1 lds
	v_smfmac_f32_16x16x64_bf16 v[60:63], v[28:31], a[184:191], v1
	v_smfmac_f32_16x16x64_bf16 v[64:67], v[28:31], a[240:247], v1
	v_smfmac_f32_16x16x64_bf16 v[68:71], v[28:31], v[160:167], v1
	v_smfmac_f32_16x16x64_bf16 v[72:75], v[28:31], v[216:223], v1
	buffer_load_dwordx4 v4, s[4:7], s86 offen offset:1024 sc1 lds
	s_waitcnt vmcnt(5)
	v_smfmac_f32_16x16x64_bf16 v[48:51], v[32:35], a[24:31], v1
	v_smfmac_f32_16x16x64_bf16 v[52:55], v[32:35], a[80:87], v1
	v_smfmac_f32_16x16x64_bf16 v[56:59], v[32:35], a[136:143], v1
	buffer_load_dwordx4 v4, s[4:7], s86 offen offset:2048 sc1 lds
	v_smfmac_f32_16x16x64_bf16 v[60:63], v[32:35], a[192:199], v1
	s_waitcnt vmcnt(5)
	v_smfmac_f32_16x16x64_bf16 v[48:51], v[36:39], a[32:39], v1
	v_smfmac_f32_16x16x64_bf16 v[52:55], v[36:39], a[88:95], v1
	v_mov_b64 v[20:21], 0
	v_smfmac_f32_16x16x64_bf16 v[56:59], v[36:39], a[144:151], v1
	buffer_load_dwordx4 v4, s[4:7], s86 offen offset:3072 sc1 lds
	v_smfmac_f32_16x16x64_bf16 v[60:63], v[36:39], a[200:207], v1
	v_mov_b64 v[22:23], 0
	s_waitcnt vmcnt(5)
	v_smfmac_f32_16x16x64_bf16 v[48:51], v[40:43], a[40:47], v1
	v_smfmac_f32_16x16x64_bf16 v[52:55], v[40:43], a[96:103], v1
	v_smfmac_f32_16x16x64_bf16 v[56:59], v[40:43], a[152:159], v1
	s_mov_b32 m0, 32768
	s_nop 0
	buffer_load_dwordx4 v4, s[4:7], s87 offen offset:0 sc1 lds
	v_smfmac_f32_16x16x64_bf16 v[60:63], v[40:43], a[208:215], v1
	s_waitcnt vmcnt(5)
	v_smfmac_f32_16x16x64_bf16 v[48:51], v[44:47], a[48:55], v1
	v_smfmac_f32_16x16x64_bf16 v[52:55], v[44:47], a[104:111], v1
	buffer_load_dwordx4 v4, s[4:7], s87 offen offset:1024 sc1 lds
	v_smfmac_f32_16x16x64_bf16 v[56:59], v[44:47], a[160:167], v1
	s_nop 0
	v_cmp_u_f32 vcc, v48, v49
	v_smfmac_f32_16x16x64_bf16 v[60:63], v[44:47], a[216:223], v1
	v_cmp_u_f32 s[38:39], v50, v51
	v_smfmac_f32_16x16x64_bf16 v[68:71], v[32:35], v[168:175], v1
	s_or_b64 vcc, vcc, s[38:39]
	s_cbranch_vccnz Lgr_66
Lgo_67:
	v_cvt_pk_bf16_f32 v48, v48, v49
	v_smfmac_f32_16x16x64_bf16 v[68:71], v[36:39], v[176:183], v1
	buffer_load_dwordx4 v4, s[4:7], s87 offen offset:2048 sc1 lds
	v_cvt_pk_bf16_f32 v49, v50, v51
	v_smfmac_f32_16x16x64_bf16 v[68:71], v[40:43], v[184:191], v1
	v_cvt_pk_bf16_f32 v50, v56, v57
	v_smfmac_f32_16x16x64_bf16 v[68:71], v[44:47], v[192:199], v1
	v_cvt_pk_bf16_f32 v51, v58, v59
	v_smfmac_f32_16x16x64_bf16 v[64:67], v[32:35], a[248:255], v1
	buffer_load_dwordx4 v4, s[4:7], s87 offen offset:3072 sc1 lds
	v_cvt_pk_bf16_f32 v52, v52, v53
	v_mfma_f32_16x16x32_bf16 v[16:19], v[48:51], v[12:15], 0
	v_cvt_pk_bf16_f32 v53, v54, v55
	v_cvt_pk_bf16_f32 v54, v60, v61
	v_smfmac_f32_16x16x64_bf16 v[64:67], v[36:39], v[120:127], v1
	v_cvt_pk_bf16_f32 v55, v62, v63
	v_smfmac_f32_16x16x64_bf16 v[64:67], v[40:43], v[128:135], v1
	v_cvt_pk_bf16_f32 v116, v68, v69
	v_mfma_f32_16x16x32_bf16 v[60:63], v[52:55], v[12:15], 0
	v_cvt_pk_bf16_f32 v117, v70, v71
	v_cvt_pk_bf16_f32 v76, v16, v17
	v_smfmac_f32_16x16x64_bf16 v[64:67], v[44:47], v[136:143], v1
	v_cvt_pk_bf16_f32 v77, v18, v19
	v_mfma_f32_16x16x32_bf16 v[68:71], v[116:119], v[12:15], 0
	v_mov_b32_dpp v28, v34 quad_perm:[2,3,2,3] row_mask:0xf bank_mask:0xf
	v_mov_b32_dpp v30, v46 quad_perm:[2,3,2,3] row_mask:0xf bank_mask:0xf
	v_smfmac_f32_16x16x64_bf16 v[72:75], v[32:35], v[224:231], v1
	v_cvt_pk_bf16_f32 v78, v60, v61
	v_smfmac_f32_16x16x64_bf16 v[72:75], v[36:39], v[232:239], v1
	v_cvt_pk_bf16_f32 v79, v62, v63
	v_smfmac_f32_16x16x64_bf16 v[72:75], v[40:43], v[240:247], v1
	v_cvt_pk_bf16_f32 v64, v64, v65
	v_smfmac_f32_16x16x64_bf16 v[72:75], v[44:47], v[248:255], v1
	v_cvt_pk_bf16_f32 v65, v66, v67
	v_smfmac_f32_16x16x64_bf16 v[80:83], v[76:79], v[84:91], v1
	v_cvt_pk_bf16_f32 v26, v68, v69
	v_mfma_f32_16x16x32_bf16 v[48:51], v[76:79], v[36:39], 0
	s_nop 0
	v_cvt_pk_bf16_f32 v66, v72, v73
	v_cvt_pk_bf16_f32 v67, v74, v75
	v_cvt_pk_bf16_f32 v27, v70, v71
	v_mov_b32_dpp v29, v35 quad_perm:[2,3,2,3] row_mask:0xf bank_mask:0xf
	v_mfma_f32_16x16x32_bf16 v[16:19], v[64:67], v[12:15], 0
	v_mov_b32_dpp v31, v47 quad_perm:[2,3,2,3] row_mask:0xf bank_mask:0xf
	v_cndmask_b32 v28, v28, v42, s[90:91]
	v_smfmac_f32_16x16x64_bf16 v[20:23], v[76:79], v[92:99], v1
	v_cndmask_b32 v29, v29, v43, s[90:91]
	s_nop 3
	v_cvt_pk_bf16_f32 v24, v16, v17
	v_cvt_pk_bf16_f32 v25, v18, v19
	s_nop 1
	v_mfma_f32_16x16x32_bf16 v[48:51], v[24:27], v[28:31], v[48:51]
	v_smfmac_f32_16x16x64_bf16 v[80:83], v[24:27], v[100:107], v1
	v_smfmac_f32_16x16x64_bf16 v[20:23], v[24:27], v[108:115], v1
	s_nop 0
	v_add_f32_dpp v48, v50, v48 quad_perm:[2,3,0,1] row_mask:0xf bank_mask:0xf
	v_add_f32_dpp v51, v49, v51 quad_perm:[2,3,0,1] row_mask:0xf bank_mask:0xf
	v_cndmask_b32 v48, v48, v51, s[90:91]
	ds_write_b32 v5, v48 offset:3584
	v_pk_add_f32 v[52:53], v[80:81], v[82:83]
	s_nop 1
	v_pk_add_f32 v[54:55], v[20:21], v[22:23]
	ds_write_b128 v4, v[52:55] offset:2560
	s_waitcnt lgkmcnt(0)
	s_barrier
	s_nop 15
	s_nop 15
	s_nop 15
	s_waitcnt vmcnt(0)
	ds_read_b128 v[84:87], v4 offset:28672
	ds_read_b128 v[92:95], v4 offset:29696
	ds_read_b128 v[88:91], v4 offset:30720
	ds_read_b128 v[96:99], v4 offset:31744
	ds_read_b128 v[100:103], v4 offset:32768
	ds_read_b128 v[108:111], v4 offset:33792
	ds_read_b128 v[104:107], v4 offset:34816
	ds_read_b128 v[112:115], v4 offset:35840
	s_waitcnt lgkmcnt(0)
	s_add_u32 s26, s26, 8192
	s_add_u32 s27, s27, 8192
	s_add_u32 s86, s86, 32768
	s_add_u32 s87, s87, 32768
	s_add_u32 s88, s88, 32768
	s_add_u32 s14, s14, 458752
	v_mov_b64 v[48:49], 0
	v_mov_b64 v[50:51], 0
	v_mov_b64 v[52:53], 0
	v_mov_b64 v[54:55], 0
	v_mov_b64 v[56:57], 0
	v_mov_b64 v[58:59], 0
	v_mov_b64 v[60:61], 0
	v_mov_b64 v[62:63], 0
	v_mov_b64 v[64:65], 0
	v_mov_b64 v[66:67], 0
	v_mov_b64 v[68:69], 0
	v_mov_b64 v[70:71], 0
	v_mov_b64 v[72:73], 0
	v_mov_b64 v[74:75], 0
	v_mov_b64 v[80:81], 0
	v_mov_b64 v[82:83], 0
	s_barrier
	s_cmp_lg_u32 s16, 63
	s_cbranch_scc1 Lca_loop3
	s_waitcnt vmcnt(0)
	s_endpgm
Lgr_66:
	s_cmp_eq_u32 s13, 0
	s_cbranch_scc1 Lgo_67
	s_sub_u32 s13, s13, 1
	s_waitcnt vmcnt(0)
	s_nop 7
	buffer_load_dwordx4 v[20:23], v4, s[4:7], s26 offen offset:1024 sc1
	buffer_load_dwordx4 v[24:27], v4, s[4:7], s26 offen offset:0 sc1
	buffer_load_dwordx4 v[28:31], v4, s[4:7], s26 offen offset:2048 sc1
	buffer_load_dwordx4 v[32:35], v4, s[4:7], s27 offen offset:0 sc1
	v_mov_b64 v[48:49], 0
	v_mov_b64 v[50:51], 0
	v_mov_b64 v[52:53], 0
	v_mov_b64 v[54:55], 0
	v_mov_b64 v[56:57], 0
	v_mov_b64 v[58:59], 0
	v_mov_b64 v[60:61], 0
	v_mov_b64 v[62:63], 0
	v_mov_b64 v[64:65], 0
	v_mov_b64 v[66:67], 0
	v_mov_b64 v[68:69], 0
	v_mov_b64 v[70:71], 0
	v_mov_b64 v[72:73], 0
	v_mov_b64 v[74:75], 0
	s_nop 1
	s_branch Lg_65
Lge_68:
	s_cmp_eq_u32 s13, 0
	s_cbranch_scc1 Lgeo_69
	s_sub_u32 s13, s13, 1
	s_waitcnt vmcnt(0)
	s_nop 7
	buffer_load_dwordx4 v[20:23], v4, s[4:7], s26 offen offset:1024 sc1
	buffer_load_dwordx4 v[24:27], v4, s[4:7], s26 offen offset:0 sc1
	buffer_load_dwordx4 v[28:31], v4, s[4:7], s26 offen offset:2048 sc1
	buffer_load_dwordx4 v[32:35], v4, s[4:7], s27 offen offset:0 sc1
	v_mov_b64 v[48:49], 0
	v_mov_b64 v[50:51], 0
	v_mov_b64 v[52:53], 0
	v_mov_b64 v[54:55], 0
	v_mov_b64 v[56:57], 0
	v_mov_b64 v[58:59], 0
	v_mov_b64 v[60:61], 0
	v_mov_b64 v[62:63], 0
	v_mov_b64 v[64:65], 0
	v_mov_b64 v[66:67], 0
	v_mov_b64 v[68:69], 0
	v_mov_b64 v[70:71], 0
	v_mov_b64 v[72:73], 0
	v_mov_b64 v[74:75], 0
	s_nop 1
	s_branch Lg_65
Lcb_j:
	s_sub_u32 s32, s32, 16
	v_lshlrev_b32 v4, 4, v0
	v_lshlrev_b32 v5, 2, v0
	v_and_b32 v20, 15, v0
	v_lshrrev_b32 v21, 4, v0
	v_mov_b32 v1, 0x4444
	v_mov_b32 v22, 0xeeee
	v_and_b32 v24, 2, v20
	v_cmp_ne_u32 vcc, 0, v24
	s_nop 1
	v_cndmask_b32 v1, v1, v22, vcc
	v_mov_b32 v25, 0x80000000
	v_cmp_eq_u32 vcc, 0, v0
	s_nop 1
	v_cndmask_b32 v6, v25, v0, vcc
	v_mul_u32_u24 v24, 1280, v0
	v_cmp_gt_u32 vcc, 8, v0
	s_nop 1
	v_cndmask_b32 v9, v25, v24, vcc
	v_mov_b32 v7, -1
	s_mov_b32 s20, 50604032
	s_mov_b32 s21, 50608128
	s_mov_b32 s22, 50612224
	s_mov_b32 s23, 0
	s_mov_b32 s24, 16384
	s_mov_b32 s26, 50003968
	s_mov_b32 s27, 50008064
	s_mov_b32 s18, 50003968
	s_mov_b32 s19, 50028544
	s_and_b32 s40, s32, 7
	s_mul_i32 s40, s40, 1280
	s_add_u32 s30, s40, 50675712
	s_lshl_b32 s40, s32, 2
	s_add_u32 s31, s40, 50675712
	s_mov_b32 s16, 0
	s_mov_b32 s29, 0x42800000
	s_mov_b32 s17, 0x40000
	s_mov_b32 s80, 0
	s_mov_b32 s81, 0
	s_mov_b32 s82, 0
	s_mov_b32 s13, 0x20000
	v_mov_b32 v12, -1
	v_mov_b32 v13, -1
	v_mov_b32 v14, -1
	v_mov_b32 v15, -1
	v_and_b32 v28, 1, v21
	v_lshrrev_b32 v29, 1, v21
	v_lshlrev_b32 v24, 4, v20
	v_lshl_add_u32 v10, v21, 2, v24
	v_add_u32 v11, 61440, v4
	v_mov_b32 v18, v4
	s_lshl_b32 s43, s32, 8
	v_mul_u32_u24 v24, 3328, v21
	v_add3_u32 v24, s43, v4, v24
	v_mov_b32 v25, 0x80000000
	v_cmp_gt_u32 vcc, 32, v0
	s_nop 1
	v_cndmask_b32 v16, v25, v24, vcc
	s_lshl_b32 s40, s32, 14
	s_add_u32 s14, s40, 12845056
	s_mov_b32 s34, 60297216
	s_add_u32 s35, s34, 4
	v_lshlrev_b32 v26, 7, v20
	s_mov_b32 s40, 0x100000
Lww_70:
	buffer_load_dword v25, v26, s[4:7], s35 offen sc1
	s_sub_u32 s40, s40, 1
	s_cbranch_scc1 Lwx_71
	s_waitcnt vmcnt(0)
	v_cmp_gt_u32 vcc, 7, v25
	s_cbranch_vccnz Lww_70
Lwx_71:
	s_waitcnt vmcnt(0)
	s_cmp_eq_u32 s33, 1
	s_cbranch_scc1 Lcb_w1
	s_cmp_eq_u32 s33, 2
	s_cbranch_scc1 Lcb_w2
	s_cmp_eq_u32 s33, 3
	s_cbranch_scc1 Lcb_w3
Lcb_w0:
	s_mul_i32 s41, s32, 229376
	s_add_u32 s40, s41, 6422528
	s_add_u32 s42, s40, 0
	buffer_load_dwordx4 a[0:3], v4, s[4:7], s42 offen offset:0 sc1
	buffer_load_dwordx4 a[4:7], v4, s[4:7], s42 offen offset:1024 sc1
	s_add_u32 s42, s40, 4096
	buffer_load_dwordx4 a[28:31], v4, s[4:7], s42 offen offset:3072 sc1
	s_add_u32 s42, s40, 8192
	buffer_load_dwordx4 a[32:35], v4, s[4:7], s42 offen offset:0 sc1
	s_add_u32 s40, s41, 6436864
	s_add_u32 s42, s40, 0
	buffer_load_dwordx4 a[56:59], v4, s[4:7], s42 offen offset:0 sc1
	buffer_load_dwordx4 a[60:63], v4, s[4:7], s42 offen offset:1024 sc1
	s_add_u32 s42, s40, 4096
	buffer_load_dwordx4 a[84:87], v4, s[4:7], s42 offen offset:3072 sc1
	s_add_u32 s42, s40, 8192
	buffer_load_dwordx4 a[88:91], v4, s[4:7], s42 offen offset:0 sc1
	s_add_u32 s40, s41, 6451200
	s_add_u32 s42, s40, 0
	buffer_load_dwordx4 a[112:115], v4, s[4:7], s42 offen offset:0 sc1
	buffer_load_dwordx4 a[116:119], v4, s[4:7], s42 offen offset:1024 sc1
	s_add_u32 s42, s40, 4096
	buffer_load_dwordx4 a[140:143], v4, s[4:7], s42 offen offset:3072 sc1
	s_waitcnt vmcnt(10)
	s_add_u32 s42, s40, 8192
	buffer_load_dwordx4 a[144:147], v4, s[4:7], s42 offen offset:0 sc1
	s_add_u32 s40, s41, 6465536
	s_add_u32 s42, s40, 0
	buffer_load_dwordx4 a[168:171], v4, s[4:7], s42 offen offset:0 sc1
	s_waitcnt vmcnt(10)
	buffer_load_dwordx4 a[172:175], v4, s[4:7], s42 offen offset:1024 sc1
	s_add_u32 s42, s40, 4096
	buffer_load_dwordx4 a[196:199], v4, s[4:7], s42 offen offset:3072 sc1
	s_waitcnt vmcnt(10)
	s_add_u32 s42, s40, 8192
	buffer_load_dwordx4 a[200:203], v4, s[4:7], s42 offen offset:0 sc1
	s_add_u32 s40, s41, 6479872
	s_add_u32 s42, s40, 0
	buffer_load_dwordx4 a[224:227], v4, s[4:7], s42 offen offset:0 sc1
	s_waitcnt vmcnt(10)
	buffer_load_dwordx4 a[228:231], v4, s[4:7], s42 offen offset:1024 sc1
	s_add_u32 s42, s40, 4096
	buffer_load_dwordx4 a[252:255], v4, s[4:7], s42 offen offset:3072 sc1
	s_waitcnt vmcnt(10)
	s_add_u32 s42, s40, 8192
	buffer_load_dwordx4 v[120:123], v4, s[4:7], s42 offen offset:0 sc1
	s_add_u32 s40, s41, 6494208
	s_add_u32 s42, s40, 0
	buffer_load_dwordx4 v[144:147], v4, s[4:7], s42 offen offset:0 sc1
	s_waitcnt vmcnt(10)
	buffer_load_dwordx4 v[148:151], v4, s[4:7], s42 offen offset:1024 sc1
	s_add_u32 s42, s40, 4096
	buffer_load_dwordx4 v[172:175], v4, s[4:7], s42 offen offset:3072 sc1
	s_waitcnt vmcnt(10)
	s_add_u32 s42, s40, 8192
	buffer_load_dwordx4 v[176:179], v4, s[4:7], s42 offen offset:0 sc1
	s_add_u32 s40, s41, 6508544
	s_add_u32 s42, s40, 0
	buffer_load_dwordx4 v[200:203], v4, s[4:7], s42 offen offset:0 sc1
	s_waitcnt vmcnt(10)
	buffer_load_dwordx4 v[204:207], v4, s[4:7], s42 offen offset:1024 sc1
	s_add_u32 s42, s40, 4096
	buffer_load_dwordx4 v[228:231], v4, s[4:7], s42 offen offset:3072 sc1
	s_waitcnt vmcnt(10)
	s_add_u32 s42, s40, 8192
	buffer_load_dwordx4 v[232:235], v4, s[4:7], s42 offen offset:0 sc1
	s_add_u32 s40, s41, 9777152
	s_add_u32 s42, s40, 0
	s_mov_b32 m0, 32768
	s_nop 0
	buffer_load_dwordx4 v4, s[4:7], s42 offen offset:0 sc1 lds
	s_waitcnt vmcnt(10)
	buffer_load_dwordx4 v4, s[4:7], s42 offen offset:1024 sc1 lds
	s_add_u32 s42, s40, 4096
	s_mov_b32 m0, 36864
	s_nop 0
	buffer_load_dwordx4 v4, s[4:7], s42 offen offset:3072 sc1 lds
	s_waitcnt vmcnt(10)
	s_add_u32 s42, s40, 8192
	s_mov_b32 m0, 40960
	s_nop 0
	buffer_load_dwordx4 v4, s[4:7], s42 offen offset:0 sc1 lds
	s_mov_b32 s40, 0x100000
Lww_72:
	buffer_load_dword v25, v26, s[4:7], s34 offen sc1
	s_sub_u32 s40, s40, 1
	s_cbranch_scc1 Lwx_73
	s_waitcnt vmcnt(0)
	v_cmp_gt_u32 vcc, 7, v25
	s_cbranch_vccnz Lww_72
Lwx_73:
	s_waitcnt vmcnt(0)
	s_add_u32 s40, s41, 6422528
	s_add_u32 s42, s40, 0
	buffer_load_dwordx4 a[8:11], v4, s[4:7], s42 offen offset:2048 sc1
	s_waitcnt vmcnt(10)
	buffer_load_dwordx4 a[12:15], v4, s[4:7], s42 offen offset:3072 sc1
	s_add_u32 s42, s40, 4096
	buffer_load_dwordx4 a[16:19], v4, s[4:7], s42 offen offset:0 sc1
	s_waitcnt vmcnt(10)
	buffer_load_dwordx4 a[20:23], v4, s[4:7], s42 offen offset:1024 sc1
	buffer_load_dwordx4 a[24:27], v4, s[4:7], s42 offen offset:2048 sc1
	s_waitcnt vmcnt(10)
	s_add_u32 s42, s40, 8192
	buffer_load_dwordx4 a[36:39], v4, s[4:7], s42 offen offset:1024 sc1
	buffer_load_dwordx4 a[40:43], v4, s[4:7], s42 offen offset:2048 sc1
	s_waitcnt vmcnt(10)
	buffer_load_dwordx4 a[44:47], v4, s[4:7], s42 offen offset:3072 sc1
	s_add_u32 s42, s40, 12288
	buffer_load_dwordx4 a[48:51], v4, s[4:7], s42 offen offset:0 sc1
	s_waitcnt vmcnt(10)
	buffer_load_dwordx4 a[52:55], v4, s[4:7], s42 offen offset:1024 sc1
	s_add_u32 s40, s41, 6436864
	s_add_u32 s42, s40, 0
	buffer_load_dwordx4 a[64:67], v4, s[4:7], s42 offen offset:2048 sc1
	s_waitcnt vmcnt(10)
	buffer_load_dwordx4 a[68:71], v4, s[4:7], s42 offen offset:3072 sc1
	s_add_u32 s42, s40, 4096
	buffer_load_dwordx4 a[72:75], v4, s[4:7], s42 offen offset:0 sc1
	s_waitcnt vmcnt(10)
	buffer_load_dwordx4 a[76:79], v4, s[4:7], s42 offen offset:1024 sc1
	buffer_load_dwordx4 a[80:83], v4, s[4:7], s42 offen offset:2048 sc1
	s_waitcnt vmcnt(10)
	s_add_u32 s42, s40, 8192
	buffer_load_dwordx4 a[92:95], v4, s[4:7], s42 offen offset:1024 sc1
	buffer_load_dwordx4 a[96:99], v4, s[4:7], s42 offen offset:2048 sc1
	s_waitcnt vmcnt(10)
	buffer_load_dwordx4 a[100:103], v4, s[4:7], s42 offen offset:3072 sc1
	s_add_u32 s42, s40, 12288
	buffer_load_dwordx4 a[104:107], v4, s[4:7], s42 offen offset:0 sc1
	s_waitcnt vmcnt(10)
	buffer_load_dwordx4 a[108:111], v4, s[4:7], s42 offen offset:1024 sc1
	s_add_u32 s40, s41, 6451200
	s_add_u32 s42, s40, 0
	buffer_load_dwordx4 a[120:123], v4, s[4:7], s42 offen offset:2048 sc1
	s_waitcnt vmcnt(10)
	buffer_load_dwordx4 a[124:127], v4, s[4:7], s42 offen offset:3072 sc1
	s_add_u32 s42, s40, 4096
	buffer_load_dwordx4 a[128:131], v4, s[4:7], s42 offen offset:0 sc1
	s_waitcnt vmcnt(10)
	buffer_load_dwordx4 a[132:135], v4, s[4:7], s42 offen offset:1024 sc1
	buffer_load_dwordx4 a[136:139], v4, s[4:7], s42 offen offset:2048 sc1
	s_waitcnt vmcnt(10)
	s_add_u32 s42, s40, 8192
	buffer_load_dwordx4 a[148:151], v4, s[4:7], s42 offen offset:1024 sc1
	buffer_load_dwordx4 a[152:155], v4, s[4:7], s42 offen offset:2048 sc1
	s_waitcnt vmcnt(10)
	buffer_load_dwordx4 a[156:159], v4, s[4:7], s42 offen offset:3072 sc1
	s_add_u32 s42, s40, 12288
	buffer_load_dwordx4 a[160:163], v4, s[4:7], s42 offen offset:0 sc1
	s_waitcnt vmcnt(10)
	buffer_load_dwordx4 a[164:167], v4, s[4:7], s42 offen offset:1024 sc1
	s_add_u32 s40, s41, 6465536
	s_add_u32 s42, s40, 0
	buffer_load_dwordx4 a[176:179], v4, s[4:7], s42 offen offset:2048 sc1
	s_waitcnt vmcnt(10)
	buffer_load_dwordx4 a[180:183], v4, s[4:7], s42 offen offset:3072 sc1
	s_add_u32 s42, s40, 4096
	buffer_load_dwordx4 a[184:187], v4, s[4:7], s42 offen offset:0 sc1
	s_waitcnt vmcnt(10)
	buffer_load_dwordx4 a[188:191], v4, s[4:7], s42 offen offset:1024 sc1
	buffer_load_dwordx4 a[192:195], v4, s[4:7], s42 offen offset:2048 sc1
	s_waitcnt vmcnt(10)
	s_add_u32 s42, s40, 8192
	buffer_load_dwordx4 a[204:207], v4, s[4:7], s42 offen offset:1024 sc1
	buffer_load_dwordx4 a[208:211], v4, s[4:7], s42 offen offset:2048 sc1
	s_waitcnt vmcnt(10)
	buffer_load_dwordx4 a[212:215], v4, s[4:7], s42 offen offset:3072 sc1
	s_add_u32 s42, s40, 12288
	buffer_load_dwordx4 a[216:219], v4, s[4:7], s42 offen offset:0 sc1
	s_waitcnt vmcnt(10)
	buffer_load_dwordx4 a[220:223], v4, s[4:7], s42 offen offset:1024 sc1
	s_add_u32 s40, s41, 6479872
	s_add_u32 s42, s40, 0
	buffer_load_dwordx4 a[232:235], v4, s[4:7], s42 offen offset:2048 sc1
	s_waitcnt vmcnt(10)
	buffer_load_dwordx4 a[236:239], v4, s[4:7], s42 offen offset:3072 sc1
	s_add_u32 s42, s40, 4096
	buffer_load_dwordx4 a[240:243], v4, s[4:7], s42 offen offset:0 sc1
	s_waitcnt vmcnt(10)
	buffer_load_dwordx4 a[244:247], v4, s[4:7], s42 offen offset:1024 sc1
	buffer_load_dwordx4 a[248:251], v4, s[4:7], s42 offen offset:2048 sc1
	s_waitcnt vmcnt(10)
	s_add_u32 s42, s40, 8192
	buffer_load_dwordx4 v[124:127], v4, s[4:7], s42 offen offset:1024 sc1
	buffer_load_dwordx4 v[128:131], v4, s[4:7], s42 offen offset:2048 sc1
	s_waitcnt vmcnt(10)
	buffer_load_dwordx4 v[132:135], v4, s[4:7], s42 offen offset:3072 sc1
	s_add_u32 s42, s40, 12288
	buffer_load_dwordx4 v[136:139], v4, s[4:7], s42 offen offset:0 sc1
	s_waitcnt vmcnt(10)
	buffer_load_dwordx4 v[140:143], v4, s[4:7], s42 offen offset:1024 sc1
	s_add_u32 s40, s41, 6494208
	s_add_u32 s42, s40, 0
	buffer_load_dwordx4 v[152:155], v4, s[4:7], s42 offen offset:2048 sc1
	s_waitcnt vmcnt(10)
	buffer_load_dwordx4 v[156:159], v4, s[4:7], s42 offen offset:3072 sc1
	s_add_u32 s42, s40, 4096
	buffer_load_dwordx4 v[160:163], v4, s[4:7], s42 offen offset:0 sc1
	s_waitcnt vmcnt(10)
	buffer_load_dwordx4 v[164:167], v4, s[4:7], s42 offen offset:1024 sc1
	buffer_load_dwordx4 v[168:171], v4, s[4:7], s42 offen offset:2048 sc1
	s_waitcnt vmcnt(10)
	s_add_u32 s42, s40, 8192
	buffer_load_dwordx4 v[180:183], v4, s[4:7], s42 offen offset:1024 sc1
	buffer_load_dwordx4 v[184:187], v4, s[4:7], s42 offen offset:2048 sc1
	s_waitcnt vmcnt(10)
	buffer_load_dwordx4 v[188:191], v4, s[4:7], s42 offen offset:3072 sc1
	s_add_u32 s42, s40, 12288
	buffer_load_dwordx4 v[192:195], v4, s[4:7], s42 offen offset:0 sc1
	s_waitcnt vmcnt(10)
	buffer_load_dwordx4 v[196:199], v4, s[4:7], s42 offen offset:1024 sc1
	s_add_u32 s40, s41, 6508544
	s_add_u32 s42, s40, 0
	buffer_load_dwordx4 v[208:211], v4, s[4:7], s42 offen offset:2048 sc1
	s_waitcnt vmcnt(10)
	buffer_load_dwordx4 v[212:215], v4, s[4:7], s42 offen offset:3072 sc1
	s_add_u32 s42, s40, 4096
	buffer_load_dwordx4 v[216:219], v4, s[4:7], s42 offen offset:0 sc1
	s_waitcnt vmcnt(10)
	buffer_load_dwordx4 v[220:223], v4, s[4:7], s42 offen offset:1024 sc1
	buffer_load_dwordx4 v[224:227], v4, s[4:7], s42 offen offset:2048 sc1
	s_waitcnt vmcnt(10)
	s_add_u32 s42, s40, 8192
	buffer_load_dwordx4 v[236:239], v4, s[4:7], s42 offen offset:1024 sc1
	buffer_load_dwordx4 v[240:243], v4, s[4:7], s42 offen offset:2048 sc1
	s_waitcnt vmcnt(10)
	buffer_load_dwordx4 v[244:247], v4, s[4:7], s42 offen offset:3072 sc1
	s_add_u32 s42, s40, 12288
	buffer_load_dwordx4 v[248:251], v4, s[4:7], s42 offen offset:0 sc1
	s_waitcnt vmcnt(10)
	buffer_load_dwordx4 v[252:255], v4, s[4:7], s42 offen offset:1024 sc1
	s_add_u32 s40, s41, 9777152
	s_add_u32 s42, s40, 0
	s_mov_b32 m0, 32768
	s_nop 0
	buffer_load_dwordx4 v4, s[4:7], s42 offen offset:2048 sc1 lds
	s_waitcnt vmcnt(10)
	buffer_load_dwordx4 v4, s[4:7], s42 offen offset:3072 sc1 lds
	s_add_u32 s42, s40, 4096
	s_mov_b32 m0, 36864
	s_nop 0
	buffer_load_dwordx4 v4, s[4:7], s42 offen offset:0 sc1 lds
	s_waitcnt vmcnt(10)
	buffer_load_dwordx4 v4, s[4:7], s42 offen offset:1024 sc1 lds
	buffer_load_dwordx4 v4, s[4:7], s42 offen offset:2048 sc1 lds
	s_waitcnt vmcnt(10)
	s_add_u32 s42, s40, 8192
	s_mov_b32 m0, 40960
	s_nop 0
	buffer_load_dwordx4 v4, s[4:7], s42 offen offset:1024 sc1 lds
	buffer_load_dwordx4 v4, s[4:7], s42 offen offset:2048 sc1 lds
	s_waitcnt vmcnt(10)
	buffer_load_dwordx4 v4, s[4:7], s42 offen offset:3072 sc1 lds
	s_add_u32 s42, s40, 12288
	s_mov_b32 m0, 45056
	s_nop 0
	buffer_load_dwordx4 v4, s[4:7], s42 offen offset:0 sc1 lds
	s_waitcnt vmcnt(10)
	buffer_load_dwordx4 v4, s[4:7], s42 offen offset:1024 sc1 lds
	v_mov_b64 v[48:49], 0
	v_mov_b64 v[50:51], 0
	v_mov_b64 v[52:53], 0
	v_mov_b64 v[54:55], 0
	v_mov_b64 v[56:57], 0
	v_mov_b64 v[58:59], 0
	v_mov_b64 v[60:61], 0
	v_mov_b64 v[62:63], 0
	v_mov_b64 v[64:65], 0
	v_mov_b64 v[66:67], 0
	v_mov_b64 v[68:69], 0
	v_mov_b64 v[70:71], 0
	v_mov_b64 v[72:73], 0
	v_mov_b64 v[74:75], 0
	v_mov_b64 v[76:77], 0
	v_mov_b64 v[78:79], 0
	v_mov_b64 v[80:81], 0
	v_mov_b64 v[82:83], 0
	s_lshl_b32 s40, s32, 10
	s_add_u32 s20, s20, s40
	s_add_u32 s21, s20, 49152
	s_waitcnt vmcnt(0)
	s_barrier
	s_barrier
.p2align 6
Lcb_loop0:
	s_nop 9
	s_add_u32 s16, s16, 1
Lmp_74:
	buffer_load_dwordx4 v[20:23], v4, s[4:7], s26 offen offset:0 sc1
	buffer_load_dwordx4 v[24:27], v4, s[4:7], s26 offen offset:1024 sc1
	ds_read_b128 v[84:87], v4 offset:47104
	ds_read_b128 v[88:91], v4 offset:48128
	ds_read_b128 v[92:95], v4 offset:49152
	ds_read_b128 v[96:99], v4 offset:50176
	ds_read_b128 v[100:103], v4 offset:51200
	ds_read_b128 v[104:107], v4 offset:52224
	s_waitcnt vmcnt(1)
	ds_write_b128 v11, v[20:23] offset:57344
	s_waitcnt vmcnt(0)
	ds_write_b128 v11, v[24:27] offset:58368
	v_dot2_f32_bf16 v17, v20, v21, 0
	v_dot2_f32_bf16 v17, v22, v23, v17
	v_dot2_f32_bf16 v17, v24, v25, v17
	v_dot2_f32_bf16 v17, v26, v27, v17
	s_nop 2
	v_cmp_u_f32 vcc, v17, v17
	s_cbranch_vccnz Lmr_75
Lmo_76:
	v_smfmac_f32_16x16x64_bf16 v[48:51], v[20:23], a[0:7], v1
	v_smfmac_f32_16x16x64_bf16 v[52:55], v[20:23], a[56:63], v1
	s_waitcnt lgkmcnt(0)
	s_barrier
	ds_read_b128 v[28:31], v11 offset:59392
	ds_read_b128 v[32:35], v11 offset:60416
	ds_read_b128 v[36:39], v11 offset:61440
	ds_read_b128 v[40:43], v11 offset:62464
	ds_read_b128 v[44:47], v11 offset:63488
	buffer_store_dwordx4 v[12:15], v16, s[4:7], s19 offen
	s_cmp_ge_u32 s32, 10
	s_cbranch_scc1 Lsk_77
	buffer_store_dwordx4 v[12:15], v4, s[4:7], s21 offen
Lsk_77:
	v_smfmac_f32_16x16x64_bf16 v[56:59], v[20:23], a[112:119], v1
	v_smfmac_f32_16x16x64_bf16 v[60:63], v[20:23], a[168:175], v1
	v_smfmac_f32_16x16x64_bf16 v[64:67], v[20:23], a[224:231], v1
	v_smfmac_f32_16x16x64_bf16 v[68:71], v[20:23], v[144:151], v1
	v_smfmac_f32_16x16x64_bf16 v[72:75], v[20:23], v[200:207], v1
	v_smfmac_f32_16x16x64_bf16 v[48:51], v[24:27], a[8:15], v1
	v_smfmac_f32_16x16x64_bf16 v[52:55], v[24:27], a[64:71], v1
	v_smfmac_f32_16x16x64_bf16 v[56:59], v[24:27], a[120:127], v1
	s_waitcnt lgkmcnt(0)
	v_smfmac_f32_16x16x64_bf16 v[48:51], v[28:31], a[16:23], v1
	v_smfmac_f32_16x16x64_bf16 v[48:51], v[32:35], a[24:31], v1
	s_waitcnt lgkmcnt(4)
	v_smfmac_f32_16x16x64_bf16 v[76:79], v[20:23], v[84:91], v1
	ds_read_b128 v[84:87], v4 offset:53248
	ds_read_b128 v[88:91], v4 offset:54272
	v_smfmac_f32_16x16x64_bf16 v[48:51], v[36:39], a[32:39], v1
	v_smfmac_f32_16x16x64_bf16 v[48:51], v[40:43], a[40:47], v1
	s_waitcnt lgkmcnt(4)
	v_smfmac_f32_16x16x64_bf16 v[76:79], v[24:27], v[92:99], v1
	ds_read_b128 v[92:95], v4 offset:55296
	ds_read_b128 v[96:99], v4 offset:56320
	v_smfmac_f32_16x16x64_bf16 v[48:51], v[44:47], a[48:55], v1
	v_smfmac_f32_16x16x64_bf16 v[52:55], v[28:31], a[72:79], v1
	s_waitcnt lgkmcnt(4)
	v_smfmac_f32_16x16x64_bf16 v[76:79], v[28:31], v[100:107], v1
	ds_read_b128 v[100:103], v4 offset:57344
	ds_read_b128 v[104:107], v4 offset:58368
	v_smfmac_f32_16x16x64_bf16 v[52:55], v[32:35], a[80:87], v1
	v_add_f32 v48, v48, v50
	v_smfmac_f32_16x16x64_bf16 v[52:55], v[36:39], a[88:95], v1
	v_add_f32 v49, v49, v51
	v_smfmac_f32_16x16x64_bf16 v[52:55], v[40:43], a[96:103], v1
	v_cvt_pk_bf16_f32 v48, v48, v49
	s_waitcnt lgkmcnt(4)
	v_smfmac_f32_16x16x64_bf16 v[76:79], v[32:35], v[84:91], v1
	ds_read_b128 v[84:87], v4 offset:59392
	ds_read_b128 v[88:91], v4 offset:60416
	v_smfmac_f32_16x16x64_bf16 v[52:55], v[44:47], a[104:111], v1
	ds_write_b32 v10, v48 offset:0
	v_smfmac_f32_16x16x64_bf16 v[56:59], v[28:31], a[128:135], v1
	v_smfmac_f32_16x16x64_bf16 v[56:59], v[32:35], a[136:143], v1
	s_waitcnt lgkmcnt(4)
	v_smfmac_f32_16x16x64_bf16 v[76:79], v[36:39], v[92:99], v1
	ds_read_b128 v[92:95], v4 offset:61440
	ds_read_b128 v[96:99], v4 offset:62464
	v_add_f32 v52, v52, v54
	v_smfmac_f32_16x16x64_bf16 v[56:59], v[36:39], a[144:151], v1
	v_add_f32 v53, v53, v55
	v_smfmac_f32_16x16x64_bf16 v[56:59], v[40:43], a[152:159], v1
	v_cvt_pk_bf16_f32 v52, v52, v53
	v_smfmac_f32_16x16x64_bf16 v[56:59], v[44:47], a[160:167], v1
	ds_write_b32 v10, v52 offset:256
	s_waitcnt lgkmcnt(4)
	v_smfmac_f32_16x16x64_bf16 v[76:79], v[40:43], v[100:107], v1
	ds_read_b128 v[100:103], v4 offset:63488
	ds_read_b128 v[104:107], v4 offset:64512
	v_smfmac_f32_16x16x64_bf16 v[60:63], v[24:27], a[176:183], v1
	v_smfmac_f32_16x16x64_bf16 v[60:63], v[28:31], a[184:191], v1
	v_add_f32 v56, v56, v58
	v_smfmac_f32_16x16x64_bf16 v[60:63], v[32:35], a[192:199], v1
	v_add_f32 v57, v57, v59
	s_waitcnt lgkmcnt(4)
	v_smfmac_f32_16x16x64_bf16 v[76:79], v[44:47], v[84:91], v1
	ds_read_b128 v[84:87], v11 offset:4096
	ds_read_b128 v[88:91], v11 offset:5120
	v_cvt_pk_bf16_f32 v56, v56, v57
	v_smfmac_f32_16x16x64_bf16 v[60:63], v[36:39], a[200:207], v1
	ds_write_b32 v10, v56 offset:512
	v_smfmac_f32_16x16x64_bf16 v[60:63], v[40:43], a[208:215], v1
	v_smfmac_f32_16x16x64_bf16 v[60:63], v[44:47], a[216:223], v1
	v_add_f32 v76, v76, v78
	s_waitcnt lgkmcnt(4)
	v_smfmac_f32_16x16x64_bf16 v[80:83], v[20:23], v[92:99], v1
	ds_read_b128 v[92:95], v11 offset:6144
	ds_read_b128 v[96:99], v11 offset:7168
	v_add_f32 v77, v77, v79
	v_smfmac_f32_16x16x64_bf16 v[64:67], v[24:27], a[232:239], v1
	v_cvt_pk_bf16_f32 v76, v76, v77
	v_smfmac_f32_16x16x64_bf16 v[64:67], v[28:31], a[240:247], v1
	v_add_f32 v60, v60, v62
	v_smfmac_f32_16x16x64_bf16 v[64:67], v[32:35], a[248:255], v1
	v_add_f32 v61, v61, v63
	s_waitcnt lgkmcnt(4)
	v_smfmac_f32_16x16x64_bf16 v[80:83], v[24:27], v[100:107], v1
	ds_read_b128 v[100:103], v11 offset:8192
	ds_read_b128 v[104:107], v11 offset:9216
	v_cvt_pk_bf16_f32 v60, v60, v61
	v_smfmac_f32_16x16x64_bf16 v[64:67], v[36:39], v[120:127], v1
	ds_write_b32 v10, v76 offset:6912
	v_smfmac_f32_16x16x64_bf16 v[64:67], v[40:43], v[128:135], v1
	ds_write_b32 v10, v60 offset:768
	v_smfmac_f32_16x16x64_bf16 v[64:67], v[44:47], v[136:143], v1
	s_waitcnt lgkmcnt(4)
	v_smfmac_f32_16x16x64_bf16 v[80:83], v[28:31], v[84:91], v1
	ds_read_b128 v[84:87], v11 offset:10240
	ds_read_b128 v[88:91], v11 offset:11264
	v_smfmac_f32_16x16x64_bf16 v[68:71], v[24:27], v[152:159], v1
	v_smfmac_f32_16x16x64_bf16 v[68:71], v[28:31], v[160:167], v1
	v_add_f32 v64, v64, v66
	v_smfmac_f32_16x16x64_bf16 v[68:71], v[32:35], v[168:175], v1
	v_add_f32 v65, v65, v67
	s_waitcnt lgkmcnt(4)
	v_smfmac_f32_16x16x64_bf16 v[80:83], v[32:35], v[92:99], v1
	ds_read_b128 v[92:95], v11 offset:12288
	ds_read_b128 v[96:99], v11 offset:13312
	v_cvt_pk_bf16_f32 v64, v64, v65
	v_smfmac_f32_16x16x64_bf16 v[68:71], v[36:39], v[176:183], v1
	ds_write_b32 v10, v64 offset:1024
	v_smfmac_f32_16x16x64_bf16 v[68:71], v[40:43], v[184:191], v1
	v_smfmac_f32_16x16x64_bf16 v[68:71], v[44:47], v[192:199], v1
	s_waitcnt lgkmcnt(4)
	v_smfmac_f32_16x16x64_bf16 v[80:83], v[36:39], v[100:107], v1
	v_smfmac_f32_16x16x64_bf16 v[72:75], v[24:27], v[208:215], v1
	v_smfmac_f32_16x16x64_bf16 v[72:75], v[28:31], v[216:223], v1
	v_add_f32 v68, v68, v70
	v_smfmac_f32_16x16x64_bf16 v[72:75], v[32:35], v[224:231], v1
	v_add_f32 v69, v69, v71
	s_waitcnt lgkmcnt(2)
	v_smfmac_f32_16x16x64_bf16 v[80:83], v[40:43], v[84:91], v1
	v_cvt_pk_bf16_f32 v68, v68, v69
	v_smfmac_f32_16x16x64_bf16 v[72:75], v[36:39], v[232:239], v1
	ds_write_b32 v10, v68 offset:1280
	v_smfmac_f32_16x16x64_bf16 v[72:75], v[40:43], v[240:247], v1
	v_smfmac_f32_16x16x64_bf16 v[72:75], v[44:47], v[248:255], v1
	s_waitcnt lgkmcnt(0)
	v_smfmac_f32_16x16x64_bf16 v[80:83], v[44:47], v[92:99], v1
	s_nop 4
	v_add_f32 v72, v72, v74
	v_add_f32 v73, v73, v75
	v_cvt_pk_bf16_f32 v72, v72, v73
	ds_write_b32 v10, v72 offset:1536
	v_add_f32 v80, v80, v82
	v_add_f32 v81, v81, v83
	v_cvt_pk_bf16_f32 v80, v80, v81
	ds_write_b32 v10, v80 offset:7168
	s_waitcnt vmcnt(0) lgkmcnt(0)
	s_barrier
	s_add_u32 s19, s19, 8192
	s_mov_b32 s21, s20
	s_add_u32 s26, s26, 8192
	s_add_u32 s27, s27, 8192
	v_add_u32 v10, 8192, v10
	v_and_b32 v10, 0x7fff, v10
	s_and_b32 s23, s16, 3
	s_cselect_b32 s23, s24, -49152
	s_add_u32 s20, s20, s23
	v_mov_b64 v[48:49], 0
	v_mov_b64 v[50:51], 0
	v_mov_b64 v[52:53], 0
	v_mov_b64 v[54:55], 0
	v_mov_b64 v[56:57], 0
	v_mov_b64 v[58:59], 0
	v_mov_b64 v[60:61], 0
	v_mov_b64 v[62:63], 0
	v_mov_b64 v[64:65], 0
	v_mov_b64 v[66:67], 0
	v_mov_b64 v[68:69], 0
	v_mov_b64 v[70:71], 0
	v_mov_b64 v[72:73], 0
	v_mov_b64 v[74:75], 0
	v_mov_b64 v[76:77], 0
	v_mov_b64 v[78:79], 0
	v_mov_b64 v[80:81], 0
	v_mov_b64 v[82:83], 0
	s_barrier
	s_cmp_lg_u32 s16, 63
	s_cbranch_scc1 Lcb_loop0
	s_nop 9
	s_add_u32 s16, s16, 1
Lmp_78:
	buffer_load_dwordx4 v[20:23], v4, s[4:7], s26 offen offset:0 sc1
	buffer_load_dwordx4 v[24:27], v4, s[4:7], s26 offen offset:1024 sc1
	ds_read_b128 v[84:87], v4 offset:47104
	ds_read_b128 v[88:91], v4 offset:48128
	ds_read_b128 v[92:95], v4 offset:49152
	ds_read_b128 v[96:99], v4 offset:50176
	ds_read_b128 v[100:103], v4 offset:51200
	ds_read_b128 v[104:107], v4 offset:52224
	s_waitcnt vmcnt(1)
	ds_write_b128 v11, v[20:23] offset:57344
	s_waitcnt vmcnt(0)
	ds_write_b128 v11, v[24:27] offset:58368
	v_dot2_f32_bf16 v17, v20, v21, 0
	v_dot2_f32_bf16 v17, v22, v23, v17
	v_dot2_f32_bf16 v17, v24, v25, v17
	v_dot2_f32_bf16 v17, v26, v27, v17
	s_nop 2
	v_cmp_u_f32 vcc, v17, v17
	s_cbranch_vccnz Lmr_79
Lmo_80:
	v_smfmac_f32_16x16x64_bf16 v[48:51], v[20:23], a[0:7], v1
	v_smfmac_f32_16x16x64_bf16 v[52:55], v[20:23], a[56:63], v1
	s_waitcnt lgkmcnt(0)
	s_barrier
	ds_read_b128 v[28:31], v11 offset:59392
	ds_read_b128 v[32:35], v11 offset:60416
	ds_read_b128 v[36:39], v11 offset:61440
	ds_read_b128 v[40:43], v11 offset:62464
	ds_read_b128 v[44:47], v11 offset:63488
	v_smfmac_f32_16x16x64_bf16 v[56:59], v[20:23], a[112:119], v1
	v_smfmac_f32_16x16x64_bf16 v[60:63], v[20:23], a[168:175], v1
	v_smfmac_f32_16x16x64_bf16 v[64:67], v[20:23], a[224:231], v1
	v_smfmac_f32_16x16x64_bf16 v[68:71], v[20:23], v[144:151], v1
	v_smfmac_f32_16x16x64_bf16 v[72:75], v[20:23], v[200:207], v1
	v_smfmac_f32_16x16x64_bf16 v[48:51], v[24:27], a[8:15], v1
	v_smfmac_f32_16x16x64_bf16 v[52:55], v[24:27], a[64:71], v1
	v_smfmac_f32_16x16x64_bf16 v[56:59], v[24:27], a[120:127], v1
	s_waitcnt lgkmcnt(0)
	v_smfmac_f32_16x16x64_bf16 v[48:51], v[28:31], a[16:23], v1
	v_smfmac_f32_16x16x64_bf16 v[48:51], v[32:35], a[24:31], v1
	s_waitcnt lgkmcnt(4)
	v_smfmac_f32_16x16x64_bf16 v[76:79], v[20:23], v[84:91], v1
	ds_read_b128 v[84:87], v4 offset:53248
	ds_read_b128 v[88:91], v4 offset:54272
	v_smfmac_f32_16x16x64_bf16 v[48:51], v[36:39], a[32:39], v1
	v_smfmac_f32_16x16x64_bf16 v[48:51], v[40:43], a[40:47], v1
	s_waitcnt lgkmcnt(4)
	v_smfmac_f32_16x16x64_bf16 v[76:79], v[24:27], v[92:99], v1
	ds_read_b128 v[92:95], v4 offset:55296
	ds_read_b128 v[96:99], v4 offset:56320
	v_smfmac_f32_16x16x64_bf16 v[48:51], v[44:47], a[48:55], v1
	v_smfmac_f32_16x16x64_bf16 v[52:55], v[28:31], a[72:79], v1
	s_waitcnt lgkmcnt(4)
	v_smfmac_f32_16x16x64_bf16 v[76:79], v[28:31], v[100:107], v1
	ds_read_b128 v[100:103], v4 offset:57344
	ds_read_b128 v[104:107], v4 offset:58368
	v_smfmac_f32_16x16x64_bf16 v[52:55], v[32:35], a[80:87], v1
	v_add_f32 v48, v48, v50
	v_smfmac_f32_16x16x64_bf16 v[52:55], v[36:39], a[88:95], v1
	v_add_f32 v49, v49, v51
	v_smfmac_f32_16x16x64_bf16 v[52:55], v[40:43], a[96:103], v1
	v_cvt_pk_bf16_f32 v48, v48, v49
	s_waitcnt lgkmcnt(4)
	v_smfmac_f32_16x16x64_bf16 v[76:79], v[32:35], v[84:91], v1
	ds_read_b128 v[84:87], v4 offset:59392
	ds_read_b128 v[88:91], v4 offset:60416
	v_smfmac_f32_16x16x64_bf16 v[52:55], v[44:47], a[104:111], v1
	ds_write_b32 v10, v48 offset:0
	v_smfmac_f32_16x16x64_bf16 v[56:59], v[28:31], a[128:135], v1
	v_smfmac_f32_16x16x64_bf16 v[56:59], v[32:35], a[136:143], v1
	s_waitcnt lgkmcnt(4)
	v_smfmac_f32_16x16x64_bf16 v[76:79], v[36:39], v[92:99], v1
	ds_read_b128 v[92:95], v4 offset:61440
	ds_read_b128 v[96:99], v4 offset:62464
	v_add_f32 v52, v52, v54
	v_smfmac_f32_16x16x64_bf16 v[56:59], v[36:39], a[144:151], v1
	v_add_f32 v53, v53, v55
	v_smfmac_f32_16x16x64_bf16 v[56:59], v[40:43], a[152:159], v1
	v_cvt_pk_bf16_f32 v52, v52, v53
	v_smfmac_f32_16x16x64_bf16 v[56:59], v[44:47], a[160:167], v1
	ds_write_b32 v10, v52 offset:256
	s_waitcnt lgkmcnt(4)
	v_smfmac_f32_16x16x64_bf16 v[76:79], v[40:43], v[100:107], v1
	ds_read_b128 v[100:103], v4 offset:63488
	ds_read_b128 v[104:107], v4 offset:64512
	v_smfmac_f32_16x16x64_bf16 v[60:63], v[24:27], a[176:183], v1
	v_smfmac_f32_16x16x64_bf16 v[60:63], v[28:31], a[184:191], v1
	v_add_f32 v56, v56, v58
	v_smfmac_f32_16x16x64_bf16 v[60:63], v[32:35], a[192:199], v1
	v_add_f32 v57, v57, v59
	s_waitcnt lgkmcnt(4)
	v_smfmac_f32_16x16x64_bf16 v[76:79], v[44:47], v[84:91], v1
	ds_read_b128 v[84:87], v11 offset:4096
	ds_read_b128 v[88:91], v11 offset:5120
	v_cvt_pk_bf16_f32 v56, v56, v57
	v_smfmac_f32_16x16x64_bf16 v[60:63], v[36:39], a[200:207], v1
	ds_write_b32 v10, v56 offset:512
	v_smfmac_f32_16x16x64_bf16 v[60:63], v[40:43], a[208:215], v1
	v_smfmac_f32_16x16x64_bf16 v[60:63], v[44:47], a[216:223], v1
	v_add_f32 v76, v76, v78
	s_waitcnt lgkmcnt(4)
	v_smfmac_f32_16x16x64_bf16 v[80:83], v[20:23], v[92:99], v1
	ds_read_b128 v[92:95], v11 offset:6144
	ds_read_b128 v[96:99], v11 offset:7168
	v_add_f32 v77, v77, v79
	v_smfmac_f32_16x16x64_bf16 v[64:67], v[24:27], a[232:239], v1
	v_cvt_pk_bf16_f32 v76, v76, v77
	v_smfmac_f32_16x16x64_bf16 v[64:67], v[28:31], a[240:247], v1
	v_add_f32 v60, v60, v62
	v_smfmac_f32_16x16x64_bf16 v[64:67], v[32:35], a[248:255], v1
	v_add_f32 v61, v61, v63
	s_waitcnt lgkmcnt(4)
	v_smfmac_f32_16x16x64_bf16 v[80:83], v[24:27], v[100:107], v1
	ds_read_b128 v[100:103], v11 offset:8192
	ds_read_b128 v[104:107], v11 offset:9216
	v_cvt_pk_bf16_f32 v60, v60, v61
	v_smfmac_f32_16x16x64_bf16 v[64:67], v[36:39], v[120:127], v1
	ds_write_b32 v10, v76 offset:6912
	v_smfmac_f32_16x16x64_bf16 v[64:67], v[40:43], v[128:135], v1
	ds_write_b32 v10, v60 offset:768
	v_smfmac_f32_16x16x64_bf16 v[64:67], v[44:47], v[136:143], v1
	s_waitcnt lgkmcnt(4)
	v_smfmac_f32_16x16x64_bf16 v[80:83], v[28:31], v[84:91], v1
	ds_read_b128 v[84:87], v11 offset:10240
	ds_read_b128 v[88:91], v11 offset:11264
	v_smfmac_f32_16x16x64_bf16 v[68:71], v[24:27], v[152:159], v1
	v_smfmac_f32_16x16x64_bf16 v[68:71], v[28:31], v[160:167], v1
	v_add_f32 v64, v64, v66
	v_smfmac_f32_16x16x64_bf16 v[68:71], v[32:35], v[168:175], v1
	v_add_f32 v65, v65, v67
	s_waitcnt lgkmcnt(4)
	v_smfmac_f32_16x16x64_bf16 v[80:83], v[32:35], v[92:99], v1
	ds_read_b128 v[92:95], v11 offset:12288
	ds_read_b128 v[96:99], v11 offset:13312
	v_cvt_pk_bf16_f32 v64, v64, v65
	v_smfmac_f32_16x16x64_bf16 v[68:71], v[36:39], v[176:183], v1
	ds_write_b32 v10, v64 offset:1024
	v_smfmac_f32_16x16x64_bf16 v[68:71], v[40:43], v[184:191], v1
	v_smfmac_f32_16x16x64_bf16 v[68:71], v[44:47], v[192:199], v1
	s_waitcnt lgkmcnt(4)
	v_smfmac_f32_16x16x64_bf16 v[80:83], v[36:39], v[100:107], v1
	v_smfmac_f32_16x16x64_bf16 v[72:75], v[24:27], v[208:215], v1
	v_smfmac_f32_16x16x64_bf16 v[72:75], v[28:31], v[216:223], v1
	v_add_f32 v68, v68, v70
	v_smfmac_f32_16x16x64_bf16 v[72:75], v[32:35], v[224:231], v1
	v_add_f32 v69, v69, v71
	s_waitcnt lgkmcnt(2)
	v_smfmac_f32_16x16x64_bf16 v[80:83], v[40:43], v[84:91], v1
	v_cvt_pk_bf16_f32 v68, v68, v69
	v_smfmac_f32_16x16x64_bf16 v[72:75], v[36:39], v[232:239], v1
	ds_write_b32 v10, v68 offset:1280
	v_smfmac_f32_16x16x64_bf16 v[72:75], v[40:43], v[240:247], v1
	v_smfmac_f32_16x16x64_bf16 v[72:75], v[44:47], v[248:255], v1
	s_waitcnt lgkmcnt(0)
	v_smfmac_f32_16x16x64_bf16 v[80:83], v[44:47], v[92:99], v1
	s_nop 4
	v_add_f32 v72, v72, v74
	v_add_f32 v73, v73, v75
	v_cvt_pk_bf16_f32 v72, v72, v73
	ds_write_b32 v10, v72 offset:1536
	v_add_f32 v80, v80, v82
	v_add_f32 v81, v81, v83
	v_cvt_pk_bf16_f32 v80, v80, v81
	ds_write_b32 v10, v80 offset:7168
	s_waitcnt lgkmcnt(0)
	s_barrier
	s_lshl_b32 s41, s32, 12
	ds_read_b128 v[20:23], v4 offset:24576
	ds_read_b128 v[24:27], v4 offset:25600
	s_waitcnt lgkmcnt(0)
	s_add_u32 s40, s41, 49430528
	buffer_store_dwordx4 v[20:23], v4, s[4:7], s40 offen offset:0 sc1
	buffer_store_dwordx4 v[24:27], v4, s[4:7], s40 offen offset:1024 sc1
	s_waitcnt vmcnt(0)
	s_endpgm
Lmr_75:
	s_cmp_eq_u32 s13, 0
	s_cbranch_scc1 Lmo_76
	s_sub_u32 s13, s13, 1
	s_branch Lmp_74
Lmr_79:
	s_cmp_eq_u32 s13, 0
	s_cbranch_scc1 Lmo_80
	s_sub_u32 s13, s13, 1
	s_branch Lmp_78
Lcb_w1:
	s_mul_i32 s41, s32, 229376
	s_add_u32 s40, s41, 6522880
	s_add_u32 s42, s40, 0
	buffer_load_dwordx4 a[0:3], v4, s[4:7], s42 offen offset:0 sc1
	buffer_load_dwordx4 a[4:7], v4, s[4:7], s42 offen offset:1024 sc1
	s_add_u32 s42, s40, 4096
	buffer_load_dwordx4 a[28:31], v4, s[4:7], s42 offen offset:3072 sc1
	s_add_u32 s42, s40, 8192
	buffer_load_dwordx4 a[32:35], v4, s[4:7], s42 offen offset:0 sc1
	s_add_u32 s40, s41, 6537216
	s_add_u32 s42, s40, 0
	buffer_load_dwordx4 a[56:59], v4, s[4:7], s42 offen offset:0 sc1
	buffer_load_dwordx4 a[60:63], v4, s[4:7], s42 offen offset:1024 sc1
	s_add_u32 s42, s40, 4096
	buffer_load_dwordx4 a[84:87], v4, s[4:7], s42 offen offset:3072 sc1
	s_add_u32 s42, s40, 8192
	buffer_load_dwordx4 a[88:91], v4, s[4:7], s42 offen offset:0 sc1
	s_add_u32 s40, s41, 6551552
	s_add_u32 s42, s40, 0
	buffer_load_dwordx4 a[112:115], v4, s[4:7], s42 offen offset:0 sc1
	buffer_load_dwordx4 a[116:119], v4, s[4:7], s42 offen offset:1024 sc1
	s_add_u32 s42, s40, 4096
	buffer_load_dwordx4 a[140:143], v4, s[4:7], s42 offen offset:3072 sc1
	s_waitcnt vmcnt(10)
	s_add_u32 s42, s40, 8192
	buffer_load_dwordx4 a[144:147], v4, s[4:7], s42 offen offset:0 sc1
	s_add_u32 s40, s41, 6565888
	s_add_u32 s42, s40, 0
	buffer_load_dwordx4 a[168:171], v4, s[4:7], s42 offen offset:0 sc1
	s_waitcnt vmcnt(10)
	buffer_load_dwordx4 a[172:175], v4, s[4:7], s42 offen offset:1024 sc1
	s_add_u32 s42, s40, 4096
	buffer_load_dwordx4 a[196:199], v4, s[4:7], s42 offen offset:3072 sc1
	s_waitcnt vmcnt(10)
	s_add_u32 s42, s40, 8192
	buffer_load_dwordx4 a[200:203], v4, s[4:7], s42 offen offset:0 sc1
	s_add_u32 s40, s41, 6580224
	s_add_u32 s42, s40, 0
	buffer_load_dwordx4 a[224:227], v4, s[4:7], s42 offen offset:0 sc1
	s_waitcnt vmcnt(10)
	buffer_load_dwordx4 a[228:231], v4, s[4:7], s42 offen offset:1024 sc1
	s_add_u32 s42, s40, 4096
	buffer_load_dwordx4 a[252:255], v4, s[4:7], s42 offen offset:3072 sc1
	s_waitcnt vmcnt(10)
	s_add_u32 s42, s40, 8192
	buffer_load_dwordx4 v[120:123], v4, s[4:7], s42 offen offset:0 sc1
	s_add_u32 s40, s41, 6594560
	s_add_u32 s42, s40, 0
	buffer_load_dwordx4 v[144:147], v4, s[4:7], s42 offen offset:0 sc1
	s_waitcnt vmcnt(10)
	buffer_load_dwordx4 v[148:151], v4, s[4:7], s42 offen offset:1024 sc1
	s_add_u32 s42, s40, 4096
	buffer_load_dwordx4 v[172:175], v4, s[4:7], s42 offen offset:3072 sc1
	s_waitcnt vmcnt(10)
	s_add_u32 s42, s40, 8192
	buffer_load_dwordx4 v[176:179], v4, s[4:7], s42 offen offset:0 sc1
	s_add_u32 s40, s41, 6608896
	s_add_u32 s42, s40, 0
	buffer_load_dwordx4 v[200:203], v4, s[4:7], s42 offen offset:0 sc1
	s_waitcnt vmcnt(10)
	buffer_load_dwordx4 v[204:207], v4, s[4:7], s42 offen offset:1024 sc1
	s_add_u32 s42, s40, 4096
	buffer_load_dwordx4 v[228:231], v4, s[4:7], s42 offen offset:3072 sc1
	s_waitcnt vmcnt(10)
	s_add_u32 s42, s40, 8192
	buffer_load_dwordx4 v[232:235], v4, s[4:7], s42 offen offset:0 sc1
	s_add_u32 s40, s41, 9791488
	s_add_u32 s42, s40, 0
	s_mov_b32 m0, 47104
	s_nop 0
	buffer_load_dwordx4 v4, s[4:7], s42 offen offset:0 sc1 lds
	s_waitcnt vmcnt(10)
	buffer_load_dwordx4 v4, s[4:7], s42 offen offset:1024 sc1 lds
	s_add_u32 s42, s40, 4096
	s_mov_b32 m0, 51200
	s_nop 0
	buffer_load_dwordx4 v4, s[4:7], s42 offen offset:3072 sc1 lds
	s_waitcnt vmcnt(10)
	s_add_u32 s42, s40, 8192
	s_mov_b32 m0, 55296
	s_nop 0
	buffer_load_dwordx4 v4, s[4:7], s42 offen offset:0 sc1 lds
	s_mov_b32 s40, 0x100000
Lww_81:
	buffer_load_dword v25, v26, s[4:7], s34 offen sc1
	s_sub_u32 s40, s40, 1
	s_cbranch_scc1 Lwx_82
	s_waitcnt vmcnt(0)
	v_cmp_gt_u32 vcc, 7, v25
	s_cbranch_vccnz Lww_81
Lwx_82:
	s_waitcnt vmcnt(0)
	s_add_u32 s40, s41, 6522880
	s_add_u32 s42, s40, 0
	buffer_load_dwordx4 a[8:11], v4, s[4:7], s42 offen offset:2048 sc1
	s_waitcnt vmcnt(10)
	buffer_load_dwordx4 a[12:15], v4, s[4:7], s42 offen offset:3072 sc1
	s_add_u32 s42, s40, 4096
	buffer_load_dwordx4 a[16:19], v4, s[4:7], s42 offen offset:0 sc1
	s_waitcnt vmcnt(10)
	buffer_load_dwordx4 a[20:23], v4, s[4:7], s42 offen offset:1024 sc1
	buffer_load_dwordx4 a[24:27], v4, s[4:7], s42 offen offset:2048 sc1
	s_waitcnt vmcnt(10)
	s_add_u32 s42, s40, 8192
	buffer_load_dwordx4 a[36:39], v4, s[4:7], s42 offen offset:1024 sc1
	buffer_load_dwordx4 a[40:43], v4, s[4:7], s42 offen offset:2048 sc1
	s_waitcnt vmcnt(10)
	buffer_load_dwordx4 a[44:47], v4, s[4:7], s42 offen offset:3072 sc1
	s_add_u32 s42, s40, 12288
	buffer_load_dwordx4 a[48:51], v4, s[4:7], s42 offen offset:0 sc1
	s_waitcnt vmcnt(10)
	buffer_load_dwordx4 a[52:55], v4, s[4:7], s42 offen offset:1024 sc1
	s_add_u32 s40, s41, 6537216
	s_add_u32 s42, s40, 0
	buffer_load_dwordx4 a[64:67], v4, s[4:7], s42 offen offset:2048 sc1
	s_waitcnt vmcnt(10)
	buffer_load_dwordx4 a[68:71], v4, s[4:7], s42 offen offset:3072 sc1
	s_add_u32 s42, s40, 4096
	buffer_load_dwordx4 a[72:75], v4, s[4:7], s42 offen offset:0 sc1
	s_waitcnt vmcnt(10)
	buffer_load_dwordx4 a[76:79], v4, s[4:7], s42 offen offset:1024 sc1
	buffer_load_dwordx4 a[80:83], v4, s[4:7], s42 offen offset:2048 sc1
	s_waitcnt vmcnt(10)
	s_add_u32 s42, s40, 8192
	buffer_load_dwordx4 a[92:95], v4, s[4:7], s42 offen offset:1024 sc1
	buffer_load_dwordx4 a[96:99], v4, s[4:7], s42 offen offset:2048 sc1
	s_waitcnt vmcnt(10)
	buffer_load_dwordx4 a[100:103], v4, s[4:7], s42 offen offset:3072 sc1
	s_add_u32 s42, s40, 12288
	buffer_load_dwordx4 a[104:107], v4, s[4:7], s42 offen offset:0 sc1
	s_waitcnt vmcnt(10)
	buffer_load_dwordx4 a[108:111], v4, s[4:7], s42 offen offset:1024 sc1
	s_add_u32 s40, s41, 6551552
	s_add_u32 s42, s40, 0
	buffer_load_dwordx4 a[120:123], v4, s[4:7], s42 offen offset:2048 sc1
	s_waitcnt vmcnt(10)
	buffer_load_dwordx4 a[124:127], v4, s[4:7], s42 offen offset:3072 sc1
	s_add_u32 s42, s40, 4096
	buffer_load_dwordx4 a[128:131], v4, s[4:7], s42 offen offset:0 sc1
	s_waitcnt vmcnt(10)
	buffer_load_dwordx4 a[132:135], v4, s[4:7], s42 offen offset:1024 sc1
	buffer_load_dwordx4 a[136:139], v4, s[4:7], s42 offen offset:2048 sc1
	s_waitcnt vmcnt(10)
	s_add_u32 s42, s40, 8192
	buffer_load_dwordx4 a[148:151], v4, s[4:7], s42 offen offset:1024 sc1
	buffer_load_dwordx4 a[152:155], v4, s[4:7], s42 offen offset:2048 sc1
	s_waitcnt vmcnt(10)
	buffer_load_dwordx4 a[156:159], v4, s[4:7], s42 offen offset:3072 sc1
	s_add_u32 s42, s40, 12288
	buffer_load_dwordx4 a[160:163], v4, s[4:7], s42 offen offset:0 sc1
	s_waitcnt vmcnt(10)
	buffer_load_dwordx4 a[164:167], v4, s[4:7], s42 offen offset:1024 sc1
	s_add_u32 s40, s41, 6565888
	s_add_u32 s42, s40, 0
	buffer_load_dwordx4 a[176:179], v4, s[4:7], s42 offen offset:2048 sc1
	s_waitcnt vmcnt(10)
	buffer_load_dwordx4 a[180:183], v4, s[4:7], s42 offen offset:3072 sc1
	s_add_u32 s42, s40, 4096
	buffer_load_dwordx4 a[184:187], v4, s[4:7], s42 offen offset:0 sc1
	s_waitcnt vmcnt(10)
	buffer_load_dwordx4 a[188:191], v4, s[4:7], s42 offen offset:1024 sc1
	buffer_load_dwordx4 a[192:195], v4, s[4:7], s42 offen offset:2048 sc1
	s_waitcnt vmcnt(10)
	s_add_u32 s42, s40, 8192
	buffer_load_dwordx4 a[204:207], v4, s[4:7], s42 offen offset:1024 sc1
	buffer_load_dwordx4 a[208:211], v4, s[4:7], s42 offen offset:2048 sc1
	s_waitcnt vmcnt(10)
	buffer_load_dwordx4 a[212:215], v4, s[4:7], s42 offen offset:3072 sc1
	s_add_u32 s42, s40, 12288
	buffer_load_dwordx4 a[216:219], v4, s[4:7], s42 offen offset:0 sc1
	s_waitcnt vmcnt(10)
	buffer_load_dwordx4 a[220:223], v4, s[4:7], s42 offen offset:1024 sc1
	s_add_u32 s40, s41, 6580224
	s_add_u32 s42, s40, 0
	buffer_load_dwordx4 a[232:235], v4, s[4:7], s42 offen offset:2048 sc1
	s_waitcnt vmcnt(10)
	buffer_load_dwordx4 a[236:239], v4, s[4:7], s42 offen offset:3072 sc1
	s_add_u32 s42, s40, 4096
	buffer_load_dwordx4 a[240:243], v4, s[4:7], s42 offen offset:0 sc1
	s_waitcnt vmcnt(10)
	buffer_load_dwordx4 a[244:247], v4, s[4:7], s42 offen offset:1024 sc1
	buffer_load_dwordx4 a[248:251], v4, s[4:7], s42 offen offset:2048 sc1
	s_waitcnt vmcnt(10)
	s_add_u32 s42, s40, 8192
	buffer_load_dwordx4 v[124:127], v4, s[4:7], s42 offen offset:1024 sc1
	buffer_load_dwordx4 v[128:131], v4, s[4:7], s42 offen offset:2048 sc1
	s_waitcnt vmcnt(10)
	buffer_load_dwordx4 v[132:135], v4, s[4:7], s42 offen offset:3072 sc1
	s_add_u32 s42, s40, 12288
	buffer_load_dwordx4 v[136:139], v4, s[4:7], s42 offen offset:0 sc1
	s_waitcnt vmcnt(10)
	buffer_load_dwordx4 v[140:143], v4, s[4:7], s42 offen offset:1024 sc1
	s_add_u32 s40, s41, 6594560
	s_add_u32 s42, s40, 0
	buffer_load_dwordx4 v[152:155], v4, s[4:7], s42 offen offset:2048 sc1
	s_waitcnt vmcnt(10)
	buffer_load_dwordx4 v[156:159], v4, s[4:7], s42 offen offset:3072 sc1
	s_add_u32 s42, s40, 4096
	buffer_load_dwordx4 v[160:163], v4, s[4:7], s42 offen offset:0 sc1
	s_waitcnt vmcnt(10)
	buffer_load_dwordx4 v[164:167], v4, s[4:7], s42 offen offset:1024 sc1
	buffer_load_dwordx4 v[168:171], v4, s[4:7], s42 offen offset:2048 sc1
	s_waitcnt vmcnt(10)
	s_add_u32 s42, s40, 8192
	buffer_load_dwordx4 v[180:183], v4, s[4:7], s42 offen offset:1024 sc1
	buffer_load_dwordx4 v[184:187], v4, s[4:7], s42 offen offset:2048 sc1
	s_waitcnt vmcnt(10)
	buffer_load_dwordx4 v[188:191], v4, s[4:7], s42 offen offset:3072 sc1
	s_add_u32 s42, s40, 12288
	buffer_load_dwordx4 v[192:195], v4, s[4:7], s42 offen offset:0 sc1
	s_waitcnt vmcnt(10)
	buffer_load_dwordx4 v[196:199], v4, s[4:7], s42 offen offset:1024 sc1
	s_add_u32 s40, s41, 6608896
	s_add_u32 s42, s40, 0
	buffer_load_dwordx4 v[208:211], v4, s[4:7], s42 offen offset:2048 sc1
	s_waitcnt vmcnt(10)
	buffer_load_dwordx4 v[212:215], v4, s[4:7], s42 offen offset:3072 sc1
	s_add_u32 s42, s40, 4096
	buffer_load_dwordx4 v[216:219], v4, s[4:7], s42 offen offset:0 sc1
	s_waitcnt vmcnt(10)
	buffer_load_dwordx4 v[220:223], v4, s[4:7], s42 offen offset:1024 sc1
	buffer_load_dwordx4 v[224:227], v4, s[4:7], s42 offen offset:2048 sc1
	s_waitcnt vmcnt(10)
	s_add_u32 s42, s40, 8192
	buffer_load_dwordx4 v[236:239], v4, s[4:7], s42 offen offset:1024 sc1
	buffer_load_dwordx4 v[240:243], v4, s[4:7], s42 offen offset:2048 sc1
	s_waitcnt vmcnt(10)
	buffer_load_dwordx4 v[244:247], v4, s[4:7], s42 offen offset:3072 sc1
	s_add_u32 s42, s40, 12288
	buffer_load_dwordx4 v[248:251], v4, s[4:7], s42 offen offset:0 sc1
	s_waitcnt vmcnt(10)
	buffer_load_dwordx4 v[252:255], v4, s[4:7], s42 offen offset:1024 sc1
	s_add_u32 s40, s41, 9791488
	s_add_u32 s42, s40, 0
	s_mov_b32 m0, 47104
	s_nop 0
	buffer_load_dwordx4 v4, s[4:7], s42 offen offset:2048 sc1 lds
	s_waitcnt vmcnt(10)
	buffer_load_dwordx4 v4, s[4:7], s42 offen offset:3072 sc1 lds
	s_add_u32 s42, s40, 4096
	s_mov_b32 m0, 51200
	s_nop 0
	buffer_load_dwordx4 v4, s[4:7], s42 offen offset:0 sc1 lds
	s_waitcnt vmcnt(10)
	buffer_load_dwordx4 v4, s[4:7], s42 offen offset:1024 sc1 lds
	buffer_load_dwordx4 v4, s[4:7], s42 offen offset:2048 sc1 lds
	s_waitcnt vmcnt(10)
	s_add_u32 s42, s40, 8192
	s_mov_b32 m0, 55296
	s_nop 0
	buffer_load_dwordx4 v4, s[4:7], s42 offen offset:1024 sc1 lds
	buffer_load_dwordx4 v4, s[4:7], s42 offen offset:2048 sc1 lds
	s_waitcnt vmcnt(10)
	buffer_load_dwordx4 v4, s[4:7], s42 offen offset:3072 sc1 lds
	s_add_u32 s42, s40, 12288
	s_mov_b32 m0, 59392
	s_nop 0
	buffer_load_dwordx4 v4, s[4:7], s42 offen offset:0 sc1 lds
	s_waitcnt vmcnt(10)
	buffer_load_dwordx4 v4, s[4:7], s42 offen offset:1024 sc1 lds
	v_mov_b64 v[48:49], 0
	v_mov_b64 v[50:51], 0
	v_mov_b64 v[52:53], 0
	v_mov_b64 v[54:55], 0
	v_mov_b64 v[56:57], 0
	v_mov_b64 v[58:59], 0
	v_mov_b64 v[60:61], 0
	v_mov_b64 v[62:63], 0
	v_mov_b64 v[64:65], 0
	v_mov_b64 v[66:67], 0
	v_mov_b64 v[68:69], 0
	v_mov_b64 v[70:71], 0
	v_mov_b64 v[72:73], 0
	v_mov_b64 v[74:75], 0
	v_mov_b64 v[76:77], 0
	v_mov_b64 v[78:79], 0
	v_mov_b64 v[80:81], 0
	v_mov_b64 v[82:83], 0
	s_waitcnt vmcnt(0)
	s_barrier
	s_mov_b64 exec, 0x7fff
Lfl_83:
	buffer_load_dword v7, v5, s[4:7], s30 offen offset:256 sc1
	v_cmp_gt_i32 vcc, s16, v7
	s_cbranch_vccz Lfo_84
	buffer_load_dword v7, v5, s[4:7], s30 offen offset:256 sc1
	v_cmp_gt_i32 vcc, s16, v7
	s_cbranch_vccz Lfo_84
	buffer_load_dword v7, v5, s[4:7], s30 offen offset:256 sc1
	v_cmp_gt_i32 vcc, s16, v7
	s_cbranch_vccz Lfo_84
	buffer_load_dword v7, v5, s[4:7], s30 offen offset:256 sc1
	v_cmp_gt_i32 vcc, s16, v7
	s_cbranch_vccz Lfo_84
	buffer_load_dword v7, v5, s[4:7], s30 offen offset:256 sc1
	v_cmp_gt_i32 vcc, s16, v7
	s_cbranch_vccz Lfo_84
	buffer_load_dword v7, v5, s[4:7], s30 offen offset:256 sc1
	v_cmp_gt_i32 vcc, s16, v7
	s_cbranch_vccz Lfo_84
	buffer_load_dword v7, v5, s[4:7], s30 offen offset:256 sc1
	v_cmp_gt_i32 vcc, s16, v7
	s_cbranch_vccz Lfo_84
	buffer_load_dword v7, v5, s[4:7], s30 offen offset:256 sc1
	v_cmp_gt_i32 vcc, s16, v7
	s_cbranch_vccz Lfo_84
	s_waitcnt vmcnt(40)
	buffer_load_dword v7, v5, s[4:7], s30 offen offset:256 sc1
	v_cmp_gt_i32 vcc, s16, v7
	s_cbranch_vccz Lfo_84
	buffer_load_dword v7, v5, s[4:7], s30 offen offset:256 sc1
	v_cmp_gt_i32 vcc, s16, v7
	s_cbranch_vccz Lfo_84
	buffer_load_dword v7, v5, s[4:7], s30 offen offset:256 sc1
	v_cmp_gt_i32 vcc, s16, v7
	s_cbranch_vccz Lfo_84
	buffer_load_dword v7, v5, s[4:7], s30 offen offset:256 sc1
	v_cmp_gt_i32 vcc, s16, v7
	s_cbranch_vccz Lfo_84
	buffer_load_dword v7, v5, s[4:7], s30 offen offset:256 sc1
	v_cmp_gt_i32 vcc, s16, v7
	s_cbranch_vccz Lfo_84
	buffer_load_dword v7, v5, s[4:7], s30 offen offset:256 sc1
	v_cmp_gt_i32 vcc, s16, v7
	s_cbranch_vccz Lfo_84
	buffer_load_dword v7, v5, s[4:7], s30 offen offset:256 sc1
	v_cmp_gt_i32 vcc, s16, v7
	s_cbranch_vccz Lfo_84
	buffer_load_dword v7, v5, s[4:7], s30 offen offset:256 sc1
	v_cmp_gt_i32 vcc, s16, v7
	s_cbranch_vccz Lfo_84
	s_waitcnt vmcnt(40)
	buffer_load_dword v7, v5, s[4:7], s30 offen offset:256 sc1
	v_cmp_gt_i32 vcc, s16, v7
	s_cbranch_vccz Lfo_84
	buffer_load_dword v7, v5, s[4:7], s30 offen offset:256 sc1
	v_cmp_gt_i32 vcc, s16, v7
	s_cbranch_vccz Lfo_84
	buffer_load_dword v7, v5, s[4:7], s30 offen offset:256 sc1
	v_cmp_gt_i32 vcc, s16, v7
	s_cbranch_vccz Lfo_84
	buffer_load_dword v7, v5, s[4:7], s30 offen offset:256 sc1
	v_cmp_gt_i32 vcc, s16, v7
	s_cbranch_vccz Lfo_84
	buffer_load_dword v7, v5, s[4:7], s30 offen offset:256 sc1
	v_cmp_gt_i32 vcc, s16, v7
	s_cbranch_vccz Lfo_84
	buffer_load_dword v7, v5, s[4:7], s30 offen offset:256 sc1
	v_cmp_gt_i32 vcc, s16, v7
	s_cbranch_vccz Lfo_84
	buffer_load_dword v7, v5, s[4:7], s30 offen offset:256 sc1
	v_cmp_gt_i32 vcc, s16, v7
	s_cbranch_vccz Lfo_84
	buffer_load_dword v7, v5, s[4:7], s30 offen offset:256 sc1
	v_cmp_gt_i32 vcc, s16, v7
	s_cbranch_vccz Lfo_84
	s_waitcnt vmcnt(40)
	s_waitcnt vmcnt(24)
	s_sub_u32 s17, s17, 1
	s_cbranch_scc0 Lfl_83
	s_mov_b32 s17, 0
Lfo_84:
	s_mov_b64 exec, -1
	s_barrier
.p2align 6
Lcb_loop1:
	s_nop 9
	s_add_u32 s16, s16, 1
Lmp_85:
	buffer_load_dwordx4 v[28:31], v4, s[4:7], s26 offen offset:2048 sc1
	buffer_load_dwordx4 v[32:35], v4, s[4:7], s26 offen offset:3072 sc1
	ds_read_b128 v[84:87], v11 offset:14336
	ds_read_b128 v[88:91], v11 offset:15360
	ds_read_b128 v[92:95], v11 offset:16384
	ds_read_b128 v[96:99], v11 offset:17408
	ds_read_b128 v[100:103], v11 offset:18432
	ds_read_b128 v[104:107], v11 offset:19456
	s_waitcnt vmcnt(1)
	ds_write_b128 v11, v[28:31] offset:59392
	s_waitcnt vmcnt(0)
	ds_write_b128 v11, v[32:35] offset:60416
	v_dot2_f32_bf16 v17, v28, v29, 0
	v_dot2_f32_bf16 v17, v30, v31, v17
	v_dot2_f32_bf16 v17, v32, v33, v17
	v_dot2_f32_bf16 v17, v34, v35, v17
	s_nop 2
	v_cmp_u_f32 vcc, v17, v17
	s_cbranch_vccnz Lmr_86
Lmo_87:
	v_smfmac_f32_16x16x64_bf16 v[48:51], v[28:31], a[16:23], v1
	v_smfmac_f32_16x16x64_bf16 v[52:55], v[28:31], a[72:79], v1
	s_waitcnt lgkmcnt(0)
	s_barrier
	ds_read_b128 v[20:23], v11 offset:57344
	ds_read_b128 v[24:27], v11 offset:58368
	ds_read_b128 v[36:39], v11 offset:61440
	ds_read_b128 v[40:43], v11 offset:62464
	ds_read_b128 v[44:47], v11 offset:63488
	v_smfmac_f32_16x16x64_bf16 v[56:59], v[28:31], a[128:135], v1
	v_smfmac_f32_16x16x64_bf16 v[60:63], v[28:31], a[184:191], v1
	v_smfmac_f32_16x16x64_bf16 v[64:67], v[28:31], a[240:247], v1
	v_smfmac_f32_16x16x64_bf16 v[68:71], v[28:31], v[160:167], v1
	v_smfmac_f32_16x16x64_bf16 v[72:75], v[28:31], v[216:223], v1
	v_smfmac_f32_16x16x64_bf16 v[48:51], v[32:35], a[24:31], v1
	v_smfmac_f32_16x16x64_bf16 v[52:55], v[32:35], a[80:87], v1
	v_smfmac_f32_16x16x64_bf16 v[56:59], v[32:35], a[136:143], v1
	s_waitcnt lgkmcnt(0)
	v_smfmac_f32_16x16x64_bf16 v[48:51], v[20:23], a[0:7], v1
	v_smfmac_f32_16x16x64_bf16 v[48:51], v[24:27], a[8:15], v1
	s_waitcnt lgkmcnt(4)
	v_smfmac_f32_16x16x64_bf16 v[76:79], v[20:23], v[84:91], v1
	ds_read_b128 v[84:87], v11 offset:20480
	ds_read_b128 v[88:91], v11 offset:21504
	v_smfmac_f32_16x16x64_bf16 v[48:51], v[36:39], a[32:39], v1
	v_smfmac_f32_16x16x64_bf16 v[48:51], v[40:43], a[40:47], v1
	s_waitcnt lgkmcnt(4)
	v_smfmac_f32_16x16x64_bf16 v[76:79], v[24:27], v[92:99], v1
	ds_read_b128 v[92:95], v11 offset:22528
	ds_read_b128 v[96:99], v11 offset:23552
	v_smfmac_f32_16x16x64_bf16 v[48:51], v[44:47], a[48:55], v1
	v_smfmac_f32_16x16x64_bf16 v[52:55], v[20:23], a[56:63], v1
	s_waitcnt lgkmcnt(4)
	v_smfmac_f32_16x16x64_bf16 v[76:79], v[28:31], v[100:107], v1
	ds_read_b128 v[100:103], v11 offset:24576
	ds_read_b128 v[104:107], v11 offset:25600
	v_smfmac_f32_16x16x64_bf16 v[52:55], v[24:27], a[64:71], v1
	v_add_f32 v48, v48, v50
	v_smfmac_f32_16x16x64_bf16 v[52:55], v[36:39], a[88:95], v1
	v_add_f32 v49, v49, v51
	v_smfmac_f32_16x16x64_bf16 v[52:55], v[40:43], a[96:103], v1
	v_cvt_pk_bf16_f32 v48, v48, v49
	s_waitcnt lgkmcnt(4)
	v_smfmac_f32_16x16x64_bf16 v[76:79], v[32:35], v[84:91], v1
	ds_read_b128 v[84:87], v11 offset:26624
	ds_read_b128 v[88:91], v11 offset:27648
	v_smfmac_f32_16x16x64_bf16 v[52:55], v[44:47], a[104:111], v1
	ds_write_b32 v10, v48 offset:1792
	v_smfmac_f32_16x16x64_bf16 v[56:59], v[20:23], a[112:119], v1
	v_smfmac_f32_16x16x64_bf16 v[56:59], v[24:27], a[120:127], v1
	s_waitcnt lgkmcnt(4)
	v_smfmac_f32_16x16x64_bf16 v[76:79], v[36:39], v[92:99], v1
	ds_read_b128 v[92:95], v11 offset:28672
	ds_read_b128 v[96:99], v11 offset:29696
	v_add_f32 v52, v52, v54
	v_smfmac_f32_16x16x64_bf16 v[56:59], v[36:39], a[144:151], v1
	v_add_f32 v53, v53, v55
	v_smfmac_f32_16x16x64_bf16 v[56:59], v[40:43], a[152:159], v1
	v_cvt_pk_bf16_f32 v52, v52, v53
	v_smfmac_f32_16x16x64_bf16 v[56:59], v[44:47], a[160:167], v1
	ds_write_b32 v10, v52 offset:2048
	s_waitcnt lgkmcnt(4)
	v_smfmac_f32_16x16x64_bf16 v[76:79], v[40:43], v[100:107], v1
	ds_read_b128 v[100:103], v11 offset:30720
	ds_read_b128 v[104:107], v11 offset:31744
	v_smfmac_f32_16x16x64_bf16 v[60:63], v[20:23], a[168:175], v1
	v_smfmac_f32_16x16x64_bf16 v[60:63], v[24:27], a[176:183], v1
	v_add_f32 v56, v56, v58
	v_smfmac_f32_16x16x64_bf16 v[60:63], v[32:35], a[192:199], v1
	v_add_f32 v57, v57, v59
	s_waitcnt lgkmcnt(4)
	v_smfmac_f32_16x16x64_bf16 v[76:79], v[44:47], v[84:91], v1
	ds_read_b128 v[84:87], v11 offset:32768
	ds_read_b128 v[88:91], v11 offset:33792
	v_cvt_pk_bf16_f32 v56, v56, v57
	v_smfmac_f32_16x16x64_bf16 v[60:63], v[36:39], a[200:207], v1
	ds_write_b32 v10, v56 offset:2304
	v_smfmac_f32_16x16x64_bf16 v[60:63], v[40:43], a[208:215], v1
	v_smfmac_f32_16x16x64_bf16 v[60:63], v[44:47], a[216:223], v1
	v_add_f32 v76, v76, v78
	s_waitcnt lgkmcnt(4)
	v_smfmac_f32_16x16x64_bf16 v[80:83], v[20:23], v[92:99], v1
	ds_read_b128 v[92:95], v11 offset:34816
	ds_read_b128 v[96:99], v11 offset:35840
	v_add_f32 v77, v77, v79
	v_smfmac_f32_16x16x64_bf16 v[64:67], v[20:23], a[224:231], v1
	v_cvt_pk_bf16_f32 v76, v76, v77
	v_smfmac_f32_16x16x64_bf16 v[64:67], v[24:27], a[232:239], v1
	v_add_f32 v60, v60, v62
	v_smfmac_f32_16x16x64_bf16 v[64:67], v[32:35], a[248:255], v1
	v_add_f32 v61, v61, v63
	s_waitcnt lgkmcnt(4)
	v_smfmac_f32_16x16x64_bf16 v[80:83], v[24:27], v[100:107], v1
	ds_read_b128 v[100:103], v11 offset:36864
	ds_read_b128 v[104:107], v11 offset:37888
	v_cvt_pk_bf16_f32 v60, v60, v61
	v_smfmac_f32_16x16x64_bf16 v[64:67], v[36:39], v[120:127], v1
	ds_write_b32 v10, v76 offset:7424
	v_smfmac_f32_16x16x64_bf16 v[64:67], v[40:43], v[128:135], v1
	ds_write_b32 v10, v60 offset:2560
	v_smfmac_f32_16x16x64_bf16 v[64:67], v[44:47], v[136:143], v1
	s_waitcnt lgkmcnt(4)
	v_smfmac_f32_16x16x64_bf16 v[80:83], v[28:31], v[84:91], v1
	ds_read_b128 v[84:87], v11 offset:38912
	ds_read_b128 v[88:91], v11 offset:39936
	v_smfmac_f32_16x16x64_bf16 v[68:71], v[20:23], v[144:151], v1
	v_smfmac_f32_16x16x64_bf16 v[68:71], v[24:27], v[152:159], v1
	v_add_f32 v64, v64, v66
	v_smfmac_f32_16x16x64_bf16 v[68:71], v[32:35], v[168:175], v1
	v_add_f32 v65, v65, v67
	s_waitcnt lgkmcnt(4)
	v_smfmac_f32_16x16x64_bf16 v[80:83], v[32:35], v[92:99], v1
	ds_read_b128 v[92:95], v11 offset:40960
	ds_read_b128 v[96:99], v11 offset:41984
	v_cvt_pk_bf16_f32 v64, v64, v65
	v_smfmac_f32_16x16x64_bf16 v[68:71], v[36:39], v[176:183], v1
	ds_write_b32 v10, v64 offset:2816
	v_smfmac_f32_16x16x64_bf16 v[68:71], v[40:43], v[184:191], v1
	v_smfmac_f32_16x16x64_bf16 v[68:71], v[44:47], v[192:199], v1
	s_waitcnt lgkmcnt(4)
	v_smfmac_f32_16x16x64_bf16 v[80:83], v[36:39], v[100:107], v1
	v_smfmac_f32_16x16x64_bf16 v[72:75], v[20:23], v[200:207], v1
	v_smfmac_f32_16x16x64_bf16 v[72:75], v[24:27], v[208:215], v1
	v_add_f32 v68, v68, v70
	v_smfmac_f32_16x16x64_bf16 v[72:75], v[32:35], v[224:231], v1
	v_add_f32 v69, v69, v71
	s_waitcnt lgkmcnt(2)
	v_smfmac_f32_16x16x64_bf16 v[80:83], v[40:43], v[84:91], v1
	v_cvt_pk_bf16_f32 v68, v68, v69
	v_smfmac_f32_16x16x64_bf16 v[72:75], v[36:39], v[232:239], v1
	ds_write_b32 v10, v68 offset:3072
	v_smfmac_f32_16x16x64_bf16 v[72:75], v[40:43], v[240:247], v1
	v_smfmac_f32_16x16x64_bf16 v[72:75], v[44:47], v[248:255], v1
	s_waitcnt lgkmcnt(0)
	v_smfmac_f32_16x16x64_bf16 v[80:83], v[44:47], v[92:99], v1
	s_nop 4
	v_add_f32 v72, v72, v74
	v_add_f32 v73, v73, v75
	v_cvt_pk_bf16_f32 v72, v72, v73
	ds_write_b32 v10, v72 offset:3328
	v_add_f32 v80, v80, v82
	v_add_f32 v81, v81, v83
	v_cvt_pk_bf16_f32 v80, v80, v81
	ds_write_b32 v10, v80 offset:7680
	s_waitcnt vmcnt(0) lgkmcnt(0)
	s_barrier
	s_add_u32 s26, s26, 8192
	s_add_u32 s27, s27, 8192
	v_add_u32 v10, 8192, v10
	v_and_b32 v10, 0x7fff, v10
	v_mov_b64 v[48:49], 0
	v_mov_b64 v[50:51], 0
	v_mov_b64 v[52:53], 0
	v_mov_b64 v[54:55], 0
	v_mov_b64 v[56:57], 0
	v_mov_b64 v[58:59], 0
	v_mov_b64 v[60:61], 0
	v_mov_b64 v[62:63], 0
	v_mov_b64 v[64:65], 0
	v_mov_b64 v[66:67], 0
	v_mov_b64 v[68:69], 0
	v_mov_b64 v[70:71], 0
	v_mov_b64 v[72:73], 0
	v_mov_b64 v[74:75], 0
	v_mov_b64 v[76:77], 0
	v_mov_b64 v[78:79], 0
	v_mov_b64 v[80:81], 0
	v_mov_b64 v[82:83], 0
	s_barrier
	s_cmp_lg_u32 s16, 63
	s_cbranch_scc1 Lcb_loop1
	s_nop 9
	s_add_u32 s16, s16, 1
Lmp_88:
	buffer_load_dwordx4 v[28:31], v4, s[4:7], s26 offen offset:2048 sc1
	buffer_load_dwordx4 v[32:35], v4, s[4:7], s26 offen offset:3072 sc1
	ds_read_b128 v[84:87], v11 offset:14336
	ds_read_b128 v[88:91], v11 offset:15360
	ds_read_b128 v[92:95], v11 offset:16384
	ds_read_b128 v[96:99], v11 offset:17408
	ds_read_b128 v[100:103], v11 offset:18432
	ds_read_b128 v[104:107], v11 offset:19456
	s_waitcnt vmcnt(1)
	ds_write_b128 v11, v[28:31] offset:59392
	s_waitcnt vmcnt(0)
	ds_write_b128 v11, v[32:35] offset:60416
	v_dot2_f32_bf16 v17, v28, v29, 0
	v_dot2_f32_bf16 v17, v30, v31, v17
	v_dot2_f32_bf16 v17, v32, v33, v17
	v_dot2_f32_bf16 v17, v34, v35, v17
	s_nop 2
	v_cmp_u_f32 vcc, v17, v17
	s_cbranch_vccnz Lmr_89
Lmo_90:
	v_smfmac_f32_16x16x64_bf16 v[48:51], v[28:31], a[16:23], v1
	v_smfmac_f32_16x16x64_bf16 v[52:55], v[28:31], a[72:79], v1
	s_waitcnt lgkmcnt(0)
	s_barrier
	ds_read_b128 v[20:23], v11 offset:57344
	ds_read_b128 v[24:27], v11 offset:58368
	ds_read_b128 v[36:39], v11 offset:61440
	ds_read_b128 v[40:43], v11 offset:62464
	ds_read_b128 v[44:47], v11 offset:63488
	v_smfmac_f32_16x16x64_bf16 v[56:59], v[28:31], a[128:135], v1
	v_smfmac_f32_16x16x64_bf16 v[60:63], v[28:31], a[184:191], v1
	v_smfmac_f32_16x16x64_bf16 v[64:67], v[28:31], a[240:247], v1
	v_smfmac_f32_16x16x64_bf16 v[68:71], v[28:31], v[160:167], v1
	v_smfmac_f32_16x16x64_bf16 v[72:75], v[28:31], v[216:223], v1
	v_smfmac_f32_16x16x64_bf16 v[48:51], v[32:35], a[24:31], v1
	v_smfmac_f32_16x16x64_bf16 v[52:55], v[32:35], a[80:87], v1
	v_smfmac_f32_16x16x64_bf16 v[56:59], v[32:35], a[136:143], v1
	s_waitcnt lgkmcnt(0)
	v_smfmac_f32_16x16x64_bf16 v[48:51], v[20:23], a[0:7], v1
	v_smfmac_f32_16x16x64_bf16 v[48:51], v[24:27], a[8:15], v1
	s_waitcnt lgkmcnt(4)
	v_smfmac_f32_16x16x64_bf16 v[76:79], v[20:23], v[84:91], v1
	ds_read_b128 v[84:87], v11 offset:20480
	ds_read_b128 v[88:91], v11 offset:21504
	v_smfmac_f32_16x16x64_bf16 v[48:51], v[36:39], a[32:39], v1
	v_smfmac_f32_16x16x64_bf16 v[48:51], v[40:43], a[40:47], v1
	s_waitcnt lgkmcnt(4)
	v_smfmac_f32_16x16x64_bf16 v[76:79], v[24:27], v[92:99], v1
	ds_read_b128 v[92:95], v11 offset:22528
	ds_read_b128 v[96:99], v11 offset:23552
	v_smfmac_f32_16x16x64_bf16 v[48:51], v[44:47], a[48:55], v1
	v_smfmac_f32_16x16x64_bf16 v[52:55], v[20:23], a[56:63], v1
	s_waitcnt lgkmcnt(4)
	v_smfmac_f32_16x16x64_bf16 v[76:79], v[28:31], v[100:107], v1
	ds_read_b128 v[100:103], v11 offset:24576
	ds_read_b128 v[104:107], v11 offset:25600
	v_smfmac_f32_16x16x64_bf16 v[52:55], v[24:27], a[64:71], v1
	v_add_f32 v48, v48, v50
	v_smfmac_f32_16x16x64_bf16 v[52:55], v[36:39], a[88:95], v1
	v_add_f32 v49, v49, v51
	v_smfmac_f32_16x16x64_bf16 v[52:55], v[40:43], a[96:103], v1
	v_cvt_pk_bf16_f32 v48, v48, v49
	s_waitcnt lgkmcnt(4)
	v_smfmac_f32_16x16x64_bf16 v[76:79], v[32:35], v[84:91], v1
	ds_read_b128 v[84:87], v11 offset:26624
	ds_read_b128 v[88:91], v11 offset:27648
	v_smfmac_f32_16x16x64_bf16 v[52:55], v[44:47], a[104:111], v1
	ds_write_b32 v10, v48 offset:1792
	v_smfmac_f32_16x16x64_bf16 v[56:59], v[20:23], a[112:119], v1
	v_smfmac_f32_16x16x64_bf16 v[56:59], v[24:27], a[120:127], v1
	s_waitcnt lgkmcnt(4)
	v_smfmac_f32_16x16x64_bf16 v[76:79], v[36:39], v[92:99], v1
	ds_read_b128 v[92:95], v11 offset:28672
	ds_read_b128 v[96:99], v11 offset:29696
	v_add_f32 v52, v52, v54
	v_smfmac_f32_16x16x64_bf16 v[56:59], v[36:39], a[144:151], v1
	v_add_f32 v53, v53, v55
	v_smfmac_f32_16x16x64_bf16 v[56:59], v[40:43], a[152:159], v1
	v_cvt_pk_bf16_f32 v52, v52, v53
	v_smfmac_f32_16x16x64_bf16 v[56:59], v[44:47], a[160:167], v1
	ds_write_b32 v10, v52 offset:2048
	s_waitcnt lgkmcnt(4)
	v_smfmac_f32_16x16x64_bf16 v[76:79], v[40:43], v[100:107], v1
	ds_read_b128 v[100:103], v11 offset:30720
	ds_read_b128 v[104:107], v11 offset:31744
	v_smfmac_f32_16x16x64_bf16 v[60:63], v[20:23], a[168:175], v1
	v_smfmac_f32_16x16x64_bf16 v[60:63], v[24:27], a[176:183], v1
	v_add_f32 v56, v56, v58
	v_smfmac_f32_16x16x64_bf16 v[60:63], v[32:35], a[192:199], v1
	v_add_f32 v57, v57, v59
	s_waitcnt lgkmcnt(4)
	v_smfmac_f32_16x16x64_bf16 v[76:79], v[44:47], v[84:91], v1
	ds_read_b128 v[84:87], v11 offset:32768
	ds_read_b128 v[88:91], v11 offset:33792
	v_cvt_pk_bf16_f32 v56, v56, v57
	v_smfmac_f32_16x16x64_bf16 v[60:63], v[36:39], a[200:207], v1
	ds_write_b32 v10, v56 offset:2304
	v_smfmac_f32_16x16x64_bf16 v[60:63], v[40:43], a[208:215], v1
	v_smfmac_f32_16x16x64_bf16 v[60:63], v[44:47], a[216:223], v1
	v_add_f32 v76, v76, v78
	s_waitcnt lgkmcnt(4)
	v_smfmac_f32_16x16x64_bf16 v[80:83], v[20:23], v[92:99], v1
	ds_read_b128 v[92:95], v11 offset:34816
	ds_read_b128 v[96:99], v11 offset:35840
	v_add_f32 v77, v77, v79
	v_smfmac_f32_16x16x64_bf16 v[64:67], v[20:23], a[224:231], v1
	v_cvt_pk_bf16_f32 v76, v76, v77
	v_smfmac_f32_16x16x64_bf16 v[64:67], v[24:27], a[232:239], v1
	v_add_f32 v60, v60, v62
	v_smfmac_f32_16x16x64_bf16 v[64:67], v[32:35], a[248:255], v1
	v_add_f32 v61, v61, v63
	s_waitcnt lgkmcnt(4)
	v_smfmac_f32_16x16x64_bf16 v[80:83], v[24:27], v[100:107], v1
	ds_read_b128 v[100:103], v11 offset:36864
	ds_read_b128 v[104:107], v11 offset:37888
	v_cvt_pk_bf16_f32 v60, v60, v61
	v_smfmac_f32_16x16x64_bf16 v[64:67], v[36:39], v[120:127], v1
	ds_write_b32 v10, v76 offset:7424
	v_smfmac_f32_16x16x64_bf16 v[64:67], v[40:43], v[128:135], v1
	ds_write_b32 v10, v60 offset:2560
	v_smfmac_f32_16x16x64_bf16 v[64:67], v[44:47], v[136:143], v1
	s_waitcnt lgkmcnt(4)
	v_smfmac_f32_16x16x64_bf16 v[80:83], v[28:31], v[84:91], v1
	ds_read_b128 v[84:87], v11 offset:38912
	ds_read_b128 v[88:91], v11 offset:39936
	v_smfmac_f32_16x16x64_bf16 v[68:71], v[20:23], v[144:151], v1
	v_smfmac_f32_16x16x64_bf16 v[68:71], v[24:27], v[152:159], v1
	v_add_f32 v64, v64, v66
	v_smfmac_f32_16x16x64_bf16 v[68:71], v[32:35], v[168:175], v1
	v_add_f32 v65, v65, v67
	s_waitcnt lgkmcnt(4)
	v_smfmac_f32_16x16x64_bf16 v[80:83], v[32:35], v[92:99], v1
	ds_read_b128 v[92:95], v11 offset:40960
	ds_read_b128 v[96:99], v11 offset:41984
	v_cvt_pk_bf16_f32 v64, v64, v65
	v_smfmac_f32_16x16x64_bf16 v[68:71], v[36:39], v[176:183], v1
	ds_write_b32 v10, v64 offset:2816
	v_smfmac_f32_16x16x64_bf16 v[68:71], v[40:43], v[184:191], v1
	v_smfmac_f32_16x16x64_bf16 v[68:71], v[44:47], v[192:199], v1
	s_waitcnt lgkmcnt(4)
	v_smfmac_f32_16x16x64_bf16 v[80:83], v[36:39], v[100:107], v1
	v_smfmac_f32_16x16x64_bf16 v[72:75], v[20:23], v[200:207], v1
	v_smfmac_f32_16x16x64_bf16 v[72:75], v[24:27], v[208:215], v1
	v_add_f32 v68, v68, v70
	v_smfmac_f32_16x16x64_bf16 v[72:75], v[32:35], v[224:231], v1
	v_add_f32 v69, v69, v71
	s_waitcnt lgkmcnt(2)
	v_smfmac_f32_16x16x64_bf16 v[80:83], v[40:43], v[84:91], v1
	v_cvt_pk_bf16_f32 v68, v68, v69
	v_smfmac_f32_16x16x64_bf16 v[72:75], v[36:39], v[232:239], v1
	ds_write_b32 v10, v68 offset:3072
	v_smfmac_f32_16x16x64_bf16 v[72:75], v[40:43], v[240:247], v1
	v_smfmac_f32_16x16x64_bf16 v[72:75], v[44:47], v[248:255], v1
	s_waitcnt lgkmcnt(0)
	v_smfmac_f32_16x16x64_bf16 v[80:83], v[44:47], v[92:99], v1
	s_nop 4
	v_add_f32 v72, v72, v74
	v_add_f32 v73, v73, v75
	v_cvt_pk_bf16_f32 v72, v72, v73
	ds_write_b32 v10, v72 offset:3328
	v_add_f32 v80, v80, v82
	v_add_f32 v81, v81, v83
	v_cvt_pk_bf16_f32 v80, v80, v81
	ds_write_b32 v10, v80 offset:7680
	s_waitcnt lgkmcnt(0)
	s_barrier
	s_lshl_b32 s41, s32, 12
	ds_read_b128 v[20:23], v4 offset:26624
	ds_read_b128 v[24:27], v4 offset:27648
	s_waitcnt lgkmcnt(0)
	s_add_u32 s40, s41, 49432576
	buffer_store_dwordx4 v[20:23], v4, s[4:7], s40 offen offset:0 sc1
	buffer_store_dwordx4 v[24:27], v4, s[4:7], s40 offen offset:1024 sc1
	s_waitcnt vmcnt(0)
	s_endpgm
Lmr_86:
	s_cmp_eq_u32 s13, 0
	s_cbranch_scc1 Lmo_87
	s_sub_u32 s13, s13, 1
	s_branch Lmp_85
Lmr_89:
	s_cmp_eq_u32 s13, 0
	s_cbranch_scc1 Lmo_90
	s_sub_u32 s13, s13, 1
	s_branch Lmp_88
Lcb_w2:
	s_mul_i32 s41, s32, 229376
	s_add_u32 s40, s41, 6623232
	s_add_u32 s42, s40, 0
	buffer_load_dwordx4 a[0:3], v4, s[4:7], s42 offen offset:0 sc1
	buffer_load_dwordx4 a[4:7], v4, s[4:7], s42 offen offset:1024 sc1
	s_add_u32 s42, s40, 4096
	buffer_load_dwordx4 a[28:31], v4, s[4:7], s42 offen offset:3072 sc1
	s_add_u32 s42, s40, 8192
	buffer_load_dwordx4 a[32:35], v4, s[4:7], s42 offen offset:0 sc1
	s_add_u32 s40, s41, 6637568
	s_add_u32 s42, s40, 0
	buffer_load_dwordx4 a[56:59], v4, s[4:7], s42 offen offset:0 sc1
	buffer_load_dwordx4 a[60:63], v4, s[4:7], s42 offen offset:1024 sc1
	s_add_u32 s42, s40, 4096
	buffer_load_dwordx4 a[84:87], v4, s[4:7], s42 offen offset:3072 sc1
	s_add_u32 s42, s40, 8192
	buffer_load_dwordx4 a[88:91], v4, s[4:7], s42 offen offset:0 sc1
	s_add_u32 s40, s41, 9633792
	s_add_u32 s42, s40, 0
	buffer_load_dwordx4 a[112:115], v4, s[4:7], s42 offen offset:0 sc1
	buffer_load_dwordx4 a[116:119], v4, s[4:7], s42 offen offset:1024 sc1
	s_add_u32 s42, s40, 4096
	buffer_load_dwordx4 a[140:143], v4, s[4:7], s42 offen offset:3072 sc1
	s_waitcnt vmcnt(10)
	s_add_u32 s42, s40, 8192
	buffer_load_dwordx4 a[144:147], v4, s[4:7], s42 offen offset:0 sc1
	s_add_u32 s40, s41, 9648128
	s_add_u32 s42, s40, 0
	buffer_load_dwordx4 a[168:171], v4, s[4:7], s42 offen offset:0 sc1
	s_waitcnt vmcnt(10)
	buffer_load_dwordx4 a[172:175], v4, s[4:7], s42 offen offset:1024 sc1
	s_add_u32 s42, s40, 4096
	buffer_load_dwordx4 a[196:199], v4, s[4:7], s42 offen offset:3072 sc1
	s_waitcnt vmcnt(10)
	s_add_u32 s42, s40, 8192
	buffer_load_dwordx4 a[200:203], v4, s[4:7], s42 offen offset:0 sc1
	s_add_u32 s40, s41, 9662464
	s_add_u32 s42, s40, 0
	buffer_load_dwordx4 a[224:227], v4, s[4:7], s42 offen offset:0 sc1
	s_waitcnt vmcnt(10)
	buffer_load_dwordx4 a[228:231], v4, s[4:7], s42 offen offset:1024 sc1
	s_add_u32 s42, s40, 4096
	buffer_load_dwordx4 a[252:255], v4, s[4:7], s42 offen offset:3072 sc1
	s_waitcnt vmcnt(10)
	s_add_u32 s42, s40, 8192
	buffer_load_dwordx4 v[120:123], v4, s[4:7], s42 offen offset:0 sc1
	s_add_u32 s40, s41, 9676800
	s_add_u32 s42, s40, 0
	buffer_load_dwordx4 v[144:147], v4, s[4:7], s42 offen offset:0 sc1
	s_waitcnt vmcnt(10)
	buffer_load_dwordx4 v[148:151], v4, s[4:7], s42 offen offset:1024 sc1
	s_add_u32 s42, s40, 4096
	buffer_load_dwordx4 v[172:175], v4, s[4:7], s42 offen offset:3072 sc1
	s_waitcnt vmcnt(10)
	s_add_u32 s42, s40, 8192
	buffer_load_dwordx4 v[176:179], v4, s[4:7], s42 offen offset:0 sc1
	s_add_u32 s40, s41, 9691136
	s_add_u32 s42, s40, 0
	buffer_load_dwordx4 v[200:203], v4, s[4:7], s42 offen offset:0 sc1
	s_waitcnt vmcnt(10)
	buffer_load_dwordx4 v[204:207], v4, s[4:7], s42 offen offset:1024 sc1
	s_add_u32 s42, s40, 4096
	buffer_load_dwordx4 v[228:231], v4, s[4:7], s42 offen offset:3072 sc1
	s_waitcnt vmcnt(10)
	s_add_u32 s42, s40, 8192
	buffer_load_dwordx4 v[232:235], v4, s[4:7], s42 offen offset:0 sc1
	s_add_u32 s40, s41, 9805824
	s_add_u32 s42, s40, 0
	s_mov_b32 m0, 61440
	s_nop 0
	buffer_load_dwordx4 v4, s[4:7], s42 offen offset:0 sc1 lds
	s_waitcnt vmcnt(10)
	buffer_load_dwordx4 v4, s[4:7], s42 offen offset:1024 sc1 lds
	s_add_u32 s42, s40, 4096
	s_mov_b32 m0, 65536
	s_nop 0
	buffer_load_dwordx4 v4, s[4:7], s42 offen offset:3072 sc1 lds
	s_waitcnt vmcnt(10)
	s_add_u32 s42, s40, 8192
	s_mov_b32 m0, 69632
	s_nop 0
	buffer_load_dwordx4 v4, s[4:7], s42 offen offset:0 sc1 lds
	s_mov_b32 s40, 0x100000
Lww_91:
	buffer_load_dword v25, v26, s[4:7], s34 offen sc1
	s_sub_u32 s40, s40, 1
	s_cbranch_scc1 Lwx_92
	s_waitcnt vmcnt(0)
	v_cmp_gt_u32 vcc, 7, v25
	s_cbranch_vccnz Lww_91
Lwx_92:
	s_waitcnt vmcnt(0)
	s_add_u32 s40, s41, 6623232
	s_add_u32 s42, s40, 0
	buffer_load_dwordx4 a[8:11], v4, s[4:7], s42 offen offset:2048 sc1
	s_waitcnt vmcnt(10)
	buffer_load_dwordx4 a[12:15], v4, s[4:7], s42 offen offset:3072 sc1
	s_add_u32 s42, s40, 4096
	buffer_load_dwordx4 a[16:19], v4, s[4:7], s42 offen offset:0 sc1
	s_waitcnt vmcnt(10)
	buffer_load_dwordx4 a[20:23], v4, s[4:7], s42 offen offset:1024 sc1
	buffer_load_dwordx4 a[24:27], v4, s[4:7], s42 offen offset:2048 sc1
	s_waitcnt vmcnt(10)
	s_add_u32 s42, s40, 8192
	buffer_load_dwordx4 a[36:39], v4, s[4:7], s42 offen offset:1024 sc1
	buffer_load_dwordx4 a[40:43], v4, s[4:7], s42 offen offset:2048 sc1
	s_waitcnt vmcnt(10)
	buffer_load_dwordx4 a[44:47], v4, s[4:7], s42 offen offset:3072 sc1
	s_add_u32 s42, s40, 12288
	buffer_load_dwordx4 a[48:51], v4, s[4:7], s42 offen offset:0 sc1
	s_waitcnt vmcnt(10)
	buffer_load_dwordx4 a[52:55], v4, s[4:7], s42 offen offset:1024 sc1
	s_add_u32 s40, s41, 6637568
	s_add_u32 s42, s40, 0
	buffer_load_dwordx4 a[64:67], v4, s[4:7], s42 offen offset:2048 sc1
	s_waitcnt vmcnt(10)
	buffer_load_dwordx4 a[68:71], v4, s[4:7], s42 offen offset:3072 sc1
	s_add_u32 s42, s40, 4096
	buffer_load_dwordx4 a[72:75], v4, s[4:7], s42 offen offset:0 sc1
	s_waitcnt vmcnt(10)
	buffer_load_dwordx4 a[76:79], v4, s[4:7], s42 offen offset:1024 sc1
	buffer_load_dwordx4 a[80:83], v4, s[4:7], s42 offen offset:2048 sc1
	s_waitcnt vmcnt(10)
	s_add_u32 s42, s40, 8192
	buffer_load_dwordx4 a[92:95], v4, s[4:7], s42 offen offset:1024 sc1
	buffer_load_dwordx4 a[96:99], v4, s[4:7], s42 offen offset:2048 sc1
	s_waitcnt vmcnt(10)
	buffer_load_dwordx4 a[100:103], v4, s[4:7], s42 offen offset:3072 sc1
	s_add_u32 s42, s40, 12288
	buffer_load_dwordx4 a[104:107], v4, s[4:7], s42 offen offset:0 sc1
	s_waitcnt vmcnt(10)
	buffer_load_dwordx4 a[108:111], v4, s[4:7], s42 offen offset:1024 sc1
	s_add_u32 s40, s41, 9633792
	s_add_u32 s42, s40, 0
	buffer_load_dwordx4 a[120:123], v4, s[4:7], s42 offen offset:2048 sc1
	s_waitcnt vmcnt(10)
	buffer_load_dwordx4 a[124:127], v4, s[4:7], s42 offen offset:3072 sc1
	s_add_u32 s42, s40, 4096
	buffer_load_dwordx4 a[128:131], v4, s[4:7], s42 offen offset:0 sc1
	s_waitcnt vmcnt(10)
	buffer_load_dwordx4 a[132:135], v4, s[4:7], s42 offen offset:1024 sc1
	buffer_load_dwordx4 a[136:139], v4, s[4:7], s42 offen offset:2048 sc1
	s_waitcnt vmcnt(10)
	s_add_u32 s42, s40, 8192
	buffer_load_dwordx4 a[148:151], v4, s[4:7], s42 offen offset:1024 sc1
	buffer_load_dwordx4 a[152:155], v4, s[4:7], s42 offen offset:2048 sc1
	s_waitcnt vmcnt(10)
	buffer_load_dwordx4 a[156:159], v4, s[4:7], s42 offen offset:3072 sc1
	s_add_u32 s42, s40, 12288
	buffer_load_dwordx4 a[160:163], v4, s[4:7], s42 offen offset:0 sc1
	s_waitcnt vmcnt(10)
	buffer_load_dwordx4 a[164:167], v4, s[4:7], s42 offen offset:1024 sc1
	s_add_u32 s40, s41, 9648128
	s_add_u32 s42, s40, 0
	buffer_load_dwordx4 a[176:179], v4, s[4:7], s42 offen offset:2048 sc1
	s_waitcnt vmcnt(10)
	buffer_load_dwordx4 a[180:183], v4, s[4:7], s42 offen offset:3072 sc1
	s_add_u32 s42, s40, 4096
	buffer_load_dwordx4 a[184:187], v4, s[4:7], s42 offen offset:0 sc1
	s_waitcnt vmcnt(10)
	buffer_load_dwordx4 a[188:191], v4, s[4:7], s42 offen offset:1024 sc1
	buffer_load_dwordx4 a[192:195], v4, s[4:7], s42 offen offset:2048 sc1
	s_waitcnt vmcnt(10)
	s_add_u32 s42, s40, 8192
	buffer_load_dwordx4 a[204:207], v4, s[4:7], s42 offen offset:1024 sc1
	buffer_load_dwordx4 a[208:211], v4, s[4:7], s42 offen offset:2048 sc1
	s_waitcnt vmcnt(10)
	buffer_load_dwordx4 a[212:215], v4, s[4:7], s42 offen offset:3072 sc1
	s_add_u32 s42, s40, 12288
	buffer_load_dwordx4 a[216:219], v4, s[4:7], s42 offen offset:0 sc1
	s_waitcnt vmcnt(10)
	buffer_load_dwordx4 a[220:223], v4, s[4:7], s42 offen offset:1024 sc1
	s_add_u32 s40, s41, 9662464
	s_add_u32 s42, s40, 0
	buffer_load_dwordx4 a[232:235], v4, s[4:7], s42 offen offset:2048 sc1
	s_waitcnt vmcnt(10)
	buffer_load_dwordx4 a[236:239], v4, s[4:7], s42 offen offset:3072 sc1
	s_add_u32 s42, s40, 4096
	buffer_load_dwordx4 a[240:243], v4, s[4:7], s42 offen offset:0 sc1
	s_waitcnt vmcnt(10)
	buffer_load_dwordx4 a[244:247], v4, s[4:7], s42 offen offset:1024 sc1
	buffer_load_dwordx4 a[248:251], v4, s[4:7], s42 offen offset:2048 sc1
	s_waitcnt vmcnt(10)
	s_add_u32 s42, s40, 8192
	buffer_load_dwordx4 v[124:127], v4, s[4:7], s42 offen offset:1024 sc1
	buffer_load_dwordx4 v[128:131], v4, s[4:7], s42 offen offset:2048 sc1
	s_waitcnt vmcnt(10)
	buffer_load_dwordx4 v[132:135], v4, s[4:7], s42 offen offset:3072 sc1
	s_add_u32 s42, s40, 12288
	buffer_load_dwordx4 v[136:139], v4, s[4:7], s42 offen offset:0 sc1
	s_waitcnt vmcnt(10)
	buffer_load_dwordx4 v[140:143], v4, s[4:7], s42 offen offset:1024 sc1
	s_add_u32 s40, s41, 9676800
	s_add_u32 s42, s40, 0
	buffer_load_dwordx4 v[152:155], v4, s[4:7], s42 offen offset:2048 sc1
	s_waitcnt vmcnt(10)
	buffer_load_dwordx4 v[156:159], v4, s[4:7], s42 offen offset:3072 sc1
	s_add_u32 s42, s40, 4096
	buffer_load_dwordx4 v[160:163], v4, s[4:7], s42 offen offset:0 sc1
	s_waitcnt vmcnt(10)
	buffer_load_dwordx4 v[164:167], v4, s[4:7], s42 offen offset:1024 sc1
	buffer_load_dwordx4 v[168:171], v4, s[4:7], s42 offen offset:2048 sc1
	s_waitcnt vmcnt(10)
	s_add_u32 s42, s40, 8192
	buffer_load_dwordx4 v[180:183], v4, s[4:7], s42 offen offset:1024 sc1
	buffer_load_dwordx4 v[184:187], v4, s[4:7], s42 offen offset:2048 sc1
	s_waitcnt vmcnt(10)
	buffer_load_dwordx4 v[188:191], v4, s[4:7], s42 offen offset:3072 sc1
	s_add_u32 s42, s40, 12288
	buffer_load_dwordx4 v[192:195], v4, s[4:7], s42 offen offset:0 sc1
	s_waitcnt vmcnt(10)
	buffer_load_dwordx4 v[196:199], v4, s[4:7], s42 offen offset:1024 sc1
	s_add_u32 s40, s41, 9691136
	s_add_u32 s42, s40, 0
	buffer_load_dwordx4 v[208:211], v4, s[4:7], s42 offen offset:2048 sc1
	s_waitcnt vmcnt(10)
	buffer_load_dwordx4 v[212:215], v4, s[4:7], s42 offen offset:3072 sc1
	s_add_u32 s42, s40, 4096
	buffer_load_dwordx4 v[216:219], v4, s[4:7], s42 offen offset:0 sc1
	s_waitcnt vmcnt(10)
	buffer_load_dwordx4 v[220:223], v4, s[4:7], s42 offen offset:1024 sc1
	buffer_load_dwordx4 v[224:227], v4, s[4:7], s42 offen offset:2048 sc1
	s_waitcnt vmcnt(10)
	s_add_u32 s42, s40, 8192
	buffer_load_dwordx4 v[236:239], v4, s[4:7], s42 offen offset:1024 sc1
	buffer_load_dwordx4 v[240:243], v4, s[4:7], s42 offen offset:2048 sc1
	s_waitcnt vmcnt(10)
	buffer_load_dwordx4 v[244:247], v4, s[4:7], s42 offen offset:3072 sc1
	s_add_u32 s42, s40, 12288
	buffer_load_dwordx4 v[248:251], v4, s[4:7], s42 offen offset:0 sc1
	s_waitcnt vmcnt(10)
	buffer_load_dwordx4 v[252:255], v4, s[4:7], s42 offen offset:1024 sc1
	s_add_u32 s40, s41, 9805824
	s_add_u32 s42, s40, 0
	s_mov_b32 m0, 61440
	s_nop 0
	buffer_load_dwordx4 v4, s[4:7], s42 offen offset:2048 sc1 lds
	s_waitcnt vmcnt(10)
	buffer_load_dwordx4 v4, s[4:7], s42 offen offset:3072 sc1 lds
	s_add_u32 s42, s40, 4096
	s_mov_b32 m0, 65536
	s_nop 0
	buffer_load_dwordx4 v4, s[4:7], s42 offen offset:0 sc1 lds
	s_waitcnt vmcnt(10)
	buffer_load_dwordx4 v4, s[4:7], s42 offen offset:1024 sc1 lds
	buffer_load_dwordx4 v4, s[4:7], s42 offen offset:2048 sc1 lds
	s_waitcnt vmcnt(10)
	s_add_u32 s42, s40, 8192
	s_mov_b32 m0, 69632
	s_nop 0
	buffer_load_dwordx4 v4, s[4:7], s42 offen offset:1024 sc1 lds
	buffer_load_dwordx4 v4, s[4:7], s42 offen offset:2048 sc1 lds
	s_waitcnt vmcnt(10)
	buffer_load_dwordx4 v4, s[4:7], s42 offen offset:3072 sc1 lds
	s_add_u32 s42, s40, 12288
	s_mov_b32 m0, 73728
	s_nop 0
	buffer_load_dwordx4 v4, s[4:7], s42 offen offset:0 sc1 lds
	s_waitcnt vmcnt(10)
	buffer_load_dwordx4 v4, s[4:7], s42 offen offset:1024 sc1 lds
	v_mov_b64 v[48:49], 0
	v_mov_b64 v[50:51], 0
	v_mov_b64 v[52:53], 0
	v_mov_b64 v[54:55], 0
	v_mov_b64 v[56:57], 0
	v_mov_b64 v[58:59], 0
	v_mov_b64 v[60:61], 0
	v_mov_b64 v[62:63], 0
	v_mov_b64 v[64:65], 0
	v_mov_b64 v[66:67], 0
	v_mov_b64 v[68:69], 0
	v_mov_b64 v[70:71], 0
	v_mov_b64 v[72:73], 0
	v_mov_b64 v[74:75], 0
	v_mov_b64 v[76:77], 0
	v_mov_b64 v[78:79], 0
	v_mov_b64 v[80:81], 0
	v_mov_b64 v[82:83], 0
	s_waitcnt vmcnt(0)
	s_barrier
	s_barrier
.p2align 6
Lcb_loop2:
	s_nop 9
	s_add_u32 s16, s16, 1
Lmp_93:
	buffer_load_dwordx4 v[36:39], v4, s[4:7], s27 offen offset:0 sc1
	buffer_load_dwordx4 v[40:43], v4, s[4:7], s27 offen offset:1024 sc1
	buffer_load_dwordx4 v[44:47], v4, s[4:7], s27 offen offset:2048 sc1
	ds_read_b128 v[84:87], v11 offset:43008
	ds_read_b128 v[88:91], v11 offset:44032
	ds_read_b128 v[92:95], v11 offset:45056
	ds_read_b128 v[96:99], v11 offset:46080
	ds_read_b128 v[100:103], v11 offset:47104
	ds_read_b128 v[104:107], v11 offset:48128
	s_waitcnt vmcnt(2)
	ds_write_b128 v11, v[36:39] offset:61440
	s_waitcnt vmcnt(1)
	ds_write_b128 v11, v[40:43] offset:62464
	s_waitcnt vmcnt(0)
	ds_write_b128 v11, v[44:47] offset:63488
	v_dot2_f32_bf16 v17, v36, v37, 0
	v_dot2_f32_bf16 v17, v38, v39, v17
	v_dot2_f32_bf16 v17, v40, v41, v17
	v_dot2_f32_bf16 v17, v42, v43, v17
	v_dot2_f32_bf16 v17, v44, v45, v17
	v_dot2_f32_bf16 v17, v46, v47, v17
	s_nop 2
	v_cmp_u_f32 vcc, v17, v17
	s_cbranch_vccnz Lmr_94
Lmo_95:
	v_smfmac_f32_16x16x64_bf16 v[48:51], v[36:39], a[32:39], v1
	v_smfmac_f32_16x16x64_bf16 v[52:55], v[36:39], a[88:95], v1
	s_waitcnt lgkmcnt(0)
	s_barrier
	ds_read_b128 v[20:23], v11 offset:57344
	ds_read_b128 v[24:27], v11 offset:58368
	ds_read_b128 v[28:31], v11 offset:59392
	ds_read_b128 v[32:35], v11 offset:60416
	v_smfmac_f32_16x16x64_bf16 v[56:59], v[36:39], a[144:151], v1
	v_smfmac_f32_16x16x64_bf16 v[60:63], v[36:39], a[200:207], v1
	v_smfmac_f32_16x16x64_bf16 v[64:67], v[36:39], v[120:127], v1
	v_smfmac_f32_16x16x64_bf16 v[68:71], v[36:39], v[176:183], v1
	v_smfmac_f32_16x16x64_bf16 v[72:75], v[36:39], v[232:239], v1
	v_smfmac_f32_16x16x64_bf16 v[48:51], v[40:43], a[40:47], v1
	v_smfmac_f32_16x16x64_bf16 v[52:55], v[40:43], a[96:103], v1
	v_smfmac_f32_16x16x64_bf16 v[56:59], v[40:43], a[152:159], v1
	s_waitcnt lgkmcnt(0)
	v_smfmac_f32_16x16x64_bf16 v[48:51], v[20:23], a[0:7], v1
	v_smfmac_f32_16x16x64_bf16 v[48:51], v[24:27], a[8:15], v1
	v_smfmac_f32_16x16x64_bf16 v[48:51], v[28:31], a[16:23], v1
	v_smfmac_f32_16x16x64_bf16 v[48:51], v[32:35], a[24:31], v1
	v_smfmac_f32_16x16x64_bf16 v[48:51], v[44:47], a[48:55], v1
	s_waitcnt lgkmcnt(4)
	v_smfmac_f32_16x16x64_bf16 v[76:79], v[20:23], v[84:91], v1
	ds_read_b128 v[84:87], v11 offset:49152
	ds_read_b128 v[88:91], v11 offset:50176
	v_smfmac_f32_16x16x64_bf16 v[52:55], v[20:23], a[56:63], v1
	v_smfmac_f32_16x16x64_bf16 v[52:55], v[24:27], a[64:71], v1
	v_add_f32 v48, v48, v50
	v_smfmac_f32_16x16x64_bf16 v[52:55], v[28:31], a[72:79], v1
	v_add_f32 v49, v49, v51
	v_smfmac_f32_16x16x64_bf16 v[52:55], v[32:35], a[80:87], v1
	v_cvt_pk_bf16_f32 v48, v48, v49
	v_smfmac_f32_16x16x64_bf16 v[52:55], v[44:47], a[104:111], v1
	ds_write_b32 v10, v48 offset:3584
	s_waitcnt lgkmcnt(4)
	v_smfmac_f32_16x16x64_bf16 v[76:79], v[24:27], v[92:99], v1
	ds_read_b128 v[92:95], v11 offset:51200
	ds_read_b128 v[96:99], v11 offset:52224
	v_smfmac_f32_16x16x64_bf16 v[56:59], v[20:23], a[112:119], v1
	v_smfmac_f32_16x16x64_bf16 v[56:59], v[24:27], a[120:127], v1
	v_add_f32 v52, v52, v54
	v_smfmac_f32_16x16x64_bf16 v[56:59], v[28:31], a[128:135], v1
	v_add_f32 v53, v53, v55
	v_smfmac_f32_16x16x64_bf16 v[56:59], v[32:35], a[136:143], v1
	v_cvt_pk_bf16_f32 v52, v52, v53
	v_smfmac_f32_16x16x64_bf16 v[56:59], v[44:47], a[160:167], v1
	ds_write_b32 v10, v52 offset:3840
	s_waitcnt lgkmcnt(4)
	v_smfmac_f32_16x16x64_bf16 v[76:79], v[28:31], v[100:107], v1
	ds_read_b128 v[100:103], v11 offset:53248
	ds_read_b128 v[104:107], v11 offset:54272
	v_smfmac_f32_16x16x64_bf16 v[60:63], v[20:23], a[168:175], v1
	v_smfmac_f32_16x16x64_bf16 v[60:63], v[24:27], a[176:183], v1
	v_add_f32 v56, v56, v58
	v_smfmac_f32_16x16x64_bf16 v[60:63], v[28:31], a[184:191], v1
	v_add_f32 v57, v57, v59
	v_smfmac_f32_16x16x64_bf16 v[60:63], v[32:35], a[192:199], v1
	v_cvt_pk_bf16_f32 v56, v56, v57
	v_smfmac_f32_16x16x64_bf16 v[60:63], v[40:43], a[208:215], v1
	ds_write_b32 v10, v56 offset:4096
	v_smfmac_f32_16x16x64_bf16 v[60:63], v[44:47], a[216:223], v1
	s_waitcnt lgkmcnt(4)
	v_smfmac_f32_16x16x64_bf16 v[76:79], v[32:35], v[84:91], v1
	ds_read_b128 v[84:87], v11 offset:55296
	ds_read_b128 v[88:91], v11 offset:56320
	v_smfmac_f32_16x16x64_bf16 v[64:67], v[20:23], a[224:231], v1
	v_smfmac_f32_16x16x64_bf16 v[64:67], v[24:27], a[232:239], v1
	v_add_f32 v60, v60, v62
	v_smfmac_f32_16x16x64_bf16 v[64:67], v[28:31], a[240:247], v1
	v_add_f32 v61, v61, v63
	v_smfmac_f32_16x16x64_bf16 v[64:67], v[32:35], a[248:255], v1
	v_cvt_pk_bf16_f32 v60, v60, v61
	v_smfmac_f32_16x16x64_bf16 v[64:67], v[40:43], v[128:135], v1
	ds_write_b32 v10, v60 offset:4352
	v_smfmac_f32_16x16x64_bf16 v[64:67], v[44:47], v[136:143], v1
	s_waitcnt lgkmcnt(4)
	v_smfmac_f32_16x16x64_bf16 v[76:79], v[36:39], v[92:99], v1
	v_smfmac_f32_16x16x64_bf16 v[68:71], v[20:23], v[144:151], v1
	v_smfmac_f32_16x16x64_bf16 v[68:71], v[24:27], v[152:159], v1
	v_add_f32 v64, v64, v66
	v_smfmac_f32_16x16x64_bf16 v[68:71], v[28:31], v[160:167], v1
	v_add_f32 v65, v65, v67
	v_smfmac_f32_16x16x64_bf16 v[68:71], v[32:35], v[168:175], v1
	v_cvt_pk_bf16_f32 v64, v64, v65
	v_smfmac_f32_16x16x64_bf16 v[68:71], v[40:43], v[184:191], v1
	ds_write_b32 v10, v64 offset:4608
	v_smfmac_f32_16x16x64_bf16 v[68:71], v[44:47], v[192:199], v1
	s_waitcnt lgkmcnt(2)
	v_smfmac_f32_16x16x64_bf16 v[76:79], v[40:43], v[100:107], v1
	v_smfmac_f32_16x16x64_bf16 v[72:75], v[20:23], v[200:207], v1
	v_smfmac_f32_16x16x64_bf16 v[72:75], v[24:27], v[208:215], v1
	v_add_f32 v68, v68, v70
	v_smfmac_f32_16x16x64_bf16 v[72:75], v[28:31], v[216:223], v1
	v_add_f32 v69, v69, v71
	v_smfmac_f32_16x16x64_bf16 v[72:75], v[32:35], v[224:231], v1
	v_cvt_pk_bf16_f32 v68, v68, v69
	v_smfmac_f32_16x16x64_bf16 v[72:75], v[40:43], v[240:247], v1
	ds_write_b32 v10, v68 offset:4864
	v_smfmac_f32_16x16x64_bf16 v[72:75], v[44:47], v[248:255], v1
	s_waitcnt lgkmcnt(0)
	v_smfmac_f32_16x16x64_bf16 v[76:79], v[44:47], v[84:91], v1
	s_nop 4
	v_add_f32 v72, v72, v74
	v_add_f32 v73, v73, v75
	v_cvt_pk_bf16_f32 v72, v72, v73
	ds_write_b32 v10, v72 offset:5120
	v_add_f32 v76, v76, v78
	v_add_f32 v77, v77, v79
	v_cvt_pk_bf16_f32 v76, v76, v77
	ds_write_b32 v10, v76 offset:7936
	s_waitcnt vmcnt(0) lgkmcnt(0)
	s_add_u32 s26, s26, 8192
	s_add_u32 s27, s27, 8192
	v_add_u32 v10, 8192, v10
	v_and_b32 v10, 0x7fff, v10
	v_mov_b64 v[48:49], 0
	v_mov_b64 v[50:51], 0
	v_mov_b64 v[52:53], 0
	v_mov_b64 v[54:55], 0
	v_mov_b64 v[56:57], 0
	v_mov_b64 v[58:59], 0
	v_mov_b64 v[60:61], 0
	v_mov_b64 v[62:63], 0
	v_mov_b64 v[64:65], 0
	v_mov_b64 v[66:67], 0
	v_mov_b64 v[68:69], 0
	v_mov_b64 v[70:71], 0
	v_mov_b64 v[72:73], 0
	v_mov_b64 v[74:75], 0
	v_mov_b64 v[76:77], 0
	v_mov_b64 v[78:79], 0
	s_barrier
	s_nop 15
	s_nop 15
	s_nop 15
	s_nop 15
	s_nop 5
	s_mov_b64 exec, 0x7fff
Lfl_96:
	buffer_load_dword v7, v5, s[4:7], s30 offen offset:512 sc1
	v_cmp_gt_i32 vcc, s16, v7
	s_cbranch_vccz Lfo_97
	s_nop 7
	buffer_load_dword v7, v5, s[4:7], s30 offen offset:512 sc1
	v_cmp_gt_i32 vcc, s16, v7
	s_cbranch_vccz Lfo_97
	s_nop 7
	buffer_load_dword v7, v5, s[4:7], s30 offen offset:512 sc1
	v_cmp_gt_i32 vcc, s16, v7
	s_cbranch_vccz Lfo_97
	s_nop 7
	buffer_load_dword v7, v5, s[4:7], s30 offen offset:512 sc1
	v_cmp_gt_i32 vcc, s16, v7
	s_cbranch_vccz Lfo_97
	s_nop 7
	buffer_load_dword v7, v5, s[4:7], s30 offen offset:512 sc1
	v_cmp_gt_i32 vcc, s16, v7
	s_cbranch_vccz Lfo_97
	s_nop 7
	buffer_load_dword v7, v5, s[4:7], s30 offen offset:512 sc1
	v_cmp_gt_i32 vcc, s16, v7
	s_cbranch_vccz Lfo_97
	s_nop 7
	buffer_load_dword v7, v5, s[4:7], s30 offen offset:512 sc1
	v_cmp_gt_i32 vcc, s16, v7
	s_cbranch_vccz Lfo_97
	s_nop 7
	buffer_load_dword v7, v5, s[4:7], s30 offen offset:512 sc1
	v_cmp_gt_i32 vcc, s16, v7
	s_cbranch_vccz Lfo_97
	s_waitcnt vmcnt(40)
	s_nop 7
	buffer_load_dword v7, v5, s[4:7], s30 offen offset:512 sc1
	v_cmp_gt_i32 vcc, s16, v7
	s_cbranch_vccz Lfo_97
	s_nop 7
	buffer_load_dword v7, v5, s[4:7], s30 offen offset:512 sc1
	v_cmp_gt_i32 vcc, s16, v7
	s_cbranch_vccz Lfo_97
	s_nop 7
	buffer_load_dword v7, v5, s[4:7], s30 offen offset:512 sc1
	v_cmp_gt_i32 vcc, s16, v7
	s_cbranch_vccz Lfo_97
	s_nop 7
	buffer_load_dword v7, v5, s[4:7], s30 offen offset:512 sc1
	v_cmp_gt_i32 vcc, s16, v7
	s_cbranch_vccz Lfo_97
	s_nop 7
	buffer_load_dword v7, v5, s[4:7], s30 offen offset:512 sc1
	v_cmp_gt_i32 vcc, s16, v7
	s_cbranch_vccz Lfo_97
	s_nop 7
	buffer_load_dword v7, v5, s[4:7], s30 offen offset:512 sc1
	v_cmp_gt_i32 vcc, s16, v7
	s_cbranch_vccz Lfo_97
	s_nop 7
	buffer_load_dword v7, v5, s[4:7], s30 offen offset:512 sc1
	v_cmp_gt_i32 vcc, s16, v7
	s_cbranch_vccz Lfo_97
	s_nop 7
	buffer_load_dword v7, v5, s[4:7], s30 offen offset:512 sc1
	v_cmp_gt_i32 vcc, s16, v7
	s_cbranch_vccz Lfo_97
	s_waitcnt vmcnt(40)
	s_nop 7
	buffer_load_dword v7, v5, s[4:7], s30 offen offset:512 sc1
	v_cmp_gt_i32 vcc, s16, v7
	s_cbranch_vccz Lfo_97
	s_nop 7
	buffer_load_dword v7, v5, s[4:7], s30 offen offset:512 sc1
	v_cmp_gt_i32 vcc, s16, v7
	s_cbranch_vccz Lfo_97
	s_nop 7
	buffer_load_dword v7, v5, s[4:7], s30 offen offset:512 sc1
	v_cmp_gt_i32 vcc, s16, v7
	s_cbranch_vccz Lfo_97
	s_nop 7
	buffer_load_dword v7, v5, s[4:7], s30 offen offset:512 sc1
	v_cmp_gt_i32 vcc, s16, v7
	s_cbranch_vccz Lfo_97
	s_nop 7
	buffer_load_dword v7, v5, s[4:7], s30 offen offset:512 sc1
	v_cmp_gt_i32 vcc, s16, v7
	s_cbranch_vccz Lfo_97
	s_nop 7
	buffer_load_dword v7, v5, s[4:7], s30 offen offset:512 sc1
	v_cmp_gt_i32 vcc, s16, v7
	s_cbranch_vccz Lfo_97
	s_nop 7
	buffer_load_dword v7, v5, s[4:7], s30 offen offset:512 sc1
	v_cmp_gt_i32 vcc, s16, v7
	s_cbranch_vccz Lfo_97
	s_nop 7
	buffer_load_dword v7, v5, s[4:7], s30 offen offset:512 sc1
	v_cmp_gt_i32 vcc, s16, v7
	s_cbranch_vccz Lfo_97
	s_waitcnt vmcnt(40)
	s_nop 7
	s_waitcnt vmcnt(24)
	s_sub_u32 s17, s17, 1
	s_cbranch_scc0 Lfl_96
	s_mov_b32 s17, 0
Lfo_97:
	s_mov_b64 exec, -1
	s_barrier
	s_cmp_lg_u32 s16, 63
	s_cbranch_scc1 Lcb_loop2
	s_nop 9
	s_add_u32 s16, s16, 1
Lmp_98:
	buffer_load_dwordx4 v[36:39], v4, s[4:7], s27 offen offset:0 sc1
	buffer_load_dwordx4 v[40:43], v4, s[4:7], s27 offen offset:1024 sc1
	buffer_load_dwordx4 v[44:47], v4, s[4:7], s27 offen offset:2048 sc1
	ds_read_b128 v[84:87], v11 offset:43008
	ds_read_b128 v[88:91], v11 offset:44032
	ds_read_b128 v[92:95], v11 offset:45056
	ds_read_b128 v[96:99], v11 offset:46080
	ds_read_b128 v[100:103], v11 offset:47104
	ds_read_b128 v[104:107], v11 offset:48128
	s_waitcnt vmcnt(2)
	ds_write_b128 v11, v[36:39] offset:61440
	s_waitcnt vmcnt(1)
	ds_write_b128 v11, v[40:43] offset:62464
	s_waitcnt vmcnt(0)
	ds_write_b128 v11, v[44:47] offset:63488
	v_dot2_f32_bf16 v17, v36, v37, 0
	v_dot2_f32_bf16 v17, v38, v39, v17
	v_dot2_f32_bf16 v17, v40, v41, v17
	v_dot2_f32_bf16 v17, v42, v43, v17
	v_dot2_f32_bf16 v17, v44, v45, v17
	v_dot2_f32_bf16 v17, v46, v47, v17
	s_nop 2
	v_cmp_u_f32 vcc, v17, v17
	s_cbranch_vccnz Lmr_99
Lmo_100:
	v_smfmac_f32_16x16x64_bf16 v[48:51], v[36:39], a[32:39], v1
	v_smfmac_f32_16x16x64_bf16 v[52:55], v[36:39], a[88:95], v1
	s_waitcnt lgkmcnt(0)
	s_barrier
	ds_read_b128 v[20:23], v11 offset:57344
	ds_read_b128 v[24:27], v11 offset:58368
	ds_read_b128 v[28:31], v11 offset:59392
	ds_read_b128 v[32:35], v11 offset:60416
	v_smfmac_f32_16x16x64_bf16 v[56:59], v[36:39], a[144:151], v1
	v_smfmac_f32_16x16x64_bf16 v[60:63], v[36:39], a[200:207], v1
	v_smfmac_f32_16x16x64_bf16 v[64:67], v[36:39], v[120:127], v1
	v_smfmac_f32_16x16x64_bf16 v[68:71], v[36:39], v[176:183], v1
	v_smfmac_f32_16x16x64_bf16 v[72:75], v[36:39], v[232:239], v1
	v_smfmac_f32_16x16x64_bf16 v[48:51], v[40:43], a[40:47], v1
	v_smfmac_f32_16x16x64_bf16 v[52:55], v[40:43], a[96:103], v1
	v_smfmac_f32_16x16x64_bf16 v[56:59], v[40:43], a[152:159], v1
	s_waitcnt lgkmcnt(0)
	v_smfmac_f32_16x16x64_bf16 v[48:51], v[20:23], a[0:7], v1
	v_smfmac_f32_16x16x64_bf16 v[48:51], v[24:27], a[8:15], v1
	v_smfmac_f32_16x16x64_bf16 v[48:51], v[28:31], a[16:23], v1
	v_smfmac_f32_16x16x64_bf16 v[48:51], v[32:35], a[24:31], v1
	v_smfmac_f32_16x16x64_bf16 v[48:51], v[44:47], a[48:55], v1
	s_waitcnt lgkmcnt(4)
	v_smfmac_f32_16x16x64_bf16 v[76:79], v[20:23], v[84:91], v1
	ds_read_b128 v[84:87], v11 offset:49152
	ds_read_b128 v[88:91], v11 offset:50176
	v_smfmac_f32_16x16x64_bf16 v[52:55], v[20:23], a[56:63], v1
	v_smfmac_f32_16x16x64_bf16 v[52:55], v[24:27], a[64:71], v1
	v_add_f32 v48, v48, v50
	v_smfmac_f32_16x16x64_bf16 v[52:55], v[28:31], a[72:79], v1
	v_add_f32 v49, v49, v51
	v_smfmac_f32_16x16x64_bf16 v[52:55], v[32:35], a[80:87], v1
	v_cvt_pk_bf16_f32 v48, v48, v49
	v_smfmac_f32_16x16x64_bf16 v[52:55], v[44:47], a[104:111], v1
	ds_write_b32 v10, v48 offset:3584
	s_waitcnt lgkmcnt(4)
	v_smfmac_f32_16x16x64_bf16 v[76:79], v[24:27], v[92:99], v1
	ds_read_b128 v[92:95], v11 offset:51200
	ds_read_b128 v[96:99], v11 offset:52224
	v_smfmac_f32_16x16x64_bf16 v[56:59], v[20:23], a[112:119], v1
	v_smfmac_f32_16x16x64_bf16 v[56:59], v[24:27], a[120:127], v1
	v_add_f32 v52, v52, v54
	v_smfmac_f32_16x16x64_bf16 v[56:59], v[28:31], a[128:135], v1
	v_add_f32 v53, v53, v55
	v_smfmac_f32_16x16x64_bf16 v[56:59], v[32:35], a[136:143], v1
	v_cvt_pk_bf16_f32 v52, v52, v53
	v_smfmac_f32_16x16x64_bf16 v[56:59], v[44:47], a[160:167], v1
	ds_write_b32 v10, v52 offset:3840
	s_waitcnt lgkmcnt(4)
	v_smfmac_f32_16x16x64_bf16 v[76:79], v[28:31], v[100:107], v1
	ds_read_b128 v[100:103], v11 offset:53248
	ds_read_b128 v[104:107], v11 offset:54272
	v_smfmac_f32_16x16x64_bf16 v[60:63], v[20:23], a[168:175], v1
	v_smfmac_f32_16x16x64_bf16 v[60:63], v[24:27], a[176:183], v1
	v_add_f32 v56, v56, v58
	v_smfmac_f32_16x16x64_bf16 v[60:63], v[28:31], a[184:191], v1
	v_add_f32 v57, v57, v59
	v_smfmac_f32_16x16x64_bf16 v[60:63], v[32:35], a[192:199], v1
	v_cvt_pk_bf16_f32 v56, v56, v57
	v_smfmac_f32_16x16x64_bf16 v[60:63], v[40:43], a[208:215], v1
	ds_write_b32 v10, v56 offset:4096
	v_smfmac_f32_16x16x64_bf16 v[60:63], v[44:47], a[216:223], v1
	s_waitcnt lgkmcnt(4)
	v_smfmac_f32_16x16x64_bf16 v[76:79], v[32:35], v[84:91], v1
	ds_read_b128 v[84:87], v11 offset:55296
	ds_read_b128 v[88:91], v11 offset:56320
	v_smfmac_f32_16x16x64_bf16 v[64:67], v[20:23], a[224:231], v1
	v_smfmac_f32_16x16x64_bf16 v[64:67], v[24:27], a[232:239], v1
	v_add_f32 v60, v60, v62
	v_smfmac_f32_16x16x64_bf16 v[64:67], v[28:31], a[240:247], v1
	v_add_f32 v61, v61, v63
	v_smfmac_f32_16x16x64_bf16 v[64:67], v[32:35], a[248:255], v1
	v_cvt_pk_bf16_f32 v60, v60, v61
	v_smfmac_f32_16x16x64_bf16 v[64:67], v[40:43], v[128:135], v1
	ds_write_b32 v10, v60 offset:4352
	v_smfmac_f32_16x16x64_bf16 v[64:67], v[44:47], v[136:143], v1
	s_waitcnt lgkmcnt(4)
	v_smfmac_f32_16x16x64_bf16 v[76:79], v[36:39], v[92:99], v1
	v_smfmac_f32_16x16x64_bf16 v[68:71], v[20:23], v[144:151], v1
	v_smfmac_f32_16x16x64_bf16 v[68:71], v[24:27], v[152:159], v1
	v_add_f32 v64, v64, v66
	v_smfmac_f32_16x16x64_bf16 v[68:71], v[28:31], v[160:167], v1
	v_add_f32 v65, v65, v67
	v_smfmac_f32_16x16x64_bf16 v[68:71], v[32:35], v[168:175], v1
	v_cvt_pk_bf16_f32 v64, v64, v65
	v_smfmac_f32_16x16x64_bf16 v[68:71], v[40:43], v[184:191], v1
	ds_write_b32 v10, v64 offset:4608
	v_smfmac_f32_16x16x64_bf16 v[68:71], v[44:47], v[192:199], v1
	s_waitcnt lgkmcnt(2)
	v_smfmac_f32_16x16x64_bf16 v[76:79], v[40:43], v[100:107], v1
	v_smfmac_f32_16x16x64_bf16 v[72:75], v[20:23], v[200:207], v1
	v_smfmac_f32_16x16x64_bf16 v[72:75], v[24:27], v[208:215], v1
	v_add_f32 v68, v68, v70
	v_smfmac_f32_16x16x64_bf16 v[72:75], v[28:31], v[216:223], v1
	v_add_f32 v69, v69, v71
	v_smfmac_f32_16x16x64_bf16 v[72:75], v[32:35], v[224:231], v1
	v_cvt_pk_bf16_f32 v68, v68, v69
	v_smfmac_f32_16x16x64_bf16 v[72:75], v[40:43], v[240:247], v1
	ds_write_b32 v10, v68 offset:4864
	v_smfmac_f32_16x16x64_bf16 v[72:75], v[44:47], v[248:255], v1
	s_waitcnt lgkmcnt(0)
	v_smfmac_f32_16x16x64_bf16 v[76:79], v[44:47], v[84:91], v1
	s_nop 4
	v_add_f32 v72, v72, v74
	v_add_f32 v73, v73, v75
	v_cvt_pk_bf16_f32 v72, v72, v73
	ds_write_b32 v10, v72 offset:5120
	v_add_f32 v76, v76, v78
	v_add_f32 v77, v77, v79
	v_cvt_pk_bf16_f32 v76, v76, v77
	ds_write_b32 v10, v76 offset:7936
	s_waitcnt lgkmcnt(0)
	s_barrier
	s_lshl_b32 s41, s32, 12
	ds_read_b128 v[20:23], v4 offset:28672
	ds_read_b128 v[24:27], v4 offset:29696
	s_waitcnt lgkmcnt(0)
	s_add_u32 s40, s41, 49487872
	buffer_store_dwordx4 v[20:23], v4, s[4:7], s40 offen offset:0 sc1
	buffer_store_dwordx4 v[24:27], v4, s[4:7], s40 offen offset:1024 sc1
	s_waitcnt vmcnt(0)
	s_endpgm
Lmr_94:
	s_cmp_eq_u32 s13, 0
	s_cbranch_scc1 Lmo_95
	s_sub_u32 s13, s13, 1
	s_branch Lmp_93
Lmr_99:
	s_cmp_eq_u32 s13, 0
	s_cbranch_scc1 Lmo_100
	s_sub_u32 s13, s13, 1
	s_branch Lmp_98
Lcb_w3:
	s_mul_i32 s41, s32, 229376
	s_add_u32 s40, s41, 9705472
	s_add_u32 s42, s40, 0
	buffer_load_dwordx4 a[0:3], v4, s[4:7], s42 offen offset:0 sc1
	buffer_load_dwordx4 a[4:7], v4, s[4:7], s42 offen offset:1024 sc1
	s_add_u32 s42, s40, 4096
	buffer_load_dwordx4 a[28:31], v4, s[4:7], s42 offen offset:3072 sc1
	s_add_u32 s42, s40, 8192
	buffer_load_dwordx4 a[32:35], v4, s[4:7], s42 offen offset:0 sc1
	s_add_u32 s40, s41, 9719808
	s_add_u32 s42, s40, 0
	buffer_load_dwordx4 a[56:59], v4, s[4:7], s42 offen offset:0 sc1
	buffer_load_dwordx4 a[60:63], v4, s[4:7], s42 offen offset:1024 sc1
	s_add_u32 s42, s40, 4096
	buffer_load_dwordx4 a[84:87], v4, s[4:7], s42 offen offset:3072 sc1
	s_add_u32 s42, s40, 8192
	buffer_load_dwordx4 a[88:91], v4, s[4:7], s42 offen offset:0 sc1
	s_add_u32 s40, s41, 9734144
	s_add_u32 s42, s40, 0
	buffer_load_dwordx4 a[112:115], v4, s[4:7], s42 offen offset:0 sc1
	buffer_load_dwordx4 a[116:119], v4, s[4:7], s42 offen offset:1024 sc1
	s_add_u32 s42, s40, 4096
	buffer_load_dwordx4 a[140:143], v4, s[4:7], s42 offen offset:3072 sc1
	s_waitcnt vmcnt(10)
	s_add_u32 s42, s40, 8192
	buffer_load_dwordx4 a[144:147], v4, s[4:7], s42 offen offset:0 sc1
	s_add_u32 s40, s41, 9748480
	s_add_u32 s42, s40, 0
	buffer_load_dwordx4 a[168:171], v4, s[4:7], s42 offen offset:0 sc1
	s_waitcnt vmcnt(10)
	buffer_load_dwordx4 a[172:175], v4, s[4:7], s42 offen offset:1024 sc1
	s_add_u32 s42, s40, 4096
	buffer_load_dwordx4 a[196:199], v4, s[4:7], s42 offen offset:3072 sc1
	s_waitcnt vmcnt(10)
	s_add_u32 s42, s40, 8192
	buffer_load_dwordx4 a[200:203], v4, s[4:7], s42 offen offset:0 sc1
	s_add_u32 s40, s41, 9762816
	s_add_u32 s42, s40, 0
	buffer_load_dwordx4 a[224:227], v4, s[4:7], s42 offen offset:0 sc1
	s_waitcnt vmcnt(10)
	buffer_load_dwordx4 a[228:231], v4, s[4:7], s42 offen offset:1024 sc1
	s_add_u32 s42, s40, 4096
	buffer_load_dwordx4 a[252:255], v4, s[4:7], s42 offen offset:3072 sc1
	s_waitcnt vmcnt(10)
	s_add_u32 s42, s40, 8192
	buffer_load_dwordx4 v[232:235], v4, s[4:7], s42 offen offset:0 sc1
	s_add_u32 s40, s41, 9820160
	s_add_u32 s42, s40, 0
	s_mov_b32 m0, 75776
	s_nop 0
	buffer_load_dwordx4 v4, s[4:7], s42 offen offset:0 sc1 lds
	s_waitcnt vmcnt(10)
	buffer_load_dwordx4 v4, s[4:7], s42 offen offset:1024 sc1 lds
	s_add_u32 s42, s40, 4096
	s_mov_b32 m0, 79872
	s_nop 0
	buffer_load_dwordx4 v4, s[4:7], s42 offen offset:3072 sc1 lds
	s_waitcnt vmcnt(10)
	s_add_u32 s42, s40, 8192
	s_mov_b32 m0, 83968
	s_nop 0
	buffer_load_dwordx4 v4, s[4:7], s42 offen offset:0 sc1 lds
	s_add_u32 s40, s41, 9834496
	s_add_u32 s42, s40, 0
	s_mov_b32 m0, 90112
	s_nop 0
	buffer_load_dwordx4 v4, s[4:7], s42 offen offset:0 sc1 lds
	s_waitcnt vmcnt(10)
	buffer_load_dwordx4 v4, s[4:7], s42 offen offset:1024 sc1 lds
	s_add_u32 s42, s40, 4096
	s_mov_b32 m0, 94208
	s_nop 0
	buffer_load_dwordx4 v4, s[4:7], s42 offen offset:3072 sc1 lds
	s_waitcnt vmcnt(10)
	s_add_u32 s42, s40, 8192
	s_mov_b32 m0, 98304
	s_nop 0
	buffer_load_dwordx4 v4, s[4:7], s42 offen offset:0 sc1 lds
	s_add_u32 s40, s41, 9848832
	s_add_u32 s42, s40, 0
	s_mov_b32 m0, 104448
	s_nop 0
	buffer_load_dwordx4 v4, s[4:7], s42 offen offset:0 sc1 lds
	s_waitcnt vmcnt(10)
	buffer_load_dwordx4 v4, s[4:7], s42 offen offset:1024 sc1 lds
	s_add_u32 s42, s40, 4096
	s_mov_b32 m0, 108544
	s_nop 0
	buffer_load_dwordx4 v4, s[4:7], s42 offen offset:3072 sc1 lds
	s_waitcnt vmcnt(10)
	s_add_u32 s42, s40, 8192
	s_mov_b32 m0, 112640
	s_nop 0
	buffer_load_dwordx4 v4, s[4:7], s42 offen offset:0 sc1 lds
	s_mov_b32 s40, 0x100000
Lww_101:
	buffer_load_dword v25, v26, s[4:7], s34 offen sc1
	s_sub_u32 s40, s40, 1
	s_cbranch_scc1 Lwx_102
	s_waitcnt vmcnt(0)
	v_cmp_gt_u32 vcc, 7, v25
	s_cbranch_vccnz Lww_101
Lwx_102:
	s_waitcnt vmcnt(0)
	s_add_u32 s40, s41, 9705472
	s_add_u32 s42, s40, 0
	buffer_load_dwordx4 a[8:11], v4, s[4:7], s42 offen offset:2048 sc1
	s_waitcnt vmcnt(10)
	buffer_load_dwordx4 a[12:15], v4, s[4:7], s42 offen offset:3072 sc1
	s_add_u32 s42, s40, 4096
	buffer_load_dwordx4 a[16:19], v4, s[4:7], s42 offen offset:0 sc1
	s_waitcnt vmcnt(10)
	buffer_load_dwordx4 a[20:23], v4, s[4:7], s42 offen offset:1024 sc1
	buffer_load_dwordx4 a[24:27], v4, s[4:7], s42 offen offset:2048 sc1
	s_waitcnt vmcnt(10)
	s_add_u32 s42, s40, 8192
	buffer_load_dwordx4 a[36:39], v4, s[4:7], s42 offen offset:1024 sc1
	buffer_load_dwordx4 a[40:43], v4, s[4:7], s42 offen offset:2048 sc1
	s_waitcnt vmcnt(10)
	buffer_load_dwordx4 a[44:47], v4, s[4:7], s42 offen offset:3072 sc1
	s_add_u32 s42, s40, 12288
	buffer_load_dwordx4 a[48:51], v4, s[4:7], s42 offen offset:0 sc1
	s_waitcnt vmcnt(10)
	buffer_load_dwordx4 a[52:55], v4, s[4:7], s42 offen offset:1024 sc1
	s_add_u32 s40, s41, 9719808
	s_add_u32 s42, s40, 0
	buffer_load_dwordx4 a[64:67], v4, s[4:7], s42 offen offset:2048 sc1
	s_waitcnt vmcnt(10)
	buffer_load_dwordx4 a[68:71], v4, s[4:7], s42 offen offset:3072 sc1
	s_add_u32 s42, s40, 4096
	buffer_load_dwordx4 a[72:75], v4, s[4:7], s42 offen offset:0 sc1
	s_waitcnt vmcnt(10)
	buffer_load_dwordx4 a[76:79], v4, s[4:7], s42 offen offset:1024 sc1
	buffer_load_dwordx4 a[80:83], v4, s[4:7], s42 offen offset:2048 sc1
	s_waitcnt vmcnt(10)
	s_add_u32 s42, s40, 8192
	buffer_load_dwordx4 a[92:95], v4, s[4:7], s42 offen offset:1024 sc1
	buffer_load_dwordx4 a[96:99], v4, s[4:7], s42 offen offset:2048 sc1
	s_waitcnt vmcnt(10)
	buffer_load_dwordx4 a[100:103], v4, s[4:7], s42 offen offset:3072 sc1
	s_add_u32 s42, s40, 12288
	buffer_load_dwordx4 a[104:107], v4, s[4:7], s42 offen offset:0 sc1
	s_waitcnt vmcnt(10)
	buffer_load_dwordx4 a[108:111], v4, s[4:7], s42 offen offset:1024 sc1
	s_add_u32 s40, s41, 9734144
	s_add_u32 s42, s40, 0
	buffer_load_dwordx4 a[120:123], v4, s[4:7], s42 offen offset:2048 sc1
	s_waitcnt vmcnt(10)
	buffer_load_dwordx4 a[124:127], v4, s[4:7], s42 offen offset:3072 sc1
	s_add_u32 s42, s40, 4096
	buffer_load_dwordx4 a[128:131], v4, s[4:7], s42 offen offset:0 sc1
	s_waitcnt vmcnt(10)
	buffer_load_dwordx4 a[132:135], v4, s[4:7], s42 offen offset:1024 sc1
	buffer_load_dwordx4 a[136:139], v4, s[4:7], s42 offen offset:2048 sc1
	s_waitcnt vmcnt(10)
	s_add_u32 s42, s40, 8192
	buffer_load_dwordx4 a[148:151], v4, s[4:7], s42 offen offset:1024 sc1
	buffer_load_dwordx4 a[152:155], v4, s[4:7], s42 offen offset:2048 sc1
	s_waitcnt vmcnt(10)
	buffer_load_dwordx4 a[156:159], v4, s[4:7], s42 offen offset:3072 sc1
	s_add_u32 s42, s40, 12288
	buffer_load_dwordx4 a[160:163], v4, s[4:7], s42 offen offset:0 sc1
	s_waitcnt vmcnt(10)
	buffer_load_dwordx4 a[164:167], v4, s[4:7], s42 offen offset:1024 sc1
	s_add_u32 s40, s41, 9748480
	s_add_u32 s42, s40, 0
	buffer_load_dwordx4 a[176:179], v4, s[4:7], s42 offen offset:2048 sc1
	s_waitcnt vmcnt(10)
	buffer_load_dwordx4 a[180:183], v4, s[4:7], s42 offen offset:3072 sc1
	s_add_u32 s42, s40, 4096
	buffer_load_dwordx4 a[184:187], v4, s[4:7], s42 offen offset:0 sc1
	s_waitcnt vmcnt(10)
	buffer_load_dwordx4 a[188:191], v4, s[4:7], s42 offen offset:1024 sc1
	buffer_load_dwordx4 a[192:195], v4, s[4:7], s42 offen offset:2048 sc1
	s_waitcnt vmcnt(10)
	s_add_u32 s42, s40, 8192
	buffer_load_dwordx4 a[204:207], v4, s[4:7], s42 offen offset:1024 sc1
	buffer_load_dwordx4 a[208:211], v4, s[4:7], s42 offen offset:2048 sc1
	s_waitcnt vmcnt(10)
	buffer_load_dwordx4 a[212:215], v4, s[4:7], s42 offen offset:3072 sc1
	s_add_u32 s42, s40, 12288
	buffer_load_dwordx4 a[216:219], v4, s[4:7], s42 offen offset:0 sc1
	s_waitcnt vmcnt(10)
	buffer_load_dwordx4 a[220:223], v4, s[4:7], s42 offen offset:1024 sc1
	s_add_u32 s40, s41, 9762816
	s_add_u32 s42, s40, 0
	buffer_load_dwordx4 a[232:235], v4, s[4:7], s42 offen offset:2048 sc1
	s_waitcnt vmcnt(10)
	buffer_load_dwordx4 a[236:239], v4, s[4:7], s42 offen offset:3072 sc1
	s_add_u32 s42, s40, 4096
	buffer_load_dwordx4 a[240:243], v4, s[4:7], s42 offen offset:0 sc1
	s_waitcnt vmcnt(10)
	buffer_load_dwordx4 a[244:247], v4, s[4:7], s42 offen offset:1024 sc1
	buffer_load_dwordx4 a[248:251], v4, s[4:7], s42 offen offset:2048 sc1
	s_waitcnt vmcnt(10)
	s_add_u32 s42, s40, 8192
	buffer_load_dwordx4 v[236:239], v4, s[4:7], s42 offen offset:1024 sc1
	buffer_load_dwordx4 v[240:243], v4, s[4:7], s42 offen offset:2048 sc1
	s_waitcnt vmcnt(10)
	buffer_load_dwordx4 v[244:247], v4, s[4:7], s42 offen offset:3072 sc1
	s_add_u32 s42, s40, 12288
	buffer_load_dwordx4 v[248:251], v4, s[4:7], s42 offen offset:0 sc1
	s_waitcnt vmcnt(10)
	buffer_load_dwordx4 v[252:255], v4, s[4:7], s42 offen offset:1024 sc1
	s_add_u32 s40, s41, 9820160
	s_add_u32 s42, s40, 0
	s_mov_b32 m0, 75776
	s_nop 0
	buffer_load_dwordx4 v4, s[4:7], s42 offen offset:2048 sc1 lds
	s_waitcnt vmcnt(10)
	buffer_load_dwordx4 v4, s[4:7], s42 offen offset:3072 sc1 lds
	s_add_u32 s42, s40, 4096
	s_mov_b32 m0, 79872
	s_nop 0
	buffer_load_dwordx4 v4, s[4:7], s42 offen offset:0 sc1 lds
	s_waitcnt vmcnt(10)
	buffer_load_dwordx4 v4, s[4:7], s42 offen offset:1024 sc1 lds
	buffer_load_dwordx4 v4, s[4:7], s42 offen offset:2048 sc1 lds
	s_waitcnt vmcnt(10)
	s_add_u32 s42, s40, 8192
	s_mov_b32 m0, 83968
	s_nop 0
	buffer_load_dwordx4 v4, s[4:7], s42 offen offset:1024 sc1 lds
	buffer_load_dwordx4 v4, s[4:7], s42 offen offset:2048 sc1 lds
	s_waitcnt vmcnt(10)
	buffer_load_dwordx4 v4, s[4:7], s42 offen offset:3072 sc1 lds
	s_add_u32 s42, s40, 12288
	s_mov_b32 m0, 88064
	s_nop 0
	buffer_load_dwordx4 v4, s[4:7], s42 offen offset:0 sc1 lds
	s_waitcnt vmcnt(10)
	buffer_load_dwordx4 v4, s[4:7], s42 offen offset:1024 sc1 lds
	v_mov_b32 v24, 0
	s_mov_b32 s40, 0x100000
Lrw_103:
	buffer_load_dword v25, v24, s[44:47], 0 offen offset:128 sc1
	s_sub_u32 s40, s40, 1
	s_cbranch_scc1 Lrx_104
	s_waitcnt vmcnt(0)
	v_cmp_gt_u32 vcc, 8, v25
	s_cbranch_vccnz Lrw_103
Lrx_104:
	s_waitcnt vmcnt(0)
	s_add_u32 s40, s41, 9834496
	s_add_u32 s42, s40, 0
	s_mov_b32 m0, 90112
	s_nop 0
	buffer_load_dwordx4 v4, s[4:7], s42 offen offset:2048 sc1 lds
	s_waitcnt vmcnt(10)
	buffer_load_dwordx4 v4, s[4:7], s42 offen offset:3072 sc1 lds
	s_add_u32 s42, s40, 4096
	s_mov_b32 m0, 94208
	s_nop 0
	buffer_load_dwordx4 v4, s[4:7], s42 offen offset:0 sc1 lds
	s_waitcnt vmcnt(10)
	buffer_load_dwordx4 v4, s[4:7], s42 offen offset:1024 sc1 lds
	buffer_load_dwordx4 v4, s[4:7], s42 offen offset:2048 sc1 lds
	s_waitcnt vmcnt(10)
	s_add_u32 s42, s40, 8192
	s_mov_b32 m0, 98304
	s_nop 0
	buffer_load_dwordx4 v4, s[4:7], s42 offen offset:1024 sc1 lds
	buffer_load_dwordx4 v4, s[4:7], s42 offen offset:2048 sc1 lds
	s_waitcnt vmcnt(10)
	buffer_load_dwordx4 v4, s[4:7], s42 offen offset:3072 sc1 lds
	s_add_u32 s42, s40, 12288
	s_mov_b32 m0, 102400
	s_nop 0
	buffer_load_dwordx4 v4, s[4:7], s42 offen offset:0 sc1 lds
	s_waitcnt vmcnt(10)
	buffer_load_dwordx4 v4, s[4:7], s42 offen offset:1024 sc1 lds
	s_add_u32 s40, s41, 9848832
	s_add_u32 s42, s40, 0
	s_mov_b32 m0, 104448
	s_nop 0
	buffer_load_dwordx4 v4, s[4:7], s42 offen offset:2048 sc1 lds
	s_waitcnt vmcnt(10)
	buffer_load_dwordx4 v4, s[4:7], s42 offen offset:3072 sc1 lds
	s_add_u32 s42, s40, 4096
	s_mov_b32 m0, 108544
	s_nop 0
	buffer_load_dwordx4 v4, s[4:7], s42 offen offset:0 sc1 lds
	s_waitcnt vmcnt(10)
	buffer_load_dwordx4 v4, s[4:7], s42 offen offset:1024 sc1 lds
	buffer_load_dwordx4 v4, s[4:7], s42 offen offset:2048 sc1 lds
	s_waitcnt vmcnt(10)
	s_add_u32 s42, s40, 8192
	s_mov_b32 m0, 112640
	s_nop 0
	buffer_load_dwordx4 v4, s[4:7], s42 offen offset:1024 sc1 lds
	buffer_load_dwordx4 v4, s[4:7], s42 offen offset:2048 sc1 lds
	s_waitcnt vmcnt(10)
	buffer_load_dwordx4 v4, s[4:7], s42 offen offset:3072 sc1 lds
	s_add_u32 s42, s40, 12288
	s_mov_b32 m0, 116736
	s_nop 0
	buffer_load_dwordx4 v4, s[4:7], s42 offen offset:0 sc1 lds
	s_waitcnt vmcnt(10)
	buffer_load_dwordx4 v4, s[4:7], s42 offen offset:1024 sc1 lds
	v_mov_b64 v[48:49], 0
	v_mov_b64 v[50:51], 0
	v_mov_b64 v[52:53], 0
	v_mov_b64 v[54:55], 0
	v_mov_b64 v[56:57], 0
	v_mov_b64 v[58:59], 0
	v_mov_b64 v[60:61], 0
	v_mov_b64 v[62:63], 0
	v_mov_b64 v[64:65], 0
	v_mov_b64 v[66:67], 0
	v_mov_b64 v[68:69], 0
	v_mov_b64 v[70:71], 0
	v_mov_b64 v[72:73], 0
	v_mov_b64 v[74:75], 0
	v_mov_b64 v[76:77], 0
	v_mov_b64 v[78:79], 0
	v_mov_b64 v[80:81], 0
	v_mov_b64 v[82:83], 0
	v_bfe_u32 v24, v20, 1, 1
	v_lshlrev_b32 v24, 5, v24
	v_lshl_add_u32 v24, v21, 6, v24
	v_lshrrev_b32 v25, 2, v20
	v_lshl_add_u32 v24, v25, 2, v24
	v_and_b32 v25, 1, v20
	v_lshl_add_u32 v24, v25, 1, v24
	v_mov_b32 v16, v11
	v_add_u32 v11, s43, v24
	v_mul_u32_u24 v24, 1792, v21
	v_lshl_add_u32 v24, v20, 1, v24
	s_lshl_b32 s40, s32, 5
	buffer_load_ushort v32, v24, s[48:51], s40 offen offset:0
	buffer_load_ushort v33, v24, s[48:51], s40 offen offset:896
	buffer_load_ushort v34, v24, s[48:51], s40 offen offset:448
	buffer_load_ushort v35, v24, s[48:51], s40 offen offset:1344
	s_waitcnt vmcnt(0)
	buffer_store_short v32, v11, s[4:7], s18 offen offset:0
	buffer_store_short v33, v11, s[4:7], s18 offen offset:16
	buffer_store_short v34, v11, s[4:7], s18 offen offset:3584
	buffer_store_short v35, v11, s[4:7], s18 offen offset:3600
	s_waitcnt vmcnt(0)
	s_barrier
	v_mov_b32 v8, 0
	buffer_store_dword v8, v9, s[4:7], s31 offen offset:256
	buffer_store_dword v8, v9, s[4:7], s31 offen offset:512
	s_barrier
.p2align 6
Lcb_loop3:
	s_nop 9
	s_add_u32 s16, s16, 1
	ds_read_b128 v[80:83], v4 offset:32768
	ds_read_b128 v[84:87], v4 offset:33792
	ds_read_b128 v[88:91], v4 offset:34816
	ds_read_b128 v[92:95], v4 offset:35840
	ds_read_b128 v[96:99], v4 offset:36864
	ds_read_b128 v[100:103], v4 offset:37888
	s_nop 1
	v_mov_b32 v8, s16
	s_add_u32 s42, s14, 0
	buffer_load_dwordx4 v[104:107], v4, s[4:7], s42 offen offset:0 sc1
	v_mov_b64 v[48:49], 0
	buffer_load_dwordx4 v[108:111], v4, s[4:7], s42 offen offset:1024 sc1
	v_mov_b64 v[50:51], 0
	buffer_load_dwordx4 v[120:123], v4, s[4:7], s42 offen offset:2048 sc1
	v_mov_b64 v[52:53], 0
	buffer_load_dwordx4 v[124:127], v4, s[4:7], s42 offen offset:3072 sc1
	v_mov_b64 v[54:55], 0
	s_add_u32 s42, s14, 4096
	buffer_load_dwordx4 v[136:139], v4, s[4:7], s42 offen offset:0 sc1
	v_mov_b64 v[56:57], 0
	buffer_load_dwordx4 v[140:143], v4, s[4:7], s42 offen offset:1024 sc1
	v_mov_b64 v[58:59], 0
	buffer_load_dwordx4 v[152:155], v4, s[4:7], s42 offen offset:2048 sc1
	v_mov_b64 v[60:61], 0
	buffer_load_dwordx4 v[156:159], v4, s[4:7], s42 offen offset:3072 sc1
	v_mov_b64 v[62:63], 0
	s_add_u32 s42, s14, 8192
	buffer_load_dwordx4 v[168:171], v4, s[4:7], s42 offen offset:0 sc1
	v_mov_b64 v[64:65], 0
	buffer_load_dwordx4 v[172:175], v4, s[4:7], s42 offen offset:1024 sc1
	v_mov_b64 v[66:67], 0
	buffer_load_dwordx4 v[184:187], v4, s[4:7], s42 offen offset:2048 sc1
	v_mov_b64 v[68:69], 0
	buffer_load_dwordx4 v[188:191], v4, s[4:7], s42 offen offset:3072 sc1
	v_mov_b64 v[70:71], 0
	s_add_u32 s42, s14, 12288
	buffer_load_dwordx4 v[200:203], v4, s[4:7], s42 offen offset:0 sc1
	v_mov_b64 v[72:73], 0
	buffer_load_dwordx4 v[204:207], v4, s[4:7], s42 offen offset:1024 sc1
	v_mov_b64 v[74:75], 0
	buffer_load_dwordx4 v[216:219], v4, s[4:7], s42 offen offset:2048 sc1
	v_mov_b64 v[76:77], 0
	buffer_load_dwordx4 v[220:223], v4, s[4:7], s42 offen offset:3072 sc1
	v_mov_b64 v[78:79], 0
	s_add_u32 s42, s14, 229376
	buffer_load_dwordx4 v[112:115], v4, s[4:7], s42 offen offset:0 sc1
	buffer_load_dwordx4 v[116:119], v4, s[4:7], s42 offen offset:1024 sc1
	buffer_load_dwordx4 v[128:131], v4, s[4:7], s42 offen offset:2048 sc1
	buffer_load_dwordx4 v[132:135], v4, s[4:7], s42 offen offset:3072 sc1
	s_add_u32 s42, s14, 233472
	buffer_load_dwordx4 v[144:147], v4, s[4:7], s42 offen offset:0 sc1
	buffer_load_dwordx4 v[148:151], v4, s[4:7], s42 offen offset:1024 sc1
	s_add_u32 s18, s18, 8192
	s_add_u32 s20, s20, s23
	s_add_u32 s21, s21, s23
	s_add_u32 s22, s22, s23
	s_barrier
	ds_read_b128 v[20:23], v16 offset:57344
	ds_read_b128 v[24:27], v16 offset:58368
	ds_read_b128 v[28:31], v16 offset:59392
	ds_read_b128 v[32:35], v16 offset:60416
	ds_read_b128 v[36:39], v16 offset:61440
	ds_read_b128 v[40:43], v16 offset:62464
	ds_read_b128 v[44:47], v16 offset:63488
	s_waitcnt lgkmcnt(6)
	v_smfmac_f32_16x16x64_bf16 v[48:51], v[20:23], a[0:7], v1
	buffer_load_dwordx4 v[160:163], v4, s[4:7], s42 offen offset:2048 sc1
	v_smfmac_f32_16x16x64_bf16 v[52:55], v[20:23], a[56:63], v1
	buffer_load_dwordx4 v[164:167], v4, s[4:7], s42 offen offset:3072 sc1
	s_waitcnt lgkmcnt(5)
	v_smfmac_f32_16x16x64_bf16 v[48:51], v[24:27], a[8:15], v1
	s_add_u32 s42, s14, 237568
	buffer_load_dwordx4 v[176:179], v4, s[4:7], s42 offen offset:0 sc1
	v_smfmac_f32_16x16x64_bf16 v[52:55], v[24:27], a[64:71], v1
	buffer_load_dwordx4 v[180:183], v4, s[4:7], s42 offen offset:1024 sc1
	s_waitcnt lgkmcnt(4)
	v_smfmac_f32_16x16x64_bf16 v[48:51], v[28:31], a[16:23], v1
	buffer_load_dwordx4 v[192:195], v4, s[4:7], s42 offen offset:2048 sc1
	v_smfmac_f32_16x16x64_bf16 v[52:55], v[28:31], a[72:79], v1
	buffer_load_dwordx4 v[196:199], v4, s[4:7], s42 offen offset:3072 sc1
	s_waitcnt lgkmcnt(3)
	v_smfmac_f32_16x16x64_bf16 v[48:51], v[32:35], a[24:31], v1
	s_add_u32 s42, s14, 241664
	buffer_load_dwordx4 v[208:211], v4, s[4:7], s42 offen offset:0 sc1
	v_smfmac_f32_16x16x64_bf16 v[52:55], v[32:35], a[80:87], v1
	buffer_load_dwordx4 v[212:215], v4, s[4:7], s42 offen offset:1024 sc1
	s_waitcnt lgkmcnt(2)
	v_smfmac_f32_16x16x64_bf16 v[48:51], v[36:39], a[32:39], v1
	buffer_load_dwordx4 v[224:227], v4, s[4:7], s42 offen offset:2048 sc1
	v_smfmac_f32_16x16x64_bf16 v[52:55], v[36:39], a[88:95], v1
	buffer_load_dwordx4 v[228:231], v4, s[4:7], s42 offen offset:3072 sc1
	s_waitcnt lgkmcnt(1)
	v_smfmac_f32_16x16x64_bf16 v[48:51], v[40:43], a[40:47], v1
	v_smfmac_f32_16x16x64_bf16 v[52:55], v[40:43], a[96:103], v1
	s_waitcnt lgkmcnt(0)
	v_smfmac_f32_16x16x64_bf16 v[48:51], v[44:47], a[48:55], v1
	v_smfmac_f32_16x16x64_bf16 v[52:55], v[44:47], a[104:111], v1
	v_smfmac_f32_16x16x64_bf16 v[56:59], v[20:23], a[112:119], v1
	v_smfmac_f32_16x16x64_bf16 v[56:59], v[24:27], a[120:127], v1
	v_add_f32 v48, v48, v50
	v_smfmac_f32_16x16x64_bf16 v[56:59], v[28:31], a[128:135], v1
	v_add_f32 v49, v49, v51
	s_waitcnt lgkmcnt(4)
	v_smfmac_f32_16x16x64_bf16 v[68:71], v[20:23], v[80:87], v1
	ds_read_b128 v[80:83], v4 offset:38912
	ds_read_b128 v[84:87], v4 offset:39936
	v_cvt_pk_bf16_f32 v48, v48, v49
	v_smfmac_f32_16x16x64_bf16 v[56:59], v[32:35], a[136:143], v1
	v_add_f32 v52, v52, v54
	v_smfmac_f32_16x16x64_bf16 v[56:59], v[36:39], a[144:151], v1
	v_add_f32 v53, v53, v55
	v_smfmac_f32_16x16x64_bf16 v[56:59], v[40:43], a[152:159], v1
	v_cvt_pk_bf16_f32 v52, v52, v53
	s_waitcnt lgkmcnt(4)
	v_smfmac_f32_16x16x64_bf16 v[68:71], v[24:27], v[88:95], v1
	ds_read_b128 v[88:91], v4 offset:40960
	ds_read_b128 v[92:95], v4 offset:41984
	v_smfmac_f32_16x16x64_bf16 v[56:59], v[44:47], a[160:167], v1
	ds_write_b32 v10, v48 offset:5376
	v_smfmac_f32_16x16x64_bf16 v[60:63], v[20:23], a[168:175], v1
	ds_write_b32 v10, v52 offset:5632
	v_smfmac_f32_16x16x64_bf16 v[60:63], v[24:27], a[176:183], v1
	s_waitcnt lgkmcnt(4)
	v_smfmac_f32_16x16x64_bf16 v[68:71], v[28:31], v[96:103], v1
	ds_read_b128 v[96:99], v4 offset:43008
	ds_read_b128 v[100:103], v4 offset:44032
	v_add_f32 v56, v56, v58
	v_smfmac_f32_16x16x64_bf16 v[60:63], v[28:31], a[184:191], v1
	v_add_f32 v57, v57, v59
	v_smfmac_f32_16x16x64_bf16 v[60:63], v[32:35], a[192:199], v1
	v_cvt_pk_bf16_f32 v56, v56, v57
	v_smfmac_f32_16x16x64_bf16 v[60:63], v[36:39], a[200:207], v1
	ds_write_b32 v10, v56 offset:5888
	s_waitcnt lgkmcnt(4)
	v_smfmac_f32_16x16x64_bf16 v[68:71], v[32:35], v[80:87], v1
	ds_read_b128 v[80:83], v4 offset:45056
	ds_read_b128 v[84:87], v4 offset:46080
	v_smfmac_f32_16x16x64_bf16 v[60:63], v[40:43], a[208:215], v1
	v_smfmac_f32_16x16x64_bf16 v[60:63], v[44:47], a[216:223], v1
	v_smfmac_f32_16x16x64_bf16 v[64:67], v[20:23], a[224:231], v1
	s_waitcnt lgkmcnt(4)
	v_smfmac_f32_16x16x64_bf16 v[68:71], v[36:39], v[88:95], v1
	v_smfmac_f32_16x16x64_bf16 v[64:67], v[24:27], a[232:239], v1
	v_add_f32 v60, v60, v62
	v_smfmac_f32_16x16x64_bf16 v[64:67], v[28:31], a[240:247], v1
	v_add_f32 v61, v61, v63
	v_smfmac_f32_16x16x64_bf16 v[64:67], v[32:35], a[248:255], v1
	v_cvt_pk_bf16_f32 v60, v60, v61
	s_waitcnt lgkmcnt(2)
	v_smfmac_f32_16x16x64_bf16 v[68:71], v[40:43], v[96:103], v1
	v_smfmac_f32_16x16x64_bf16 v[64:67], v[36:39], v[232:239], v1
	ds_write_b32 v10, v60 offset:6144
	v_smfmac_f32_16x16x64_bf16 v[64:67], v[40:43], v[240:247], v1
	v_smfmac_f32_16x16x64_bf16 v[64:67], v[44:47], v[248:255], v1
	s_waitcnt lgkmcnt(0)
	v_smfmac_f32_16x16x64_bf16 v[68:71], v[44:47], v[80:87], v1
	s_nop 4
	v_add_f32 v64, v64, v66
	v_add_f32 v65, v65, v67
	v_cvt_pk_bf16_f32 v64, v64, v65
	ds_write_b32 v10, v64 offset:6400
	v_add_f32 v68, v68, v70
	v_add_f32 v69, v69, v71
	v_cvt_pk_bf16_f32 v68, v68, v69
	ds_write_b32 v10, v68 offset:6656
	s_add_u32 s26, s26, 8192
	s_add_u32 s27, s27, 8192
	v_add_u32 v10, 8192, v10
	v_and_b32 v10, 0x7fff, v10
	s_add_u32 s14, s14, 458752
	s_and_b32 s23, s16, 3
	s_cselect_b32 s23, s24, -49152
	s_waitcnt lgkmcnt(0)
	v_mov_b64 v[60:61], 0
	v_mov_b64 v[62:63], 0
	v_mov_b64 v[64:65], 0
	v_mov_b64 v[66:67], 0
	s_mov_b64 exec, 0xffff
Lfl_110:
	buffer_load_dword v7, v5, s[4:7], s30 offen offset:0 sc1
	v_cmp_gt_i32 vcc, s16, v7
	s_cbranch_vccz Lfo_111
	buffer_load_dword v7, v5, s[4:7], s30 offen offset:0 sc1
	v_cmp_gt_i32 vcc, s16, v7
	s_cbranch_vccz Lfo_111
	buffer_load_dword v7, v5, s[4:7], s30 offen offset:0 sc1
	v_cmp_gt_i32 vcc, s16, v7
	s_cbranch_vccz Lfo_111
	buffer_load_dword v7, v5, s[4:7], s30 offen offset:0 sc1
	v_cmp_gt_i32 vcc, s16, v7
	s_cbranch_vccz Lfo_111
	buffer_load_dword v7, v5, s[4:7], s30 offen offset:0 sc1
	v_cmp_gt_i32 vcc, s16, v7
	s_cbranch_vccz Lfo_111
	buffer_load_dword v7, v5, s[4:7], s30 offen offset:0 sc1
	v_cmp_gt_i32 vcc, s16, v7
	s_cbranch_vccz Lfo_111
	buffer_load_dword v7, v5, s[4:7], s30 offen offset:0 sc1
	v_cmp_gt_i32 vcc, s16, v7
	s_cbranch_vccz Lfo_111
	buffer_load_dword v7, v5, s[4:7], s30 offen offset:0 sc1
	v_cmp_gt_i32 vcc, s16, v7
	s_cbranch_vccz Lfo_111
	s_waitcnt vmcnt(40)
	buffer_load_dword v7, v5, s[4:7], s30 offen offset:0 sc1
	v_cmp_gt_i32 vcc, s16, v7
	s_cbranch_vccz Lfo_111
	buffer_load_dword v7, v5, s[4:7], s30 offen offset:0 sc1
	v_cmp_gt_i32 vcc, s16, v7
	s_cbranch_vccz Lfo_111
	buffer_load_dword v7, v5, s[4:7], s30 offen offset:0 sc1
	v_cmp_gt_i32 vcc, s16, v7
	s_cbranch_vccz Lfo_111
	buffer_load_dword v7, v5, s[4:7], s30 offen offset:0 sc1
	v_cmp_gt_i32 vcc, s16, v7
	s_cbranch_vccz Lfo_111
	buffer_load_dword v7, v5, s[4:7], s30 offen offset:0 sc1
	v_cmp_gt_i32 vcc, s16, v7
	s_cbranch_vccz Lfo_111
	buffer_load_dword v7, v5, s[4:7], s30 offen offset:0 sc1
	v_cmp_gt_i32 vcc, s16, v7
	s_cbranch_vccz Lfo_111
	buffer_load_dword v7, v5, s[4:7], s30 offen offset:0 sc1
	v_cmp_gt_i32 vcc, s16, v7
	s_cbranch_vccz Lfo_111
	buffer_load_dword v7, v5, s[4:7], s30 offen offset:0 sc1
	v_cmp_gt_i32 vcc, s16, v7
	s_cbranch_vccz Lfo_111
	s_waitcnt vmcnt(40)
	buffer_load_dword v7, v5, s[4:7], s30 offen offset:0 sc1
	v_cmp_gt_i32 vcc, s16, v7
	s_cbranch_vccz Lfo_111
	buffer_load_dword v7, v5, s[4:7], s30 offen offset:0 sc1
	v_cmp_gt_i32 vcc, s16, v7
	s_cbranch_vccz Lfo_111
	buffer_load_dword v7, v5, s[4:7], s30 offen offset:0 sc1
	v_cmp_gt_i32 vcc, s16, v7
	s_cbranch_vccz Lfo_111
	buffer_load_dword v7, v5, s[4:7], s30 offen offset:0 sc1
	v_cmp_gt_i32 vcc, s16, v7
	s_cbranch_vccz Lfo_111
	buffer_load_dword v7, v5, s[4:7], s30 offen offset:0 sc1
	v_cmp_gt_i32 vcc, s16, v7
	s_cbranch_vccz Lfo_111
	buffer_load_dword v7, v5, s[4:7], s30 offen offset:0 sc1
	v_cmp_gt_i32 vcc, s16, v7
	s_cbranch_vccz Lfo_111
	buffer_load_dword v7, v5, s[4:7], s30 offen offset:0 sc1
	v_cmp_gt_i32 vcc, s16, v7
	s_cbranch_vccz Lfo_111
	buffer_load_dword v7, v5, s[4:7], s30 offen offset:0 sc1
	v_cmp_gt_i32 vcc, s16, v7
	s_cbranch_vccz Lfo_111
	s_waitcnt vmcnt(40)
	s_waitcnt vmcnt(24)
	s_sub_u32 s17, s17, 1
	s_cbranch_scc0 Lfl_110
	s_mov_b32 s17, 0
Lfo_111:
	s_mov_b64 exec, -1
	s_nop 10
	buffer_load_dwordx4 v[20:23], v4, s[4:7], s20 offen offset:0 sc1
	buffer_load_dwordx4 v[24:27], v4, s[4:7], s20 offen offset:1024 sc1
	buffer_load_dwordx4 v[28:31], v4, s[4:7], s20 offen offset:2048 sc1
	buffer_load_dwordx4 v[32:35], v4, s[4:7], s20 offen offset:3072 sc1
	buffer_load_dwordx4 v[36:39], v4, s[4:7], s21 offen offset:0 sc1
	buffer_load_dwordx4 v[40:43], v4, s[4:7], s21 offen offset:1024 sc1
	buffer_load_dwordx4 v[44:47], v4, s[4:7], s21 offen offset:2048 sc1
	buffer_load_dwordx4 v[48:51], v4, s[4:7], s21 offen offset:3072 sc1
	buffer_load_dwordx4 v[52:55], v4, s[4:7], s22 offen offset:0 sc1
	buffer_load_dwordx4 v[56:59], v4, s[4:7], s22 offen offset:1024 sc1
	s_barrier
	ds_read_b128 v[68:71], v18 offset:0
	ds_read_b128 v[72:75], v18 offset:1024
	ds_read_b128 v[84:87], v18 offset:2048
	ds_read_b128 v[88:91], v18 offset:3072
	ds_read_b128 v[76:79], v18 offset:4096
	ds_read_b128 v[80:83], v18 offset:5120
	ds_read_b128 v[92:95], v18 offset:6144
	ds_read_b128 v[96:99], v18 offset:7168
	s_waitcnt vmcnt(9)
	v_smfmac_f32_16x16x64_bf16 v[60:63], v[20:23], v[104:111], v1
	v_smfmac_f32_16x16x64_bf16 v[64:67], v[20:23], v[112:119], v1
	s_waitcnt vmcnt(8)
	v_smfmac_f32_16x16x64_bf16 v[60:63], v[24:27], v[120:127], v1
	s_waitcnt vmcnt(7)
	v_smfmac_f32_16x16x64_bf16 v[60:63], v[28:31], v[136:143], v1
	buffer_store_dword v8, v9, s[4:7], s31 offen offset:256
	s_waitcnt vmcnt(7)
	v_smfmac_f32_16x16x64_bf16 v[60:63], v[32:35], v[152:159], v1
	buffer_store_dword v8, v9, s[4:7], s31 offen offset:512
	s_waitcnt vmcnt(7)
	v_smfmac_f32_16x16x64_bf16 v[60:63], v[36:39], v[168:175], v1
	s_waitcnt vmcnt(6)
	v_smfmac_f32_16x16x64_bf16 v[60:63], v[40:43], v[184:191], v1
	s_waitcnt vmcnt(5)
	v_smfmac_f32_16x16x64_bf16 v[60:63], v[44:47], v[200:207], v1
	s_waitcnt vmcnt(4)
	v_smfmac_f32_16x16x64_bf16 v[60:63], v[48:51], v[216:223], v1
	s_waitcnt vmcnt(3) lgkmcnt(0)
	v_smfmac_f32_16x16x64_bf16 v[60:63], v[52:55], v[68:75], v1
	s_waitcnt vmcnt(2)
	v_smfmac_f32_16x16x64_bf16 v[60:63], v[56:59], v[84:91], v1
	v_smfmac_f32_16x16x64_bf16 v[64:67], v[24:27], v[128:135], v1
	v_smfmac_f32_16x16x64_bf16 v[64:67], v[28:31], v[144:151], v1
	s_nop 0
	v_pk_add_f32 v[60:61], v[60:61], v[62:63]
	v_cvt_pk_bf16_f32 v62, v60, v61
	buffer_store_short v62, v11, s[4:7], s18 offen offset:0
	buffer_store_short_d16_hi v62, v11, s[4:7], s18 offen offset:16
	v_smfmac_f32_16x16x64_bf16 v[64:67], v[32:35], v[160:167], v1
	v_smfmac_f32_16x16x64_bf16 v[64:67], v[36:39], v[176:183], v1
	v_smfmac_f32_16x16x64_bf16 v[64:67], v[40:43], v[192:199], v1
	v_smfmac_f32_16x16x64_bf16 v[64:67], v[44:47], v[208:215], v1
	v_smfmac_f32_16x16x64_bf16 v[64:67], v[48:51], v[224:231], v1
	s_waitcnt lgkmcnt(0)
	v_smfmac_f32_16x16x64_bf16 v[64:67], v[52:55], v[76:83], v1
	v_smfmac_f32_16x16x64_bf16 v[64:67], v[56:59], v[92:99], v1
	s_nop 7
	v_pk_add_f32 v[64:65], v[64:65], v[66:67]
	v_cvt_pk_bf16_f32 v66, v64, v65
	buffer_store_short v66, v11, s[4:7], s18 offen offset:3584
	buffer_store_short_d16_hi v66, v11, s[4:7], s18 offen offset:3600
	v_cmp_u_f32 vcc, v64, v65
	s_cbranch_vccnz Lpr_108
Lpo_109:
	v_add_u32 v18, 8192, v18
	v_and_b32 v18, 0x7fff, v18
	s_barrier
	s_cmp_lg_u32 s16, 63
	s_cbranch_scc1 Lcb_loop3
	s_nop 9
	s_add_u32 s16, s16, 1
	ds_read_b128 v[80:83], v4 offset:32768
	ds_read_b128 v[84:87], v4 offset:33792
	ds_read_b128 v[88:91], v4 offset:34816
	ds_read_b128 v[92:95], v4 offset:35840
	ds_read_b128 v[96:99], v4 offset:36864
	ds_read_b128 v[100:103], v4 offset:37888
	s_nop 1
	v_mov_b32 v8, s16
	v_mov_b64 v[48:49], 0
	v_mov_b64 v[50:51], 0
	v_mov_b64 v[52:53], 0
	v_mov_b64 v[54:55], 0
	v_mov_b64 v[56:57], 0
	v_mov_b64 v[58:59], 0
	v_mov_b64 v[60:61], 0
	v_mov_b64 v[62:63], 0
	v_mov_b64 v[64:65], 0
	v_mov_b64 v[66:67], 0
	v_mov_b64 v[68:69], 0
	v_mov_b64 v[70:71], 0
	v_mov_b64 v[72:73], 0
	v_mov_b64 v[74:75], 0
	v_mov_b64 v[76:77], 0
	v_mov_b64 v[78:79], 0
	s_add_u32 s18, s18, 8192
	s_add_u32 s20, s20, s23
	s_add_u32 s21, s21, s23
	s_add_u32 s22, s22, s23
	s_barrier
	s_lshl_b32 s41, s32, 12
	ds_read_b128 v[104:107], v4 offset:0
	ds_read_b128 v[108:111], v4 offset:1024
	ds_read_b128 v[112:115], v4 offset:8192
	ds_read_b128 v[116:119], v4 offset:9216
	ds_read_b128 v[120:123], v4 offset:16384
	ds_read_b128 v[124:127], v4 offset:17408
	s_waitcnt lgkmcnt(0)
	s_add_u32 s40, s41, 49086464
	buffer_store_dwordx4 v[104:107], v4, s[4:7], s40 offen offset:0 sc1
	buffer_store_dwordx4 v[108:111], v4, s[4:7], s40 offen offset:1024 sc1
	s_add_u32 s40, s41, 49201152
	buffer_store_dwordx4 v[112:115], v4, s[4:7], s40 offen offset:0 sc1
	buffer_store_dwordx4 v[116:119], v4, s[4:7], s40 offen offset:1024 sc1
	s_add_u32 s40, s41, 49315840
	buffer_store_dwordx4 v[120:123], v4, s[4:7], s40 offen offset:0 sc1
	buffer_store_dwordx4 v[124:127], v4, s[4:7], s40 offen offset:1024 sc1
	s_lshl_b32 s41, s32, 12
	ds_read_b128 v[128:131], v4 offset:2048
	ds_read_b128 v[132:135], v4 offset:3072
	ds_read_b128 v[136:139], v4 offset:10240
	ds_read_b128 v[140:143], v4 offset:11264
	ds_read_b128 v[144:147], v4 offset:18432
	ds_read_b128 v[148:151], v4 offset:19456
	s_waitcnt lgkmcnt(0)
	s_add_u32 s40, s41, 49088512
	buffer_store_dwordx4 v[128:131], v4, s[4:7], s40 offen offset:0 sc1
	buffer_store_dwordx4 v[132:135], v4, s[4:7], s40 offen offset:1024 sc1
	s_add_u32 s40, s41, 49203200
	buffer_store_dwordx4 v[136:139], v4, s[4:7], s40 offen offset:0 sc1
	buffer_store_dwordx4 v[140:143], v4, s[4:7], s40 offen offset:1024 sc1
	s_add_u32 s40, s41, 49317888
	buffer_store_dwordx4 v[144:147], v4, s[4:7], s40 offen offset:0 sc1
	buffer_store_dwordx4 v[148:151], v4, s[4:7], s40 offen offset:1024 sc1
	s_lshl_b32 s41, s32, 12
	ds_read_b128 v[152:155], v4 offset:4096
	ds_read_b128 v[156:159], v4 offset:5120
	ds_read_b128 v[160:163], v4 offset:12288
	ds_read_b128 v[164:167], v4 offset:13312
	ds_read_b128 v[168:171], v4 offset:20480
	ds_read_b128 v[172:175], v4 offset:21504
	s_waitcnt lgkmcnt(0)
	s_add_u32 s40, s41, 49143808
	buffer_store_dwordx4 v[152:155], v4, s[4:7], s40 offen offset:0 sc1
	buffer_store_dwordx4 v[156:159], v4, s[4:7], s40 offen offset:1024 sc1
	s_add_u32 s40, s41, 49258496
	buffer_store_dwordx4 v[160:163], v4, s[4:7], s40 offen offset:0 sc1
	buffer_store_dwordx4 v[164:167], v4, s[4:7], s40 offen offset:1024 sc1
	s_add_u32 s40, s41, 49373184
	buffer_store_dwordx4 v[168:171], v4, s[4:7], s40 offen offset:0 sc1
	buffer_store_dwordx4 v[172:175], v4, s[4:7], s40 offen offset:1024 sc1
	s_lshl_b32 s41, s32, 12
	ds_read_b128 v[176:179], v4 offset:6144
	ds_read_b128 v[180:183], v4 offset:7168
	ds_read_b128 v[184:187], v4 offset:14336
	ds_read_b128 v[188:191], v4 offset:15360
	ds_read_b128 v[192:195], v4 offset:22528
	ds_read_b128 v[196:199], v4 offset:23552
	s_waitcnt lgkmcnt(0)
	s_add_u32 s40, s41, 49145856
	buffer_store_dwordx4 v[176:179], v4, s[4:7], s40 offen offset:0 sc1
	buffer_store_dwordx4 v[180:183], v4, s[4:7], s40 offen offset:1024 sc1
	s_add_u32 s40, s41, 49260544
	buffer_store_dwordx4 v[184:187], v4, s[4:7], s40 offen offset:0 sc1
	buffer_store_dwordx4 v[188:191], v4, s[4:7], s40 offen offset:1024 sc1
	s_add_u32 s40, s41, 49375232
	buffer_store_dwordx4 v[192:195], v4, s[4:7], s40 offen offset:0 sc1
	buffer_store_dwordx4 v[196:199], v4, s[4:7], s40 offen offset:1024 sc1
	ds_read_b128 v[20:23], v16 offset:57344
	ds_read_b128 v[24:27], v16 offset:58368
	ds_read_b128 v[28:31], v16 offset:59392
	ds_read_b128 v[32:35], v16 offset:60416
	ds_read_b128 v[36:39], v16 offset:61440
	ds_read_b128 v[40:43], v16 offset:62464
	ds_read_b128 v[44:47], v16 offset:63488
	s_waitcnt lgkmcnt(6)
	v_smfmac_f32_16x16x64_bf16 v[48:51], v[20:23], a[0:7], v1
	v_smfmac_f32_16x16x64_bf16 v[52:55], v[20:23], a[56:63], v1
	s_waitcnt lgkmcnt(5)
	v_smfmac_f32_16x16x64_bf16 v[48:51], v[24:27], a[8:15], v1
	v_smfmac_f32_16x16x64_bf16 v[52:55], v[24:27], a[64:71], v1
	s_waitcnt lgkmcnt(4)
	v_smfmac_f32_16x16x64_bf16 v[48:51], v[28:31], a[16:23], v1
	v_smfmac_f32_16x16x64_bf16 v[52:55], v[28:31], a[72:79], v1
	s_waitcnt lgkmcnt(3)
	v_smfmac_f32_16x16x64_bf16 v[48:51], v[32:35], a[24:31], v1
	v_smfmac_f32_16x16x64_bf16 v[52:55], v[32:35], a[80:87], v1
	s_waitcnt lgkmcnt(2)
	v_smfmac_f32_16x16x64_bf16 v[48:51], v[36:39], a[32:39], v1
	v_smfmac_f32_16x16x64_bf16 v[52:55], v[36:39], a[88:95], v1
	s_waitcnt lgkmcnt(1)
	v_smfmac_f32_16x16x64_bf16 v[48:51], v[40:43], a[40:47], v1
	v_smfmac_f32_16x16x64_bf16 v[52:55], v[40:43], a[96:103], v1
	s_waitcnt lgkmcnt(0)
	v_smfmac_f32_16x16x64_bf16 v[48:51], v[44:47], a[48:55], v1
	v_smfmac_f32_16x16x64_bf16 v[52:55], v[44:47], a[104:111], v1
	v_smfmac_f32_16x16x64_bf16 v[56:59], v[20:23], a[112:119], v1
	v_smfmac_f32_16x16x64_bf16 v[56:59], v[24:27], a[120:127], v1
	v_add_f32 v48, v48, v50
	v_smfmac_f32_16x16x64_bf16 v[56:59], v[28:31], a[128:135], v1
	v_add_f32 v49, v49, v51
	s_waitcnt lgkmcnt(4)
	v_smfmac_f32_16x16x64_bf16 v[68:71], v[20:23], v[80:87], v1
	ds_read_b128 v[80:83], v4 offset:38912
	ds_read_b128 v[84:87], v4 offset:39936
	v_cvt_pk_bf16_f32 v48, v48, v49
	v_smfmac_f32_16x16x64_bf16 v[56:59], v[32:35], a[136:143], v1
	v_add_f32 v52, v52, v54
	v_smfmac_f32_16x16x64_bf16 v[56:59], v[36:39], a[144:151], v1
	v_add_f32 v53, v53, v55
	v_smfmac_f32_16x16x64_bf16 v[56:59], v[40:43], a[152:159], v1
	v_cvt_pk_bf16_f32 v52, v52, v53
	s_waitcnt lgkmcnt(4)
	v_smfmac_f32_16x16x64_bf16 v[68:71], v[24:27], v[88:95], v1
	ds_read_b128 v[88:91], v4 offset:40960
	ds_read_b128 v[92:95], v4 offset:41984
	v_smfmac_f32_16x16x64_bf16 v[56:59], v[44:47], a[160:167], v1
	ds_write_b32 v10, v48 offset:5376
	v_smfmac_f32_16x16x64_bf16 v[60:63], v[20:23], a[168:175], v1
	ds_write_b32 v10, v52 offset:5632
	v_smfmac_f32_16x16x64_bf16 v[60:63], v[24:27], a[176:183], v1
	s_waitcnt lgkmcnt(4)
	v_smfmac_f32_16x16x64_bf16 v[68:71], v[28:31], v[96:103], v1
	ds_read_b128 v[96:99], v4 offset:43008
	ds_read_b128 v[100:103], v4 offset:44032
	v_add_f32 v56, v56, v58
	v_smfmac_f32_16x16x64_bf16 v[60:63], v[28:31], a[184:191], v1
	v_add_f32 v57, v57, v59
	v_smfmac_f32_16x16x64_bf16 v[60:63], v[32:35], a[192:199], v1
	v_cvt_pk_bf16_f32 v56, v56, v57
	v_smfmac_f32_16x16x64_bf16 v[60:63], v[36:39], a[200:207], v1
	ds_write_b32 v10, v56 offset:5888
	s_waitcnt lgkmcnt(4)
	v_smfmac_f32_16x16x64_bf16 v[68:71], v[32:35], v[80:87], v1
	ds_read_b128 v[80:83], v4 offset:45056
	ds_read_b128 v[84:87], v4 offset:46080
	v_smfmac_f32_16x16x64_bf16 v[60:63], v[40:43], a[208:215], v1
	v_smfmac_f32_16x16x64_bf16 v[60:63], v[44:47], a[216:223], v1
	v_smfmac_f32_16x16x64_bf16 v[64:67], v[20:23], a[224:231], v1
	s_waitcnt lgkmcnt(4)
	v_smfmac_f32_16x16x64_bf16 v[68:71], v[36:39], v[88:95], v1
	v_smfmac_f32_16x16x64_bf16 v[64:67], v[24:27], a[232:239], v1
	v_add_f32 v60, v60, v62
	v_smfmac_f32_16x16x64_bf16 v[64:67], v[28:31], a[240:247], v1
	v_add_f32 v61, v61, v63
	v_smfmac_f32_16x16x64_bf16 v[64:67], v[32:35], a[248:255], v1
	v_cvt_pk_bf16_f32 v60, v60, v61
	s_waitcnt lgkmcnt(2)
	v_smfmac_f32_16x16x64_bf16 v[68:71], v[40:43], v[96:103], v1
	v_smfmac_f32_16x16x64_bf16 v[64:67], v[36:39], v[232:239], v1
	ds_write_b32 v10, v60 offset:6144
	v_smfmac_f32_16x16x64_bf16 v[64:67], v[40:43], v[240:247], v1
	v_smfmac_f32_16x16x64_bf16 v[64:67], v[44:47], v[248:255], v1
	s_waitcnt lgkmcnt(0)
	v_smfmac_f32_16x16x64_bf16 v[68:71], v[44:47], v[80:87], v1
	s_nop 4
	v_add_f32 v64, v64, v66
	v_add_f32 v65, v65, v67
	v_cvt_pk_bf16_f32 v64, v64, v65
	ds_write_b32 v10, v64 offset:6400
	v_add_f32 v68, v68, v70
	v_add_f32 v69, v69, v71
	v_cvt_pk_bf16_f32 v68, v68, v69
	ds_write_b32 v10, v68 offset:6656
	s_waitcnt lgkmcnt(0)
	s_barrier
	s_lshl_b32 s41, s32, 12
	ds_read_b128 v[20:23], v4 offset:30720
	ds_read_b128 v[24:27], v4 offset:31744
	s_waitcnt lgkmcnt(0)
	s_add_u32 s40, s41, 49489920
	buffer_store_dwordx4 v[20:23], v4, s[4:7], s40 offen offset:0 sc1
	buffer_store_dwordx4 v[24:27], v4, s[4:7], s40 offen offset:1024 sc1
	s_waitcnt vmcnt(0)
	s_endpgm
Lpr_108:
	s_cmp_eq_u32 s13, 0
	s_cbranch_scc1 Lpo_109
	s_sub_u32 s13, s13, 1
	buffer_load_dwordx4 v[20:23], v4, s[4:7], s20 offen offset:0 sc1
	buffer_load_dwordx4 v[24:27], v4, s[4:7], s20 offen offset:1024 sc1
	buffer_load_dwordx4 v[28:31], v4, s[4:7], s20 offen offset:2048 sc1
	buffer_load_dwordx4 v[32:35], v4, s[4:7], s20 offen offset:3072 sc1
	buffer_load_dwordx4 v[36:39], v4, s[4:7], s21 offen offset:0 sc1
	buffer_load_dwordx4 v[40:43], v4, s[4:7], s21 offen offset:1024 sc1
	buffer_load_dwordx4 v[44:47], v4, s[4:7], s21 offen offset:2048 sc1
	buffer_load_dwordx4 v[48:51], v4, s[4:7], s21 offen offset:3072 sc1
	buffer_load_dwordx4 v[52:55], v4, s[4:7], s22 offen offset:0 sc1
	buffer_load_dwordx4 v[56:59], v4, s[4:7], s22 offen offset:1024 sc1
	v_mov_b64 v[60:61], 0
	v_mov_b64 v[62:63], 0
	v_mov_b64 v[64:65], 0
	v_mov_b64 v[66:67], 0
	s_waitcnt vmcnt(9)
	v_smfmac_f32_16x16x64_bf16 v[60:63], v[20:23], v[104:111], v1
	v_smfmac_f32_16x16x64_bf16 v[64:67], v[20:23], v[112:119], v1
	s_waitcnt vmcnt(8)
	v_smfmac_f32_16x16x64_bf16 v[60:63], v[24:27], v[120:127], v1
	s_waitcnt vmcnt(7)
	v_smfmac_f32_16x16x64_bf16 v[60:63], v[28:31], v[136:143], v1
	s_waitcnt vmcnt(6)
	v_smfmac_f32_16x16x64_bf16 v[60:63], v[32:35], v[152:159], v1
	s_waitcnt vmcnt(5)
	v_smfmac_f32_16x16x64_bf16 v[60:63], v[36:39], v[168:175], v1
	s_waitcnt vmcnt(4)
	v_smfmac_f32_16x16x64_bf16 v[60:63], v[40:43], v[184:191], v1
	s_waitcnt vmcnt(3)
	v_smfmac_f32_16x16x64_bf16 v[60:63], v[44:47], v[200:207], v1
	s_waitcnt vmcnt(2)
	v_smfmac_f32_16x16x64_bf16 v[60:63], v[48:51], v[216:223], v1
	s_waitcnt vmcnt(1) lgkmcnt(0)
	v_smfmac_f32_16x16x64_bf16 v[60:63], v[52:55], v[68:75], v1
	s_waitcnt vmcnt(0)
	v_smfmac_f32_16x16x64_bf16 v[60:63], v[56:59], v[84:91], v1
	v_smfmac_f32_16x16x64_bf16 v[64:67], v[24:27], v[128:135], v1
	v_smfmac_f32_16x16x64_bf16 v[64:67], v[28:31], v[144:151], v1
	s_nop 0
	v_pk_add_f32 v[60:61], v[60:61], v[62:63]
	v_cvt_pk_bf16_f32 v62, v60, v61
	buffer_store_short v62, v11, s[4:7], s18 offen offset:0
	buffer_store_short_d16_hi v62, v11, s[4:7], s18 offen offset:16
	v_smfmac_f32_16x16x64_bf16 v[64:67], v[32:35], v[160:167], v1
	v_smfmac_f32_16x16x64_bf16 v[64:67], v[36:39], v[176:183], v1
	v_smfmac_f32_16x16x64_bf16 v[64:67], v[40:43], v[192:199], v1
	v_smfmac_f32_16x16x64_bf16 v[64:67], v[44:47], v[208:215], v1
	v_smfmac_f32_16x16x64_bf16 v[64:67], v[48:51], v[224:231], v1
	s_waitcnt lgkmcnt(0)
	v_smfmac_f32_16x16x64_bf16 v[64:67], v[52:55], v[76:83], v1
	v_smfmac_f32_16x16x64_bf16 v[64:67], v[56:59], v[92:99], v1
	s_nop 7
	v_pk_add_f32 v[64:65], v[64:65], v[66:67]
	v_cvt_pk_bf16_f32 v66, v64, v65
	buffer_store_short v66, v11, s[4:7], s18 offen offset:3584
	buffer_store_short_d16_hi v66, v11, s[4:7], s18 offen offset:3600
	v_cmp_u_f32 vcc, v64, v65
	s_cbranch_vccnz Lpr_108
	s_branch Lpo_109
Lcode_end:
	s_endpgm
.section .rodata,"a"
.p2align 6
.amdhsa_kernel gated_mix__memory_aug_recurrent_mem_tr__mixer_channel_mlp__prompt_kernel
  .amdhsa_next_free_vgpr 512
  .amdhsa_next_free_sgpr 102
  .amdhsa_accum_offset 256
  .amdhsa_group_segment_fixed_size 0
  .amdhsa_kernarg_size 128
  .amdhsa_user_sgpr_count 2
  .amdhsa_user_sgpr_kernarg_segment_ptr 1
  .amdhsa_system_sgpr_workgroup_id_x 1
  .amdhsa_float_denorm_mode_32 3
  .amdhsa_float_denorm_mode_16_64 3
.end_amdhsa_kernel
```
